```python
import torch

def _softmax(x, axis=-1):
    return torch.softmax(x, dim=axis)

def _gelu(x):
    return torch.nn.functional.gelu(x, approximate='tanh')

def _silu(x):
    return torch.nn.functional.silu(x)

def _sigmoid(x):
    return torch.sigmoid(x)

def _layernorm(x, axis=-1, eps=1e-05):
    m = x.mean(dim=axis, keepdim=True)
    v = x.var(dim=axis, keepdim=True, unbiased=False)
    return (x - m) / torch.sqrt(v + eps)

def _scatter_add(tgt, idx, src, axis=0):
    return tgt.clone().index_add_(axis, idx, src)

def _segment_sum(src, seg, n):
    out = torch.zeros((n,) + src.shape[1:], dtype=src.dtype)
    return out.index_add_(0, seg, src)

def _pad(x, pw):
    flat = tuple((v for pair in reversed(pw) for v in pair))
    return torch.nn.functional.pad(x, flat)
kernel_name = 'gated_mix__memory_aug_recurrent_mem_tr__swiglu_ffn__prompt'

def setup_inputs():

    _w = lambda a: (lambda t: t.to(torch.bfloat16) if t.is_floating_point() else t)(torch.as_tensor(a))

    def _A_setup():
        B, S, Dm = (1, 2048, 1024)
        H, Dh = (32, 128)
        M, seg = (8, 32)
        seg = min(seg, S)
        S = S // seg * seg
        return {'x': _w((lambda *s: torch.randn(*s, dtype=torch.bfloat16) * 0.05)(B, S, Dm)), 'mem0': _w((lambda *s: torch.randn(*s, dtype=torch.bfloat16) * 0.4)(B, M, Dm)), 'Wq': _w((lambda *s: torch.randn(*s, dtype=torch.bfloat16) * 6.4)(Dm, H, Dh) * Dm ** (-0.5)), 'Wk': _w((lambda *s: torch.randn(*s, dtype=torch.bfloat16) * 6.4)(Dm, H, Dh) * Dm ** (-0.5)), 'Wv': _w((lambda *s: torch.randn(*s, dtype=torch.bfloat16) * 0.4)(Dm, H, Dh) * Dm ** (-0.5)), 'Wo': _w((lambda *s: torch.randn(*s, dtype=torch.bfloat16) * 0.4)(H, Dh, Dm) * (H * Dh) ** (-0.5)), 'seg_len': seg}
    _A_in = _A_setup()

    def _B_setup():
        B, S, D, F = (1, 2048, 1024, 3584)
        return {'x': _w((lambda *s: torch.randn(*s, dtype=torch.bfloat16) * 0.05)(B, S, D)), 'w_gate': _w((lambda *s: torch.randn(*s, dtype=torch.bfloat16) * 0.05)(D, F)), 'w_up': _w((lambda *s: torch.randn(*s, dtype=torch.bfloat16) * 0.05)(D, F)), 'w_down': _w((lambda *s: torch.randn(*s, dtype=torch.bfloat16) * 0.05)(F, D))}
    _B_in = _B_setup()
    return {'A_x': _A_in['x'], 'A_mem0': _A_in['mem0'], 'A_Wq': _A_in['Wq'], 'A_Wk': _A_in['Wk'], 'A_Wv': _A_in['Wv'], 'A_Wo': _A_in['Wo'], 'A_seg_len': _A_in['seg_len'], 'B_x': _B_in['x'], 'B_w_gate': _B_in['w_gate'], 'B_w_up': _B_in['w_up'], 'B_w_down': _B_in['w_down'], 'gate_w': _w((lambda *s: torch.randn(*s, dtype=torch.bfloat16) * 0.05)(1024) * 16.0)}

def reference(A_x, A_mem0, A_Wq, A_Wk, A_Wv, A_Wo, A_seg_len, B_x, B_w_gate, B_w_up, B_w_down, gate_w):

    def _A_ref(x, mem0, Wq, Wk, Wv, Wo, seg_len):
        B, S, Dm = x.shape
        H, Dh = (Wq.shape[1], Wq.shape[2])
        M = mem0.shape[1]
        scale = Dh ** (-0.5)
        n_seg = S // seg_len
        L = M + seg_len
        idx = torch.arange(L)
        mask = (idx[:, None] < M) | (idx[:, None] >= idx[None, :])
        mem = mem0
        outs = []
        for s in range(n_seg):
            xs = x[:, s * seg_len:(s + 1) * seg_len, :].clone()
            h = torch.concatenate([mem, xs], axis=1)
            q = torch.einsum('btd,dhe->bhte', h, Wq)
            k = torch.einsum('btd,dhe->bhte', h, Wk)
            v = torch.einsum('btd,dhe->bhte', h, Wv)
            scores = torch.einsum('bhqe,bhke->bhqk', q, k) * scale
            scores = torch.where(mask[None, None], scores, -1000000000.0)
            p = _softmax(scores, axis=-1)
            o = torch.einsum('bhqk,bhke->bhqe', p, v)
            o = torch.einsum('bhte,hed->btd', o, Wo)
            mem = o[:, :M, :].clone()
            outs.append(o[:, M:, :])
        return torch.concatenate(outs, axis=1)

    def _B_ref(x, w_gate, w_up, w_down):
        g = _silu(x @ w_gate)
        u = x @ w_up
        return g * u @ w_down
    x = A_x
    g = _sigmoid((x * gate_w).sum(-1, keepdims=True))
    a = _A_ref(x, A_mem0, A_Wq, A_Wk, A_Wv, A_Wo, A_seg_len)
    b = _B_ref(x, B_w_gate, B_w_up, B_w_down)
    return g * a + (1 - g) * b
```

```asm
; @launch grid=(256,1,1) block=(256,1,1) lds=147456
.amdgcn_target "amdgcn-amd-amdhsa--gfx950"
.text
.globl gated_mix__memory_aug_recurrent_mem_tr__swiglu_ffn__prompt_kernel
.p2align 8
.type gated_mix__memory_aug_recurrent_mem_tr__swiglu_ffn__prompt_kernel,@function
gated_mix__memory_aug_recurrent_mem_tr__swiglu_ffn__prompt_kernel:
    s_cmp_ge_u32 s2, 256
    s_cbranch_scc1 L_end
    s_load_dwordx2 s[4:5], s[0:1], 104
    s_load_dwordx2 s[6:7], s[0:1], 112
    s_load_dwordx2 s[8:9], s[0:1], 0
    s_getreg_b32 s20, hwreg(HW_REG_XCC_ID, 0, 4)
    s_waitcnt lgkmcnt(0)
    s_mov_b32 s8, s6
    s_mov_b32 s9, s7
    s_mov_b32 s10, 0x10000000
    s_mov_b32 s11, 0x20000
    s_mov_b32 s16, s4
    s_mov_b32 s17, s5
    s_mov_b32 s18, 0x100
    s_mov_b32 s19, 0x20000
    s_cmp_ge_u32 s20, 8
    s_cbranch_scc1 L_exit
    s_lshr_b32 s21, s2, 3
    s_cmp_lt_u32 s20, 4
    s_cselect_b32 s3, 3, 0
    s_mul_i32 s21, s21, 33
    s_lshr_b32 s21, s21, s3
    s_and_b32 s21, s21, 31
    s_lshl_b32 s3, 1, s21
    v_mov_b32 v1, s3
    s_lshl_b32 s3, s20, 2
    v_mov_b32 v2, s3
    v_cmp_eq_u32 vcc, 0, v0
    s_cbranch_vccz L_tk
    s_mov_b64 exec, 1
    buffer_atomic_add v1, v2, s[16:19], 0 offen sc1
    s_mov_b64 exec, -1
L_tk:
    s_cmp_ge_u32 s20, 4
    s_cbranch_scc1 L_other
    s_load_dwordx2 s[68:69], s[0:1], 0
    s_load_dwordx2 s[58:59], s[0:1], 88
    v_and_b32 v1, 63, v0
    v_lshrrev_b32 v32, 6, v0
    s_nop 0
    v_readfirstlane_b32 s24, v32
    s_lshr_b32 s22, s21, 2
    s_lshl_b32 s52, s20, 3
    s_add_u32 s22, s22, s52
    s_and_b32 s23, s21, 3
    v_lshrrev_b32 v32, 4, v1
    v_bfe_u32 v33, v1, 3, 1
    v_and_b32 v34, 7, v1
    v_and_b32 v35, 15, v1
    v_lshlrev_b32 v3, 4, v1
    v_lshlrev_b32 v25, 3, v1
    v_add_u32 v25, 0xec00, v25
    v_mov_b32 v19, 0xee00
    v_mov_b32 v27, 1
    v_lshlrev_b32 v36, 7, v32
    v_lshl_add_u32 v36, v34, 4, v36
    v_mov_b32 v14, v36
    v_lshl_add_u32 v2, v33, 9, v36
    s_lshl_b32 s52, s24, 12
    v_add_u32 v2, s52, v2
    s_lshl_b32 s52, s21, 9
    v_add_u32 v6, s52, v36
    v_lshl_add_u32 v7, v33, 3, v6
    s_add_u32 s52, s23, 0
    s_and_b32 s52, s52, 3
    s_lshl_b32 s52, s52, 10
    v_add_u32 v8, s52, v3
    s_add_u32 s52, s20, 0
    s_and_b32 s52, s52, 3
    s_lshl_b32 s52, s52, 10
    v_add_u32 v20, s52, v3
    s_add_u32 s52, s23, 1
    s_and_b32 s52, s52, 3
    s_lshl_b32 s52, s52, 10
    v_add_u32 v9, s52, v3
    s_add_u32 s52, s20, 1
    s_and_b32 s52, s52, 3
    s_lshl_b32 s52, s52, 10
    v_add_u32 v21, s52, v3
    s_add_u32 s52, s23, 2
    s_and_b32 s52, s52, 3
    s_lshl_b32 s52, s52, 10
    v_add_u32 v10, s52, v3
    s_add_u32 s52, s20, 2
    s_and_b32 s52, s52, 3
    s_lshl_b32 s52, s52, 10
    v_add_u32 v22, s52, v3
    s_add_u32 s52, s23, 3
    s_and_b32 s52, s52, 3
    s_lshl_b32 s52, s52, 10
    v_add_u32 v11, s52, v3
    s_add_u32 s52, s20, 3
    s_and_b32 s52, s52, 3
    s_lshl_b32 s52, s52, 10
    v_add_u32 v23, s52, v3
    v_and_b32 v37, 1, v32
    v_lshlrev_b32 v12, 9, v37
    v_lshl_add_u32 v12, v34, 4, v12
    s_lshl_b32 s52, s23, 2
    s_add_u32 s52, s52, 0x1000
    v_add_u32 v12, s52, v12
    v_add_u32 v13, 0x1000, v3
    s_lshl_b32 s52, s22, 2
    s_add_u32 s52, s52, s23
    s_lshl_b32 s52, s52, 9
    v_add_u32 v14, s52, v14
    v_lshlrev_b32 v15, 4, v35
    v_lshl_add_u32 v15, v32, 2, v15
    v_add_u32 v15, s52, v15
    s_lshl_b32 s52, s24, 14
    v_add_u32 v5, s52, v3
    v_add_u32 v0, 0x1000, v5
    v_lshlrev_b32 v24, 7, v35
    s_lshl_b32 s52, s21, 11
    v_add_u32 v24, s52, v24
    v_lshrrev_b32 v36, 1, v32
    v_lshl_add_u32 v36, v36, 4, v35
    v_lshlrev_b32 v36, 4, v36
    v_lshl_add_u32 v36, v37, 3, v36
    v_add_u32 v16, 0x3100, v36
    v_add_u32 v17, 2048, v16
    s_lshl_b32 s52, s24, 10
    v_add_u32 v4, s52, v3
    s_lshl_b32 s52, s24, 13
    s_add_u32 s52, s52, 0x5c00
    v_add_u32 v18, s52, v3
    s_lshl_b32 s52, s24, 12
    s_add_u32 s52, s52, 0x10000
    v_mov_b32 v26, s52
    s_lshl_b32 s52, s20, 16
    s_add_u32 s26, s52, 0x0
    s_add_u32 s27, s52, 0x40000
    s_lshl_b32 s52, s21, 14
    s_add_u32 s28, s52, 0x80000
    s_lshl_b32 s52, s22, 15
    s_add_u32 s29, s52, 0x100000
    s_mov_b32 s44, 0x00ff00ff
    s_mov_b32 s45, 0x00ff00ff
    s_mov_b32 s46, 0xff00ff00
    s_mov_b32 s47, 0xff00ff00
    s_mov_b32 s48, 0
    s_mov_b32 s49, 0x00ff00ff
    s_mov_b32 s50, 0x3e0293ee
    v_mov_b32 v28, -1
    s_mov_b32 s70, 0
    v_mov_b32 v29, -1
    s_mov_b32 s71, 0
    v_mov_b32 v30, -1
    s_mov_b32 s72, 0
    v_mov_b32 v31, -1
    s_mov_b32 s73, 0
    v_mov_b32 v149, 0
    v_mov_b32 v153, 0
    v_mov_b32 v153, 0
    v_mov_b32 v150, 0
    v_mov_b32 v154, 0
    v_mov_b32 v154, 0
    v_mov_b32 v151, 0
    v_mov_b32 v155, 0
    v_mov_b32 v155, 0
    s_lshl_b32 s52, s21, 15
    s_add_u32 s28, s52, 0x300000
    s_lshl_b32 s52, s24, 12
    v_add_u32 v2, s52, v3
    s_lshl_b32 s52, s21, 9
    v_lshlrev_b32 v36, 3, v1
    v_add_u32 v7, s52, v36
    v_mov_b32 v154, 0x44444444
    s_mov_b32 exec_lo, 0xcccccccc
    s_mov_b32 exec_hi, 0xcccccccc
    v_mov_b32 v154, 0xeeeeeeee
    s_mov_b64 exec, -1
    v_mul_u32_u24 v36, 192, v32
    v_lshl_add_u32 v37, v35, 2, v36
    s_mul_i32 s52, s24, 3136
    s_add_u32 s52, s52, 0
    v_add_u32 v155, s52, v37
    v_add_u32 v159, 1568, v155
    v_and_b32 v156, 9, v35
    v_bfe_u32 v37, v35, 1, 1
    v_lshl_add_u32 v156, v37, 2, v156
    v_bfe_u32 v37, v35, 2, 1
    v_lshl_add_u32 v156, v37, 1, v156
    v_lshl_add_u32 v156, v156, 2, v36
    s_mul_i32 s52, s24, 1600
    s_add_u32 s52, s52, 16640
    v_add_u32 v156, s52, v156
    v_lshrrev_b32 v36, 3, v35
    v_mul_u32_u24 v157, 1568, v36
    v_and_b32 v36, 1, v35
    v_mul_u32_u24 v36, 784, v36
    v_add_u32 v157, v157, v36
    v_bfe_u32 v36, v35, 1, 2
    v_mul_u32_u24 v36, 192, v36
    v_add_u32 v157, v157, v36
    v_lshl_add_u32 v157, v32, 4, v157
    v_add_u32 v157, 0, v157
    v_bfe_u32 v36, v1, 1, 1
    v_mul_u32_u24 v158, 896, v36
    v_bfe_u32 v36, v1, 3, 2
    v_mul_u32_u24 v36, 192, v36
    v_add_u32 v158, v158, v36
    v_lshrrev_b32 v37, 5, v1
    v_lshl_add_u32 v158, v37, 6, v158
    v_and_b32 v37, 1, v1
    v_lshl_add_u32 v158, v37, 5, v158
    v_bfe_u32 v37, v1, 2, 1
    v_lshl_add_u32 v158, v37, 4, v158
    v_add_u32 v158, 16640, v158
    v_lshrrev_b32 v36, 1, v32
    v_lshlrev_b32 v6, 8, v36
    v_and_b32 v36, 1, v32
    v_lshl_add_u32 v6, v36, 5, v6
    v_bfe_u32 v36, v35, 1, 2
    v_lshl_add_u32 v6, v36, 6, v6
    v_and_b32 v36, 1, v35
    v_lshl_add_u32 v6, v36, 4, v6
    s_lshl_b32 s52, s21, 9
    v_add_u32 v6, s52, v6
    v_add_u32 v15, 0x400000, v15
    v_mov_b32 v149, 0
    v_mov_b32 v151, 0
    v_mov_b32 v153, 0
    s_lshl_b32 s52, s20, 5
    s_add_u32 s52, s52, s21
    s_lshl_b32 s52, s52, 2
    s_add_u32 s52, s52, 0x200000
    v_mov_b32 v16, s52
    s_lshl_b32 s52, s21, 20
    s_add_u32 s98, s52, 0xc000000
    v_and_b32 v36, 7, v1
    v_lshlrev_b32 v14, 7, v32
    v_lshl_add_u32 v14, v36, 4, v14
    v_lshlrev_b32 v15, 4, v35
    v_lshl_add_u32 v15, v32, 2, v15
    v_add_u32 v15, 512, v15
    v_mov_b32 v24, 0xff
    v_lshlrev_b32 v5, 11, v35
    v_lshl_add_u32 v5, v32, 4, v5
    s_lshl_b32 s52, s24, 9
    v_add_u32 v5, s52, v5
    v_lshlrev_b32 v36, 3, v1
    s_add_u32 s52, s20, 0
    s_and_b32 s52, s52, 3
    s_lshl_b32 s52, s52, 11
    v_add_u32 v20, s52, v36
    v_add_u32 v17, s52, v3
    s_add_u32 s52, s20, 1
    s_and_b32 s52, s52, 3
    s_lshl_b32 s52, s52, 11
    v_add_u32 v21, s52, v36
    s_add_u32 s52, s20, 2
    s_and_b32 s52, s52, 3
    s_lshl_b32 s52, s52, 11
    v_add_u32 v22, s52, v36
    s_add_u32 s52, s20, 3
    s_and_b32 s52, s52, 3
    s_lshl_b32 s52, s52, 11
    v_add_u32 v23, s52, v36
    v_add_u32 v15, 512, v36
    s_waitcnt lgkmcnt(0)
    s_mov_b32 s76, s68
    s_mov_b32 s77, s69
    s_mov_b32 s78, 0x400000
    s_mov_b32 s79, 0x20000
    s_mov_b32 s80, s58
    s_mov_b32 s81, s59
    s_mov_b32 s82, 0x800
    s_mov_b32 s83, 0x20000
    s_lshl_b32 s40, s20, 5
    s_add_u32 s40, s40, s21
    s_lshr_b32 s54, s21, 1
    s_lshl_b32 s54, s54, 15
    s_and_b32 s53, s21, 1
    s_lshl_b32 s53, s53, 8
    s_add_u32 s54, s54, s53
    buffer_load_dwordx4 v[40:43], v5, s[76:79], s54 offen offset:0
    buffer_load_dwordx4 v[44:47], v5, s[76:79], s54 offen offset:64
    buffer_load_dwordx4 v[48:51], v5, s[76:79], s54 offen offset:128
    buffer_load_dwordx4 v[52:55], v5, s[76:79], s54 offen offset:192
    v_lshrrev_b32 v32, 2, v1
    v_and_b32 v33, 3, v1
    v_lshlrev_b32 v96, 13, v32
    v_lshl_add_u32 v96, v33, 4, v96
    s_lshl_b32 s52, s24, 21
    s_lshl_b32 s53, s22, 8
    s_add_u32 s52, s52, s53
    s_lshl_b32 s53, s23, 6
    s_add_u32 s52, s52, s53
    v_add_u32 v96, s52, v96
    v_lshlrev_b32 v97, 11, v32
    v_lshl_add_u32 v97, v33, 4, v97
    s_lshl_b32 s52, s20, 21
    s_lshl_b32 s53, s24, 19
    s_add_u32 s52, s52, s53
    s_lshl_b32 s53, s21, 6
    s_add_u32 s52, s52, s53
    v_add_u32 v97, s52, v97
    s_lshl_b32 s54, s24, 15
    s_add_u32 s54, s54, 0x4000
    v_lshrrev_b32 v32, 4, v1
    v_bfe_u32 v34, v1, 2, 2
    v_lshl_add_u32 v98, v32, 3, v34
    v_lshlrev_b32 v98, 6, v98
    v_lshl_add_u32 v98, v33, 3, v98
    v_add_u32 v98, s54, v98
    v_and_b32 v99, 1, v34
    v_lshrrev_b32 v35, 1, v34
    v_lshl_add_u32 v99, v35, 2, v99
    v_lshrrev_b32 v35, 1, v32
    v_lshl_add_u32 v99, v35, 3, v99
    v_and_b32 v35, 1, v32
    v_lshl_add_u32 v99, v35, 4, v99
    v_lshlrev_b32 v99, 6, v99
    v_lshl_add_u32 v99, v33, 3, v99
    v_add_u32 v99, s54, v99
    s_load_dwordx2 s[60:61], s[0:1], 24
    s_load_dwordx2 s[62:63], s[0:1], 32
    s_load_dwordx2 s[64:65], s[0:1], 16
    s_load_dwordx2 s[66:67], s[0:1], 40
    s_waitcnt lgkmcnt(0)
    s_lshl_b32 s70, s24, 14
    v_mov_b32 v144, v96
    v_mov_b32 v145, v97
    v_subrev_u32 v146, s70, v98
    v_subrev_u32 v147, s70, v99
    v_add_u32 v147, 0x10000, v147
    s_mov_b32 s12, s60
    s_mov_b32 s13, s61
    s_mov_b32 s14, 0x800000
    s_mov_b32 s15, 0x20000
    s_mov_b32 s12, s60
    s_mov_b32 s13, s61
    s_add_u32 m0, s70, 0x4000
    s_mov_b32 s71, 0x0
    buffer_load_dwordx4 v144, s[12:15], s71 offen lds
    s_add_u32 m0, s70, 0x4400
    s_mov_b32 s71, 0x20000
    buffer_load_dwordx4 v144, s[12:15], s71 offen lds
    s_add_u32 m0, s70, 0x4800
    s_mov_b32 s71, 0x40000
    buffer_load_dwordx4 v144, s[12:15], s71 offen lds
    s_add_u32 m0, s70, 0x4c00
    s_mov_b32 s71, 0x60000
    buffer_load_dwordx4 v144, s[12:15], s71 offen lds
    s_cmp_lg_u32 s20, 0
    s_cbranch_scc1 w0_3
    s_add_u32 s86, s98, 0xa1f00
    s_add_u32 s87, s98, 0xa3f00
    s_buffer_load_dword s92, s[8:11], s86
    s_buffer_load_dword s91, s[8:11], s87
w0_3:
    s_waitcnt vmcnt(4)
    s_lshr_b32 s56, s21, 1
    s_lshl_b32 s56, s56, 2
    s_add_u32 s56, s56, s24
    s_lshl_b32 s56, s56, 1
    s_and_b32 s57, s21, 1
    s_add_u32 s56, s56, s57
    s_lshl_b32 s56, s56, 12
    s_lshl_b32 s57, s20, 19
    s_add_u32 s56, s56, s57
    s_add_u32 s56, s56, 0x7400000
    buffer_store_dwordx4 v[40:43], v3, s[8:11], s56 offen offset:0
    buffer_store_dwordx4 v[44:47], v3, s[8:11], s56 offen offset:1024
    buffer_store_dwordx4 v[48:51], v3, s[8:11], s56 offen offset:2048
    buffer_store_dwordx4 v[52:55], v3, s[8:11], s56 offen offset:3072
    s_lshl_b32 s52, s40, 15
    buffer_load_dwordx4 v[192:195], v5, s[76:79], s52 offen offset:0
    buffer_load_dwordx4 v[196:199], v5, s[76:79], s52 offen offset:64
    buffer_load_dwordx4 v[200:203], v5, s[76:79], s52 offen offset:128
    buffer_load_dwordx4 v[204:207], v5, s[76:79], s52 offen offset:192
    buffer_load_dwordx4 v[208:211], v5, s[76:79], s52 offen offset:256
    buffer_load_dwordx4 v[212:215], v5, s[76:79], s52 offen offset:320
    buffer_load_dwordx4 v[216:219], v5, s[76:79], s52 offen offset:384
    buffer_load_dwordx4 v[220:223], v5, s[76:79], s52 offen offset:448
    v_and_b32 v38, 0x30, v1
    s_lshl_b32 s52, s24, 9
    buffer_load_dwordx4 v[224:227], v38, s[80:83], s52 offen offset:0
    buffer_load_dwordx4 v[228:231], v38, s[80:83], s52 offen offset:64
    buffer_load_dwordx4 v[232:235], v38, s[80:83], s52 offen offset:128
    buffer_load_dwordx4 v[236:239], v38, s[80:83], s52 offen offset:192
    buffer_load_dwordx4 v[240:243], v38, s[80:83], s52 offen offset:256
    buffer_load_dwordx4 v[244:247], v38, s[80:83], s52 offen offset:320
    buffer_load_dwordx4 v[248:251], v38, s[80:83], s52 offen offset:384
    buffer_load_dwordx4 v[252:255], v38, s[80:83], s52 offen offset:448
    s_mov_b32 s25, s24
    s_add_u32 s28, s98, 0xb0000
    s_and_b32 s54, s25, 3
    s_lshl_b32 s54, s54, 14
    s_add_u32 s35, s54, s26
    s_and_b32 s54, s25, 3
    s_lshl_b32 s54, s54, 14
    s_add_u32 s36, s54, s27
    s_and_b32 s54, s25, 3
    s_lshl_b32 s54, s54, 14
    s_add_u32 s37, s54, s28
    s_and_b32 s54, s25, 3
    s_lshl_b32 s54, s54, 13
    s_add_u32 s38, s54, s29
    buffer_store_dwordx4 v[28:31], v8, s[8:11], s38 offen
    s_mov_b64 exec, s[44:45]
    buffer_store_dwordx4 v[28:31], v6, s[8:11], s36 offen
    buffer_store_dwordx4 v[28:31], v6, s[8:11], s35 offen
    s_mov_b64 exec, s[48:49]
    buffer_store_dword v28, v12, s[8:11], s38 offen offset:0
    buffer_store_dword v28, v12, s[8:11], s38 offen offset:128
    buffer_store_dword v28, v12, s[8:11], s38 offen offset:256
    buffer_store_dword v28, v12, s[8:11], s38 offen offset:384
    s_mov_b64 exec, -1
    buffer_store_dwordx4 v[28:31], v17, s[8:11], s37 offen offset:0 sc1
    s_add_u32 s37, s37, 0x2000
    buffer_store_dwordx4 v[28:31], v17, s[8:11], s37 offen offset:0 sc1
    s_and_b32 s56, s24, 1
    s_lshl_b32 s56, s56, 13
    s_add_u32 s28, s98, s56
    s_lshl_b32 s52, s20, 17
    s_add_u32 s52, s52, s28
    s_add_u32 s99, s52, 0x10000
    s_lshl_b32 s52, s20, 2
    s_add_u32 s52, s52, s28
    s_add_u32 s52, s52, 0x8000
    v_mov_b32 v16, s52
    s_add_u32 s28, s28, 0xb0000
    v_mov_b32 v32, 0
    s_mov_b64 exec, 1
    buffer_store_dword v32, v16, s[8:11], 0 offen sc1
    s_mov_b64 exec, -1
    s_lshl_b32 s52, s21, 2
    s_add_u32 s52, s52, s20
    s_lshl_b32 s52, s52, 3
    s_add_u32 s52, s52, s24
    s_lshl_b32 s52, s52, 12
    s_add_u32 s52, s52, 0xb000000
    s_add_u32 s53, s52, 0x4000
    buffer_store_dwordx4 v[28:31], v3, s[8:11], s52 offen offset:1024 sc1
    buffer_store_dwordx4 v[28:31], v3, s[8:11], s52 offen offset:2048 sc1
    buffer_store_dwordx4 v[28:31], v3, s[8:11], s52 offen offset:3072 sc1
    buffer_store_dwordx4 v[28:31], v3, s[8:11], s53 offen offset:1024 sc1
    buffer_store_dwordx4 v[28:31], v3, s[8:11], s53 offen offset:2048 sc1
    buffer_store_dwordx4 v[28:31], v3, s[8:11], s53 offen offset:3072 sc1
    buffer_store_dword v32, v3, s[8:11], s52 offen sc1
    s_add_u32 m0, s70, 0x5000
    s_mov_b32 s71, 0x80000
    buffer_load_dwordx4 v144, s[12:15], s71 offen lds
    s_add_u32 m0, s70, 0x5400
    s_mov_b32 s71, 0xa0000
    buffer_load_dwordx4 v144, s[12:15], s71 offen lds
    s_add_u32 m0, s70, 0x5800
    s_mov_b32 s71, 0xc0000
    buffer_load_dwordx4 v144, s[12:15], s71 offen lds
    s_add_u32 m0, s70, 0x5c00
    s_mov_b32 s71, 0xe0000
    buffer_load_dwordx4 v144, s[12:15], s71 offen lds
    s_add_u32 m0, s70, 0x6000
    s_mov_b32 s71, 0x100000
    buffer_load_dwordx4 v144, s[12:15], s71 offen lds
    s_add_u32 m0, s70, 0x6400
    s_mov_b32 s71, 0x120000
    buffer_load_dwordx4 v144, s[12:15], s71 offen lds
    s_add_u32 m0, s70, 0x6800
    s_mov_b32 s71, 0x140000
    buffer_load_dwordx4 v144, s[12:15], s71 offen lds
    s_add_u32 m0, s70, 0x6c00
    s_mov_b32 s71, 0x160000
    buffer_load_dwordx4 v144, s[12:15], s71 offen lds
    s_add_u32 m0, s70, 0x7000
    s_mov_b32 s71, 0x180000
    buffer_load_dwordx4 v144, s[12:15], s71 offen lds
    s_add_u32 m0, s70, 0x7400
    s_mov_b32 s71, 0x1a0000
    buffer_load_dwordx4 v144, s[12:15], s71 offen lds
    s_add_u32 m0, s70, 0x7800
    s_mov_b32 s71, 0x1c0000
    buffer_load_dwordx4 v144, s[12:15], s71 offen lds
    s_add_u32 m0, s70, 0x7c00
    s_mov_b32 s71, 0x1e0000
    buffer_load_dwordx4 v144, s[12:15], s71 offen lds
    s_cmp_lg_u32 s20, 0
    s_cbranch_scc1 c0_4
    s_mov_b32 s84, -1
    s_mov_b32 s85, -1
    s_add_u32 s86, s98, 0xa0000
    s_mul_i32 s87, s24, 512
    s_add_u32 s86, s86, s87
    s_mov_b32 s87, 0
cl_5:
    s_memtime s[88:89]
    s_waitcnt lgkmcnt(0)
    s_buffer_load_dword s92, s[8:11], s86
    s_waitcnt lgkmcnt(0)
    s_memtime s[90:91]
    s_xor_b32 s86, s86, 0x2000
    s_waitcnt lgkmcnt(0)
    s_sub_u32 s88, s90, s88
    s_min_u32 s84, s84, s88
    s_memtime s[88:89]
    s_waitcnt lgkmcnt(0)
    s_buffer_load_dword s92, s[8:11], s86
    s_waitcnt lgkmcnt(0)
    s_memtime s[90:91]
    s_xor_b32 s86, s86, 0x2000
    s_waitcnt lgkmcnt(0)
    s_sub_u32 s88, s90, s88
    s_min_u32 s85, s85, s88
    s_add_u32 s86, s86, 256
    s_add_u32 s87, s87, 1
    s_cmp_lt_u32 s87, 2
    s_cbranch_scc1 cl_5
    s_lshl_b32 s87, s24, 3
    v_mov_b32 v34, s84
    v_mov_b32 v35, s85
    v_mov_b32 v36, s87
    ds_write_b64 v36, v[34:35] offset:1024
c0_4:
    s_waitcnt vmcnt(45)
    s_lshl_b32 s56, s20, 2
    s_add_u32 s56, s56, 112
    v_mov_b32 v39, s56
    s_cmp_lg_u32 s24, 0
    s_barrier
    s_cbranch_scc1 xa_6
    s_mov_b64 exec, 1
    buffer_atomic_add v27, v39, s[16:19], 0 offen sc1
    s_mov_b64 exec, -1
xa_6:
    s_mov_b32 s12, s62
    s_mov_b32 s13, s63
    s_add_u32 m0, s70, 0x14000
    s_mov_b32 s71, 0x0
    buffer_load_dwordx4 v144, s[12:15], s71 offen lds
    s_add_u32 m0, s70, 0x14400
    s_mov_b32 s71, 0x20000
    buffer_load_dwordx4 v144, s[12:15], s71 offen lds
    s_add_u32 m0, s70, 0x14800
    s_mov_b32 s71, 0x40000
    buffer_load_dwordx4 v144, s[12:15], s71 offen lds
    s_add_u32 m0, s70, 0x14c00
    s_mov_b32 s71, 0x60000
    buffer_load_dwordx4 v144, s[12:15], s71 offen lds
    s_add_u32 m0, s70, 0x15000
    s_mov_b32 s71, 0x80000
    buffer_load_dwordx4 v144, s[12:15], s71 offen lds
    s_add_u32 m0, s70, 0x15400
    s_mov_b32 s71, 0xa0000
    buffer_load_dwordx4 v144, s[12:15], s71 offen lds
    s_add_u32 m0, s70, 0x15800
    s_mov_b32 s71, 0xc0000
    buffer_load_dwordx4 v144, s[12:15], s71 offen lds
    s_add_u32 m0, s70, 0x15c00
    s_mov_b32 s71, 0xe0000
    buffer_load_dwordx4 v144, s[12:15], s71 offen lds
    s_add_u32 m0, s70, 0x16000
    s_mov_b32 s71, 0x100000
    buffer_load_dwordx4 v144, s[12:15], s71 offen lds
    s_add_u32 m0, s70, 0x16400
    s_mov_b32 s71, 0x120000
    buffer_load_dwordx4 v144, s[12:15], s71 offen lds
    s_add_u32 m0, s70, 0x16800
    s_mov_b32 s71, 0x140000
    buffer_load_dwordx4 v144, s[12:15], s71 offen lds
    s_add_u32 m0, s70, 0x16c00
    s_mov_b32 s71, 0x160000
    buffer_load_dwordx4 v144, s[12:15], s71 offen lds
    s_add_u32 m0, s70, 0x17000
    s_mov_b32 s71, 0x180000
    buffer_load_dwordx4 v144, s[12:15], s71 offen lds
    s_add_u32 m0, s70, 0x17400
    s_mov_b32 s71, 0x1a0000
    buffer_load_dwordx4 v144, s[12:15], s71 offen lds
    s_add_u32 m0, s70, 0x17800
    s_mov_b32 s71, 0x1c0000
    buffer_load_dwordx4 v144, s[12:15], s71 offen lds
    s_add_u32 m0, s70, 0x17c00
    s_mov_b32 s71, 0x1e0000
    buffer_load_dwordx4 v144, s[12:15], s71 offen lds
    s_waitcnt vmcnt(45)
    v_mfma_f32_16x16x32_bf16 v[160:163], v[224:227], v[192:195], 0
    v_mfma_f32_16x16x32_bf16 v[160:163], v[228:231], v[196:199], v[160:163]
    v_mfma_f32_16x16x32_bf16 v[160:163], v[232:235], v[200:203], v[160:163]
    v_mfma_f32_16x16x32_bf16 v[160:163], v[236:239], v[204:207], v[160:163]
    v_mfma_f32_16x16x32_bf16 v[160:163], v[240:243], v[208:211], v[160:163]
    v_mfma_f32_16x16x32_bf16 v[160:163], v[244:247], v[212:215], v[160:163]
    v_mfma_f32_16x16x32_bf16 v[160:163], v[248:251], v[216:219], v[160:163]
    v_mfma_f32_16x16x32_bf16 v[160:163], v[252:255], v[220:223], v[160:163]
    v_lshlrev_b32 v32, 2, v1
    s_lshl_b32 s56, s24, 8
    v_add_u32 v33, s56, v32
    s_nop 4
    ds_write_b32 v33, v160
    s_waitcnt lgkmcnt(0)
    s_barrier
    s_cmp_lg_u32 s24, 0
    s_cbranch_scc1 gt_7
    ds_read_b32 v160, v32 offset:0
    ds_read_b32 v161, v32 offset:256
    ds_read_b32 v162, v32 offset:512
    ds_read_b32 v163, v32 offset:768
    s_waitcnt lgkmcnt(0)
    v_add_f32 v160, v160, v161
    v_add_f32 v162, v162, v163
    v_add_f32 v160, v160, v162
    v_mul_f32 v160, 0xbfb8aa3b, v160
    v_exp_f32 v160, v160
    s_nop 0
    v_add_f32 v160, 1.0, v160
    v_rcp_f32 v160, v160
    s_lshl_b32 s56, s40, 6
    s_add_u32 s56, s56, 0x7000000
    s_mov_b64 exec, 0xffff
    buffer_store_dword v160, v32, s[8:11], s56 offen sc1
    s_mov_b64 exec, -1
gt_7:
    s_cmp_lg_u32 s24, 3
    s_cbranch_scc1 cb_8
    s_cmp_lg_u32 s20, 0
    s_cbranch_scc1 cb_8
    v_mov_b32 v32, 0
    ds_read_b128 v[160:163], v32 offset:1024
    ds_read_b128 v[164:167], v32 offset:1040
    s_waitcnt lgkmcnt(0)
    v_min_u32 v160, v160, v162
    v_min3_u32 v160, v160, v164, v166
    v_min_u32 v161, v161, v163
    v_min3_u32 v161, v161, v165, v167
    v_readfirstlane_b32 s84, v160
    v_readfirstlane_b32 s85, v161
    s_cmp_lt_u32 s85, s84
    s_cselect_b32 s87, 1, 0
    s_lshl_b32 s87, s87, s21
    v_mov_b32 v32, s87
    v_mov_b32 v33, 68
    s_mov_b64 exec, 1
    buffer_atomic_or v32, v33, s[16:19], 0 offen sc1
    s_mov_b64 exec, -1
cb_8:
    s_waitcnt vmcnt(16)
    ds_read_b64_tr_b16 a[64:65], v146 offset:0
    ds_read_b64_tr_b16 a[66:67], v146 offset:256
    ds_read_b64_tr_b16 a[96:97], v146 offset:32
    ds_read_b64_tr_b16 a[98:99], v146 offset:288
    ds_read_b64_tr_b16 a[68:69], v146 offset:2048
    ds_read_b64_tr_b16 a[70:71], v146 offset:2304
    ds_read_b64_tr_b16 a[100:101], v146 offset:2080
    ds_read_b64_tr_b16 a[102:103], v146 offset:2336
    s_waitcnt lgkmcnt(0)
    ds_read_b64_tr_b16 a[72:73], v146 offset:4096
    ds_read_b64_tr_b16 a[74:75], v146 offset:4352
    ds_read_b64_tr_b16 a[104:105], v146 offset:4128
    ds_read_b64_tr_b16 a[106:107], v146 offset:4384
    ds_read_b64_tr_b16 a[76:77], v146 offset:6144
    ds_read_b64_tr_b16 a[78:79], v146 offset:6400
    ds_read_b64_tr_b16 a[108:109], v146 offset:6176
    ds_read_b64_tr_b16 a[110:111], v146 offset:6432
    s_waitcnt lgkmcnt(0)
    ds_read_b64_tr_b16 a[80:81], v146 offset:8192
    ds_read_b64_tr_b16 a[82:83], v146 offset:8448
    ds_read_b64_tr_b16 a[112:113], v146 offset:8224
    ds_read_b64_tr_b16 a[114:115], v146 offset:8480
    ds_read_b64_tr_b16 a[84:85], v146 offset:10240
    ds_read_b64_tr_b16 a[86:87], v146 offset:10496
    ds_read_b64_tr_b16 a[116:117], v146 offset:10272
    ds_read_b64_tr_b16 a[118:119], v146 offset:10528
    s_waitcnt lgkmcnt(0)
    ds_read_b64_tr_b16 a[88:89], v146 offset:12288
    ds_read_b64_tr_b16 a[90:91], v146 offset:12544
    ds_read_b64_tr_b16 a[120:121], v146 offset:12320
    ds_read_b64_tr_b16 a[122:123], v146 offset:12576
    ds_read_b64_tr_b16 a[92:93], v146 offset:14336
    ds_read_b64_tr_b16 a[94:95], v146 offset:14592
    ds_read_b64_tr_b16 a[124:125], v146 offset:14368
    ds_read_b64_tr_b16 a[126:127], v146 offset:14624
    s_waitcnt lgkmcnt(0)
    s_mov_b32 s40, 0
    s_mov_b32 s41, 0x8000
    buffer_load_dword v38, v39, s[16:19], 0 offen sc1
    s_mov_b32 s12, s64
    s_mov_b32 s13, s65
    s_add_u32 m0, s70, 0x4000
    s_mov_b32 s71, 0x0
    buffer_load_dwordx4 v144, s[12:15], s71 offen lds
    s_add_u32 m0, s70, 0x4400
    s_mov_b32 s71, 0x20000
    buffer_load_dwordx4 v144, s[12:15], s71 offen lds
    s_add_u32 m0, s70, 0x4800
    s_mov_b32 s71, 0x40000
    buffer_load_dwordx4 v144, s[12:15], s71 offen lds
    s_add_u32 m0, s70, 0x4c00
    s_mov_b32 s71, 0x60000
    buffer_load_dwordx4 v144, s[12:15], s71 offen lds
    s_add_u32 m0, s70, 0x5000
    s_mov_b32 s71, 0x80000
    buffer_load_dwordx4 v144, s[12:15], s71 offen lds
    s_add_u32 m0, s70, 0x5400
    s_mov_b32 s71, 0xa0000
    buffer_load_dwordx4 v144, s[12:15], s71 offen lds
    s_add_u32 m0, s70, 0x5800
    s_mov_b32 s71, 0xc0000
    buffer_load_dwordx4 v144, s[12:15], s71 offen lds
    s_add_u32 m0, s70, 0x5c00
    s_mov_b32 s71, 0xe0000
    buffer_load_dwordx4 v144, s[12:15], s71 offen lds
    s_add_u32 m0, s70, 0x6000
    s_mov_b32 s71, 0x100000
    buffer_load_dwordx4 v144, s[12:15], s71 offen lds
    s_add_u32 m0, s70, 0x6400
    s_mov_b32 s71, 0x120000
    buffer_load_dwordx4 v144, s[12:15], s71 offen lds
    s_add_u32 m0, s70, 0x6800
    s_mov_b32 s71, 0x140000
    buffer_load_dwordx4 v144, s[12:15], s71 offen lds
    s_add_u32 m0, s70, 0x6c00
    s_mov_b32 s71, 0x160000
    buffer_load_dwordx4 v144, s[12:15], s71 offen lds
    s_add_u32 m0, s70, 0x7000
    s_mov_b32 s71, 0x180000
    buffer_load_dwordx4 v144, s[12:15], s71 offen lds
    s_add_u32 m0, s70, 0x7400
    s_mov_b32 s71, 0x1a0000
    buffer_load_dwordx4 v144, s[12:15], s71 offen lds
    s_add_u32 m0, s70, 0x7800
    s_mov_b32 s71, 0x1c0000
    buffer_load_dwordx4 v144, s[12:15], s71 offen lds
    s_add_u32 m0, s70, 0x7c00
    s_mov_b32 s71, 0x1e0000
    buffer_load_dwordx4 v144, s[12:15], s71 offen lds
    v_add_u32 v146, 0x10000, v146
    s_waitcnt vmcnt(16)
    ds_read_b64_tr_b16 a[128:129], v146 offset:0
    ds_read_b64_tr_b16 a[130:131], v146 offset:256
    ds_read_b64_tr_b16 a[160:161], v146 offset:32
    ds_read_b64_tr_b16 a[162:163], v146 offset:288
    ds_read_b64_tr_b16 a[132:133], v146 offset:2048
    ds_read_b64_tr_b16 a[134:135], v146 offset:2304
    ds_read_b64_tr_b16 a[164:165], v146 offset:2080
    ds_read_b64_tr_b16 a[166:167], v146 offset:2336
    s_waitcnt lgkmcnt(0)
    ds_read_b64_tr_b16 a[136:137], v146 offset:4096
    ds_read_b64_tr_b16 a[138:139], v146 offset:4352
    ds_read_b64_tr_b16 a[168:169], v146 offset:4128
    ds_read_b64_tr_b16 a[170:171], v146 offset:4384
    ds_read_b64_tr_b16 a[140:141], v146 offset:6144
    ds_read_b64_tr_b16 a[142:143], v146 offset:6400
    ds_read_b64_tr_b16 a[172:173], v146 offset:6176
    ds_read_b64_tr_b16 a[174:175], v146 offset:6432
    s_waitcnt lgkmcnt(0)
    ds_read_b64_tr_b16 a[144:145], v146 offset:8192
    ds_read_b64_tr_b16 a[146:147], v146 offset:8448
    ds_read_b64_tr_b16 a[176:177], v146 offset:8224
    ds_read_b64_tr_b16 a[178:179], v146 offset:8480
    ds_read_b64_tr_b16 a[148:149], v146 offset:10240
    ds_read_b64_tr_b16 a[150:151], v146 offset:10496
    ds_read_b64_tr_b16 a[180:181], v146 offset:10272
    ds_read_b64_tr_b16 a[182:183], v146 offset:10528
    s_waitcnt lgkmcnt(0)
    ds_read_b64_tr_b16 a[152:153], v146 offset:12288
    ds_read_b64_tr_b16 a[154:155], v146 offset:12544
    ds_read_b64_tr_b16 a[184:185], v146 offset:12320
    ds_read_b64_tr_b16 a[186:187], v146 offset:12576
    ds_read_b64_tr_b16 a[156:157], v146 offset:14336
    ds_read_b64_tr_b16 a[158:159], v146 offset:14592
    ds_read_b64_tr_b16 a[188:189], v146 offset:14368
    ds_read_b64_tr_b16 a[190:191], v146 offset:14624
    s_waitcnt lgkmcnt(0)
    v_readfirstlane_b32 s56, v38
    s_cmp_ge_u32 s56, 32
    s_cbranch_scc1 xy_10
    s_mov_b32 s43, 0
xw_9:
    buffer_load_dword v38, v39, s[16:19], 0 offen sc1
    s_add_u32 s43, s43, 1
    s_cmp_ge_u32 s43, 0x20000
    s_cbranch_scc1 L_exit
    s_waitcnt vmcnt(0)
    v_readfirstlane_b32 s56, v38
    s_cmp_lt_u32 s56, 32
    s_cbranch_scc1 xw_9
xy_10:
    s_mov_b32 s76, s6
    s_mov_b32 s77, s7
    s_mov_b32 s78, 0x10000000
    s_mov_b32 s79, 0x20000
    s_lshl_b32 s56, s20, 19
    s_lshl_b32 s57, s24, 13
    s_add_u32 s56, s56, s57
    s_add_u32 s56, s56, 0x7400000
    v_add_u32 v5, s56, v3
    v_add_u32 v0, 0x1000, v5
    buffer_load_dwordx4 v[192:195], v5, s[76:79], s40 offen offset:0
    buffer_load_dwordx4 v[196:199], v5, s[76:79], s40 offen offset:1024
    buffer_load_dwordx4 v[200:203], v5, s[76:79], s40 offen offset:2048
    buffer_load_dwordx4 v[204:207], v5, s[76:79], s40 offen offset:3072
    buffer_load_dwordx4 v[208:211], v0, s[76:79], s40 offen offset:0
    buffer_load_dwordx4 v[212:215], v0, s[76:79], s40 offen offset:1024
    buffer_load_dwordx4 v[216:219], v0, s[76:79], s40 offen offset:2048
    buffer_load_dwordx4 v[220:223], v0, s[76:79], s40 offen offset:3072
    buffer_load_dwordx4 v[224:227], v5, s[76:79], s41 offen offset:0
    buffer_load_dwordx4 v[228:231], v5, s[76:79], s41 offen offset:1024
    buffer_load_dwordx4 v[232:235], v5, s[76:79], s41 offen offset:2048
    buffer_load_dwordx4 v[236:239], v5, s[76:79], s41 offen offset:3072
    buffer_load_dwordx4 v[240:243], v0, s[76:79], s41 offen offset:0
    buffer_load_dwordx4 v[244:247], v0, s[76:79], s41 offen offset:1024
    buffer_load_dwordx4 v[248:251], v0, s[76:79], s41 offen offset:2048
    buffer_load_dwordx4 v[252:255], v0, s[76:79], s41 offen offset:3072
    s_add_u32 s40, s40, 0x10000
    s_add_u32 s41, s41, 0x10000
    buffer_load_dwordx4 v[40:43], v5, s[76:79], s40 offen offset:0
    buffer_load_dwordx4 v[44:47], v5, s[76:79], s40 offen offset:1024
    buffer_load_dwordx4 v[48:51], v5, s[76:79], s40 offen offset:2048
    buffer_load_dwordx4 v[52:55], v5, s[76:79], s40 offen offset:3072
    buffer_load_dwordx4 v[56:59], v0, s[76:79], s40 offen offset:0
    buffer_load_dwordx4 v[60:63], v0, s[76:79], s40 offen offset:1024
    buffer_load_dwordx4 v[64:67], v0, s[76:79], s40 offen offset:2048
    buffer_load_dwordx4 v[68:71], v0, s[76:79], s40 offen offset:3072
    buffer_load_dwordx4 v[72:75], v5, s[76:79], s41 offen offset:0
    buffer_load_dwordx4 v[76:79], v5, s[76:79], s41 offen offset:1024
    buffer_load_dwordx4 v[80:83], v5, s[76:79], s41 offen offset:2048
    buffer_load_dwordx4 v[84:87], v5, s[76:79], s41 offen offset:3072
    buffer_load_dwordx4 v[88:91], v0, s[76:79], s41 offen offset:0
    buffer_load_dwordx4 v[92:95], v0, s[76:79], s41 offen offset:1024
    buffer_load_dwordx4 v[96:99], v0, s[76:79], s41 offen offset:2048
    buffer_load_dwordx4 v[100:103], v0, s[76:79], s41 offen offset:3072
    s_add_u32 s40, s40, 0x10000
    s_add_u32 s41, s41, 0x10000
    s_mov_b32 s12, s66
    s_mov_b32 s13, s67
    s_add_u32 m0, s70, 0x14000
    s_mov_b32 s71, 0x0
    buffer_load_dwordx4 v145, s[12:15], s71 offen lds
    s_add_u32 m0, s70, 0x14400
    s_mov_b32 s71, 0x8000
    buffer_load_dwordx4 v145, s[12:15], s71 offen lds
    s_add_u32 m0, s70, 0x14800
    s_mov_b32 s71, 0x10000
    buffer_load_dwordx4 v145, s[12:15], s71 offen lds
    s_add_u32 m0, s70, 0x14c00
    s_mov_b32 s71, 0x18000
    buffer_load_dwordx4 v145, s[12:15], s71 offen lds
    s_add_u32 m0, s70, 0x15000
    s_mov_b32 s71, 0x20000
    buffer_load_dwordx4 v145, s[12:15], s71 offen lds
    s_add_u32 m0, s70, 0x15400
    s_mov_b32 s71, 0x28000
    buffer_load_dwordx4 v145, s[12:15], s71 offen lds
    s_add_u32 m0, s70, 0x15800
    s_mov_b32 s71, 0x30000
    buffer_load_dwordx4 v145, s[12:15], s71 offen lds
    s_add_u32 m0, s70, 0x15c00
    s_mov_b32 s71, 0x38000
    buffer_load_dwordx4 v145, s[12:15], s71 offen lds
    s_add_u32 m0, s70, 0x16000
    s_mov_b32 s71, 0x40000
    buffer_load_dwordx4 v145, s[12:15], s71 offen lds
    s_add_u32 m0, s70, 0x16400
    s_mov_b32 s71, 0x48000
    buffer_load_dwordx4 v145, s[12:15], s71 offen lds
    s_add_u32 m0, s70, 0x16800
    s_mov_b32 s71, 0x50000
    buffer_load_dwordx4 v145, s[12:15], s71 offen lds
    s_add_u32 m0, s70, 0x16c00
    s_mov_b32 s71, 0x58000
    buffer_load_dwordx4 v145, s[12:15], s71 offen lds
    s_add_u32 m0, s70, 0x17000
    s_mov_b32 s71, 0x60000
    buffer_load_dwordx4 v145, s[12:15], s71 offen lds
    s_add_u32 m0, s70, 0x17400
    s_mov_b32 s71, 0x68000
    buffer_load_dwordx4 v145, s[12:15], s71 offen lds
    s_add_u32 m0, s70, 0x17800
    s_mov_b32 s71, 0x70000
    buffer_load_dwordx4 v145, s[12:15], s71 offen lds
    s_add_u32 m0, s70, 0x17c00
    s_mov_b32 s71, 0x78000
    buffer_load_dwordx4 v145, s[12:15], s71 offen lds
    v_subrev_u32 v146, 0x10000, v146
    s_waitcnt vmcnt(48)
    ds_read_b64_tr_b16 a[0:1], v146 offset:0
    ds_read_b64_tr_b16 a[2:3], v146 offset:256
    ds_read_b64_tr_b16 a[32:33], v146 offset:32
    ds_read_b64_tr_b16 a[34:35], v146 offset:288
    ds_read_b64_tr_b16 a[4:5], v146 offset:2048
    ds_read_b64_tr_b16 a[6:7], v146 offset:2304
    ds_read_b64_tr_b16 a[36:37], v146 offset:2080
    ds_read_b64_tr_b16 a[38:39], v146 offset:2336
    s_waitcnt lgkmcnt(0)
    ds_read_b64_tr_b16 a[8:9], v146 offset:4096
    ds_read_b64_tr_b16 a[10:11], v146 offset:4352
    ds_read_b64_tr_b16 a[40:41], v146 offset:4128
    ds_read_b64_tr_b16 a[42:43], v146 offset:4384
    ds_read_b64_tr_b16 a[12:13], v146 offset:6144
    ds_read_b64_tr_b16 a[14:15], v146 offset:6400
    ds_read_b64_tr_b16 a[44:45], v146 offset:6176
    ds_read_b64_tr_b16 a[46:47], v146 offset:6432
    s_waitcnt lgkmcnt(0)
    ds_read_b64_tr_b16 a[16:17], v146 offset:8192
    ds_read_b64_tr_b16 a[18:19], v146 offset:8448
    ds_read_b64_tr_b16 a[48:49], v146 offset:8224
    ds_read_b64_tr_b16 a[50:51], v146 offset:8480
    ds_read_b64_tr_b16 a[20:21], v146 offset:10240
    ds_read_b64_tr_b16 a[22:23], v146 offset:10496
    ds_read_b64_tr_b16 a[52:53], v146 offset:10272
    ds_read_b64_tr_b16 a[54:55], v146 offset:10528
    s_waitcnt lgkmcnt(0)
    ds_read_b64_tr_b16 a[24:25], v146 offset:12288
    ds_read_b64_tr_b16 a[26:27], v146 offset:12544
    ds_read_b64_tr_b16 a[56:57], v146 offset:12320
    ds_read_b64_tr_b16 a[58:59], v146 offset:12576
    ds_read_b64_tr_b16 a[28:29], v146 offset:14336
    ds_read_b64_tr_b16 a[30:31], v146 offset:14592
    ds_read_b64_tr_b16 a[60:61], v146 offset:14368
    ds_read_b64_tr_b16 a[62:63], v146 offset:14624
    s_waitcnt lgkmcnt(0)
    s_barrier
    s_cmp_lg_u32 s24, 0
    s_cbranch_scc1 arr_11
    v_mov_b32 v33, 64
    s_mov_b64 exec, 1
    buffer_atomic_add v27, v33, s[16:19], 0 offen sc1
    s_mov_b64 exec, -1
arr_11:
    s_cmp_lt_u32 s24, 2
    s_cselect_b32 s52, 4, 1
    s_cselect_b32 s53, 1, 4
    s_lshl_b32 s52, s52, 10
    s_lshl_b32 s53, s53, 10
    s_mul_i32 s54, s52, s24
    s_add_u32 s54, s54, 0x4000
    v_add_u32 v136, s54, v3
    v_add_u32 v137, s53, v136
    s_lshl_b32 s54, s24, 13
    s_add_u32 s54, s54, 0x4000
    v_add_u32 v18, s54, v3
    s_and_b32 s54, s24, 1
    s_mul_i32 s54, s54, s52
    s_cmp_lt_u32 s24, 2
    s_cselect_b32 s55, 10, 11
    s_lshl_b32 s55, s23, s55
    s_add_u32 s54, s54, s55
    s_lshl_b32 s55, s22, 13
    s_add_u32 s54, s54, s55
    s_cmp_lt_u32 s24, 2
    s_mov_b32 s55, 0x1000000
    s_cselect_b32 s56, 0, 0x1200000
    s_add_u32 s54, s54, s55
    s_add_u32 s42, s54, s56
    s_mov_b32 s25, 0
    s_waitcnt vmcnt(32)
    v_mfma_f32_16x16x32_bf16 v[160:163], a[64:67], v[192:195], 0
    v_mfma_f32_16x16x32_bf16 v[164:167], a[96:99], v[192:195], 0
    v_mfma_f32_16x16x32_bf16 v[168:171], v[192:195], a[128:131], 0
    v_mfma_f32_16x16x32_bf16 v[172:175], v[192:195], a[160:163], 0
    v_mfma_f32_16x16x32_bf16 v[160:163], a[68:71], v[196:199], v[160:163]
    v_mfma_f32_16x16x32_bf16 v[164:167], a[100:103], v[196:199], v[164:167]
    v_mfma_f32_16x16x32_bf16 v[168:171], v[196:199], a[132:135], v[168:171]
    v_mfma_f32_16x16x32_bf16 v[172:175], v[196:199], a[164:167], v[172:175]
    v_mfma_f32_16x16x32_bf16 v[160:163], a[72:75], v[200:203], v[160:163]
    v_mfma_f32_16x16x32_bf16 v[164:167], a[104:107], v[200:203], v[164:167]
    v_mfma_f32_16x16x32_bf16 v[168:171], v[200:203], a[136:139], v[168:171]
    v_mfma_f32_16x16x32_bf16 v[172:175], v[200:203], a[168:171], v[172:175]
    v_mfma_f32_16x16x32_bf16 v[160:163], a[76:79], v[204:207], v[160:163]
    v_mfma_f32_16x16x32_bf16 v[164:167], a[108:111], v[204:207], v[164:167]
    v_mfma_f32_16x16x32_bf16 v[168:171], v[204:207], a[140:143], v[168:171]
    v_mfma_f32_16x16x32_bf16 v[172:175], v[204:207], a[172:175], v[172:175]
    v_mfma_f32_16x16x32_bf16 v[160:163], a[80:83], v[208:211], v[160:163]
    v_mfma_f32_16x16x32_bf16 v[164:167], a[112:115], v[208:211], v[164:167]
    v_mfma_f32_16x16x32_bf16 v[168:171], v[208:211], a[144:147], v[168:171]
    v_mfma_f32_16x16x32_bf16 v[172:175], v[208:211], a[176:179], v[172:175]
    v_mfma_f32_16x16x32_bf16 v[160:163], a[84:87], v[212:215], v[160:163]
    v_mfma_f32_16x16x32_bf16 v[164:167], a[116:119], v[212:215], v[164:167]
    v_mfma_f32_16x16x32_bf16 v[168:171], v[212:215], a[148:151], v[168:171]
    v_mfma_f32_16x16x32_bf16 v[172:175], v[212:215], a[180:183], v[172:175]
    v_mfma_f32_16x16x32_bf16 v[160:163], a[88:91], v[216:219], v[160:163]
    v_mfma_f32_16x16x32_bf16 v[164:167], a[120:123], v[216:219], v[164:167]
    v_mfma_f32_16x16x32_bf16 v[168:171], v[216:219], a[152:155], v[168:171]
    v_mfma_f32_16x16x32_bf16 v[172:175], v[216:219], a[184:187], v[172:175]
    v_mfma_f32_16x16x32_bf16 v[160:163], a[92:95], v[220:223], v[160:163]
    v_mfma_f32_16x16x32_bf16 v[164:167], a[124:127], v[220:223], v[164:167]
    v_mfma_f32_16x16x32_bf16 v[168:171], v[220:223], a[156:159], v[168:171]
    v_mfma_f32_16x16x32_bf16 v[172:175], v[220:223], a[188:191], v[172:175]
    v_mfma_f32_16x16x32_bf16 v[176:179], a[64:67], v[224:227], 0
    v_mfma_f32_16x16x32_bf16 v[180:183], a[96:99], v[224:227], 0
    buffer_load_dwordx4 v[192:195], v5, s[76:79], s40 offen offset:0
    v_mfma_f32_16x16x32_bf16 v[184:187], v[224:227], a[128:131], 0
    v_mfma_f32_16x16x32_bf16 v[188:191], v[224:227], a[160:163], 0
    buffer_load_dwordx4 v[196:199], v5, s[76:79], s40 offen offset:1024
    v_mfma_f32_16x16x32_bf16 v[176:179], a[68:71], v[228:231], v[176:179]
    v_mfma_f32_16x16x32_bf16 v[180:183], a[100:103], v[228:231], v[180:183]
    buffer_load_dwordx4 v[200:203], v5, s[76:79], s40 offen offset:2048
    v_mfma_f32_16x16x32_bf16 v[184:187], v[228:231], a[132:135], v[184:187]
    v_mfma_f32_16x16x32_bf16 v[188:191], v[228:231], a[164:167], v[188:191]
    buffer_load_dwordx4 v[204:207], v5, s[76:79], s40 offen offset:3072
    v_mfma_f32_16x16x32_bf16 v[176:179], a[72:75], v[232:235], v[176:179]
    ds_write_b128 v18, v[160:163] offset:0
    ds_write_b128 v18, v[164:167] offset:1024
    ds_write_b128 v18, v[168:171] offset:2048
    ds_write_b128 v18, v[172:175] offset:3072
    v_mfma_f32_16x16x32_bf16 v[180:183], a[104:107], v[232:235], v[180:183]
    buffer_load_dwordx4 v[208:211], v0, s[76:79], s40 offen offset:0
    v_mfma_f32_16x16x32_bf16 v[184:187], v[232:235], a[136:139], v[184:187]
    v_mfma_f32_16x16x32_bf16 v[188:191], v[232:235], a[168:171], v[188:191]
    buffer_load_dwordx4 v[212:215], v0, s[76:79], s40 offen offset:1024
    v_mfma_f32_16x16x32_bf16 v[176:179], a[76:79], v[236:239], v[176:179]
    v_mfma_f32_16x16x32_bf16 v[180:183], a[108:111], v[236:239], v[180:183]
    buffer_load_dwordx4 v[216:219], v0, s[76:79], s40 offen offset:2048
    v_mfma_f32_16x16x32_bf16 v[184:187], v[236:239], a[140:143], v[184:187]
    v_mfma_f32_16x16x32_bf16 v[188:191], v[236:239], a[172:175], v[188:191]
    buffer_load_dwordx4 v[220:223], v0, s[76:79], s40 offen offset:3072
    v_mfma_f32_16x16x32_bf16 v[176:179], a[80:83], v[240:243], v[176:179]
    v_mfma_f32_16x16x32_bf16 v[180:183], a[112:115], v[240:243], v[180:183]
    v_mfma_f32_16x16x32_bf16 v[184:187], v[240:243], a[144:147], v[184:187]
    v_mfma_f32_16x16x32_bf16 v[188:191], v[240:243], a[176:179], v[188:191]
    v_mfma_f32_16x16x32_bf16 v[176:179], a[84:87], v[244:247], v[176:179]
    v_mfma_f32_16x16x32_bf16 v[180:183], a[116:119], v[244:247], v[180:183]
    v_mfma_f32_16x16x32_bf16 v[184:187], v[244:247], a[148:151], v[184:187]
    v_mfma_f32_16x16x32_bf16 v[188:191], v[244:247], a[180:183], v[188:191]
    v_mfma_f32_16x16x32_bf16 v[176:179], a[88:91], v[248:251], v[176:179]
    v_mfma_f32_16x16x32_bf16 v[180:183], a[120:123], v[248:251], v[180:183]
    v_mfma_f32_16x16x32_bf16 v[184:187], v[248:251], a[152:155], v[184:187]
    v_mfma_f32_16x16x32_bf16 v[188:191], v[248:251], a[184:187], v[188:191]
    v_mfma_f32_16x16x32_bf16 v[176:179], a[92:95], v[252:255], v[176:179]
    v_mfma_f32_16x16x32_bf16 v[180:183], a[124:127], v[252:255], v[180:183]
    v_mfma_f32_16x16x32_bf16 v[184:187], v[252:255], a[156:159], v[184:187]
    v_mfma_f32_16x16x32_bf16 v[188:191], v[252:255], a[188:191], v[188:191]
    buffer_load_dwordx4 v[224:227], v5, s[76:79], s41 offen offset:0
    buffer_load_dwordx4 v[228:231], v5, s[76:79], s41 offen offset:1024
    buffer_load_dwordx4 v[232:235], v5, s[76:79], s41 offen offset:2048
    buffer_load_dwordx4 v[236:239], v5, s[76:79], s41 offen offset:3072
    buffer_load_dwordx4 v[240:243], v0, s[76:79], s41 offen offset:0
    buffer_load_dwordx4 v[244:247], v0, s[76:79], s41 offen offset:1024
    buffer_load_dwordx4 v[248:251], v0, s[76:79], s41 offen offset:2048
    buffer_load_dwordx4 v[252:255], v0, s[76:79], s41 offen offset:3072
    s_add_u32 s40, s40, 0x10000
    s_add_u32 s41, s41, 0x10000
    ds_write_b128 v18, v[176:179] offset:4096
    ds_write_b128 v18, v[180:183] offset:5120
    ds_write_b128 v18, v[184:187] offset:6144
    ds_write_b128 v18, v[188:191] offset:7168
    s_waitcnt lgkmcnt(0)
    s_barrier
    s_waitcnt vmcnt(32)
    v_mfma_f32_16x16x32_bf16 v[160:163], a[64:67], v[40:43], 0
    ds_read_b128 v[104:107], v136 offset:0
    v_mfma_f32_16x16x32_bf16 v[164:167], a[96:99], v[40:43], 0
    ds_read_b128 v[108:111], v137 offset:0
    v_mfma_f32_16x16x32_bf16 v[168:171], v[40:43], a[128:131], 0
    ds_read_b128 v[112:115], v136 offset:8192
    v_mfma_f32_16x16x32_bf16 v[172:175], v[40:43], a[160:163], 0
    ds_read_b128 v[116:119], v137 offset:8192
    v_mfma_f32_16x16x32_bf16 v[160:163], a[68:71], v[44:47], v[160:163]
    ds_read_b128 v[120:123], v136 offset:16384
    v_mfma_f32_16x16x32_bf16 v[164:167], a[100:103], v[44:47], v[164:167]
    ds_read_b128 v[124:127], v137 offset:16384
    v_mfma_f32_16x16x32_bf16 v[168:171], v[44:47], a[132:135], v[168:171]
    ds_read_b128 v[128:131], v136 offset:24576
    v_mfma_f32_16x16x32_bf16 v[172:175], v[44:47], a[164:167], v[172:175]
    ds_read_b128 v[132:135], v137 offset:24576
    v_mfma_f32_16x16x32_bf16 v[160:163], a[72:75], v[48:51], v[160:163]
    v_mfma_f32_16x16x32_bf16 v[164:167], a[104:107], v[48:51], v[164:167]
    v_mfma_f32_16x16x32_bf16 v[168:171], v[48:51], a[136:139], v[168:171]
    v_mfma_f32_16x16x32_bf16 v[172:175], v[48:51], a[168:171], v[172:175]
    s_waitcnt lgkmcnt(0)
    v_mfma_f32_16x16x32_bf16 v[160:163], a[76:79], v[52:55], v[160:163]
    v_pk_add_f32 v[104:105], v[104:105], v[112:113]
    v_pk_add_f32 v[106:107], v[106:107], v[114:115]
    v_mfma_f32_16x16x32_bf16 v[164:167], a[108:111], v[52:55], v[164:167]
    v_pk_add_f32 v[108:109], v[108:109], v[116:117]
    v_pk_add_f32 v[110:111], v[110:111], v[118:119]
    v_mfma_f32_16x16x32_bf16 v[168:171], v[52:55], a[140:143], v[168:171]
    v_pk_add_f32 v[120:121], v[120:121], v[128:129]
    v_pk_add_f32 v[122:123], v[122:123], v[130:131]
    v_mfma_f32_16x16x32_bf16 v[172:175], v[52:55], a[172:175], v[172:175]
    v_pk_add_f32 v[124:125], v[124:125], v[132:133]
    v_pk_add_f32 v[126:127], v[126:127], v[134:135]
    v_mfma_f32_16x16x32_bf16 v[160:163], a[80:83], v[56:59], v[160:163]
    v_pk_add_f32 v[104:105], v[104:105], v[120:121]
    v_pk_add_f32 v[106:107], v[106:107], v[122:123]
    v_mfma_f32_16x16x32_bf16 v[164:167], a[112:115], v[56:59], v[164:167]
    v_pk_add_f32 v[108:109], v[108:109], v[124:125]
    v_pk_add_f32 v[110:111], v[110:111], v[126:127]
    v_mfma_f32_16x16x32_bf16 v[168:171], v[56:59], a[144:147], v[168:171]
    v_cvt_pk_bf16_f32 v140, v104, v105
    v_cvt_pk_bf16_f32 v141, v106, v107
    v_mfma_f32_16x16x32_bf16 v[172:175], v[56:59], a[176:179], v[172:175]
    v_cvt_pk_bf16_f32 v142, v108, v109
    v_cvt_pk_bf16_f32 v143, v110, v111
    v_mfma_f32_16x16x32_bf16 v[160:163], a[84:87], v[60:63], v[160:163]
    v_mfma_f32_16x16x32_bf16 v[164:167], a[116:119], v[60:63], v[164:167]
    v_mfma_f32_16x16x32_bf16 v[168:171], v[60:63], a[148:151], v[168:171]
    buffer_store_dwordx4 v[140:143], v3, s[8:11], s42 offen sc1
    s_add_u32 s42, s42, 0x40000
    v_mfma_f32_16x16x32_bf16 v[172:175], v[60:63], a[180:183], v[172:175]
    v_mfma_f32_16x16x32_bf16 v[160:163], a[88:91], v[64:67], v[160:163]
    v_mfma_f32_16x16x32_bf16 v[164:167], a[120:123], v[64:67], v[164:167]
    v_mfma_f32_16x16x32_bf16 v[168:171], v[64:67], a[152:155], v[168:171]
    v_mfma_f32_16x16x32_bf16 v[172:175], v[64:67], a[184:187], v[172:175]
    v_mfma_f32_16x16x32_bf16 v[160:163], a[92:95], v[68:71], v[160:163]
    v_mfma_f32_16x16x32_bf16 v[164:167], a[124:127], v[68:71], v[164:167]
    v_mfma_f32_16x16x32_bf16 v[168:171], v[68:71], a[156:159], v[168:171]
    v_mfma_f32_16x16x32_bf16 v[172:175], v[68:71], a[188:191], v[172:175]
    v_mfma_f32_16x16x32_bf16 v[176:179], a[64:67], v[72:75], 0
    v_mfma_f32_16x16x32_bf16 v[180:183], a[96:99], v[72:75], 0
    buffer_load_dwordx4 v[40:43], v5, s[76:79], s40 offen offset:0
    v_mfma_f32_16x16x32_bf16 v[184:187], v[72:75], a[128:131], 0
    v_mfma_f32_16x16x32_bf16 v[188:191], v[72:75], a[160:163], 0
    buffer_load_dwordx4 v[44:47], v5, s[76:79], s40 offen offset:1024
    v_mfma_f32_16x16x32_bf16 v[176:179], a[68:71], v[76:79], v[176:179]
    v_mfma_f32_16x16x32_bf16 v[180:183], a[100:103], v[76:79], v[180:183]
    buffer_load_dwordx4 v[48:51], v5, s[76:79], s40 offen offset:2048
    v_mfma_f32_16x16x32_bf16 v[184:187], v[76:79], a[132:135], v[184:187]
    v_mfma_f32_16x16x32_bf16 v[188:191], v[76:79], a[164:167], v[188:191]
    buffer_load_dwordx4 v[52:55], v5, s[76:79], s40 offen offset:3072
    v_mfma_f32_16x16x32_bf16 v[176:179], a[72:75], v[80:83], v[176:179]
    ds_write_b128 v18, v[160:163] offset:32768
    ds_write_b128 v18, v[164:167] offset:33792
    ds_write_b128 v18, v[168:171] offset:34816
    ds_write_b128 v18, v[172:175] offset:35840
    v_mfma_f32_16x16x32_bf16 v[180:183], a[104:107], v[80:83], v[180:183]
    buffer_load_dwordx4 v[56:59], v0, s[76:79], s40 offen offset:0
    v_mfma_f32_16x16x32_bf16 v[184:187], v[80:83], a[136:139], v[184:187]
    v_mfma_f32_16x16x32_bf16 v[188:191], v[80:83], a[168:171], v[188:191]
    buffer_load_dwordx4 v[60:63], v0, s[76:79], s40 offen offset:1024
    v_mfma_f32_16x16x32_bf16 v[176:179], a[76:79], v[84:87], v[176:179]
    v_mfma_f32_16x16x32_bf16 v[180:183], a[108:111], v[84:87], v[180:183]
    buffer_load_dwordx4 v[64:67], v0, s[76:79], s40 offen offset:2048
    v_mfma_f32_16x16x32_bf16 v[184:187], v[84:87], a[140:143], v[184:187]
    v_mfma_f32_16x16x32_bf16 v[188:191], v[84:87], a[172:175], v[188:191]
    buffer_load_dwordx4 v[68:71], v0, s[76:79], s40 offen offset:3072
    v_mfma_f32_16x16x32_bf16 v[176:179], a[80:83], v[88:91], v[176:179]
    v_mfma_f32_16x16x32_bf16 v[180:183], a[112:115], v[88:91], v[180:183]
    v_mfma_f32_16x16x32_bf16 v[184:187], v[88:91], a[144:147], v[184:187]
    v_mfma_f32_16x16x32_bf16 v[188:191], v[88:91], a[176:179], v[188:191]
    v_mfma_f32_16x16x32_bf16 v[176:179], a[84:87], v[92:95], v[176:179]
    v_mfma_f32_16x16x32_bf16 v[180:183], a[116:119], v[92:95], v[180:183]
    v_mfma_f32_16x16x32_bf16 v[184:187], v[92:95], a[148:151], v[184:187]
    v_mfma_f32_16x16x32_bf16 v[188:191], v[92:95], a[180:183], v[188:191]
    v_mfma_f32_16x16x32_bf16 v[176:179], a[88:91], v[96:99], v[176:179]
    v_mfma_f32_16x16x32_bf16 v[180:183], a[120:123], v[96:99], v[180:183]
    v_mfma_f32_16x16x32_bf16 v[184:187], v[96:99], a[152:155], v[184:187]
    v_mfma_f32_16x16x32_bf16 v[188:191], v[96:99], a[184:187], v[188:191]
    v_mfma_f32_16x16x32_bf16 v[176:179], a[92:95], v[100:103], v[176:179]
    v_mfma_f32_16x16x32_bf16 v[180:183], a[124:127], v[100:103], v[180:183]
    v_mfma_f32_16x16x32_bf16 v[184:187], v[100:103], a[156:159], v[184:187]
    v_mfma_f32_16x16x32_bf16 v[188:191], v[100:103], a[188:191], v[188:191]
    buffer_load_dwordx4 v[72:75], v5, s[76:79], s41 offen offset:0
    buffer_load_dwordx4 v[76:79], v5, s[76:79], s41 offen offset:1024
    buffer_load_dwordx4 v[80:83], v5, s[76:79], s41 offen offset:2048
    buffer_load_dwordx4 v[84:87], v5, s[76:79], s41 offen offset:3072
    buffer_load_dwordx4 v[88:91], v0, s[76:79], s41 offen offset:0
    buffer_load_dwordx4 v[92:95], v0, s[76:79], s41 offen offset:1024
    buffer_load_dwordx4 v[96:99], v0, s[76:79], s41 offen offset:2048
    buffer_load_dwordx4 v[100:103], v0, s[76:79], s41 offen offset:3072
    s_add_u32 s40, s40, 0x10000
    s_add_u32 s41, s41, 0x10000
    ds_write_b128 v18, v[176:179] offset:36864
    ds_write_b128 v18, v[180:183] offset:37888
    ds_write_b128 v18, v[184:187] offset:38912
    ds_write_b128 v18, v[188:191] offset:39936
    s_waitcnt lgkmcnt(0)
    s_barrier
    s_waitcnt vmcnt(17)
    v_mfma_f32_16x16x32_bf16 v[160:163], a[64:67], v[192:195], 0
    ds_read_b128 v[104:107], v136 offset:32768
    v_mfma_f32_16x16x32_bf16 v[164:167], a[96:99], v[192:195], 0
    ds_read_b128 v[108:111], v137 offset:32768
    v_mfma_f32_16x16x32_bf16 v[168:171], v[192:195], a[128:131], 0
    ds_read_b128 v[112:115], v136 offset:40960
    v_mfma_f32_16x16x32_bf16 v[172:175], v[192:195], a[160:163], 0
    ds_read_b128 v[116:119], v137 offset:40960
    v_mfma_f32_16x16x32_bf16 v[160:163], a[68:71], v[196:199], v[160:163]
    ds_read_b128 v[120:123], v136 offset:49152
    v_mfma_f32_16x16x32_bf16 v[164:167], a[100:103], v[196:199], v[164:167]
    ds_read_b128 v[124:127], v137 offset:49152
    v_mfma_f32_16x16x32_bf16 v[168:171], v[196:199], a[132:135], v[168:171]
    ds_read_b128 v[128:131], v136 offset:57344
    v_mfma_f32_16x16x32_bf16 v[172:175], v[196:199], a[164:167], v[172:175]
    ds_read_b128 v[132:135], v137 offset:57344
    v_mfma_f32_16x16x32_bf16 v[160:163], a[72:75], v[200:203], v[160:163]
    v_mfma_f32_16x16x32_bf16 v[164:167], a[104:107], v[200:203], v[164:167]
    v_mfma_f32_16x16x32_bf16 v[168:171], v[200:203], a[136:139], v[168:171]
    v_mfma_f32_16x16x32_bf16 v[172:175], v[200:203], a[168:171], v[172:175]
    s_waitcnt lgkmcnt(0)
    v_mfma_f32_16x16x32_bf16 v[160:163], a[76:79], v[204:207], v[160:163]
    v_pk_add_f32 v[104:105], v[104:105], v[112:113]
    v_pk_add_f32 v[106:107], v[106:107], v[114:115]
    v_mfma_f32_16x16x32_bf16 v[164:167], a[108:111], v[204:207], v[164:167]
    v_pk_add_f32 v[108:109], v[108:109], v[116:117]
    v_pk_add_f32 v[110:111], v[110:111], v[118:119]
    v_mfma_f32_16x16x32_bf16 v[168:171], v[204:207], a[140:143], v[168:171]
    v_pk_add_f32 v[120:121], v[120:121], v[128:129]
    v_pk_add_f32 v[122:123], v[122:123], v[130:131]
    v_mfma_f32_16x16x32_bf16 v[172:175], v[204:207], a[172:175], v[172:175]
    v_pk_add_f32 v[124:125], v[124:125], v[132:133]
    v_pk_add_f32 v[126:127], v[126:127], v[134:135]
    v_mfma_f32_16x16x32_bf16 v[160:163], a[80:83], v[208:211], v[160:163]
    v_pk_add_f32 v[104:105], v[104:105], v[120:121]
    v_pk_add_f32 v[106:107], v[106:107], v[122:123]
    v_mfma_f32_16x16x32_bf16 v[164:167], a[112:115], v[208:211], v[164:167]
    v_pk_add_f32 v[108:109], v[108:109], v[124:125]
    v_pk_add_f32 v[110:111], v[110:111], v[126:127]
    v_mfma_f32_16x16x32_bf16 v[168:171], v[208:211], a[144:147], v[168:171]
    v_cvt_pk_bf16_f32 v140, v104, v105
    v_cvt_pk_bf16_f32 v141, v106, v107
    v_mfma_f32_16x16x32_bf16 v[172:175], v[208:211], a[176:179], v[172:175]
    v_cvt_pk_bf16_f32 v142, v108, v109
    v_cvt_pk_bf16_f32 v143, v110, v111
    v_mfma_f32_16x16x32_bf16 v[160:163], a[84:87], v[212:215], v[160:163]
    v_mfma_f32_16x16x32_bf16 v[164:167], a[116:119], v[212:215], v[164:167]
    v_mfma_f32_16x16x32_bf16 v[168:171], v[212:215], a[148:151], v[168:171]
    buffer_store_dwordx4 v[140:143], v3, s[8:11], s42 offen sc1
    s_add_u32 s42, s42, 0x40000
    v_mfma_f32_16x16x32_bf16 v[172:175], v[212:215], a[180:183], v[172:175]
    ds_read_b64_tr_b16 a[192:193], v147 offset:0
    v_mfma_f32_16x16x32_bf16 v[160:163], a[88:91], v[216:219], v[160:163]
    ds_read_b64_tr_b16 a[194:195], v147 offset:128
    v_mfma_f32_16x16x32_bf16 v[164:167], a[120:123], v[216:219], v[164:167]
    ds_read_b64_tr_b16 a[224:225], v147 offset:32
    v_mfma_f32_16x16x32_bf16 v[168:171], v[216:219], a[152:155], v[168:171]
    ds_read_b64_tr_b16 a[226:227], v147 offset:160
    v_mfma_f32_16x16x32_bf16 v[172:175], v[216:219], a[184:187], v[172:175]
    ds_read_b64_tr_b16 a[196:197], v147 offset:2048
    v_mfma_f32_16x16x32_bf16 v[160:163], a[92:95], v[220:223], v[160:163]
    ds_read_b64_tr_b16 a[198:199], v147 offset:2176
    v_mfma_f32_16x16x32_bf16 v[164:167], a[124:127], v[220:223], v[164:167]
    ds_read_b64_tr_b16 a[228:229], v147 offset:2080
    v_mfma_f32_16x16x32_bf16 v[168:171], v[220:223], a[156:159], v[168:171]
    ds_read_b64_tr_b16 a[230:231], v147 offset:2208
    v_mfma_f32_16x16x32_bf16 v[172:175], v[220:223], a[188:191], v[172:175]
    ds_read_b64_tr_b16 a[200:201], v147 offset:4096
    v_mfma_f32_16x16x32_bf16 v[176:179], a[64:67], v[224:227], 0
    ds_read_b64_tr_b16 a[202:203], v147 offset:4224
    v_mfma_f32_16x16x32_bf16 v[180:183], a[96:99], v[224:227], 0
    ds_read_b64_tr_b16 a[232:233], v147 offset:4128
    buffer_load_dwordx4 v[192:195], v5, s[76:79], s40 offen offset:0
    v_mfma_f32_16x16x32_bf16 v[184:187], v[224:227], a[128:131], 0
    ds_read_b64_tr_b16 a[234:235], v147 offset:4256
    v_mfma_f32_16x16x32_bf16 v[188:191], v[224:227], a[160:163], 0
    ds_read_b64_tr_b16 a[204:205], v147 offset:6144
    buffer_load_dwordx4 v[196:199], v5, s[76:79], s40 offen offset:1024
    v_mfma_f32_16x16x32_bf16 v[176:179], a[68:71], v[228:231], v[176:179]
    ds_read_b64_tr_b16 a[206:207], v147 offset:6272
    v_mfma_f32_16x16x32_bf16 v[180:183], a[100:103], v[228:231], v[180:183]
    ds_read_b64_tr_b16 a[236:237], v147 offset:6176
    buffer_load_dwordx4 v[200:203], v5, s[76:79], s40 offen offset:2048
    v_mfma_f32_16x16x32_bf16 v[184:187], v[228:231], a[132:135], v[184:187]
    ds_read_b64_tr_b16 a[238:239], v147 offset:6304
    v_mfma_f32_16x16x32_bf16 v[188:191], v[228:231], a[164:167], v[188:191]
    buffer_load_dwordx4 v[204:207], v5, s[76:79], s40 offen offset:3072
    v_mfma_f32_16x16x32_bf16 v[176:179], a[72:75], v[232:235], v[176:179]
    ds_write_b128 v18, v[160:163] offset:0
    ds_write_b128 v18, v[164:167] offset:1024
    ds_write_b128 v18, v[168:171] offset:2048
    ds_write_b128 v18, v[172:175] offset:3072
    v_mfma_f32_16x16x32_bf16 v[180:183], a[104:107], v[232:235], v[180:183]
    buffer_load_dwordx4 v[208:211], v0, s[76:79], s40 offen offset:0
    v_mfma_f32_16x16x32_bf16 v[184:187], v[232:235], a[136:139], v[184:187]
    v_mfma_f32_16x16x32_bf16 v[188:191], v[232:235], a[168:171], v[188:191]
    buffer_load_dwordx4 v[212:215], v0, s[76:79], s40 offen offset:1024
    v_mfma_f32_16x16x32_bf16 v[176:179], a[76:79], v[236:239], v[176:179]
    v_mfma_f32_16x16x32_bf16 v[180:183], a[108:111], v[236:239], v[180:183]
    buffer_load_dwordx4 v[216:219], v0, s[76:79], s40 offen offset:2048
    v_mfma_f32_16x16x32_bf16 v[184:187], v[236:239], a[140:143], v[184:187]
    v_mfma_f32_16x16x32_bf16 v[188:191], v[236:239], a[172:175], v[188:191]
    buffer_load_dwordx4 v[220:223], v0, s[76:79], s40 offen offset:3072
    v_mfma_f32_16x16x32_bf16 v[176:179], a[80:83], v[240:243], v[176:179]
    v_mfma_f32_16x16x32_bf16 v[180:183], a[112:115], v[240:243], v[180:183]
    v_mfma_f32_16x16x32_bf16 v[184:187], v[240:243], a[144:147], v[184:187]
    v_mfma_f32_16x16x32_bf16 v[188:191], v[240:243], a[176:179], v[188:191]
    v_mfma_f32_16x16x32_bf16 v[176:179], a[84:87], v[244:247], v[176:179]
    v_mfma_f32_16x16x32_bf16 v[180:183], a[116:119], v[244:247], v[180:183]
    v_mfma_f32_16x16x32_bf16 v[184:187], v[244:247], a[148:151], v[184:187]
    v_mfma_f32_16x16x32_bf16 v[188:191], v[244:247], a[180:183], v[188:191]
    v_mfma_f32_16x16x32_bf16 v[176:179], a[88:91], v[248:251], v[176:179]
    v_mfma_f32_16x16x32_bf16 v[180:183], a[120:123], v[248:251], v[180:183]
    v_mfma_f32_16x16x32_bf16 v[184:187], v[248:251], a[152:155], v[184:187]
    v_mfma_f32_16x16x32_bf16 v[188:191], v[248:251], a[184:187], v[188:191]
    v_mfma_f32_16x16x32_bf16 v[176:179], a[92:95], v[252:255], v[176:179]
    v_mfma_f32_16x16x32_bf16 v[180:183], a[124:127], v[252:255], v[180:183]
    v_mfma_f32_16x16x32_bf16 v[184:187], v[252:255], a[156:159], v[184:187]
    v_mfma_f32_16x16x32_bf16 v[188:191], v[252:255], a[188:191], v[188:191]
    buffer_load_dwordx4 v[224:227], v5, s[76:79], s41 offen offset:0
    buffer_load_dwordx4 v[228:231], v5, s[76:79], s41 offen offset:1024
    buffer_load_dwordx4 v[232:235], v5, s[76:79], s41 offen offset:2048
    buffer_load_dwordx4 v[236:239], v5, s[76:79], s41 offen offset:3072
    buffer_load_dwordx4 v[240:243], v0, s[76:79], s41 offen offset:0
    buffer_load_dwordx4 v[244:247], v0, s[76:79], s41 offen offset:1024
    buffer_load_dwordx4 v[248:251], v0, s[76:79], s41 offen offset:2048
    buffer_load_dwordx4 v[252:255], v0, s[76:79], s41 offen offset:3072
    s_add_u32 s40, s40, 0x10000
    s_add_u32 s41, s41, 0x10000
    ds_write_b128 v18, v[176:179] offset:4096
    ds_write_b128 v18, v[180:183] offset:5120
    ds_write_b128 v18, v[184:187] offset:6144
    ds_write_b128 v18, v[188:191] offset:7168
    s_waitcnt lgkmcnt(0)
    s_barrier
    s_waitcnt vmcnt(17)
    v_mfma_f32_16x16x32_bf16 v[160:163], a[64:67], v[40:43], 0
    ds_read_b128 v[104:107], v136 offset:0
    v_xor_b32 v145, 64, v145
    s_add_u32 m0, s70, 0x14000
    s_mov_b32 s71, 0x0
    buffer_load_dwordx4 v145, s[12:15], s71 offen lds
    v_mfma_f32_16x16x32_bf16 v[164:167], a[96:99], v[40:43], 0
    ds_read_b128 v[108:111], v137 offset:0
    s_add_u32 m0, s70, 0x14400
    s_mov_b32 s71, 0x8000
    buffer_load_dwordx4 v145, s[12:15], s71 offen lds
    v_mfma_f32_16x16x32_bf16 v[168:171], v[40:43], a[128:131], 0
    ds_read_b128 v[112:115], v136 offset:8192
    s_add_u32 m0, s70, 0x14800
    s_mov_b32 s71, 0x10000
    buffer_load_dwordx4 v145, s[12:15], s71 offen lds
    v_mfma_f32_16x16x32_bf16 v[172:175], v[40:43], a[160:163], 0
    ds_read_b128 v[116:119], v137 offset:8192
    s_add_u32 m0, s70, 0x14c00
    s_mov_b32 s71, 0x18000
    buffer_load_dwordx4 v145, s[12:15], s71 offen lds
    v_mfma_f32_16x16x32_bf16 v[160:163], a[68:71], v[44:47], v[160:163]
    ds_read_b128 v[120:123], v136 offset:16384
    s_add_u32 m0, s70, 0x15000
    s_mov_b32 s71, 0x20000
    buffer_load_dwordx4 v145, s[12:15], s71 offen lds
    v_mfma_f32_16x16x32_bf16 v[164:167], a[100:103], v[44:47], v[164:167]
    ds_read_b128 v[124:127], v137 offset:16384
    s_add_u32 m0, s70, 0x15400
    s_mov_b32 s71, 0x28000
    buffer_load_dwordx4 v145, s[12:15], s71 offen lds
    v_mfma_f32_16x16x32_bf16 v[168:171], v[44:47], a[132:135], v[168:171]
    ds_read_b128 v[128:131], v136 offset:24576
    s_add_u32 m0, s70, 0x15800
    s_mov_b32 s71, 0x30000
    buffer_load_dwordx4 v145, s[12:15], s71 offen lds
    v_mfma_f32_16x16x32_bf16 v[172:175], v[44:47], a[164:167], v[172:175]
    ds_read_b128 v[132:135], v137 offset:24576
    s_add_u32 m0, s70, 0x15c00
    s_mov_b32 s71, 0x38000
    buffer_load_dwordx4 v145, s[12:15], s71 offen lds
    v_mfma_f32_16x16x32_bf16 v[160:163], a[72:75], v[48:51], v[160:163]
    v_mfma_f32_16x16x32_bf16 v[164:167], a[104:107], v[48:51], v[164:167]
    v_mfma_f32_16x16x32_bf16 v[168:171], v[48:51], a[136:139], v[168:171]
    v_mfma_f32_16x16x32_bf16 v[172:175], v[48:51], a[168:171], v[172:175]
    s_waitcnt lgkmcnt(0)
    v_mfma_f32_16x16x32_bf16 v[160:163], a[76:79], v[52:55], v[160:163]
    v_pk_add_f32 v[104:105], v[104:105], v[112:113]
    v_pk_add_f32 v[106:107], v[106:107], v[114:115]
    v_mfma_f32_16x16x32_bf16 v[164:167], a[108:111], v[52:55], v[164:167]
    v_pk_add_f32 v[108:109], v[108:109], v[116:117]
    v_pk_add_f32 v[110:111], v[110:111], v[118:119]
    v_mfma_f32_16x16x32_bf16 v[168:171], v[52:55], a[140:143], v[168:171]
    v_pk_add_f32 v[120:121], v[120:121], v[128:129]
    v_pk_add_f32 v[122:123], v[122:123], v[130:131]
    v_mfma_f32_16x16x32_bf16 v[172:175], v[52:55], a[172:175], v[172:175]
    v_pk_add_f32 v[124:125], v[124:125], v[132:133]
    v_pk_add_f32 v[126:127], v[126:127], v[134:135]
    v_mfma_f32_16x16x32_bf16 v[160:163], a[80:83], v[56:59], v[160:163]
    v_pk_add_f32 v[104:105], v[104:105], v[120:121]
    v_pk_add_f32 v[106:107], v[106:107], v[122:123]
    v_mfma_f32_16x16x32_bf16 v[164:167], a[112:115], v[56:59], v[164:167]
    v_pk_add_f32 v[108:109], v[108:109], v[124:125]
    v_pk_add_f32 v[110:111], v[110:111], v[126:127]
    v_mfma_f32_16x16x32_bf16 v[168:171], v[56:59], a[144:147], v[168:171]
    v_cvt_pk_bf16_f32 v140, v104, v105
    v_cvt_pk_bf16_f32 v141, v106, v107
    v_mfma_f32_16x16x32_bf16 v[172:175], v[56:59], a[176:179], v[172:175]
    v_cvt_pk_bf16_f32 v142, v108, v109
    v_cvt_pk_bf16_f32 v143, v110, v111
    v_mfma_f32_16x16x32_bf16 v[160:163], a[84:87], v[60:63], v[160:163]
    v_mfma_f32_16x16x32_bf16 v[164:167], a[116:119], v[60:63], v[164:167]
    v_mfma_f32_16x16x32_bf16 v[168:171], v[60:63], a[148:151], v[168:171]
    buffer_store_dwordx4 v[140:143], v3, s[8:11], s42 offen sc1
    s_add_u32 s42, s42, 0x40000
    v_mfma_f32_16x16x32_bf16 v[172:175], v[60:63], a[180:183], v[172:175]
    ds_read_b64_tr_b16 a[208:209], v147 offset:8192
    v_mfma_f32_16x16x32_bf16 v[160:163], a[88:91], v[64:67], v[160:163]
    ds_read_b64_tr_b16 a[210:211], v147 offset:8320
    v_mfma_f32_16x16x32_bf16 v[164:167], a[120:123], v[64:67], v[164:167]
    ds_read_b64_tr_b16 a[240:241], v147 offset:8224
    v_mfma_f32_16x16x32_bf16 v[168:171], v[64:67], a[152:155], v[168:171]
    ds_read_b64_tr_b16 a[242:243], v147 offset:8352
    v_mfma_f32_16x16x32_bf16 v[172:175], v[64:67], a[184:187], v[172:175]
    ds_read_b64_tr_b16 a[212:213], v147 offset:10240
    v_mfma_f32_16x16x32_bf16 v[160:163], a[92:95], v[68:71], v[160:163]
    ds_read_b64_tr_b16 a[214:215], v147 offset:10368
    v_mfma_f32_16x16x32_bf16 v[164:167], a[124:127], v[68:71], v[164:167]
    ds_read_b64_tr_b16 a[244:245], v147 offset:10272
    v_mfma_f32_16x16x32_bf16 v[168:171], v[68:71], a[156:159], v[168:171]
    ds_read_b64_tr_b16 a[246:247], v147 offset:10400
    v_mfma_f32_16x16x32_bf16 v[172:175], v[68:71], a[188:191], v[172:175]
    ds_read_b64_tr_b16 a[216:217], v147 offset:12288
    v_mfma_f32_16x16x32_bf16 v[176:179], a[64:67], v[72:75], 0
    ds_read_b64_tr_b16 a[218:219], v147 offset:12416
    v_mfma_f32_16x16x32_bf16 v[180:183], a[96:99], v[72:75], 0
    ds_read_b64_tr_b16 a[248:249], v147 offset:12320
    buffer_load_dwordx4 v[40:43], v5, s[76:79], s40 offen offset:0
    v_mfma_f32_16x16x32_bf16 v[184:187], v[72:75], a[128:131], 0
    ds_read_b64_tr_b16 a[250:251], v147 offset:12448
    v_mfma_f32_16x16x32_bf16 v[188:191], v[72:75], a[160:163], 0
    ds_read_b64_tr_b16 a[220:221], v147 offset:14336
    buffer_load_dwordx4 v[44:47], v5, s[76:79], s40 offen offset:1024
    v_mfma_f32_16x16x32_bf16 v[176:179], a[68:71], v[76:79], v[176:179]
    ds_read_b64_tr_b16 a[222:223], v147 offset:14464
    v_mfma_f32_16x16x32_bf16 v[180:183], a[100:103], v[76:79], v[180:183]
    ds_read_b64_tr_b16 a[252:253], v147 offset:14368
    buffer_load_dwordx4 v[48:51], v5, s[76:79], s40 offen offset:2048
    v_mfma_f32_16x16x32_bf16 v[184:187], v[76:79], a[132:135], v[184:187]
    ds_read_b64_tr_b16 a[254:255], v147 offset:14496
    v_mfma_f32_16x16x32_bf16 v[188:191], v[76:79], a[164:167], v[188:191]
    buffer_load_dwordx4 v[52:55], v5, s[76:79], s40 offen offset:3072
    v_mfma_f32_16x16x32_bf16 v[176:179], a[72:75], v[80:83], v[176:179]
    ds_write_b128 v18, v[160:163] offset:32768
    ds_write_b128 v18, v[164:167] offset:33792
    ds_write_b128 v18, v[168:171] offset:34816
    ds_write_b128 v18, v[172:175] offset:35840
    v_mfma_f32_16x16x32_bf16 v[180:183], a[104:107], v[80:83], v[180:183]
    buffer_load_dwordx4 v[56:59], v0, s[76:79], s40 offen offset:0
    v_mfma_f32_16x16x32_bf16 v[184:187], v[80:83], a[136:139], v[184:187]
    v_mfma_f32_16x16x32_bf16 v[188:191], v[80:83], a[168:171], v[188:191]
    buffer_load_dwordx4 v[60:63], v0, s[76:79], s40 offen offset:1024
    v_mfma_f32_16x16x32_bf16 v[176:179], a[76:79], v[84:87], v[176:179]
    v_mfma_f32_16x16x32_bf16 v[180:183], a[108:111], v[84:87], v[180:183]
    buffer_load_dwordx4 v[64:67], v0, s[76:79], s40 offen offset:2048
    v_mfma_f32_16x16x32_bf16 v[184:187], v[84:87], a[140:143], v[184:187]
    v_mfma_f32_16x16x32_bf16 v[188:191], v[84:87], a[172:175], v[188:191]
    buffer_load_dwordx4 v[68:71], v0, s[76:79], s40 offen offset:3072
    v_mfma_f32_16x16x32_bf16 v[176:179], a[80:83], v[88:91], v[176:179]
    v_mfma_f32_16x16x32_bf16 v[180:183], a[112:115], v[88:91], v[180:183]
    v_mfma_f32_16x16x32_bf16 v[184:187], v[88:91], a[144:147], v[184:187]
    v_mfma_f32_16x16x32_bf16 v[188:191], v[88:91], a[176:179], v[188:191]
    v_mfma_f32_16x16x32_bf16 v[176:179], a[84:87], v[92:95], v[176:179]
    v_mfma_f32_16x16x32_bf16 v[180:183], a[116:119], v[92:95], v[180:183]
    v_mfma_f32_16x16x32_bf16 v[184:187], v[92:95], a[148:151], v[184:187]
    v_mfma_f32_16x16x32_bf16 v[188:191], v[92:95], a[180:183], v[188:191]
    v_mfma_f32_16x16x32_bf16 v[176:179], a[88:91], v[96:99], v[176:179]
    v_mfma_f32_16x16x32_bf16 v[180:183], a[120:123], v[96:99], v[180:183]
    v_mfma_f32_16x16x32_bf16 v[184:187], v[96:99], a[152:155], v[184:187]
    v_mfma_f32_16x16x32_bf16 v[188:191], v[96:99], a[184:187], v[188:191]
    v_mfma_f32_16x16x32_bf16 v[176:179], a[92:95], v[100:103], v[176:179]
    v_mfma_f32_16x16x32_bf16 v[180:183], a[124:127], v[100:103], v[180:183]
    v_mfma_f32_16x16x32_bf16 v[184:187], v[100:103], a[156:159], v[184:187]
    v_mfma_f32_16x16x32_bf16 v[188:191], v[100:103], a[188:191], v[188:191]
    buffer_load_dwordx4 v[72:75], v5, s[76:79], s41 offen offset:0
    buffer_load_dwordx4 v[76:79], v5, s[76:79], s41 offen offset:1024
    buffer_load_dwordx4 v[80:83], v5, s[76:79], s41 offen offset:2048
    buffer_load_dwordx4 v[84:87], v5, s[76:79], s41 offen offset:3072
    buffer_load_dwordx4 v[88:91], v0, s[76:79], s41 offen offset:0
    buffer_load_dwordx4 v[92:95], v0, s[76:79], s41 offen offset:1024
    buffer_load_dwordx4 v[96:99], v0, s[76:79], s41 offen offset:2048
    buffer_load_dwordx4 v[100:103], v0, s[76:79], s41 offen offset:3072
    s_add_u32 s40, s40, 0x10000
    s_add_u32 s41, s41, 0x10000
    ds_write_b128 v18, v[176:179] offset:36864
    ds_write_b128 v18, v[180:183] offset:37888
    ds_write_b128 v18, v[184:187] offset:38912
    ds_write_b128 v18, v[188:191] offset:39936
    s_waitcnt lgkmcnt(0)
    s_barrier
    s_waitcnt vmcnt(25)
    v_mfma_f32_16x16x32_bf16 v[160:163], a[64:67], v[192:195], 0
    ds_read_b128 v[104:107], v136 offset:32768
    s_add_u32 m0, s70, 0x16000
    s_mov_b32 s71, 0x40000
    buffer_load_dwordx4 v145, s[12:15], s71 offen lds
    v_mfma_f32_16x16x32_bf16 v[164:167], a[96:99], v[192:195], 0
    ds_read_b128 v[108:111], v137 offset:32768
    s_add_u32 m0, s70, 0x16400
    s_mov_b32 s71, 0x48000
    buffer_load_dwordx4 v145, s[12:15], s71 offen lds
    v_mfma_f32_16x16x32_bf16 v[168:171], v[192:195], a[128:131], 0
    ds_read_b128 v[112:115], v136 offset:40960
    s_add_u32 m0, s70, 0x16800
    s_mov_b32 s71, 0x50000
    buffer_load_dwordx4 v145, s[12:15], s71 offen lds
    v_mfma_f32_16x16x32_bf16 v[172:175], v[192:195], a[160:163], 0
    ds_read_b128 v[116:119], v137 offset:40960
    s_add_u32 m0, s70, 0x16c00
    s_mov_b32 s71, 0x58000
    buffer_load_dwordx4 v145, s[12:15], s71 offen lds
    v_mfma_f32_16x16x32_bf16 v[160:163], a[68:71], v[196:199], v[160:163]
    ds_read_b128 v[120:123], v136 offset:49152
    s_add_u32 m0, s70, 0x17000
    s_mov_b32 s71, 0x60000
    buffer_load_dwordx4 v145, s[12:15], s71 offen lds
    v_mfma_f32_16x16x32_bf16 v[164:167], a[100:103], v[196:199], v[164:167]
    ds_read_b128 v[124:127], v137 offset:49152
    s_add_u32 m0, s70, 0x17400
    s_mov_b32 s71, 0x68000
    buffer_load_dwordx4 v145, s[12:15], s71 offen lds
    v_mfma_f32_16x16x32_bf16 v[168:171], v[196:199], a[132:135], v[168:171]
    ds_read_b128 v[128:131], v136 offset:57344
    s_add_u32 m0, s70, 0x17800
    s_mov_b32 s71, 0x70000
    buffer_load_dwordx4 v145, s[12:15], s71 offen lds
    v_mfma_f32_16x16x32_bf16 v[172:175], v[196:199], a[164:167], v[172:175]
    ds_read_b128 v[132:135], v137 offset:57344
    s_add_u32 m0, s70, 0x17c00
    s_mov_b32 s71, 0x78000
    buffer_load_dwordx4 v145, s[12:15], s71 offen lds
    v_mfma_f32_16x16x32_bf16 v[160:163], a[72:75], v[200:203], v[160:163]
    v_mfma_f32_16x16x32_bf16 v[164:167], a[104:107], v[200:203], v[164:167]
    v_mfma_f32_16x16x32_bf16 v[168:171], v[200:203], a[136:139], v[168:171]
    v_mfma_f32_16x16x32_bf16 v[172:175], v[200:203], a[168:171], v[172:175]
    s_waitcnt lgkmcnt(0)
    v_mfma_f32_16x16x32_bf16 v[160:163], a[76:79], v[204:207], v[160:163]
    v_pk_add_f32 v[104:105], v[104:105], v[112:113]
    v_pk_add_f32 v[106:107], v[106:107], v[114:115]
    v_mfma_f32_16x16x32_bf16 v[164:167], a[108:111], v[204:207], v[164:167]
    v_pk_add_f32 v[108:109], v[108:109], v[116:117]
    v_pk_add_f32 v[110:111], v[110:111], v[118:119]
    v_mfma_f32_16x16x32_bf16 v[168:171], v[204:207], a[140:143], v[168:171]
    v_pk_add_f32 v[120:121], v[120:121], v[128:129]
    v_pk_add_f32 v[122:123], v[122:123], v[130:131]
    v_mfma_f32_16x16x32_bf16 v[172:175], v[204:207], a[172:175], v[172:175]
    v_pk_add_f32 v[124:125], v[124:125], v[132:133]
    v_pk_add_f32 v[126:127], v[126:127], v[134:135]
    v_mfma_f32_16x16x32_bf16 v[160:163], a[80:83], v[208:211], v[160:163]
    v_pk_add_f32 v[104:105], v[104:105], v[120:121]
    v_pk_add_f32 v[106:107], v[106:107], v[122:123]
    v_mfma_f32_16x16x32_bf16 v[164:167], a[112:115], v[208:211], v[164:167]
    v_pk_add_f32 v[108:109], v[108:109], v[124:125]
    v_pk_add_f32 v[110:111], v[110:111], v[126:127]
    v_mfma_f32_16x16x32_bf16 v[168:171], v[208:211], a[144:147], v[168:171]
    v_cvt_pk_bf16_f32 v140, v104, v105
    v_cvt_pk_bf16_f32 v141, v106, v107
    v_mfma_f32_16x16x32_bf16 v[172:175], v[208:211], a[176:179], v[172:175]
    v_cvt_pk_bf16_f32 v142, v108, v109
    v_cvt_pk_bf16_f32 v143, v110, v111
    v_mfma_f32_16x16x32_bf16 v[160:163], a[84:87], v[212:215], v[160:163]
    v_mfma_f32_16x16x32_bf16 v[164:167], a[116:119], v[212:215], v[164:167]
    v_mfma_f32_16x16x32_bf16 v[168:171], v[212:215], a[148:151], v[168:171]
    buffer_store_dwordx4 v[140:143], v3, s[8:11], s42 offen sc1
    s_add_u32 s42, s42, 0x40000
    v_mfma_f32_16x16x32_bf16 v[172:175], v[212:215], a[180:183], v[172:175]
    v_mfma_f32_16x16x32_bf16 v[160:163], a[88:91], v[216:219], v[160:163]
    v_mfma_f32_16x16x32_bf16 v[164:167], a[120:123], v[216:219], v[164:167]
    v_mfma_f32_16x16x32_bf16 v[168:171], v[216:219], a[152:155], v[168:171]
    v_mfma_f32_16x16x32_bf16 v[172:175], v[216:219], a[184:187], v[172:175]
    v_mfma_f32_16x16x32_bf16 v[160:163], a[92:95], v[220:223], v[160:163]
    v_mfma_f32_16x16x32_bf16 v[164:167], a[124:127], v[220:223], v[164:167]
    v_mfma_f32_16x16x32_bf16 v[168:171], v[220:223], a[156:159], v[168:171]
    v_mfma_f32_16x16x32_bf16 v[172:175], v[220:223], a[188:191], v[172:175]
    v_mfma_f32_16x16x32_bf16 v[176:179], a[64:67], v[224:227], 0
    v_mfma_f32_16x16x32_bf16 v[180:183], a[96:99], v[224:227], 0
    buffer_load_dwordx4 v[192:195], v5, s[76:79], s40 offen offset:0
    v_mfma_f32_16x16x32_bf16 v[184:187], v[224:227], a[128:131], 0
    v_mfma_f32_16x16x32_bf16 v[188:191], v[224:227], a[160:163], 0
    buffer_load_dwordx4 v[196:199], v5, s[76:79], s40 offen offset:1024
    v_mfma_f32_16x16x32_bf16 v[176:179], a[68:71], v[228:231], v[176:179]
    v_mfma_f32_16x16x32_bf16 v[180:183], a[100:103], v[228:231], v[180:183]
    buffer_load_dwordx4 v[200:203], v5, s[76:79], s40 offen offset:2048
    v_mfma_f32_16x16x32_bf16 v[184:187], v[228:231], a[132:135], v[184:187]
    v_mfma_f32_16x16x32_bf16 v[188:191], v[228:231], a[164:167], v[188:191]
    buffer_load_dwordx4 v[204:207], v5, s[76:79], s40 offen offset:3072
    v_mfma_f32_16x16x32_bf16 v[176:179], a[72:75], v[232:235], v[176:179]
    ds_write_b128 v18, v[160:163] offset:0
    ds_write_b128 v18, v[164:167] offset:1024
    ds_write_b128 v18, v[168:171] offset:2048
    ds_write_b128 v18, v[172:175] offset:3072
    v_mfma_f32_16x16x32_bf16 v[180:183], a[104:107], v[232:235], v[180:183]
    buffer_load_dwordx4 v[208:211], v0, s[76:79], s40 offen offset:0
    v_mfma_f32_16x16x32_bf16 v[184:187], v[232:235], a[136:139], v[184:187]
    v_mfma_f32_16x16x32_bf16 v[188:191], v[232:235], a[168:171], v[188:191]
    buffer_load_dwordx4 v[212:215], v0, s[76:79], s40 offen offset:1024
    v_mfma_f32_16x16x32_bf16 v[176:179], a[76:79], v[236:239], v[176:179]
    v_mfma_f32_16x16x32_bf16 v[180:183], a[108:111], v[236:239], v[180:183]
    buffer_load_dwordx4 v[216:219], v0, s[76:79], s40 offen offset:2048
    v_mfma_f32_16x16x32_bf16 v[184:187], v[236:239], a[140:143], v[184:187]
    v_mfma_f32_16x16x32_bf16 v[188:191], v[236:239], a[172:175], v[188:191]
    buffer_load_dwordx4 v[220:223], v0, s[76:79], s40 offen offset:3072
    v_mfma_f32_16x16x32_bf16 v[176:179], a[80:83], v[240:243], v[176:179]
    v_mfma_f32_16x16x32_bf16 v[180:183], a[112:115], v[240:243], v[180:183]
    v_mfma_f32_16x16x32_bf16 v[184:187], v[240:243], a[144:147], v[184:187]
    v_mfma_f32_16x16x32_bf16 v[188:191], v[240:243], a[176:179], v[188:191]
    v_mfma_f32_16x16x32_bf16 v[176:179], a[84:87], v[244:247], v[176:179]
    v_mfma_f32_16x16x32_bf16 v[180:183], a[116:119], v[244:247], v[180:183]
    v_mfma_f32_16x16x32_bf16 v[184:187], v[244:247], a[148:151], v[184:187]
    v_mfma_f32_16x16x32_bf16 v[188:191], v[244:247], a[180:183], v[188:191]
    v_mfma_f32_16x16x32_bf16 v[176:179], a[88:91], v[248:251], v[176:179]
    v_mfma_f32_16x16x32_bf16 v[180:183], a[120:123], v[248:251], v[180:183]
    v_mfma_f32_16x16x32_bf16 v[184:187], v[248:251], a[152:155], v[184:187]
    v_mfma_f32_16x16x32_bf16 v[188:191], v[248:251], a[184:187], v[188:191]
    v_mfma_f32_16x16x32_bf16 v[176:179], a[92:95], v[252:255], v[176:179]
    v_mfma_f32_16x16x32_bf16 v[180:183], a[124:127], v[252:255], v[180:183]
    v_mfma_f32_16x16x32_bf16 v[184:187], v[252:255], a[156:159], v[184:187]
    v_mfma_f32_16x16x32_bf16 v[188:191], v[252:255], a[188:191], v[188:191]
    buffer_load_dwordx4 v[224:227], v5, s[76:79], s41 offen offset:0
    buffer_load_dwordx4 v[228:231], v5, s[76:79], s41 offen offset:1024
    buffer_load_dwordx4 v[232:235], v5, s[76:79], s41 offen offset:2048
    buffer_load_dwordx4 v[236:239], v5, s[76:79], s41 offen offset:3072
    buffer_load_dwordx4 v[240:243], v0, s[76:79], s41 offen offset:0
    buffer_load_dwordx4 v[244:247], v0, s[76:79], s41 offen offset:1024
    buffer_load_dwordx4 v[248:251], v0, s[76:79], s41 offen offset:2048
    buffer_load_dwordx4 v[252:255], v0, s[76:79], s41 offen offset:3072
    s_add_u32 s40, s40, 0x10000
    s_add_u32 s41, s41, 0x10000
    ds_write_b128 v18, v[176:179] offset:4096
    ds_write_b128 v18, v[180:183] offset:5120
    ds_write_b128 v18, v[184:187] offset:6144
    ds_write_b128 v18, v[188:191] offset:7168
    s_waitcnt lgkmcnt(0)
    s_barrier
    s_waitcnt vmcnt(25)
    v_mfma_f32_16x16x32_bf16 v[160:163], a[64:67], v[40:43], 0
    ds_read_b128 v[104:107], v136 offset:0
    v_mfma_f32_16x16x32_bf16 v[164:167], a[96:99], v[40:43], 0
    ds_read_b128 v[108:111], v137 offset:0
    v_mfma_f32_16x16x32_bf16 v[168:171], v[40:43], a[128:131], 0
    ds_read_b128 v[112:115], v136 offset:8192
    v_mfma_f32_16x16x32_bf16 v[172:175], v[40:43], a[160:163], 0
    ds_read_b128 v[116:119], v137 offset:8192
    v_mfma_f32_16x16x32_bf16 v[160:163], a[68:71], v[44:47], v[160:163]
    ds_read_b128 v[120:123], v136 offset:16384
    v_mfma_f32_16x16x32_bf16 v[164:167], a[100:103], v[44:47], v[164:167]
    ds_read_b128 v[124:127], v137 offset:16384
    v_mfma_f32_16x16x32_bf16 v[168:171], v[44:47], a[132:135], v[168:171]
    ds_read_b128 v[128:131], v136 offset:24576
    v_mfma_f32_16x16x32_bf16 v[172:175], v[44:47], a[164:167], v[172:175]
    ds_read_b128 v[132:135], v137 offset:24576
    v_mfma_f32_16x16x32_bf16 v[160:163], a[72:75], v[48:51], v[160:163]
    v_mfma_f32_16x16x32_bf16 v[164:167], a[104:107], v[48:51], v[164:167]
    v_mfma_f32_16x16x32_bf16 v[168:171], v[48:51], a[136:139], v[168:171]
    v_mfma_f32_16x16x32_bf16 v[172:175], v[48:51], a[168:171], v[172:175]
    s_waitcnt lgkmcnt(0)
    v_mfma_f32_16x16x32_bf16 v[160:163], a[76:79], v[52:55], v[160:163]
    v_pk_add_f32 v[104:105], v[104:105], v[112:113]
    v_pk_add_f32 v[106:107], v[106:107], v[114:115]
    v_mfma_f32_16x16x32_bf16 v[164:167], a[108:111], v[52:55], v[164:167]
    v_pk_add_f32 v[108:109], v[108:109], v[116:117]
    v_pk_add_f32 v[110:111], v[110:111], v[118:119]
    v_mfma_f32_16x16x32_bf16 v[168:171], v[52:55], a[140:143], v[168:171]
    v_pk_add_f32 v[120:121], v[120:121], v[128:129]
    v_pk_add_f32 v[122:123], v[122:123], v[130:131]
    v_mfma_f32_16x16x32_bf16 v[172:175], v[52:55], a[172:175], v[172:175]
    v_pk_add_f32 v[124:125], v[124:125], v[132:133]
    v_pk_add_f32 v[126:127], v[126:127], v[134:135]
    v_mfma_f32_16x16x32_bf16 v[160:163], a[80:83], v[56:59], v[160:163]
    v_pk_add_f32 v[104:105], v[104:105], v[120:121]
    v_pk_add_f32 v[106:107], v[106:107], v[122:123]
    v_mfma_f32_16x16x32_bf16 v[164:167], a[112:115], v[56:59], v[164:167]
    v_pk_add_f32 v[108:109], v[108:109], v[124:125]
    v_pk_add_f32 v[110:111], v[110:111], v[126:127]
    v_mfma_f32_16x16x32_bf16 v[168:171], v[56:59], a[144:147], v[168:171]
    v_cvt_pk_bf16_f32 v140, v104, v105
    v_cvt_pk_bf16_f32 v141, v106, v107
    v_mfma_f32_16x16x32_bf16 v[172:175], v[56:59], a[176:179], v[172:175]
    v_cvt_pk_bf16_f32 v142, v108, v109
    v_cvt_pk_bf16_f32 v143, v110, v111
    v_mfma_f32_16x16x32_bf16 v[160:163], a[84:87], v[60:63], v[160:163]
    v_mfma_f32_16x16x32_bf16 v[164:167], a[116:119], v[60:63], v[164:167]
    v_mfma_f32_16x16x32_bf16 v[168:171], v[60:63], a[148:151], v[168:171]
    buffer_store_dwordx4 v[140:143], v3, s[8:11], s42 offen sc1
    s_add_u32 s42, s42, 0x40000
    v_mfma_f32_16x16x32_bf16 v[172:175], v[60:63], a[180:183], v[172:175]
    v_mfma_f32_16x16x32_bf16 v[160:163], a[88:91], v[64:67], v[160:163]
    v_mfma_f32_16x16x32_bf16 v[164:167], a[120:123], v[64:67], v[164:167]
    v_mfma_f32_16x16x32_bf16 v[168:171], v[64:67], a[152:155], v[168:171]
    v_mfma_f32_16x16x32_bf16 v[172:175], v[64:67], a[184:187], v[172:175]
    v_mfma_f32_16x16x32_bf16 v[160:163], a[92:95], v[68:71], v[160:163]
    v_mfma_f32_16x16x32_bf16 v[164:167], a[124:127], v[68:71], v[164:167]
    v_mfma_f32_16x16x32_bf16 v[168:171], v[68:71], a[156:159], v[168:171]
    v_mfma_f32_16x16x32_bf16 v[172:175], v[68:71], a[188:191], v[172:175]
    v_mfma_f32_16x16x32_bf16 v[176:179], a[64:67], v[72:75], 0
    v_mfma_f32_16x16x32_bf16 v[180:183], a[96:99], v[72:75], 0
    buffer_load_dwordx4 v[40:43], v5, s[76:79], s40 offen offset:0
    v_mfma_f32_16x16x32_bf16 v[184:187], v[72:75], a[128:131], 0
    v_mfma_f32_16x16x32_bf16 v[188:191], v[72:75], a[160:163], 0
    buffer_load_dwordx4 v[44:47], v5, s[76:79], s40 offen offset:1024
    v_mfma_f32_16x16x32_bf16 v[176:179], a[68:71], v[76:79], v[176:179]
    v_mfma_f32_16x16x32_bf16 v[180:183], a[100:103], v[76:79], v[180:183]
    buffer_load_dwordx4 v[48:51], v5, s[76:79], s40 offen offset:2048
    v_mfma_f32_16x16x32_bf16 v[184:187], v[76:79], a[132:135], v[184:187]
    v_mfma_f32_16x16x32_bf16 v[188:191], v[76:79], a[164:167], v[188:191]
    buffer_load_dwordx4 v[52:55], v5, s[76:79], s40 offen offset:3072
    v_mfma_f32_16x16x32_bf16 v[176:179], a[72:75], v[80:83], v[176:179]
    ds_write_b128 v18, v[160:163] offset:32768
    ds_write_b128 v18, v[164:167] offset:33792
    ds_write_b128 v18, v[168:171] offset:34816
    ds_write_b128 v18, v[172:175] offset:35840
    v_mfma_f32_16x16x32_bf16 v[180:183], a[104:107], v[80:83], v[180:183]
    buffer_load_dwordx4 v[56:59], v0, s[76:79], s40 offen offset:0
    v_mfma_f32_16x16x32_bf16 v[184:187], v[80:83], a[136:139], v[184:187]
    v_mfma_f32_16x16x32_bf16 v[188:191], v[80:83], a[168:171], v[188:191]
    buffer_load_dwordx4 v[60:63], v0, s[76:79], s40 offen offset:1024
    v_mfma_f32_16x16x32_bf16 v[176:179], a[76:79], v[84:87], v[176:179]
    v_mfma_f32_16x16x32_bf16 v[180:183], a[108:111], v[84:87], v[180:183]
    buffer_load_dwordx4 v[64:67], v0, s[76:79], s40 offen offset:2048
    v_mfma_f32_16x16x32_bf16 v[184:187], v[84:87], a[140:143], v[184:187]
    v_mfma_f32_16x16x32_bf16 v[188:191], v[84:87], a[172:175], v[188:191]
    buffer_load_dwordx4 v[68:71], v0, s[76:79], s40 offen offset:3072
    v_mfma_f32_16x16x32_bf16 v[176:179], a[80:83], v[88:91], v[176:179]
    v_mfma_f32_16x16x32_bf16 v[180:183], a[112:115], v[88:91], v[180:183]
    v_mfma_f32_16x16x32_bf16 v[184:187], v[88:91], a[144:147], v[184:187]
    v_mfma_f32_16x16x32_bf16 v[188:191], v[88:91], a[176:179], v[188:191]
    v_mfma_f32_16x16x32_bf16 v[176:179], a[84:87], v[92:95], v[176:179]
    v_mfma_f32_16x16x32_bf16 v[180:183], a[116:119], v[92:95], v[180:183]
    v_mfma_f32_16x16x32_bf16 v[184:187], v[92:95], a[148:151], v[184:187]
    v_mfma_f32_16x16x32_bf16 v[188:191], v[92:95], a[180:183], v[188:191]
    v_mfma_f32_16x16x32_bf16 v[176:179], a[88:91], v[96:99], v[176:179]
    v_mfma_f32_16x16x32_bf16 v[180:183], a[120:123], v[96:99], v[180:183]
    v_mfma_f32_16x16x32_bf16 v[184:187], v[96:99], a[152:155], v[184:187]
    v_mfma_f32_16x16x32_bf16 v[188:191], v[96:99], a[184:187], v[188:191]
    v_mfma_f32_16x16x32_bf16 v[176:179], a[92:95], v[100:103], v[176:179]
    v_mfma_f32_16x16x32_bf16 v[180:183], a[124:127], v[100:103], v[180:183]
    v_mfma_f32_16x16x32_bf16 v[184:187], v[100:103], a[156:159], v[184:187]
    v_mfma_f32_16x16x32_bf16 v[188:191], v[100:103], a[188:191], v[188:191]
    buffer_load_dwordx4 v[72:75], v5, s[76:79], s41 offen offset:0
    buffer_load_dwordx4 v[76:79], v5, s[76:79], s41 offen offset:1024
    buffer_load_dwordx4 v[80:83], v5, s[76:79], s41 offen offset:2048
    buffer_load_dwordx4 v[84:87], v5, s[76:79], s41 offen offset:3072
    buffer_load_dwordx4 v[88:91], v0, s[76:79], s41 offen offset:0
    buffer_load_dwordx4 v[92:95], v0, s[76:79], s41 offen offset:1024
    buffer_load_dwordx4 v[96:99], v0, s[76:79], s41 offen offset:2048
    buffer_load_dwordx4 v[100:103], v0, s[76:79], s41 offen offset:3072
    s_add_u32 s40, s40, 0x10000
    s_add_u32 s41, s41, 0x10000
    ds_write_b128 v18, v[176:179] offset:36864
    ds_write_b128 v18, v[180:183] offset:37888
    ds_write_b128 v18, v[184:187] offset:38912
    ds_write_b128 v18, v[188:191] offset:39936
    s_waitcnt lgkmcnt(0)
    s_barrier
    s_waitcnt vmcnt(17)
    v_mfma_f32_16x16x32_bf16 v[160:163], a[64:67], v[192:195], 0
    ds_read_b128 v[104:107], v136 offset:32768
    v_mfma_f32_16x16x32_bf16 v[164:167], a[96:99], v[192:195], 0
    ds_read_b128 v[108:111], v137 offset:32768
    v_mfma_f32_16x16x32_bf16 v[168:171], v[192:195], a[128:131], 0
    ds_read_b128 v[112:115], v136 offset:40960
    v_mfma_f32_16x16x32_bf16 v[172:175], v[192:195], a[160:163], 0
    ds_read_b128 v[116:119], v137 offset:40960
    v_mfma_f32_16x16x32_bf16 v[160:163], a[68:71], v[196:199], v[160:163]
    ds_read_b128 v[120:123], v136 offset:49152
    v_mfma_f32_16x16x32_bf16 v[164:167], a[100:103], v[196:199], v[164:167]
    ds_read_b128 v[124:127], v137 offset:49152
    v_mfma_f32_16x16x32_bf16 v[168:171], v[196:199], a[132:135], v[168:171]
    ds_read_b128 v[128:131], v136 offset:57344
    v_mfma_f32_16x16x32_bf16 v[172:175], v[196:199], a[164:167], v[172:175]
    ds_read_b128 v[132:135], v137 offset:57344
    v_mfma_f32_16x16x32_bf16 v[160:163], a[72:75], v[200:203], v[160:163]
    v_mfma_f32_16x16x32_bf16 v[164:167], a[104:107], v[200:203], v[164:167]
    v_mfma_f32_16x16x32_bf16 v[168:171], v[200:203], a[136:139], v[168:171]
    v_mfma_f32_16x16x32_bf16 v[172:175], v[200:203], a[168:171], v[172:175]
    s_waitcnt lgkmcnt(0)
    v_mfma_f32_16x16x32_bf16 v[160:163], a[76:79], v[204:207], v[160:163]
    v_pk_add_f32 v[104:105], v[104:105], v[112:113]
    v_pk_add_f32 v[106:107], v[106:107], v[114:115]
    v_mfma_f32_16x16x32_bf16 v[164:167], a[108:111], v[204:207], v[164:167]
    v_pk_add_f32 v[108:109], v[108:109], v[116:117]
    v_pk_add_f32 v[110:111], v[110:111], v[118:119]
    v_mfma_f32_16x16x32_bf16 v[168:171], v[204:207], a[140:143], v[168:171]
    v_pk_add_f32 v[120:121], v[120:121], v[128:129]
    v_pk_add_f32 v[122:123], v[122:123], v[130:131]
    v_mfma_f32_16x16x32_bf16 v[172:175], v[204:207], a[172:175], v[172:175]
    v_pk_add_f32 v[124:125], v[124:125], v[132:133]
    v_pk_add_f32 v[126:127], v[126:127], v[134:135]
    v_mfma_f32_16x16x32_bf16 v[160:163], a[80:83], v[208:211], v[160:163]
    v_pk_add_f32 v[104:105], v[104:105], v[120:121]
    v_pk_add_f32 v[106:107], v[106:107], v[122:123]
    v_mfma_f32_16x16x32_bf16 v[164:167], a[112:115], v[208:211], v[164:167]
    v_pk_add_f32 v[108:109], v[108:109], v[124:125]
    v_pk_add_f32 v[110:111], v[110:111], v[126:127]
    v_mfma_f32_16x16x32_bf16 v[168:171], v[208:211], a[144:147], v[168:171]
    v_cvt_pk_bf16_f32 v140, v104, v105
    v_cvt_pk_bf16_f32 v141, v106, v107
    v_mfma_f32_16x16x32_bf16 v[172:175], v[208:211], a[176:179], v[172:175]
    v_cvt_pk_bf16_f32 v142, v108, v109
    v_cvt_pk_bf16_f32 v143, v110, v111
    v_mfma_f32_16x16x32_bf16 v[160:163], a[84:87], v[212:215], v[160:163]
    v_mfma_f32_16x16x32_bf16 v[164:167], a[116:119], v[212:215], v[164:167]
    v_mfma_f32_16x16x32_bf16 v[168:171], v[212:215], a[148:151], v[168:171]
    buffer_store_dwordx4 v[140:143], v3, s[8:11], s42 offen sc1
    s_add_u32 s42, s42, 0x40000
    v_mfma_f32_16x16x32_bf16 v[172:175], v[212:215], a[180:183], v[172:175]
    v_mfma_f32_16x16x32_bf16 v[160:163], a[88:91], v[216:219], v[160:163]
    v_mfma_f32_16x16x32_bf16 v[164:167], a[120:123], v[216:219], v[164:167]
    v_mfma_f32_16x16x32_bf16 v[168:171], v[216:219], a[152:155], v[168:171]
    v_mfma_f32_16x16x32_bf16 v[172:175], v[216:219], a[184:187], v[172:175]
    v_mfma_f32_16x16x32_bf16 v[160:163], a[92:95], v[220:223], v[160:163]
    v_mfma_f32_16x16x32_bf16 v[164:167], a[124:127], v[220:223], v[164:167]
    v_mfma_f32_16x16x32_bf16 v[168:171], v[220:223], a[156:159], v[168:171]
    v_mfma_f32_16x16x32_bf16 v[172:175], v[220:223], a[188:191], v[172:175]
    v_mfma_f32_16x16x32_bf16 v[176:179], a[64:67], v[224:227], 0
    v_mfma_f32_16x16x32_bf16 v[180:183], a[96:99], v[224:227], 0
    v_mfma_f32_16x16x32_bf16 v[184:187], v[224:227], a[128:131], 0
    v_mfma_f32_16x16x32_bf16 v[188:191], v[224:227], a[160:163], 0
    v_mfma_f32_16x16x32_bf16 v[176:179], a[68:71], v[228:231], v[176:179]
    v_mfma_f32_16x16x32_bf16 v[180:183], a[100:103], v[228:231], v[180:183]
    v_mfma_f32_16x16x32_bf16 v[184:187], v[228:231], a[132:135], v[184:187]
    v_mfma_f32_16x16x32_bf16 v[188:191], v[228:231], a[164:167], v[188:191]
    v_mfma_f32_16x16x32_bf16 v[176:179], a[72:75], v[232:235], v[176:179]
    ds_write_b128 v18, v[160:163] offset:0
    ds_write_b128 v18, v[164:167] offset:1024
    ds_write_b128 v18, v[168:171] offset:2048
    ds_write_b128 v18, v[172:175] offset:3072
    v_mfma_f32_16x16x32_bf16 v[180:183], a[104:107], v[232:235], v[180:183]
    v_mfma_f32_16x16x32_bf16 v[184:187], v[232:235], a[136:139], v[184:187]
    v_mfma_f32_16x16x32_bf16 v[188:191], v[232:235], a[168:171], v[188:191]
    v_mfma_f32_16x16x32_bf16 v[176:179], a[76:79], v[236:239], v[176:179]
    v_mfma_f32_16x16x32_bf16 v[180:183], a[108:111], v[236:239], v[180:183]
    v_mfma_f32_16x16x32_bf16 v[184:187], v[236:239], a[140:143], v[184:187]
    v_mfma_f32_16x16x32_bf16 v[188:191], v[236:239], a[172:175], v[188:191]
    v_mfma_f32_16x16x32_bf16 v[176:179], a[80:83], v[240:243], v[176:179]
    v_mfma_f32_16x16x32_bf16 v[180:183], a[112:115], v[240:243], v[180:183]
    v_mfma_f32_16x16x32_bf16 v[184:187], v[240:243], a[144:147], v[184:187]
    v_mfma_f32_16x16x32_bf16 v[188:191], v[240:243], a[176:179], v[188:191]
    v_mfma_f32_16x16x32_bf16 v[176:179], a[84:87], v[244:247], v[176:179]
    v_mfma_f32_16x16x32_bf16 v[180:183], a[116:119], v[244:247], v[180:183]
    v_mfma_f32_16x16x32_bf16 v[184:187], v[244:247], a[148:151], v[184:187]
    v_mfma_f32_16x16x32_bf16 v[188:191], v[244:247], a[180:183], v[188:191]
    v_mfma_f32_16x16x32_bf16 v[176:179], a[88:91], v[248:251], v[176:179]
    v_mfma_f32_16x16x32_bf16 v[180:183], a[120:123], v[248:251], v[180:183]
    v_mfma_f32_16x16x32_bf16 v[184:187], v[248:251], a[152:155], v[184:187]
    v_mfma_f32_16x16x32_bf16 v[188:191], v[248:251], a[184:187], v[188:191]
    v_mfma_f32_16x16x32_bf16 v[176:179], a[92:95], v[252:255], v[176:179]
    v_mfma_f32_16x16x32_bf16 v[180:183], a[124:127], v[252:255], v[180:183]
    v_mfma_f32_16x16x32_bf16 v[184:187], v[252:255], a[156:159], v[184:187]
    v_mfma_f32_16x16x32_bf16 v[188:191], v[252:255], a[188:191], v[188:191]
    s_nop 4
    ds_write_b128 v18, v[176:179] offset:4096
    ds_write_b128 v18, v[180:183] offset:5120
    ds_write_b128 v18, v[184:187] offset:6144
    ds_write_b128 v18, v[188:191] offset:7168
    s_waitcnt lgkmcnt(0)
    s_barrier
    s_waitcnt vmcnt(1)
    v_mfma_f32_16x16x32_bf16 v[160:163], a[64:67], v[40:43], 0
    ds_read_b128 v[104:107], v136 offset:0
    v_mfma_f32_16x16x32_bf16 v[164:167], a[96:99], v[40:43], 0
    ds_read_b128 v[108:111], v137 offset:0
    v_mfma_f32_16x16x32_bf16 v[168:171], v[40:43], a[128:131], 0
    ds_read_b128 v[112:115], v136 offset:8192
    v_mfma_f32_16x16x32_bf16 v[172:175], v[40:43], a[160:163], 0
    ds_read_b128 v[116:119], v137 offset:8192
    v_mfma_f32_16x16x32_bf16 v[160:163], a[68:71], v[44:47], v[160:163]
    ds_read_b128 v[120:123], v136 offset:16384
    v_mfma_f32_16x16x32_bf16 v[164:167], a[100:103], v[44:47], v[164:167]
    ds_read_b128 v[124:127], v137 offset:16384
    v_mfma_f32_16x16x32_bf16 v[168:171], v[44:47], a[132:135], v[168:171]
    ds_read_b128 v[128:131], v136 offset:24576
    v_mfma_f32_16x16x32_bf16 v[172:175], v[44:47], a[164:167], v[172:175]
    ds_read_b128 v[132:135], v137 offset:24576
    v_mfma_f32_16x16x32_bf16 v[160:163], a[72:75], v[48:51], v[160:163]
    v_mfma_f32_16x16x32_bf16 v[164:167], a[104:107], v[48:51], v[164:167]
    v_mfma_f32_16x16x32_bf16 v[168:171], v[48:51], a[136:139], v[168:171]
    v_mfma_f32_16x16x32_bf16 v[172:175], v[48:51], a[168:171], v[172:175]
    s_waitcnt lgkmcnt(0)
    v_mfma_f32_16x16x32_bf16 v[160:163], a[76:79], v[52:55], v[160:163]
    v_pk_add_f32 v[104:105], v[104:105], v[112:113]
    v_pk_add_f32 v[106:107], v[106:107], v[114:115]
    v_mfma_f32_16x16x32_bf16 v[164:167], a[108:111], v[52:55], v[164:167]
    v_pk_add_f32 v[108:109], v[108:109], v[116:117]
    v_pk_add_f32 v[110:111], v[110:111], v[118:119]
    v_mfma_f32_16x16x32_bf16 v[168:171], v[52:55], a[140:143], v[168:171]
    v_pk_add_f32 v[120:121], v[120:121], v[128:129]
    v_pk_add_f32 v[122:123], v[122:123], v[130:131]
    v_mfma_f32_16x16x32_bf16 v[172:175], v[52:55], a[172:175], v[172:175]
    v_pk_add_f32 v[124:125], v[124:125], v[132:133]
    v_pk_add_f32 v[126:127], v[126:127], v[134:135]
    v_mfma_f32_16x16x32_bf16 v[160:163], a[80:83], v[56:59], v[160:163]
    v_pk_add_f32 v[104:105], v[104:105], v[120:121]
    v_pk_add_f32 v[106:107], v[106:107], v[122:123]
    v_mfma_f32_16x16x32_bf16 v[164:167], a[112:115], v[56:59], v[164:167]
    v_pk_add_f32 v[108:109], v[108:109], v[124:125]
    v_pk_add_f32 v[110:111], v[110:111], v[126:127]
    v_mfma_f32_16x16x32_bf16 v[168:171], v[56:59], a[144:147], v[168:171]
    v_cvt_pk_bf16_f32 v140, v104, v105
    v_cvt_pk_bf16_f32 v141, v106, v107
    v_mfma_f32_16x16x32_bf16 v[172:175], v[56:59], a[176:179], v[172:175]
    v_cvt_pk_bf16_f32 v142, v108, v109
    v_cvt_pk_bf16_f32 v143, v110, v111
    v_mfma_f32_16x16x32_bf16 v[160:163], a[84:87], v[60:63], v[160:163]
    v_mfma_f32_16x16x32_bf16 v[164:167], a[116:119], v[60:63], v[164:167]
    v_mfma_f32_16x16x32_bf16 v[168:171], v[60:63], a[148:151], v[168:171]
    buffer_store_dwordx4 v[140:143], v3, s[8:11], s42 offen sc1
    s_add_u32 s42, s42, 0x40000
    v_mfma_f32_16x16x32_bf16 v[172:175], v[60:63], a[180:183], v[172:175]
    v_mfma_f32_16x16x32_bf16 v[160:163], a[88:91], v[64:67], v[160:163]
    v_mfma_f32_16x16x32_bf16 v[164:167], a[120:123], v[64:67], v[164:167]
    v_mfma_f32_16x16x32_bf16 v[168:171], v[64:67], a[152:155], v[168:171]
    v_mfma_f32_16x16x32_bf16 v[172:175], v[64:67], a[184:187], v[172:175]
    v_mfma_f32_16x16x32_bf16 v[160:163], a[92:95], v[68:71], v[160:163]
    v_mfma_f32_16x16x32_bf16 v[164:167], a[124:127], v[68:71], v[164:167]
    v_mfma_f32_16x16x32_bf16 v[168:171], v[68:71], a[156:159], v[168:171]
    v_mfma_f32_16x16x32_bf16 v[172:175], v[68:71], a[188:191], v[172:175]
    v_mfma_f32_16x16x32_bf16 v[176:179], a[64:67], v[72:75], 0
    v_mfma_f32_16x16x32_bf16 v[180:183], a[96:99], v[72:75], 0
    v_mfma_f32_16x16x32_bf16 v[184:187], v[72:75], a[128:131], 0
    v_mfma_f32_16x16x32_bf16 v[188:191], v[72:75], a[160:163], 0
    v_mfma_f32_16x16x32_bf16 v[176:179], a[68:71], v[76:79], v[176:179]
    v_mfma_f32_16x16x32_bf16 v[180:183], a[100:103], v[76:79], v[180:183]
    v_mfma_f32_16x16x32_bf16 v[184:187], v[76:79], a[132:135], v[184:187]
    v_mfma_f32_16x16x32_bf16 v[188:191], v[76:79], a[164:167], v[188:191]
    v_mfma_f32_16x16x32_bf16 v[176:179], a[72:75], v[80:83], v[176:179]
    ds_write_b128 v18, v[160:163] offset:32768
    ds_write_b128 v18, v[164:167] offset:33792
    ds_write_b128 v18, v[168:171] offset:34816
    ds_write_b128 v18, v[172:175] offset:35840
    v_mfma_f32_16x16x32_bf16 v[180:183], a[104:107], v[80:83], v[180:183]
    v_mfma_f32_16x16x32_bf16 v[184:187], v[80:83], a[136:139], v[184:187]
    v_mfma_f32_16x16x32_bf16 v[188:191], v[80:83], a[168:171], v[188:191]
    v_mfma_f32_16x16x32_bf16 v[176:179], a[76:79], v[84:87], v[176:179]
    v_mfma_f32_16x16x32_bf16 v[180:183], a[108:111], v[84:87], v[180:183]
    v_mfma_f32_16x16x32_bf16 v[184:187], v[84:87], a[140:143], v[184:187]
    v_mfma_f32_16x16x32_bf16 v[188:191], v[84:87], a[172:175], v[188:191]
    v_mfma_f32_16x16x32_bf16 v[176:179], a[80:83], v[88:91], v[176:179]
    v_mfma_f32_16x16x32_bf16 v[180:183], a[112:115], v[88:91], v[180:183]
    v_mfma_f32_16x16x32_bf16 v[184:187], v[88:91], a[144:147], v[184:187]
    v_mfma_f32_16x16x32_bf16 v[188:191], v[88:91], a[176:179], v[188:191]
    v_mfma_f32_16x16x32_bf16 v[176:179], a[84:87], v[92:95], v[176:179]
    v_mfma_f32_16x16x32_bf16 v[180:183], a[116:119], v[92:95], v[180:183]
    v_mfma_f32_16x16x32_bf16 v[184:187], v[92:95], a[148:151], v[184:187]
    v_mfma_f32_16x16x32_bf16 v[188:191], v[92:95], a[180:183], v[188:191]
    v_mfma_f32_16x16x32_bf16 v[176:179], a[88:91], v[96:99], v[176:179]
    v_mfma_f32_16x16x32_bf16 v[180:183], a[120:123], v[96:99], v[180:183]
    v_mfma_f32_16x16x32_bf16 v[184:187], v[96:99], a[152:155], v[184:187]
    v_mfma_f32_16x16x32_bf16 v[188:191], v[96:99], a[184:187], v[188:191]
    v_mfma_f32_16x16x32_bf16 v[176:179], a[92:95], v[100:103], v[176:179]
    v_mfma_f32_16x16x32_bf16 v[180:183], a[124:127], v[100:103], v[180:183]
    v_mfma_f32_16x16x32_bf16 v[184:187], v[100:103], a[156:159], v[184:187]
    v_mfma_f32_16x16x32_bf16 v[188:191], v[100:103], a[188:191], v[188:191]
    s_nop 4
    ds_write_b128 v18, v[176:179] offset:36864
    ds_write_b128 v18, v[180:183] offset:37888
    ds_write_b128 v18, v[184:187] offset:38912
    ds_write_b128 v18, v[188:191] offset:39936
    s_waitcnt lgkmcnt(0)
    s_barrier
    ds_read_b128 v[104:107], v136 offset:32768
    ds_read_b128 v[108:111], v137 offset:32768
    ds_read_b128 v[112:115], v136 offset:40960
    ds_read_b128 v[116:119], v137 offset:40960
    ds_read_b128 v[120:123], v136 offset:49152
    ds_read_b128 v[124:127], v137 offset:49152
    ds_read_b128 v[128:131], v136 offset:57344
    ds_read_b128 v[132:135], v137 offset:57344
    s_waitcnt lgkmcnt(0)
    v_pk_add_f32 v[104:105], v[104:105], v[112:113]
    v_pk_add_f32 v[106:107], v[106:107], v[114:115]
    v_pk_add_f32 v[108:109], v[108:109], v[116:117]
    v_pk_add_f32 v[110:111], v[110:111], v[118:119]
    v_pk_add_f32 v[120:121], v[120:121], v[128:129]
    v_pk_add_f32 v[122:123], v[122:123], v[130:131]
    v_pk_add_f32 v[124:125], v[124:125], v[132:133]
    v_pk_add_f32 v[126:127], v[126:127], v[134:135]
    v_pk_add_f32 v[104:105], v[104:105], v[120:121]
    v_pk_add_f32 v[106:107], v[106:107], v[122:123]
    v_pk_add_f32 v[108:109], v[108:109], v[124:125]
    v_pk_add_f32 v[110:111], v[110:111], v[126:127]
    v_cvt_pk_bf16_f32 v140, v104, v105
    v_cvt_pk_bf16_f32 v141, v106, v107
    v_cvt_pk_bf16_f32 v142, v108, v109
    v_cvt_pk_bf16_f32 v143, v110, v111
    buffer_store_dwordx4 v[140:143], v3, s[8:11], s42 offen sc1
    s_add_u32 s42, s42, 0x40000
    s_mov_b32 s25, 0
    v_mov_b32 v38, 64
    s_mov_b32 s43, 0
sb_12:
    buffer_load_dwordx2 v[36:37], v38, s[16:19], 0 offen sc1
    s_add_u32 s43, s43, 1
    s_cmp_ge_u32 s43, 0x20000
    s_cbranch_scc1 L_exit
    s_waitcnt vmcnt(0)
    v_readfirstlane_b32 s52, v36
    v_readfirstlane_b32 s56, v37
    s_cmp_lt_u32 s52, 128
    s_cbranch_scc1 sb_12
    s_lshr_b32 s56, s56, s21
    s_and_b32 s56, s56, 1
    s_lshl_b32 s56, s56, 13
    s_add_u32 s28, s98, s56
    s_lshl_b32 s52, s20, 17
    s_add_u32 s52, s52, s28
    s_add_u32 s99, s52, 0x10000
    s_lshl_b32 s52, s20, 2
    s_add_u32 s52, s52, s28
    s_add_u32 s52, s52, 0x8000
    v_mov_b32 v16, s52
    s_add_u32 s28, s28, 0xb0000
    v_mov_b32 v32, 0
    ds_write_b32 v19, v32
    v_mov_b32 v56, 0
    v_mov_b32 v57, 0
    v_mov_b32 v58, 0
    v_mov_b32 v59, 0
    v_mov_b32 v60, 0
    v_mov_b32 v61, 0
    v_mov_b32 v62, 0
    v_mov_b32 v63, 0
    v_mov_b32 v64, 0
    v_mov_b32 v65, 0
    v_mov_b32 v66, 0
    v_mov_b32 v67, 0
    v_mov_b32 v68, 0
    v_mov_b32 v69, 0
    v_mov_b32 v70, 0
    v_mov_b32 v71, 0
    v_mov_b32 v72, 0
    v_mov_b32 v73, 0
    v_mov_b32 v74, 0
    v_mov_b32 v75, 0
    v_mov_b32 v76, 0
    v_mov_b32 v77, 0
    v_mov_b32 v78, 0
    v_mov_b32 v79, 0
    v_mov_b32 v80, 0
    v_mov_b32 v81, 0
    v_mov_b32 v82, 0
    v_mov_b32 v83, 0
    v_mov_b32 v84, 0
    v_mov_b32 v85, 0
    v_mov_b32 v86, 0
    v_mov_b32 v87, 0
    v_mov_b32 v39, 32
    s_mov_b32 s30, s26
    s_mov_b32 s31, s27
    s_cmp_eq_u32 s24, 2
    s_cselect_b32 s33, s28, s29
    s_mov_b32 s51, 3
    s_mov_b32 s4, 0x3f80
    s_mov_b32 s5, 0x3f800000
    v_readfirstlane_b32 s97, v37
    s_waitcnt lgkmcnt(0)
    s_barrier
    s_cmp_lg_u32 s24, 1
    s_cbranch_scc1 p1_13
    s_load_dwordx2 s[60:61], s[0:1], 8
    s_waitcnt lgkmcnt(0)
    s_mov_b32 s12, s60
    s_mov_b32 s13, s61
    s_mov_b32 s14, 0x4000
    s_mov_b32 s15, 0x20000
    v_bfe_u32 v32, v1, 3, 2
    v_lshlrev_b32 v32, 12, v32
    v_bfe_u32 v33, v1, 1, 1
    v_lshl_add_u32 v32, v33, 11, v32
    v_lshrrev_b32 v33, 5, v1
    v_lshl_add_u32 v32, v33, 5, v32
    v_and_b32 v33, 1, v1
    v_lshl_add_u32 v32, v33, 4, v32
    v_bfe_u32 v33, v1, 2, 1
    v_lshl_add_u32 v32, v33, 2, v32
    s_lshl_b32 s52, s21, 6
    buffer_load_dword v34, v32, s[12:15], s52 offen
    buffer_load_dword v35, v32, s[12:15], s52 offen offset:8
    s_waitcnt vmcnt(0)
    v_min_u32 v34, -2, v34
    v_min_u32 v35, -2, v35
    buffer_store_dwordx2 v[34:35], v7, s[8:11], s26 offen
p1_13:
    s_cmp_lg_u32 s24, 0
    s_cbranch_scc1 p2_14
    v_mov_b32 v28, 0x3f803f80
    v_mov_b32 v29, 0x3f803f80
    v_mov_b32 v30, 0x3f803f80
    v_mov_b32 v31, 0x3f803f80
    s_mov_b32 s25, -1
    s_add_u32 s54, s25, 1
    s_lshl_b32 s54, s54, 5
    s_add_u32 s54, s54, s22
    s_lshl_b32 s54, s54, 3
    s_add_u32 s54, s54, s23
    s_add_u32 s55, s54, s23
    s_lshl_b32 s54, s54, 10
    s_lshl_b32 s55, s55, 10
    s_add_u32 s40, s54, 0x1000000
    s_add_u32 s41, s55, 0x2200000
    buffer_load_dwordx4 v[132:135], v3, s[8:11], s40 offen sc1
    buffer_load_dwordx4 v[136:139], v13, s[8:11], s40 offen sc1
    buffer_load_dwordx4 v[140:143], v3, s[8:11], s41 offen sc1
    buffer_load_dwordx4 v[144:147], v3, s[8:11], s41 offen offset:1024 sc1
    s_mov_b32 s25, 0
p2_14:
    s_branch step_15
    .p2align 6
    s_nop 0
    s_nop 0
    s_nop 0
    s_nop 0
    s_nop 0
    s_nop 0
    s_nop 0
    s_nop 0
step_15:
    buffer_load_dwordx4 v[40:43], v2, s[8:11], s30 offen offset:0 sc1
    buffer_load_dwordx4 v[44:47], v2, s[8:11], s30 offen offset:1024 sc1
    buffer_load_dwordx4 v[48:51], v2, s[8:11], s30 offen offset:2048 sc1
    buffer_load_dwordx4 v[52:55], v2, s[8:11], s30 offen offset:3072 sc1
    s_mov_b32 s43, 0
    s_waitcnt vmcnt(3)
    v_max_u32 v32, v40, v42
    v_cmp_eq_u32 vcc, -1, v32
    s_cbranch_vccnz gfm_22
    v_smfmac_f32_16x16x64_bf16 v[56:59], v[40:43], a[0:7], v154
    v_smfmac_f32_16x16x64_bf16 v[60:63], v[40:43], a[64:71], v154
    v_smfmac_f32_16x16x64_bf16 v[64:67], v[40:43], a[32:39], v154
    s_waitcnt vmcnt(2)
    v_max_u32 v32, v44, v46
    v_cmp_eq_u32 vcc, -1, v32
    v_smfmac_f32_16x16x64_bf16 v[68:71], v[40:43], a[96:103], v154
    s_cbranch_vccnz gfm_23
    v_smfmac_f32_16x16x64_bf16 v[56:59], v[44:47], a[8:15], v154
    v_smfmac_f32_16x16x64_bf16 v[60:63], v[44:47], a[72:79], v154
    v_smfmac_f32_16x16x64_bf16 v[64:67], v[44:47], a[40:47], v154
    s_waitcnt vmcnt(1)
    v_max_u32 v32, v48, v50
    v_cmp_eq_u32 vcc, -1, v32
    v_smfmac_f32_16x16x64_bf16 v[68:71], v[44:47], a[104:111], v154
    s_cbranch_vccnz gfm_24
    v_smfmac_f32_16x16x64_bf16 v[56:59], v[48:51], a[16:23], v154
    v_smfmac_f32_16x16x64_bf16 v[60:63], v[48:51], a[80:87], v154
    v_smfmac_f32_16x16x64_bf16 v[64:67], v[48:51], a[48:55], v154
    s_waitcnt vmcnt(0)
    v_max_u32 v32, v52, v54
    v_cmp_eq_u32 vcc, -1, v32
    v_smfmac_f32_16x16x64_bf16 v[68:71], v[48:51], a[112:119], v154
    s_cbranch_vccnz gfm_25
    v_smfmac_f32_16x16x64_bf16 v[56:59], v[52:55], a[24:31], v154
    v_smfmac_f32_16x16x64_bf16 v[60:63], v[52:55], a[88:95], v154
    v_smfmac_f32_16x16x64_bf16 v[64:67], v[52:55], a[56:63], v154
    v_smfmac_f32_16x16x64_bf16 v[68:71], v[52:55], a[120:127], v154
gdm_21:
    s_nop 4
    v_pk_add_f32 v[88:89], v[56:57], v[58:59]
    ds_write2_b32 v155, v88, v89 offset0:0 offset1:196
    v_pk_add_f32 v[90:91], v[60:61], v[62:63]
    ds_write2_b32 v159, v90, v91 offset0:0 offset1:196
    v_pk_add_f32 v[92:93], v[64:65], v[66:67]
    ds_write2_b32 v155, v92, v93 offset0:16 offset1:212
    v_pk_add_f32 v[94:95], v[68:69], v[70:71]
    ds_write2_b32 v159, v94, v95 offset0:16 offset1:212
    s_cmp_eq_u32 s24, 0
    s_waitcnt lgkmcnt(0)
    s_barrier
    s_cbranch_scc0 Bo_17
    ds_read_b128 v[96:99], v157 offset:0
    ds_read_b128 v[100:103], v157 offset:64
    ds_read_b128 v[104:107], v157 offset:3136
    ds_read_b128 v[108:111], v157 offset:3200
    ds_read_b128 v[112:115], v157 offset:6272
    ds_read_b128 v[116:119], v157 offset:6336
    ds_read_b128 v[120:123], v157 offset:9408
    ds_read_b128 v[124:127], v157 offset:9472
    s_cmp_eq_u32 s25, 63
    s_waitcnt lgkmcnt(4)
    v_pk_add_f32 v[96:97], v[96:97], v[104:105]
    v_pk_add_f32 v[98:99], v[98:99], v[106:107]
    v_pk_add_f32 v[100:101], v[100:101], v[108:109]
    v_pk_add_f32 v[102:103], v[102:103], v[110:111]
    s_waitcnt lgkmcnt(2)
    v_pk_add_f32 v[96:97], v[96:97], v[112:113]
    v_pk_add_f32 v[98:99], v[98:99], v[114:115]
    v_pk_add_f32 v[100:101], v[100:101], v[116:117]
    v_pk_add_f32 v[102:103], v[102:103], v[118:119]
    s_waitcnt lgkmcnt(0)
    v_pk_add_f32 v[96:97], v[96:97], v[120:121]
    v_pk_add_f32 v[98:99], v[98:99], v[122:123]
    v_pk_add_f32 v[100:101], v[100:101], v[124:125]
    v_pk_add_f32 v[102:103], v[102:103], v[126:127]
    v_cvt_pk_bf16_f32 v128, v96, v97
    v_cvt_pk_bf16_f32 v129, v98, v99
    v_cvt_pk_bf16_f32 v130, v100, v101
    v_cvt_pk_bf16_f32 v131, v102, v103
    s_cbranch_scc1 last_16
    s_nop 0
    v_mfma_f32_16x16x32_bf16 v[120:123], v[128:131], v[128:131], 0
    v_mfma_f32_16x16x32_bf16 v[112:115], v[132:135], v[128:131], 0
    v_mfma_f32_16x16x32_bf16 v[116:119], v[136:139], v[128:131], 0
    s_mov_b64 exec, s[48:49]
    s_nop 4
    buffer_store_dword v120, v12, s[8:11], s33 offen offset:0
    buffer_store_dword v121, v12, s[8:11], s33 offen offset:128
    buffer_store_dword v122, v12, s[8:11], s33 offen offset:256
    buffer_store_dword v123, v12, s[8:11], s33 offen offset:384
    s_mov_b64 exec, s[44:45]
    buffer_store_dwordx4 v[112:115], v8, s[8:11], s33 offen
    buffer_store_dwordx4 v[116:119], v8, s[8:11], s33 offen offset:128
    s_mov_b64 exec, -1
    v_smfmac_f32_16x16x64_bf16 v[72:75], v[40:43], a[128:135], v154
    v_mov_b32_dpp v112, v116 row_ror:8 row_mask:0xf bank_mask:0xc
    v_mov_b32_dpp v113, v117 row_ror:8 row_mask:0xf bank_mask:0xc
    v_mov_b32_dpp v114, v118 row_ror:8 row_mask:0xf bank_mask:0xc
    v_mov_b32_dpp v115, v119 row_ror:8 row_mask:0xf bank_mask:0xc
    v_smfmac_f32_16x16x64_bf16 v[76:79], v[40:43], a[160:167], v154
    v_mov_b32 v80, 0
    v_mov_b32 v81, 0
    v_smfmac_f32_16x16x64_bf16 v[72:75], v[44:47], a[136:143], v154
    v_mov_b32 v82, 0
    v_mov_b32 v83, 0
    v_smfmac_f32_16x16x64_bf16 v[76:79], v[44:47], a[168:175], v154
    v_mov_b32 v84, 0
    v_mov_b32 v85, 0
    buffer_load_dwordx4 v[56:59], v9, s[8:11], s33 offen sc1
    buffer_load_dwordx4 v[60:63], v10, s[8:11], s33 offen sc1
    buffer_load_dwordx4 v[64:67], v11, s[8:11], s33 offen sc1
    buffer_load_dwordx4 v[68:71], v13, s[8:11], s33 offen sc1
    v_smfmac_f32_16x16x64_bf16 v[72:75], v[48:51], a[144:151], v154
    v_mov_b32 v86, 0
    v_mov_b32 v87, 0
    v_smfmac_f32_16x16x64_bf16 v[76:79], v[48:51], a[176:183], v154
    v_smfmac_f32_16x16x64_bf16 v[72:75], v[52:55], a[152:159], v154
    v_smfmac_f32_16x16x64_bf16 v[76:79], v[52:55], a[184:191], v154
    buffer_load_dwordx4 v[56:59], v9, s[8:11], s33 offen sc1
    buffer_load_dwordx4 v[60:63], v10, s[8:11], s33 offen sc1
    buffer_load_dwordx4 v[64:67], v11, s[8:11], s33 offen sc1
    buffer_load_dwordx4 v[68:71], v13, s[8:11], s33 offen sc1
    s_nop 2
    v_pk_add_f32 v[88:89], v[72:73], v[74:75]
    v_pk_add_f32 v[90:91], v[76:77], v[78:79]
    ds_read_b32 v34, v19
    ds_read_b128 v[96:99], v3 offset:13568
    ds_read_b128 v[100:103], v3 offset:14592
    ds_read_b128 v[104:107], v3 offset:15616
    buffer_load_dwordx4 v[56:59], v9, s[8:11], s33 offen sc1
    buffer_load_dwordx4 v[60:63], v10, s[8:11], s33 offen sc1
    buffer_load_dwordx4 v[64:67], v11, s[8:11], s33 offen sc1
    buffer_load_dwordx4 v[68:71], v13, s[8:11], s33 offen sc1
    s_waitcnt lgkmcnt(0)
    v_cmp_ne_u32 vcc, s51, v34
    s_cbranch_vccnz vr_27
vm_26:
    v_pk_add_f32 v[88:89], v[88:89], v[96:97]
    v_pk_add_f32 v[100:101], v[100:101], v[104:105]
    v_pk_add_f32 v[90:91], v[90:91], v[98:99]
    v_pk_add_f32 v[102:103], v[102:103], v[106:107]
    v_pk_add_f32 v[88:89], v[88:89], v[100:101]
    v_pk_add_f32 v[90:91], v[90:91], v[102:103]
    v_cvt_pk_bf16_f32 v148, v88, v89
    v_cvt_pk_bf16_f32 v150, v90, v91
    s_mov_b32 s43, 0
sct_28:
    s_waitcnt vmcnt(8)
    v_pk_add_f32 v[96:97], v[112:113], v[56:57]
    v_pk_add_f32 v[102:103], v[60:61], v[64:65]
    v_pk_add_f32 v[98:99], v[114:115], v[58:59]
    v_pk_add_f32 v[104:105], v[62:63], v[66:67]
    v_pk_add_f32 v[100:101], v[68:69], v[70:71]
    v_pk_add_f32 v[96:97], v[96:97], v[102:103]
    v_pk_add_f32 v[98:99], v[98:99], v[104:105]
    v_add_f32 v100, v100, v101
    v_pk_add_f32 v[102:103], v[96:97], v[98:99]
    v_max3_f32 v32, v96, v97, v98
    v_add_f32 v102, v102, v100
    v_max3_f32 v32, v32, v99, v100
    v_cmp_u_f32 vcc, v102, v103
    s_nop 0
    v_max_f32_dpp v32, v32, v32 row_ror:8 row_mask:0xf bank_mask:0xf
    s_cbranch_vccnz pm_30
sco_29:
    v_mov_b32 v33, v32
    s_nop 1
    v_permlane16_swap_b32 v32, v33
    v_max_f32 v32, v32, v33
    v_mov_b32 v33, v32
    s_nop 1
    v_permlane32_swap_b32 v32, v33
    v_max_f32 v32, v32, v33
    v_mul_f32 v32, s50, v32
    v_fma_f32 v100, v100, s50, -v32
    v_fma_f32 v96, v96, s50, -v32
    v_fma_f32 v97, v97, s50, -v32
    v_fma_f32 v98, v98, s50, -v32
    v_fma_f32 v99, v99, s50, -v32
    v_exp_f32 v100, v100
    v_exp_f32 v96, v96
    v_exp_f32 v97, v97
    v_mov_b32_dpp v33, v100 row_ror:8 row_mask:0xf bank_mask:0xf
    v_exp_f32 v98, v98
    v_cvt_pk_bf16_f32 v152, v100, v33
    v_cvt_pk_bf16_f32 v92, v96, v97
    v_exp_f32 v99, v99
    v_mfma_f32_16x16x16_bf16 v[112:115], v[28:29], v[152:153], 0
    v_cvt_pk_bf16_f32 v93, v98, v99
    v_mov_b32_dpp v94, v92 row_ror:8 row_mask:0xf bank_mask:0xf
    v_mfma_f32_16x16x16_bf16 v[104:107], v[148:149], v[152:153], 0
    v_mfma_f32_16x16x16_bf16 v[108:111], v[150:151], v[152:153], 0
    v_mov_b32_dpp v95, v93 row_ror:8 row_mask:0xf bank_mask:0xf
    s_nop 1
    v_mfma_f32_16x16x32_bf16 v[112:115], v[28:31], v[92:95], v[112:115]
    s_nop 0
    v_mfma_f32_16x16x32_bf16 v[104:107], v[140:143], v[92:95], v[104:107]
    v_mfma_f32_16x16x32_bf16 v[108:111], v[144:147], v[92:95], v[108:111]
    s_nop 4
    v_rcp_f32 v32, v112
    s_mov_b64 exec, s[44:45]
    v_pk_mul_f32 v[104:105], v[104:105], v[32:33] op_sel_hi:[1,0]
    v_cvt_pk_bf16_f32 v88, v104, v105
    v_pk_mul_f32 v[106:107], v[106:107], v[32:33] op_sel_hi:[1,0]
    v_cvt_pk_bf16_f32 v89, v106, v107
    v_pk_mul_f32 v[108:109], v[108:109], v[32:33] op_sel_hi:[1,0]
    v_cvt_pk_bf16_f32 v90, v108, v109
    v_pk_mul_f32 v[110:111], v[110:111], v[32:33] op_sel_hi:[1,0]
    v_cvt_pk_bf16_f32 v91, v110, v111
    buffer_store_dwordx4 v[88:91], v6, s[8:11], s31 offen
    s_mov_b64 exec, -1
    s_barrier
    buffer_load_dwordx4 v[40:43], v2, s[8:11], s31 offen offset:0 sc1
    buffer_load_dwordx4 v[44:47], v2, s[8:11], s31 offen offset:1024 sc1
    buffer_load_dwordx4 v[48:51], v2, s[8:11], s31 offen offset:2048 sc1
    buffer_load_dwordx4 v[52:55], v2, s[8:11], s31 offen offset:3072 sc1
C_18:
    s_mov_b32 s43, 0
    s_waitcnt vmcnt(3)
    v_cmp_eq_u32_e64 vcc, -1, v40
    s_cbranch_vccnz gfo_33
    v_smfmac_f32_16x16x64_bf16 v[80:83], v[40:43], a[192:199], v154
    s_waitcnt vmcnt(2)
    v_cmp_eq_u32_e64 vcc, -1, v44
    v_smfmac_f32_16x16x64_bf16 v[84:87], v[40:43], a[224:231], v154
    s_cbranch_vccnz gfo_34
    v_smfmac_f32_16x16x64_bf16 v[80:83], v[44:47], a[200:207], v154
    s_waitcnt vmcnt(1)
    v_cmp_eq_u32 vcc, -1, v48
    v_smfmac_f32_16x16x64_bf16 v[84:87], v[44:47], a[232:239], v154
    s_cbranch_vccnz gfo_35
    v_smfmac_f32_16x16x64_bf16 v[80:83], v[48:51], a[208:215], v154
    s_waitcnt vmcnt(0)
    v_cmp_eq_u32 vcc, -1, v52
    v_smfmac_f32_16x16x64_bf16 v[84:87], v[48:51], a[240:247], v154
    s_cbranch_vccnz gfo_36
    v_smfmac_f32_16x16x64_bf16 v[80:83], v[52:55], a[216:223], v154
    v_smfmac_f32_16x16x64_bf16 v[84:87], v[52:55], a[248:255], v154
gdo_32:
    s_nop 6
    v_pk_add_f32 v[88:89], v[80:81], v[82:83]
    ds_write2_b32 v156, v88, v89 offset0:0 offset1:224
    v_pk_add_f32 v[90:91], v[84:85], v[86:87]
    ds_write2_b32 v156, v90, v91 offset0:16 offset1:240
    s_cmp_eq_u32 s24, 2
    s_waitcnt lgkmcnt(0)
    s_barrier
    s_cbranch_scc0 Do_19
    ds_read_b128 v[96:99], v158 offset:0
    ds_read_b128 v[100:103], v158 offset:1600
    ds_read_b128 v[104:107], v158 offset:3200
    ds_read_b128 v[108:111], v158 offset:4800
    s_waitcnt lgkmcnt(2)
    v_pk_add_f32 v[96:97], v[96:97], v[100:101]
    v_pk_add_f32 v[98:99], v[98:99], v[102:103]
    s_waitcnt lgkmcnt(0)
    v_pk_add_f32 v[104:105], v[104:105], v[108:109]
    v_pk_add_f32 v[106:107], v[106:107], v[110:111]
    v_pk_add_f32 v[88:89], v[96:97], v[104:105]
    v_pk_add_f32 v[90:91], v[98:99], v[106:107]
    v_cvt_pk_bf16_f32 v92, v88, v89
    v_cvt_pk_bf16_f32 v93, v90, v91
    buffer_store_dwordx2 v[92:93], v20, s[8:11], s32 offen offset:0 sc1
    ds_read_b128 v[56:59], v157 offset:0
    ds_read_b128 v[60:63], v157 offset:64
    ds_read_b128 v[64:67], v157 offset:3136
    ds_read_b128 v[68:71], v157 offset:3200
    ds_read_b128 v[72:75], v157 offset:6272
    ds_read_b128 v[76:79], v157 offset:6336
    ds_read_b128 v[80:83], v157 offset:9408
    ds_read_b128 v[84:87], v157 offset:9472
    s_lshr_b32 s54, s25, 3
    s_and_b32 s55, s25, 7
    s_lshl_b32 s54, s54, 14
    s_lshl_b32 s55, s55, 10
    s_add_u32 s54, s54, s55
    s_add_u32 s42, s54, s99
    s_waitcnt lgkmcnt(4)
    v_pk_add_f32 v[56:57], v[56:57], v[64:65]
    v_pk_add_f32 v[58:59], v[58:59], v[66:67]
    v_pk_add_f32 v[60:61], v[60:61], v[68:69]
    v_pk_add_f32 v[62:63], v[62:63], v[70:71]
    s_waitcnt lgkmcnt(2)
    v_pk_add_f32 v[56:57], v[56:57], v[72:73]
    v_pk_add_f32 v[58:59], v[58:59], v[74:75]
    v_pk_add_f32 v[60:61], v[60:61], v[76:77]
    v_pk_add_f32 v[62:63], v[62:63], v[78:79]
    s_waitcnt lgkmcnt(0)
    v_pk_add_f32 v[56:57], v[56:57], v[80:81]
    v_pk_add_f32 v[58:59], v[58:59], v[82:83]
    v_pk_add_f32 v[60:61], v[60:61], v[84:85]
    v_pk_add_f32 v[62:63], v[62:63], v[86:87]
    v_cvt_pk_bf16_f32 v128, v56, v57
    v_cvt_pk_bf16_f32 v129, v58, v59
    v_cvt_pk_bf16_f32 v130, v60, v61
    v_cvt_pk_bf16_f32 v131, v62, v63
    s_mov_b64 exec, s[46:47]
    buffer_store_dwordx4 v[128:131], v14, s[8:11], s42 offen sc1
    s_mov_b64 exec, -1
    s_add_u32 s54, s25, 1
    s_and_b32 s54, s54, 3
    s_lshl_b32 s54, s54, 14
    s_add_u32 s31, s54, s27
    s_add_u32 s54, s25, 1
    s_and_b32 s54, s54, 3
    s_lshl_b32 s54, s54, 14
    s_add_u32 s34, s54, s26
    s_add_u32 s54, s25, 2
    s_and_b32 s54, s54, 3
    s_lshl_b32 s54, s54, 14
    s_add_u32 s37, s54, s28
    s_add_u32 s54, s25, 3
    s_and_b32 s54, s54, 3
    s_lshl_b32 s54, s54, 14
    s_add_u32 s35, s54, s26
    s_add_u32 s54, s25, 2
    s_and_b32 s54, s54, 3
    s_lshl_b32 s54, s54, 14
    s_add_u32 s36, s54, s27
    s_add_u32 s54, s25, 2
    s_and_b32 s54, s54, 3
    s_lshl_b32 s54, s54, 13
    s_add_u32 s38, s54, s29
    buffer_store_dwordx4 v[28:31], v8, s[8:11], s38 offen
    s_mov_b64 exec, s[44:45]
    buffer_store_dwordx4 v[28:31], v6, s[8:11], s36 offen
    buffer_store_dwordx4 v[28:31], v6, s[8:11], s35 offen
    s_mov_b64 exec, s[48:49]
    buffer_store_dword v28, v12, s[8:11], s38 offen offset:0
    buffer_store_dword v28, v12, s[8:11], s38 offen offset:128
    buffer_store_dword v28, v12, s[8:11], s38 offen offset:256
    buffer_store_dword v28, v12, s[8:11], s38 offen offset:384
    s_mov_b64 exec, -1
    buffer_store_dwordx4 v[28:31], v17, s[8:11], s37 offen offset:0 sc1
    v_mov_b32 v80, 0
    v_mov_b32 v81, 0
    v_mov_b32 v82, 0
    v_mov_b32 v83, 0
    v_mov_b32 v84, 0
    v_mov_b32 v85, 0
    v_mov_b32 v86, 0
    v_mov_b32 v87, 0
    v_mov_b32 v56, 0
    v_mov_b32 v57, 0
    v_mov_b32 v58, 0
    v_mov_b32 v59, 0
    v_mov_b32 v60, 0
    v_mov_b32 v61, 0
    v_mov_b32 v62, 0
    v_mov_b32 v63, 0
    v_mov_b32 v64, 0
    v_mov_b32 v65, 0
    v_mov_b32 v66, 0
    v_mov_b32 v67, 0
    v_mov_b32 v68, 0
    v_mov_b32 v69, 0
    v_mov_b32 v70, 0
    v_mov_b32 v71, 0
    v_mov_b32 v72, 0
    v_mov_b32 v73, 0
    v_mov_b32 v74, 0
    v_mov_b32 v75, 0
    v_mov_b32 v76, 0
    v_mov_b32 v77, 0
    v_mov_b32 v78, 0
    v_mov_b32 v79, 0
    s_mov_b32 s30, s34
    s_add_u32 s25, s25, 1
    s_mov_b32 s43, 0
    buffer_load_dwordx2 v[112:113], v21, s[8:11], s32 offen offset:0 sc1
    buffer_load_dwordx2 v[114:115], v22, s[8:11], s32 offen offset:0 sc1
    buffer_load_dwordx2 v[116:117], v23, s[8:11], s32 offen offset:0 sc1
w0_37:
    s_waitcnt vmcnt(0)
    v_max3_u32 v32, v112, v114, v116
    v_dot2_f32_bf16 v96, v112, s4, v88
    v_cmp_eq_u32 vcc, -1, v32
    v_dot2_f32_bf16 v97, v112, s5, v89
    v_dot2_f32_bf16 v98, v113, s4, v90
    v_dot2_f32_bf16 v99, v113, s5, v91
    v_dot2c_f32_bf16 v96, s4, v114
    v_dot2c_f32_bf16 v97, s5, v114
    v_dot2c_f32_bf16 v98, s4, v115
    v_dot2c_f32_bf16 v99, s5, v115
    s_cbranch_vccnz w1_38
    v_dot2c_f32_bf16 v96, s4, v116
    v_dot2c_f32_bf16 v97, s5, v116
    v_dot2c_f32_bf16 v98, s4, v117
    v_dot2c_f32_bf16 v99, s5, v117
    s_nop 0
    v_cvt_pk_bf16_f32 v104, v96, v97
    s_nop 0
    v_cvt_pk_bf16_f32 v105, v98, v99
    buffer_store_dwordx2 v[104:105], v7, s[8:11], s30 offen
    s_barrier
    s_branch step_15
    .p2align 5
Bo_17:
    v_smfmac_f32_16x16x64_bf16 v[72:75], v[40:43], a[128:135], v154
    v_smfmac_f32_16x16x64_bf16 v[76:79], v[40:43], a[160:167], v154
    v_smfmac_f32_16x16x64_bf16 v[72:75], v[44:47], a[136:143], v154
    v_smfmac_f32_16x16x64_bf16 v[76:79], v[44:47], a[168:175], v154
    v_smfmac_f32_16x16x64_bf16 v[72:75], v[48:51], a[144:151], v154
    v_smfmac_f32_16x16x64_bf16 v[76:79], v[48:51], a[176:183], v154
    v_smfmac_f32_16x16x64_bf16 v[72:75], v[52:55], a[152:159], v154
    v_smfmac_f32_16x16x64_bf16 v[76:79], v[52:55], a[184:191], v154
    s_nop 6
    v_pk_add_f32 v[88:89], v[72:73], v[74:75]
    v_pk_add_f32 v[90:91], v[76:77], v[78:79]
    ds_write_b128 v4, v[88:91] offset:12544
    s_mov_b64 exec, 1
    ds_add_u32 v19, v27
    s_mov_b64 exec, -1
    s_cmp_eq_u32 s25, 63
    s_cbranch_scc1 L_done
    s_and_b32 s54, s25, 3
    s_lshl_b32 s54, s54, 14
    s_add_u32 s32, s54, s28
    s_barrier
    buffer_load_dwordx4 v[40:43], v2, s[8:11], s31 offen offset:0 sc1
    buffer_load_dwordx4 v[44:47], v2, s[8:11], s31 offen offset:1024 sc1
    buffer_load_dwordx4 v[48:51], v2, s[8:11], s31 offen offset:2048 sc1
    buffer_load_dwordx4 v[52:55], v2, s[8:11], s31 offen offset:3072 sc1
    s_branch C_18
    .p2align 5
Do_19:
    s_cmp_lg_u32 s24, 0
    s_cbranch_scc1 d0_39
    s_lshr_b32 s54, s25, 3
    s_and_b32 s55, s25, 7
    s_lshl_b32 s54, s54, 14
    s_lshl_b32 s55, s55, 10
    s_add_u32 s54, s54, s55
    s_add_u32 s42, s54, s99
    v_mov_b32 v36, v148
    v_mov_b32 v37, v150
    buffer_store_dwordx2 v[36:37], v15, s[8:11], s42 offen sc1
    s_and_b32 s57, s25, 7
    s_cmp_eq_u32 s57, 7
    s_cbranch_scc1 ks_42
k1_40:
    s_add_u32 s54, s25, 1
    s_lshl_b32 s54, s54, 5
    s_add_u32 s54, s54, s22
    s_lshl_b32 s54, s54, 3
    s_add_u32 s54, s54, s23
    s_add_u32 s55, s54, s23
    s_lshl_b32 s54, s54, 10
    s_lshl_b32 s55, s55, 10
    s_add_u32 s40, s54, 0x1000000
    s_add_u32 s41, s55, 0x2200000
    buffer_load_dwordx4 v[132:135], v3, s[8:11], s40 offen sc1
    buffer_load_dwordx4 v[136:139], v13, s[8:11], s40 offen sc1
    buffer_load_dwordx4 v[140:143], v3, s[8:11], s41 offen sc1
    buffer_load_dwordx4 v[144:147], v3, s[8:11], s41 offen offset:1024 sc1
    s_cmp_eq_u32 s57, 6
    s_cbranch_scc0 k2_41
    s_lshr_b32 s52, s25, 1
    s_add_u32 s52, s52, 33
    s_min_u32 s52, s52, 60
    v_mov_b32 v39, s52
    buffer_load_dword v5, v39, s[16:19], 0 offen sc1
k2_41:
    s_cmp_eq_u32 s57, 0
    s_cbranch_scc0 k3_43
    v_mov_b32 v32, s25
    s_mov_b64 exec, 1
    buffer_store_dword v32, v16, s[8:11], 0 offen sc1
    s_mov_b64 exec, -1
k3_43:
    s_add_u32 s54, s25, 1
    s_and_b32 s54, s54, 3
    s_lshl_b32 s54, s54, 13
    s_add_u32 s33, s54, s29
    s_add_u32 s51, s51, 3
d0_39:
    s_add_u32 s54, s25, 1
    s_and_b32 s54, s54, 3
    s_lshl_b32 s54, s54, 14
    s_add_u32 s31, s54, s27
    s_add_u32 s54, s25, 1
    s_and_b32 s54, s54, 3
    s_lshl_b32 s54, s54, 14
    s_add_u32 s34, s54, s26
    s_cmp_lg_u32 s24, 3
    s_cbranch_scc1 d3_44
d3_44:
    v_mov_b32 v80, 0
    v_mov_b32 v81, 0
    v_mov_b32 v82, 0
    v_mov_b32 v83, 0
    v_mov_b32 v84, 0
    v_mov_b32 v85, 0
    v_mov_b32 v86, 0
    v_mov_b32 v87, 0
    v_mov_b32 v56, 0
    v_mov_b32 v57, 0
    v_mov_b32 v58, 0
    v_mov_b32 v59, 0
    v_mov_b32 v60, 0
    v_mov_b32 v61, 0
    v_mov_b32 v62, 0
    v_mov_b32 v63, 0
    v_mov_b32 v64, 0
    v_mov_b32 v65, 0
    v_mov_b32 v66, 0
    v_mov_b32 v67, 0
    v_mov_b32 v68, 0
    v_mov_b32 v69, 0
    v_mov_b32 v70, 0
    v_mov_b32 v71, 0
    v_mov_b32 v72, 0
    v_mov_b32 v73, 0
    v_mov_b32 v74, 0
    v_mov_b32 v75, 0
    v_mov_b32 v76, 0
    v_mov_b32 v77, 0
    v_mov_b32 v78, 0
    v_mov_b32 v79, 0
    s_mov_b32 s30, s34
    s_add_u32 s25, s25, 1
    s_barrier
    s_branch step_15
    .p2align 5
ks_42:
    s_cmp_lt_u32 s25, 7
    s_cbranch_scc1 k1_40
    s_mov_b32 s43, 0
kp_45:
    v_readfirstlane_b32 s52, v5
    s_and_b32 s52, s52, 0xff
    s_cmp_ge_u32 s52, 32
    s_cbranch_scc1 k1_40
    buffer_load_dword v5, v39, s[16:19], 0 offen sc1
    s_add_u32 s43, s43, 1
    s_cmp_ge_u32 s43, 0x20000
    s_cbranch_scc1 L_exit
    s_waitcnt vmcnt(0)
    s_branch kp_45
    .p2align 5
last_16:
    v_smfmac_f32_16x16x64_bf16 v[72:75], v[40:43], a[128:135], v154
    v_smfmac_f32_16x16x64_bf16 v[76:79], v[40:43], a[160:167], v154
    v_smfmac_f32_16x16x64_bf16 v[72:75], v[44:47], a[136:143], v154
    v_smfmac_f32_16x16x64_bf16 v[76:79], v[44:47], a[168:175], v154
    v_smfmac_f32_16x16x64_bf16 v[72:75], v[48:51], a[144:151], v154
    v_smfmac_f32_16x16x64_bf16 v[76:79], v[48:51], a[176:183], v154
    v_smfmac_f32_16x16x64_bf16 v[72:75], v[52:55], a[152:159], v154
    v_smfmac_f32_16x16x64_bf16 v[76:79], v[52:55], a[184:191], v154
    s_nop 6
    v_pk_add_f32 v[88:89], v[72:73], v[74:75]
    v_pk_add_f32 v[90:91], v[76:77], v[78:79]
    ds_read_b32 v34, v19
    ds_read_b128 v[96:99], v3 offset:13568
    ds_read_b128 v[100:103], v3 offset:14592
    ds_read_b128 v[104:107], v3 offset:15616
    s_waitcnt lgkmcnt(0)
    v_cmp_ne_u32 vcc, s51, v34
    s_cbranch_vccnz vr_47
vm_46:
    v_pk_add_f32 v[88:89], v[88:89], v[96:97]
    v_pk_add_f32 v[100:101], v[100:101], v[104:105]
    v_pk_add_f32 v[90:91], v[90:91], v[98:99]
    v_pk_add_f32 v[102:103], v[102:103], v[106:107]
    v_pk_add_f32 v[88:89], v[88:89], v[100:101]
    v_pk_add_f32 v[90:91], v[90:91], v[102:103]
    v_cvt_pk_bf16_f32 v148, v88, v89
    v_cvt_pk_bf16_f32 v150, v90, v91
    s_lshr_b32 s54, s25, 3
    s_and_b32 s55, s25, 7
    s_lshl_b32 s54, s54, 14
    s_lshl_b32 s55, s55, 10
    s_add_u32 s54, s54, s55
    s_add_u32 s42, s54, s99
    s_mov_b64 exec, s[46:47]
    buffer_store_dwordx4 v[128:131], v14, s[8:11], s42 offen
    s_mov_b64 exec, -1
    v_mov_b32 v36, v148
    v_mov_b32 v37, v150
    buffer_store_dwordx2 v[36:37], v15, s[8:11], s42 offen
    v_mov_b32 v32, 64
    s_waitcnt vmcnt(0)
    s_mov_b64 exec, 1
    buffer_store_dword v32, v16, s[8:11], 0 offen
    s_mov_b64 exec, -1
    s_branch L_done
    .p2align 5
gfm_22:
    s_mov_b64 s[60:61], vcc
    s_mov_b64 exec, vcc
    buffer_load_dwordx4 v[40:43], v2, s[8:11], s30 offen offset:0 sc1
    s_mov_b64 exec, -1
    s_waitcnt vmcnt(3)
    v_max_u32 v32, v44, v46
    v_cmp_eq_u32 vcc, -1, v32
    s_cbranch_vccnz gfm_48
    v_smfmac_f32_16x16x64_bf16 v[56:59], v[44:47], a[8:15], v154
    v_smfmac_f32_16x16x64_bf16 v[60:63], v[44:47], a[72:79], v154
    v_smfmac_f32_16x16x64_bf16 v[64:67], v[44:47], a[40:47], v154
    s_waitcnt vmcnt(2)
    v_max_u32 v32, v48, v50
    v_cmp_eq_u32 vcc, -1, v32
    v_smfmac_f32_16x16x64_bf16 v[68:71], v[44:47], a[104:111], v154
    s_cbranch_vccnz gfm_49
    v_smfmac_f32_16x16x64_bf16 v[56:59], v[48:51], a[16:23], v154
    v_smfmac_f32_16x16x64_bf16 v[60:63], v[48:51], a[80:87], v154
    v_smfmac_f32_16x16x64_bf16 v[64:67], v[48:51], a[48:55], v154
    s_waitcnt vmcnt(1)
    v_max_u32 v32, v52, v54
    v_cmp_eq_u32 vcc, -1, v32
    v_smfmac_f32_16x16x64_bf16 v[68:71], v[48:51], a[112:119], v154
    s_cbranch_vccnz gfm_50
    v_smfmac_f32_16x16x64_bf16 v[56:59], v[52:55], a[24:31], v154
    v_smfmac_f32_16x16x64_bf16 v[60:63], v[52:55], a[88:95], v154
    v_smfmac_f32_16x16x64_bf16 v[64:67], v[52:55], a[56:63], v154
    v_smfmac_f32_16x16x64_bf16 v[68:71], v[52:55], a[120:127], v154
    s_branch gsm_51
    .p2align 5
gfm_23:
    s_mov_b64 s[62:63], vcc
    s_mov_b64 exec, vcc
    buffer_load_dwordx4 v[44:47], v2, s[8:11], s30 offen offset:1024 sc1
    s_mov_b64 exec, -1
    s_waitcnt vmcnt(2)
    v_max_u32 v32, v48, v50
    v_cmp_eq_u32 vcc, -1, v32
    s_cbranch_vccnz gfm_52
    v_smfmac_f32_16x16x64_bf16 v[56:59], v[48:51], a[16:23], v154
    v_smfmac_f32_16x16x64_bf16 v[60:63], v[48:51], a[80:87], v154
    v_smfmac_f32_16x16x64_bf16 v[64:67], v[48:51], a[48:55], v154
    s_waitcnt vmcnt(1)
    v_max_u32 v32, v52, v54
    v_cmp_eq_u32 vcc, -1, v32
    v_smfmac_f32_16x16x64_bf16 v[68:71], v[48:51], a[112:119], v154
    s_cbranch_vccnz gfm_53
    v_smfmac_f32_16x16x64_bf16 v[56:59], v[52:55], a[24:31], v154
    v_smfmac_f32_16x16x64_bf16 v[60:63], v[52:55], a[88:95], v154
    v_smfmac_f32_16x16x64_bf16 v[64:67], v[52:55], a[56:63], v154
    v_smfmac_f32_16x16x64_bf16 v[68:71], v[52:55], a[120:127], v154
    s_branch gsm_54
    .p2align 5
gfm_24:
    s_mov_b64 s[64:65], vcc
    s_mov_b64 exec, vcc
    buffer_load_dwordx4 v[48:51], v2, s[8:11], s30 offen offset:2048 sc1
    s_mov_b64 exec, -1
    s_waitcnt vmcnt(1)
    v_max_u32 v32, v52, v54
    v_cmp_eq_u32 vcc, -1, v32
    s_cbranch_vccnz gfm_55
    v_smfmac_f32_16x16x64_bf16 v[56:59], v[52:55], a[24:31], v154
    v_smfmac_f32_16x16x64_bf16 v[60:63], v[52:55], a[88:95], v154
    v_smfmac_f32_16x16x64_bf16 v[64:67], v[52:55], a[56:63], v154
    v_smfmac_f32_16x16x64_bf16 v[68:71], v[52:55], a[120:127], v154
    s_branch gsm_56
    .p2align 5
gfm_25:
    s_mov_b64 s[66:67], vcc
    s_mov_b64 exec, vcc
    buffer_load_dwordx4 v[52:55], v2, s[8:11], s30 offen offset:3072 sc1
    s_branch gsm_57
    .p2align 5
gfm_48:
    s_mov_b64 s[62:63], vcc
    s_mov_b64 exec, vcc
    buffer_load_dwordx4 v[44:47], v2, s[8:11], s30 offen offset:1024 sc1
    s_mov_b64 exec, -1
    s_waitcnt vmcnt(3)
    v_max_u32 v32, v48, v50
    v_cmp_eq_u32 vcc, -1, v32
    s_cbranch_vccnz gfm_58
    v_smfmac_f32_16x16x64_bf16 v[56:59], v[48:51], a[16:23], v154
    v_smfmac_f32_16x16x64_bf16 v[60:63], v[48:51], a[80:87], v154
    v_smfmac_f32_16x16x64_bf16 v[64:67], v[48:51], a[48:55], v154
    s_waitcnt vmcnt(2)
    v_max_u32 v32, v52, v54
    v_cmp_eq_u32 vcc, -1, v32
    v_smfmac_f32_16x16x64_bf16 v[68:71], v[48:51], a[112:119], v154
    s_cbranch_vccnz gfm_59
    v_smfmac_f32_16x16x64_bf16 v[56:59], v[52:55], a[24:31], v154
    v_smfmac_f32_16x16x64_bf16 v[60:63], v[52:55], a[88:95], v154
    v_smfmac_f32_16x16x64_bf16 v[64:67], v[52:55], a[56:63], v154
    v_smfmac_f32_16x16x64_bf16 v[68:71], v[52:55], a[120:127], v154
    s_branch gsm_60
    .p2align 5
gfm_49:
    s_mov_b64 s[64:65], vcc
    s_mov_b64 exec, vcc
    buffer_load_dwordx4 v[48:51], v2, s[8:11], s30 offen offset:2048 sc1
    s_mov_b64 exec, -1
    s_waitcnt vmcnt(2)
    v_max_u32 v32, v52, v54
    v_cmp_eq_u32 vcc, -1, v32
    s_cbranch_vccnz gfm_61
    v_smfmac_f32_16x16x64_bf16 v[56:59], v[52:55], a[24:31], v154
    v_smfmac_f32_16x16x64_bf16 v[60:63], v[52:55], a[88:95], v154
    v_smfmac_f32_16x16x64_bf16 v[64:67], v[52:55], a[56:63], v154
    v_smfmac_f32_16x16x64_bf16 v[68:71], v[52:55], a[120:127], v154
    s_branch gsm_62
    .p2align 5
gfm_50:
    s_mov_b64 s[66:67], vcc
    s_mov_b64 exec, vcc
    buffer_load_dwordx4 v[52:55], v2, s[8:11], s30 offen offset:3072 sc1
    s_branch gsm_63
    .p2align 5
gfm_52:
    s_mov_b64 s[64:65], vcc
    s_mov_b64 exec, vcc
    buffer_load_dwordx4 v[48:51], v2, s[8:11], s30 offen offset:2048 sc1
    s_mov_b64 exec, -1
    s_waitcnt vmcnt(2)
    v_max_u32 v32, v52, v54
    v_cmp_eq_u32 vcc, -1, v32
    s_cbranch_vccnz gfm_64
    v_smfmac_f32_16x16x64_bf16 v[56:59], v[52:55], a[24:31], v154
    v_smfmac_f32_16x16x64_bf16 v[60:63], v[52:55], a[88:95], v154
    v_smfmac_f32_16x16x64_bf16 v[64:67], v[52:55], a[56:63], v154
    v_smfmac_f32_16x16x64_bf16 v[68:71], v[52:55], a[120:127], v154
    s_branch gsm_65
    .p2align 5
gfm_53:
    s_mov_b64 s[66:67], vcc
    s_mov_b64 exec, vcc
    buffer_load_dwordx4 v[52:55], v2, s[8:11], s30 offen offset:3072 sc1
    s_branch gsm_66
    .p2align 5
gfm_55:
    s_mov_b64 s[66:67], vcc
    s_mov_b64 exec, vcc
    buffer_load_dwordx4 v[52:55], v2, s[8:11], s30 offen offset:3072 sc1
    s_branch gsm_67
    .p2align 5
gfm_58:
    s_mov_b64 s[64:65], vcc
    s_mov_b64 exec, vcc
    buffer_load_dwordx4 v[48:51], v2, s[8:11], s30 offen offset:2048 sc1
    s_mov_b64 exec, -1
    s_waitcnt vmcnt(3)
    v_max_u32 v32, v52, v54
    v_cmp_eq_u32 vcc, -1, v32
    s_cbranch_vccnz gfm_68
    v_smfmac_f32_16x16x64_bf16 v[56:59], v[52:55], a[24:31], v154
    v_smfmac_f32_16x16x64_bf16 v[60:63], v[52:55], a[88:95], v154
    v_smfmac_f32_16x16x64_bf16 v[64:67], v[52:55], a[56:63], v154
    v_smfmac_f32_16x16x64_bf16 v[68:71], v[52:55], a[120:127], v154
    s_branch gsm_69
    .p2align 5
gfm_59:
    s_mov_b64 s[66:67], vcc
    s_mov_b64 exec, vcc
    buffer_load_dwordx4 v[52:55], v2, s[8:11], s30 offen offset:3072 sc1
    s_branch gsm_70
    .p2align 5
gfm_61:
    s_mov_b64 s[66:67], vcc
    s_mov_b64 exec, vcc
    buffer_load_dwordx4 v[52:55], v2, s[8:11], s30 offen offset:3072 sc1
    s_branch gsm_71
    .p2align 5
gfm_64:
    s_mov_b64 s[66:67], vcc
    s_mov_b64 exec, vcc
    buffer_load_dwordx4 v[52:55], v2, s[8:11], s30 offen offset:3072 sc1
    s_branch gsm_72
    .p2align 5
gfm_68:
    s_mov_b64 s[66:67], vcc
    s_mov_b64 exec, vcc
    buffer_load_dwordx4 v[52:55], v2, s[8:11], s30 offen offset:3072 sc1
    s_branch gsm_73
    .p2align 5
gsm_51:
    s_mov_b64 exec, s[60:61]
glm_74:
    s_waitcnt vmcnt(4)
    v_max_u32 v32, v40, v42
    v_cmp_eq_u32 vcc, -1, v32
    s_cbranch_vccz gom_75
    buffer_load_dwordx4 v[40:43], v2, s[8:11], s30 offen offset:0 sc1
    s_waitcnt vmcnt(4)
    v_max_u32 v32, v40, v42
    v_cmp_eq_u32 vcc, -1, v32
    s_cbranch_vccz gom_75
    buffer_load_dwordx4 v[40:43], v2, s[8:11], s30 offen offset:0 sc1
    s_add_u32 s43, s43, 1
    s_cmp_lt_u32 s43, 0x20000
    s_cbranch_scc1 glm_74
    s_mov_b64 exec, -1
    s_branch L_exit
    .p2align 5
gom_75:
    s_mov_b64 exec, -1
    v_smfmac_f32_16x16x64_bf16 v[56:59], v[40:43], a[0:7], v154
    v_smfmac_f32_16x16x64_bf16 v[60:63], v[40:43], a[64:71], v154
    v_smfmac_f32_16x16x64_bf16 v[64:67], v[40:43], a[32:39], v154
    v_smfmac_f32_16x16x64_bf16 v[68:71], v[40:43], a[96:103], v154
    s_branch gdm_21
    .p2align 5
gsm_54:
    s_mov_b64 exec, s[62:63]
glm_76:
    s_waitcnt vmcnt(4)
    v_max_u32 v32, v44, v46
    v_cmp_eq_u32 vcc, -1, v32
    s_cbranch_vccz gom_77
    buffer_load_dwordx4 v[44:47], v2, s[8:11], s30 offen offset:1024 sc1
    s_waitcnt vmcnt(4)
    v_max_u32 v32, v44, v46
    v_cmp_eq_u32 vcc, -1, v32
    s_cbranch_vccz gom_77
    buffer_load_dwordx4 v[44:47], v2, s[8:11], s30 offen offset:1024 sc1
    s_add_u32 s43, s43, 1
    s_cmp_lt_u32 s43, 0x20000
    s_cbranch_scc1 glm_76
    s_mov_b64 exec, -1
    s_branch L_exit
    .p2align 5
gom_77:
    s_mov_b64 exec, -1
    v_smfmac_f32_16x16x64_bf16 v[56:59], v[44:47], a[8:15], v154
    v_smfmac_f32_16x16x64_bf16 v[60:63], v[44:47], a[72:79], v154
    v_smfmac_f32_16x16x64_bf16 v[64:67], v[44:47], a[40:47], v154
    v_smfmac_f32_16x16x64_bf16 v[68:71], v[44:47], a[104:111], v154
    s_branch gdm_21
    .p2align 5
gsm_56:
    s_mov_b64 exec, s[64:65]
glm_78:
    s_waitcnt vmcnt(4)
    v_max_u32 v32, v48, v50
    v_cmp_eq_u32 vcc, -1, v32
    s_cbranch_vccz gom_79
    buffer_load_dwordx4 v[48:51], v2, s[8:11], s30 offen offset:2048 sc1
    s_waitcnt vmcnt(4)
    v_max_u32 v32, v48, v50
    v_cmp_eq_u32 vcc, -1, v32
    s_cbranch_vccz gom_79
    buffer_load_dwordx4 v[48:51], v2, s[8:11], s30 offen offset:2048 sc1
    s_add_u32 s43, s43, 1
    s_cmp_lt_u32 s43, 0x20000
    s_cbranch_scc1 glm_78
    s_mov_b64 exec, -1
    s_branch L_exit
    .p2align 5
gom_79:
    s_mov_b64 exec, -1
    v_smfmac_f32_16x16x64_bf16 v[56:59], v[48:51], a[16:23], v154
    v_smfmac_f32_16x16x64_bf16 v[60:63], v[48:51], a[80:87], v154
    v_smfmac_f32_16x16x64_bf16 v[64:67], v[48:51], a[48:55], v154
    v_smfmac_f32_16x16x64_bf16 v[68:71], v[48:51], a[112:119], v154
    s_branch gdm_21
    .p2align 5
gsm_57:
    s_mov_b64 exec, s[66:67]
glm_80:
    s_waitcnt vmcnt(4)
    v_max_u32 v32, v52, v54
    v_cmp_eq_u32 vcc, -1, v32
    s_cbranch_vccz gom_81
    buffer_load_dwordx4 v[52:55], v2, s[8:11], s30 offen offset:3072 sc1
    s_waitcnt vmcnt(4)
    v_max_u32 v32, v52, v54
    v_cmp_eq_u32 vcc, -1, v32
    s_cbranch_vccz gom_81
    buffer_load_dwordx4 v[52:55], v2, s[8:11], s30 offen offset:3072 sc1
    s_add_u32 s43, s43, 1
    s_cmp_lt_u32 s43, 0x20000
    s_cbranch_scc1 glm_80
    s_mov_b64 exec, -1
    s_branch L_exit
    .p2align 5
gom_81:
    s_mov_b64 exec, -1
    v_smfmac_f32_16x16x64_bf16 v[56:59], v[52:55], a[24:31], v154
    v_smfmac_f32_16x16x64_bf16 v[60:63], v[52:55], a[88:95], v154
    v_smfmac_f32_16x16x64_bf16 v[64:67], v[52:55], a[56:63], v154
    v_smfmac_f32_16x16x64_bf16 v[68:71], v[52:55], a[120:127], v154
    s_branch gdm_21
    .p2align 5
gsm_60:
glm_82:
    s_mov_b64 exec, s[60:61]
    s_waitcnt vmcnt(4)
    v_max_u32 v32, v40, v42
    v_cmp_eq_u32 vcc, -1, v32
    s_cbranch_vccz gom_83
    buffer_load_dwordx4 v[40:43], v2, s[8:11], s30 offen offset:0 sc1
    s_mov_b64 exec, s[62:63]
    s_waitcnt vmcnt(4)
    v_max_u32 v32, v44, v46
    v_cmp_eq_u32 vcc, -1, v32
    s_cbranch_vccz gom_84
    buffer_load_dwordx4 v[44:47], v2, s[8:11], s30 offen offset:1024 sc1
    s_add_u32 s43, s43, 1
    s_cmp_lt_u32 s43, 0x20000
    s_cbranch_scc1 glm_82
    s_mov_b64 exec, -1
    s_branch L_exit
    .p2align 5
gom_83:
    s_mov_b64 exec, -1
    v_smfmac_f32_16x16x64_bf16 v[56:59], v[40:43], a[0:7], v154
    v_smfmac_f32_16x16x64_bf16 v[60:63], v[40:43], a[64:71], v154
    v_smfmac_f32_16x16x64_bf16 v[64:67], v[40:43], a[32:39], v154
    v_smfmac_f32_16x16x64_bf16 v[68:71], v[40:43], a[96:103], v154
    s_branch gsm_54
    .p2align 5
gom_84:
    s_mov_b64 exec, -1
    v_smfmac_f32_16x16x64_bf16 v[56:59], v[44:47], a[8:15], v154
    v_smfmac_f32_16x16x64_bf16 v[60:63], v[44:47], a[72:79], v154
    v_smfmac_f32_16x16x64_bf16 v[64:67], v[44:47], a[40:47], v154
    v_smfmac_f32_16x16x64_bf16 v[68:71], v[44:47], a[104:111], v154
    s_branch gsm_51
    .p2align 5
gsm_62:
glm_85:
    s_mov_b64 exec, s[60:61]
    s_waitcnt vmcnt(4)
    v_max_u32 v32, v40, v42
    v_cmp_eq_u32 vcc, -1, v32
    s_cbranch_vccz gom_86
    buffer_load_dwordx4 v[40:43], v2, s[8:11], s30 offen offset:0 sc1
    s_mov_b64 exec, s[64:65]
    s_waitcnt vmcnt(4)
    v_max_u32 v32, v48, v50
    v_cmp_eq_u32 vcc, -1, v32
    s_cbranch_vccz gom_87
    buffer_load_dwordx4 v[48:51], v2, s[8:11], s30 offen offset:2048 sc1
    s_add_u32 s43, s43, 1
    s_cmp_lt_u32 s43, 0x20000
    s_cbranch_scc1 glm_85
    s_mov_b64 exec, -1
    s_branch L_exit
    .p2align 5
gom_86:
    s_mov_b64 exec, -1
    v_smfmac_f32_16x16x64_bf16 v[56:59], v[40:43], a[0:7], v154
    v_smfmac_f32_16x16x64_bf16 v[60:63], v[40:43], a[64:71], v154
    v_smfmac_f32_16x16x64_bf16 v[64:67], v[40:43], a[32:39], v154
    v_smfmac_f32_16x16x64_bf16 v[68:71], v[40:43], a[96:103], v154
    s_branch gsm_56
    .p2align 5
gom_87:
    s_mov_b64 exec, -1
    v_smfmac_f32_16x16x64_bf16 v[56:59], v[48:51], a[16:23], v154
    v_smfmac_f32_16x16x64_bf16 v[60:63], v[48:51], a[80:87], v154
    v_smfmac_f32_16x16x64_bf16 v[64:67], v[48:51], a[48:55], v154
    v_smfmac_f32_16x16x64_bf16 v[68:71], v[48:51], a[112:119], v154
    s_branch gsm_51
    .p2align 5
gsm_63:
glm_88:
    s_mov_b64 exec, s[60:61]
    s_waitcnt vmcnt(4)
    v_max_u32 v32, v40, v42
    v_cmp_eq_u32 vcc, -1, v32
    s_cbranch_vccz gom_89
    buffer_load_dwordx4 v[40:43], v2, s[8:11], s30 offen offset:0 sc1
    s_mov_b64 exec, s[66:67]
    s_waitcnt vmcnt(4)
    v_max_u32 v32, v52, v54
    v_cmp_eq_u32 vcc, -1, v32
    s_cbranch_vccz gom_90
    buffer_load_dwordx4 v[52:55], v2, s[8:11], s30 offen offset:3072 sc1
    s_add_u32 s43, s43, 1
    s_cmp_lt_u32 s43, 0x20000
    s_cbranch_scc1 glm_88
    s_mov_b64 exec, -1
    s_branch L_exit
    .p2align 5
gom_89:
    s_mov_b64 exec, -1
    v_smfmac_f32_16x16x64_bf16 v[56:59], v[40:43], a[0:7], v154
    v_smfmac_f32_16x16x64_bf16 v[60:63], v[40:43], a[64:71], v154
    v_smfmac_f32_16x16x64_bf16 v[64:67], v[40:43], a[32:39], v154
    v_smfmac_f32_16x16x64_bf16 v[68:71], v[40:43], a[96:103], v154
    s_branch gsm_57
    .p2align 5
gom_90:
    s_mov_b64 exec, -1
    v_smfmac_f32_16x16x64_bf16 v[56:59], v[52:55], a[24:31], v154
    v_smfmac_f32_16x16x64_bf16 v[60:63], v[52:55], a[88:95], v154
    v_smfmac_f32_16x16x64_bf16 v[64:67], v[52:55], a[56:63], v154
    v_smfmac_f32_16x16x64_bf16 v[68:71], v[52:55], a[120:127], v154
    s_branch gsm_51
    .p2align 5
gsm_65:
glm_91:
    s_mov_b64 exec, s[62:63]
    s_waitcnt vmcnt(4)
    v_max_u32 v32, v44, v46
    v_cmp_eq_u32 vcc, -1, v32
    s_cbranch_vccz gom_92
    buffer_load_dwordx4 v[44:47], v2, s[8:11], s30 offen offset:1024 sc1
    s_mov_b64 exec, s[64:65]
    s_waitcnt vmcnt(4)
    v_max_u32 v32, v48, v50
    v_cmp_eq_u32 vcc, -1, v32
    s_cbranch_vccz gom_93
    buffer_load_dwordx4 v[48:51], v2, s[8:11], s30 offen offset:2048 sc1
    s_add_u32 s43, s43, 1
    s_cmp_lt_u32 s43, 0x20000
    s_cbranch_scc1 glm_91
    s_mov_b64 exec, -1
    s_branch L_exit
    .p2align 5
gom_92:
    s_mov_b64 exec, -1
    v_smfmac_f32_16x16x64_bf16 v[56:59], v[44:47], a[8:15], v154
    v_smfmac_f32_16x16x64_bf16 v[60:63], v[44:47], a[72:79], v154
    v_smfmac_f32_16x16x64_bf16 v[64:67], v[44:47], a[40:47], v154
    v_smfmac_f32_16x16x64_bf16 v[68:71], v[44:47], a[104:111], v154
    s_branch gsm_56
    .p2align 5
gom_93:
    s_mov_b64 exec, -1
    v_smfmac_f32_16x16x64_bf16 v[56:59], v[48:51], a[16:23], v154
    v_smfmac_f32_16x16x64_bf16 v[60:63], v[48:51], a[80:87], v154
    v_smfmac_f32_16x16x64_bf16 v[64:67], v[48:51], a[48:55], v154
    v_smfmac_f32_16x16x64_bf16 v[68:71], v[48:51], a[112:119], v154
    s_branch gsm_54
    .p2align 5
gsm_66:
glm_94:
    s_mov_b64 exec, s[62:63]
    s_waitcnt vmcnt(4)
    v_max_u32 v32, v44, v46
    v_cmp_eq_u32 vcc, -1, v32
    s_cbranch_vccz gom_95
    buffer_load_dwordx4 v[44:47], v2, s[8:11], s30 offen offset:1024 sc1
    s_mov_b64 exec, s[66:67]
    s_waitcnt vmcnt(4)
    v_max_u32 v32, v52, v54
    v_cmp_eq_u32 vcc, -1, v32
    s_cbranch_vccz gom_96
    buffer_load_dwordx4 v[52:55], v2, s[8:11], s30 offen offset:3072 sc1
    s_add_u32 s43, s43, 1
    s_cmp_lt_u32 s43, 0x20000
    s_cbranch_scc1 glm_94
    s_mov_b64 exec, -1
    s_branch L_exit
    .p2align 5
gom_95:
    s_mov_b64 exec, -1
    v_smfmac_f32_16x16x64_bf16 v[56:59], v[44:47], a[8:15], v154
    v_smfmac_f32_16x16x64_bf16 v[60:63], v[44:47], a[72:79], v154
    v_smfmac_f32_16x16x64_bf16 v[64:67], v[44:47], a[40:47], v154
    v_smfmac_f32_16x16x64_bf16 v[68:71], v[44:47], a[104:111], v154
    s_branch gsm_57
    .p2align 5
gom_96:
    s_mov_b64 exec, -1
    v_smfmac_f32_16x16x64_bf16 v[56:59], v[52:55], a[24:31], v154
    v_smfmac_f32_16x16x64_bf16 v[60:63], v[52:55], a[88:95], v154
    v_smfmac_f32_16x16x64_bf16 v[64:67], v[52:55], a[56:63], v154
    v_smfmac_f32_16x16x64_bf16 v[68:71], v[52:55], a[120:127], v154
    s_branch gsm_54
    .p2align 5
gsm_67:
glm_97:
    s_mov_b64 exec, s[64:65]
    s_waitcnt vmcnt(4)
    v_max_u32 v32, v48, v50
    v_cmp_eq_u32 vcc, -1, v32
    s_cbranch_vccz gom_98
    buffer_load_dwordx4 v[48:51], v2, s[8:11], s30 offen offset:2048 sc1
    s_mov_b64 exec, s[66:67]
    s_waitcnt vmcnt(4)
    v_max_u32 v32, v52, v54
    v_cmp_eq_u32 vcc, -1, v32
    s_cbranch_vccz gom_99
    buffer_load_dwordx4 v[52:55], v2, s[8:11], s30 offen offset:3072 sc1
    s_add_u32 s43, s43, 1
    s_cmp_lt_u32 s43, 0x20000
    s_cbranch_scc1 glm_97
    s_mov_b64 exec, -1
    s_branch L_exit
    .p2align 5
gom_98:
    s_mov_b64 exec, -1
    v_smfmac_f32_16x16x64_bf16 v[56:59], v[48:51], a[16:23], v154
    v_smfmac_f32_16x16x64_bf16 v[60:63], v[48:51], a[80:87], v154
    v_smfmac_f32_16x16x64_bf16 v[64:67], v[48:51], a[48:55], v154
    v_smfmac_f32_16x16x64_bf16 v[68:71], v[48:51], a[112:119], v154
    s_branch gsm_57
    .p2align 5
gom_99:
    s_mov_b64 exec, -1
    v_smfmac_f32_16x16x64_bf16 v[56:59], v[52:55], a[24:31], v154
    v_smfmac_f32_16x16x64_bf16 v[60:63], v[52:55], a[88:95], v154
    v_smfmac_f32_16x16x64_bf16 v[64:67], v[52:55], a[56:63], v154
    v_smfmac_f32_16x16x64_bf16 v[68:71], v[52:55], a[120:127], v154
    s_branch gsm_56
    .p2align 5
gsm_69:
glm_100:
    s_mov_b64 exec, s[60:61]
    s_waitcnt vmcnt(6)
    v_max_u32 v32, v40, v42
    v_cmp_eq_u32 vcc, -1, v32
    s_cbranch_vccz gom_101
    buffer_load_dwordx4 v[40:43], v2, s[8:11], s30 offen offset:0 sc1
    s_mov_b64 exec, s[62:63]
    s_waitcnt vmcnt(6)
    v_max_u32 v32, v44, v46
    v_cmp_eq_u32 vcc, -1, v32
    s_cbranch_vccz gom_102
    buffer_load_dwordx4 v[44:47], v2, s[8:11], s30 offen offset:1024 sc1
    s_mov_b64 exec, s[64:65]
    s_waitcnt vmcnt(6)
    v_max_u32 v32, v48, v50
    v_cmp_eq_u32 vcc, -1, v32
    s_cbranch_vccz gom_103
    buffer_load_dwordx4 v[48:51], v2, s[8:11], s30 offen offset:2048 sc1
    s_add_u32 s43, s43, 1
    s_cmp_lt_u32 s43, 0x20000
    s_cbranch_scc1 glm_100
    s_mov_b64 exec, -1
    s_branch L_exit
    .p2align 5
gom_101:
    s_mov_b64 exec, -1
    v_smfmac_f32_16x16x64_bf16 v[56:59], v[40:43], a[0:7], v154
    v_smfmac_f32_16x16x64_bf16 v[60:63], v[40:43], a[64:71], v154
    v_smfmac_f32_16x16x64_bf16 v[64:67], v[40:43], a[32:39], v154
    v_smfmac_f32_16x16x64_bf16 v[68:71], v[40:43], a[96:103], v154
    s_branch gsm_65
    .p2align 5
gom_102:
    s_mov_b64 exec, -1
    v_smfmac_f32_16x16x64_bf16 v[56:59], v[44:47], a[8:15], v154
    v_smfmac_f32_16x16x64_bf16 v[60:63], v[44:47], a[72:79], v154
    v_smfmac_f32_16x16x64_bf16 v[64:67], v[44:47], a[40:47], v154
    v_smfmac_f32_16x16x64_bf16 v[68:71], v[44:47], a[104:111], v154
    s_branch gsm_62
    .p2align 5
gom_103:
    s_mov_b64 exec, -1
    v_smfmac_f32_16x16x64_bf16 v[56:59], v[48:51], a[16:23], v154
    v_smfmac_f32_16x16x64_bf16 v[60:63], v[48:51], a[80:87], v154
    v_smfmac_f32_16x16x64_bf16 v[64:67], v[48:51], a[48:55], v154
    v_smfmac_f32_16x16x64_bf16 v[68:71], v[48:51], a[112:119], v154
    s_branch gsm_60
    .p2align 5
gsm_70:
glm_104:
    s_mov_b64 exec, s[60:61]
    s_waitcnt vmcnt(6)
    v_max_u32 v32, v40, v42
    v_cmp_eq_u32 vcc, -1, v32
    s_cbranch_vccz gom_105
    buffer_load_dwordx4 v[40:43], v2, s[8:11], s30 offen offset:0 sc1
    s_mov_b64 exec, s[62:63]
    s_waitcnt vmcnt(6)
    v_max_u32 v32, v44, v46
    v_cmp_eq_u32 vcc, -1, v32
    s_cbranch_vccz gom_106
    buffer_load_dwordx4 v[44:47], v2, s[8:11], s30 offen offset:1024 sc1
    s_mov_b64 exec, s[66:67]
    s_waitcnt vmcnt(6)
    v_max_u32 v32, v52, v54
    v_cmp_eq_u32 vcc, -1, v32
    s_cbranch_vccz gom_107
    buffer_load_dwordx4 v[52:55], v2, s[8:11], s30 offen offset:3072 sc1
    s_add_u32 s43, s43, 1
    s_cmp_lt_u32 s43, 0x20000
    s_cbranch_scc1 glm_104
    s_mov_b64 exec, -1
    s_branch L_exit
    .p2align 5
gom_105:
    s_mov_b64 exec, -1
    v_smfmac_f32_16x16x64_bf16 v[56:59], v[40:43], a[0:7], v154
    v_smfmac_f32_16x16x64_bf16 v[60:63], v[40:43], a[64:71], v154
    v_smfmac_f32_16x16x64_bf16 v[64:67], v[40:43], a[32:39], v154
    v_smfmac_f32_16x16x64_bf16 v[68:71], v[40:43], a[96:103], v154
    s_branch gsm_66
    .p2align 5
gom_106:
    s_mov_b64 exec, -1
    v_smfmac_f32_16x16x64_bf16 v[56:59], v[44:47], a[8:15], v154
    v_smfmac_f32_16x16x64_bf16 v[60:63], v[44:47], a[72:79], v154
    v_smfmac_f32_16x16x64_bf16 v[64:67], v[44:47], a[40:47], v154
    v_smfmac_f32_16x16x64_bf16 v[68:71], v[44:47], a[104:111], v154
    s_branch gsm_63
    .p2align 5
gom_107:
    s_mov_b64 exec, -1
    v_smfmac_f32_16x16x64_bf16 v[56:59], v[52:55], a[24:31], v154
    v_smfmac_f32_16x16x64_bf16 v[60:63], v[52:55], a[88:95], v154
    v_smfmac_f32_16x16x64_bf16 v[64:67], v[52:55], a[56:63], v154
    v_smfmac_f32_16x16x64_bf16 v[68:71], v[52:55], a[120:127], v154
    s_branch gsm_60
    .p2align 5
gsm_71:
glm_108:
    s_mov_b64 exec, s[60:61]
    s_waitcnt vmcnt(6)
    v_max_u32 v32, v40, v42
    v_cmp_eq_u32 vcc, -1, v32
    s_cbranch_vccz gom_109
    buffer_load_dwordx4 v[40:43], v2, s[8:11], s30 offen offset:0 sc1
    s_mov_b64 exec, s[64:65]
    s_waitcnt vmcnt(6)
    v_max_u32 v32, v48, v50
    v_cmp_eq_u32 vcc, -1, v32
    s_cbranch_vccz gom_110
    buffer_load_dwordx4 v[48:51], v2, s[8:11], s30 offen offset:2048 sc1
    s_mov_b64 exec, s[66:67]
    s_waitcnt vmcnt(6)
    v_max_u32 v32, v52, v54
    v_cmp_eq_u32 vcc, -1, v32
    s_cbranch_vccz gom_111
    buffer_load_dwordx4 v[52:55], v2, s[8:11], s30 offen offset:3072 sc1
    s_add_u32 s43, s43, 1
    s_cmp_lt_u32 s43, 0x20000
    s_cbranch_scc1 glm_108
    s_mov_b64 exec, -1
    s_branch L_exit
    .p2align 5
gom_109:
    s_mov_b64 exec, -1
    v_smfmac_f32_16x16x64_bf16 v[56:59], v[40:43], a[0:7], v154
    v_smfmac_f32_16x16x64_bf16 v[60:63], v[40:43], a[64:71], v154
    v_smfmac_f32_16x16x64_bf16 v[64:67], v[40:43], a[32:39], v154
    v_smfmac_f32_16x16x64_bf16 v[68:71], v[40:43], a[96:103], v154
    s_branch gsm_67
    .p2align 5
gom_110:
    s_mov_b64 exec, -1
    v_smfmac_f32_16x16x64_bf16 v[56:59], v[48:51], a[16:23], v154
    v_smfmac_f32_16x16x64_bf16 v[60:63], v[48:51], a[80:87], v154
    v_smfmac_f32_16x16x64_bf16 v[64:67], v[48:51], a[48:55], v154
    v_smfmac_f32_16x16x64_bf16 v[68:71], v[48:51], a[112:119], v154
    s_branch gsm_63
    .p2align 5
gom_111:
    s_mov_b64 exec, -1
    v_smfmac_f32_16x16x64_bf16 v[56:59], v[52:55], a[24:31], v154
    v_smfmac_f32_16x16x64_bf16 v[60:63], v[52:55], a[88:95], v154
    v_smfmac_f32_16x16x64_bf16 v[64:67], v[52:55], a[56:63], v154
    v_smfmac_f32_16x16x64_bf16 v[68:71], v[52:55], a[120:127], v154
    s_branch gsm_62
    .p2align 5
gsm_72:
glm_112:
    s_mov_b64 exec, s[62:63]
    s_waitcnt vmcnt(6)
    v_max_u32 v32, v44, v46
    v_cmp_eq_u32 vcc, -1, v32
    s_cbranch_vccz gom_113
    buffer_load_dwordx4 v[44:47], v2, s[8:11], s30 offen offset:1024 sc1
    s_mov_b64 exec, s[64:65]
    s_waitcnt vmcnt(6)
    v_max_u32 v32, v48, v50
    v_cmp_eq_u32 vcc, -1, v32
    s_cbranch_vccz gom_114
    buffer_load_dwordx4 v[48:51], v2, s[8:11], s30 offen offset:2048 sc1
    s_mov_b64 exec, s[66:67]
    s_waitcnt vmcnt(6)
    v_max_u32 v32, v52, v54
    v_cmp_eq_u32 vcc, -1, v32
    s_cbranch_vccz gom_115
    buffer_load_dwordx4 v[52:55], v2, s[8:11], s30 offen offset:3072 sc1
    s_add_u32 s43, s43, 1
    s_cmp_lt_u32 s43, 0x20000
    s_cbranch_scc1 glm_112
    s_mov_b64 exec, -1
    s_branch L_exit
    .p2align 5
gom_113:
    s_mov_b64 exec, -1
    v_smfmac_f32_16x16x64_bf16 v[56:59], v[44:47], a[8:15], v154
    v_smfmac_f32_16x16x64_bf16 v[60:63], v[44:47], a[72:79], v154
    v_smfmac_f32_16x16x64_bf16 v[64:67], v[44:47], a[40:47], v154
    v_smfmac_f32_16x16x64_bf16 v[68:71], v[44:47], a[104:111], v154
    s_branch gsm_67
    .p2align 5
gom_114:
    s_mov_b64 exec, -1
    v_smfmac_f32_16x16x64_bf16 v[56:59], v[48:51], a[16:23], v154
    v_smfmac_f32_16x16x64_bf16 v[60:63], v[48:51], a[80:87], v154
    v_smfmac_f32_16x16x64_bf16 v[64:67], v[48:51], a[48:55], v154
    v_smfmac_f32_16x16x64_bf16 v[68:71], v[48:51], a[112:119], v154
    s_branch gsm_66
    .p2align 5
gom_115:
    s_mov_b64 exec, -1
    v_smfmac_f32_16x16x64_bf16 v[56:59], v[52:55], a[24:31], v154
    v_smfmac_f32_16x16x64_bf16 v[60:63], v[52:55], a[88:95], v154
    v_smfmac_f32_16x16x64_bf16 v[64:67], v[52:55], a[56:63], v154
    v_smfmac_f32_16x16x64_bf16 v[68:71], v[52:55], a[120:127], v154
    s_branch gsm_65
    .p2align 5
gsm_73:
glm_116:
    s_mov_b64 exec, s[60:61]
    s_waitcnt vmcnt(8)
    v_max_u32 v32, v40, v42
    v_cmp_eq_u32 vcc, -1, v32
    s_cbranch_vccz gom_117
    buffer_load_dwordx4 v[40:43], v2, s[8:11], s30 offen offset:0 sc1
    s_mov_b64 exec, s[62:63]
    s_waitcnt vmcnt(8)
    v_max_u32 v32, v44, v46
    v_cmp_eq_u32 vcc, -1, v32
    s_cbranch_vccz gom_118
    buffer_load_dwordx4 v[44:47], v2, s[8:11], s30 offen offset:1024 sc1
    s_mov_b64 exec, s[64:65]
    s_waitcnt vmcnt(8)
    v_max_u32 v32, v48, v50
    v_cmp_eq_u32 vcc, -1, v32
    s_cbranch_vccz gom_119
    buffer_load_dwordx4 v[48:51], v2, s[8:11], s30 offen offset:2048 sc1
    s_mov_b64 exec, s[66:67]
    s_waitcnt vmcnt(8)
    v_max_u32 v32, v52, v54
    v_cmp_eq_u32 vcc, -1, v32
    s_cbranch_vccz gom_120
    buffer_load_dwordx4 v[52:55], v2, s[8:11], s30 offen offset:3072 sc1
    s_add_u32 s43, s43, 1
    s_cmp_lt_u32 s43, 0x20000
    s_cbranch_scc1 glm_116
    s_mov_b64 exec, -1
    s_branch L_exit
    .p2align 5
gom_117:
    s_mov_b64 exec, -1
    v_smfmac_f32_16x16x64_bf16 v[56:59], v[40:43], a[0:7], v154
    v_smfmac_f32_16x16x64_bf16 v[60:63], v[40:43], a[64:71], v154
    v_smfmac_f32_16x16x64_bf16 v[64:67], v[40:43], a[32:39], v154
    v_smfmac_f32_16x16x64_bf16 v[68:71], v[40:43], a[96:103], v154
    s_branch gsm_72
    .p2align 5
gom_118:
    s_mov_b64 exec, -1
    v_smfmac_f32_16x16x64_bf16 v[56:59], v[44:47], a[8:15], v154
    v_smfmac_f32_16x16x64_bf16 v[60:63], v[44:47], a[72:79], v154
    v_smfmac_f32_16x16x64_bf16 v[64:67], v[44:47], a[40:47], v154
    v_smfmac_f32_16x16x64_bf16 v[68:71], v[44:47], a[104:111], v154
    s_branch gsm_71
    .p2align 5
gom_119:
    s_mov_b64 exec, -1
    v_smfmac_f32_16x16x64_bf16 v[56:59], v[48:51], a[16:23], v154
    v_smfmac_f32_16x16x64_bf16 v[60:63], v[48:51], a[80:87], v154
    v_smfmac_f32_16x16x64_bf16 v[64:67], v[48:51], a[48:55], v154
    v_smfmac_f32_16x16x64_bf16 v[68:71], v[48:51], a[112:119], v154
    s_branch gsm_70
    .p2align 5
gom_120:
    s_mov_b64 exec, -1
    v_smfmac_f32_16x16x64_bf16 v[56:59], v[52:55], a[24:31], v154
    v_smfmac_f32_16x16x64_bf16 v[60:63], v[52:55], a[88:95], v154
    v_smfmac_f32_16x16x64_bf16 v[64:67], v[52:55], a[56:63], v154
    v_smfmac_f32_16x16x64_bf16 v[68:71], v[52:55], a[120:127], v154
    s_branch gsm_69
    .p2align 5
vr_27:
    s_mov_b32 s43, 0
vrl_121:
    ds_read_b32 v34, v19
    ds_read_b128 v[96:99], v3 offset:13568
    ds_read_b128 v[100:103], v3 offset:14592
    ds_read_b128 v[104:107], v3 offset:15616
    s_add_u32 s43, s43, 1
    s_cmp_ge_u32 s43, 0x80000
    s_cbranch_scc1 L_exit
    s_waitcnt lgkmcnt(0)
    v_cmp_ne_u32 vcc, s51, v34
    s_cbranch_vccnz vrl_121
    s_branch vm_26
    .p2align 5
pm_30:
    buffer_load_dwordx4 v[56:59], v9, s[8:11], s33 offen sc1
    buffer_load_dwordx4 v[60:63], v10, s[8:11], s33 offen sc1
    buffer_load_dwordx4 v[64:67], v11, s[8:11], s33 offen sc1
    buffer_load_dwordx4 v[68:71], v13, s[8:11], s33 offen sc1
    s_add_u32 s43, s43, 1
    s_and_b32 s52, s43, 63
    s_cbranch_scc1 sct_28
    s_cmp_ge_u32 s43, 0x20000
    s_cbranch_scc1 L_exit
    s_waitcnt vmcnt(0)
    v_max3_u32 v32, v56, v57, v58
    v_max_u32 v32, v32, v59
    v_cmp_eq_u32 s[60:61], -1, v32
    v_max3_u32 v33, v60, v61, v62
    v_max_u32 v33, v33, v63
    v_cmp_eq_u32 s[62:63], -1, v33
    v_max3_u32 v32, v64, v65, v66
    v_max_u32 v32, v32, v67
    v_cmp_eq_u32 s[64:65], -1, v32
    v_max3_u32 v33, v68, v69, v70
    v_max_u32 v33, v33, v71
    v_cmp_eq_u32 s[66:67], -1, v33
    s_or_b64 s[52:53], s[60:61], s[62:63]
    s_or_b64 s[52:53], s[52:53], s[64:65]
    s_or_b64 s[52:53], s[52:53], s[66:67]
    s_cbranch_scc1 sct_28
    v_pk_add_f32 v[96:97], v[112:113], v[56:57]
    v_pk_add_f32 v[102:103], v[60:61], v[64:65]
    v_pk_add_f32 v[98:99], v[114:115], v[58:59]
    v_pk_add_f32 v[104:105], v[62:63], v[66:67]
    v_pk_add_f32 v[100:101], v[68:69], v[70:71]
    v_pk_add_f32 v[96:97], v[96:97], v[102:103]
    v_pk_add_f32 v[98:99], v[98:99], v[104:105]
    v_add_f32 v100, v100, v101
    v_pk_add_f32 v[102:103], v[96:97], v[98:99]
    v_max3_f32 v32, v96, v97, v98
    v_add_f32 v102, v102, v100
    v_max3_f32 v32, v32, v99, v100
    v_cmp_u_f32 vcc, v102, v103
    s_nop 0
    v_max_f32_dpp v32, v32, v32 row_ror:8 row_mask:0xf bank_mask:0xf
    s_branch sco_29
    .p2align 5
gfo_33:
    s_mov_b64 s[60:61], vcc
    s_mov_b64 exec, vcc
    buffer_load_dwordx4 v[40:43], v2, s[8:11], s31 offen offset:0 sc1
    s_mov_b64 exec, -1
    s_waitcnt vmcnt(3)
    v_cmp_eq_u32 vcc, -1, v44
    s_cbranch_vccnz gfo_122
    v_smfmac_f32_16x16x64_bf16 v[80:83], v[44:47], a[200:207], v154
    s_waitcnt vmcnt(2)
    v_cmp_eq_u32 vcc, -1, v48
    v_smfmac_f32_16x16x64_bf16 v[84:87], v[44:47], a[232:239], v154
    s_cbranch_vccnz gfo_123
    v_smfmac_f32_16x16x64_bf16 v[80:83], v[48:51], a[208:215], v154
    s_waitcnt vmcnt(1)
    v_cmp_eq_u32 vcc, -1, v52
    v_smfmac_f32_16x16x64_bf16 v[84:87], v[48:51], a[240:247], v154
    s_cbranch_vccnz gfo_124
    v_smfmac_f32_16x16x64_bf16 v[80:83], v[52:55], a[216:223], v154
    v_smfmac_f32_16x16x64_bf16 v[84:87], v[52:55], a[248:255], v154
    s_branch gso_125
    .p2align 5
gfo_34:
    s_mov_b64 s[62:63], vcc
    s_mov_b64 exec, vcc
    buffer_load_dwordx4 v[44:47], v2, s[8:11], s31 offen offset:1024 sc1
    s_mov_b64 exec, -1
    s_waitcnt vmcnt(2)
    v_cmp_eq_u32 vcc, -1, v48
    s_cbranch_vccnz gfo_126
    v_smfmac_f32_16x16x64_bf16 v[80:83], v[48:51], a[208:215], v154
    s_waitcnt vmcnt(1)
    v_cmp_eq_u32 vcc, -1, v52
    v_smfmac_f32_16x16x64_bf16 v[84:87], v[48:51], a[240:247], v154
    s_cbranch_vccnz gfo_127
    v_smfmac_f32_16x16x64_bf16 v[80:83], v[52:55], a[216:223], v154
    v_smfmac_f32_16x16x64_bf16 v[84:87], v[52:55], a[248:255], v154
    s_branch gso_128
    .p2align 5
gfo_35:
    s_mov_b64 s[64:65], vcc
    s_mov_b64 exec, vcc
    buffer_load_dwordx4 v[48:51], v2, s[8:11], s31 offen offset:2048 sc1
    s_mov_b64 exec, -1
    s_waitcnt vmcnt(1)
    v_cmp_eq_u32 vcc, -1, v52
    s_cbranch_vccnz gfo_129
    v_smfmac_f32_16x16x64_bf16 v[80:83], v[52:55], a[216:223], v154
    v_smfmac_f32_16x16x64_bf16 v[84:87], v[52:55], a[248:255], v154
    s_branch gso_130
    .p2align 5
gfo_36:
    s_mov_b64 s[66:67], vcc
    s_mov_b64 exec, vcc
    buffer_load_dwordx4 v[52:55], v2, s[8:11], s31 offen offset:3072 sc1
    s_branch gso_131
    .p2align 5
gfo_122:
    s_mov_b64 s[62:63], vcc
    s_mov_b64 exec, vcc
    buffer_load_dwordx4 v[44:47], v2, s[8:11], s31 offen offset:1024 sc1
    s_mov_b64 exec, -1
    s_waitcnt vmcnt(3)
    v_cmp_eq_u32 vcc, -1, v48
    s_cbranch_vccnz gfo_132
    v_smfmac_f32_16x16x64_bf16 v[80:83], v[48:51], a[208:215], v154
    s_waitcnt vmcnt(2)
    v_cmp_eq_u32 vcc, -1, v52
    v_smfmac_f32_16x16x64_bf16 v[84:87], v[48:51], a[240:247], v154
    s_cbranch_vccnz gfo_133
    v_smfmac_f32_16x16x64_bf16 v[80:83], v[52:55], a[216:223], v154
    v_smfmac_f32_16x16x64_bf16 v[84:87], v[52:55], a[248:255], v154
    s_branch gso_134
    .p2align 5
gfo_123:
    s_mov_b64 s[64:65], vcc
    s_mov_b64 exec, vcc
    buffer_load_dwordx4 v[48:51], v2, s[8:11], s31 offen offset:2048 sc1
    s_mov_b64 exec, -1
    s_waitcnt vmcnt(2)
    v_cmp_eq_u32 vcc, -1, v52
    s_cbranch_vccnz gfo_135
    v_smfmac_f32_16x16x64_bf16 v[80:83], v[52:55], a[216:223], v154
    v_smfmac_f32_16x16x64_bf16 v[84:87], v[52:55], a[248:255], v154
    s_branch gso_136
    .p2align 5
gfo_124:
    s_mov_b64 s[66:67], vcc
    s_mov_b64 exec, vcc
    buffer_load_dwordx4 v[52:55], v2, s[8:11], s31 offen offset:3072 sc1
    s_branch gso_137
    .p2align 5
gfo_126:
    s_mov_b64 s[64:65], vcc
    s_mov_b64 exec, vcc
    buffer_load_dwordx4 v[48:51], v2, s[8:11], s31 offen offset:2048 sc1
    s_mov_b64 exec, -1
    s_waitcnt vmcnt(2)
    v_cmp_eq_u32 vcc, -1, v52
    s_cbranch_vccnz gfo_138
    v_smfmac_f32_16x16x64_bf16 v[80:83], v[52:55], a[216:223], v154
    v_smfmac_f32_16x16x64_bf16 v[84:87], v[52:55], a[248:255], v154
    s_branch gso_139
    .p2align 5
gfo_127:
    s_mov_b64 s[66:67], vcc
    s_mov_b64 exec, vcc
    buffer_load_dwordx4 v[52:55], v2, s[8:11], s31 offen offset:3072 sc1
    s_branch gso_140
    .p2align 5
gfo_129:
    s_mov_b64 s[66:67], vcc
    s_mov_b64 exec, vcc
    buffer_load_dwordx4 v[52:55], v2, s[8:11], s31 offen offset:3072 sc1
    s_branch gso_141
    .p2align 5
gfo_132:
    s_mov_b64 s[64:65], vcc
    s_mov_b64 exec, vcc
    buffer_load_dwordx4 v[48:51], v2, s[8:11], s31 offen offset:2048 sc1
    s_mov_b64 exec, -1
    s_waitcnt vmcnt(3)
    v_cmp_eq_u32 vcc, -1, v52
    s_cbranch_vccnz gfo_142
    v_smfmac_f32_16x16x64_bf16 v[80:83], v[52:55], a[216:223], v154
    v_smfmac_f32_16x16x64_bf16 v[84:87], v[52:55], a[248:255], v154
    s_branch gso_143
    .p2align 5
gfo_133:
    s_mov_b64 s[66:67], vcc
    s_mov_b64 exec, vcc
    buffer_load_dwordx4 v[52:55], v2, s[8:11], s31 offen offset:3072 sc1
    s_branch gso_144
    .p2align 5
gfo_135:
    s_mov_b64 s[66:67], vcc
    s_mov_b64 exec, vcc
    buffer_load_dwordx4 v[52:55], v2, s[8:11], s31 offen offset:3072 sc1
    s_branch gso_145
    .p2align 5
gfo_138:
    s_mov_b64 s[66:67], vcc
    s_mov_b64 exec, vcc
    buffer_load_dwordx4 v[52:55], v2, s[8:11], s31 offen offset:3072 sc1
    s_branch gso_146
    .p2align 5
gfo_142:
    s_mov_b64 s[66:67], vcc
    s_mov_b64 exec, vcc
    buffer_load_dwordx4 v[52:55], v2, s[8:11], s31 offen offset:3072 sc1
    s_branch gso_147
    .p2align 5
gso_125:
    s_mov_b64 exec, s[60:61]
glo_148:
    s_waitcnt vmcnt(4)
    v_cmp_eq_u32 vcc, -1, v40
    s_cbranch_vccz goo_149
    buffer_load_dwordx4 v[40:43], v2, s[8:11], s31 offen offset:0 sc1
    s_waitcnt vmcnt(4)
    v_cmp_eq_u32 vcc, -1, v40
    s_cbranch_vccz goo_149
    buffer_load_dwordx4 v[40:43], v2, s[8:11], s31 offen offset:0 sc1
    s_add_u32 s43, s43, 1
    s_cmp_lt_u32 s43, 0x20000
    s_cbranch_scc1 glo_148
    s_mov_b64 exec, -1
    s_branch L_exit
    .p2align 5
goo_149:
    s_mov_b64 exec, -1
    v_smfmac_f32_16x16x64_bf16 v[80:83], v[40:43], a[192:199], v154
    v_smfmac_f32_16x16x64_bf16 v[84:87], v[40:43], a[224:231], v154
    s_branch gdo_32
    .p2align 5
gso_128:
    s_mov_b64 exec, s[62:63]
glo_150:
    s_waitcnt vmcnt(4)
    v_cmp_eq_u32 vcc, -1, v44
    s_cbranch_vccz goo_151
    buffer_load_dwordx4 v[44:47], v2, s[8:11], s31 offen offset:1024 sc1
    s_waitcnt vmcnt(4)
    v_cmp_eq_u32 vcc, -1, v44
    s_cbranch_vccz goo_151
    buffer_load_dwordx4 v[44:47], v2, s[8:11], s31 offen offset:1024 sc1
    s_add_u32 s43, s43, 1
    s_cmp_lt_u32 s43, 0x20000
    s_cbranch_scc1 glo_150
    s_mov_b64 exec, -1
    s_branch L_exit
    .p2align 5
goo_151:
    s_mov_b64 exec, -1
    v_smfmac_f32_16x16x64_bf16 v[80:83], v[44:47], a[200:207], v154
    v_smfmac_f32_16x16x64_bf16 v[84:87], v[44:47], a[232:239], v154
    s_branch gdo_32
    .p2align 5
gso_130:
    s_mov_b64 exec, s[64:65]
glo_152:
    s_waitcnt vmcnt(4)
    v_cmp_eq_u32 vcc, -1, v48
    s_cbranch_vccz goo_153
    buffer_load_dwordx4 v[48:51], v2, s[8:11], s31 offen offset:2048 sc1
    s_waitcnt vmcnt(4)
    v_cmp_eq_u32 vcc, -1, v48
    s_cbranch_vccz goo_153
    buffer_load_dwordx4 v[48:51], v2, s[8:11], s31 offen offset:2048 sc1
    s_add_u32 s43, s43, 1
    s_cmp_lt_u32 s43, 0x20000
    s_cbranch_scc1 glo_152
    s_mov_b64 exec, -1
    s_branch L_exit
    .p2align 5
goo_153:
    s_mov_b64 exec, -1
    v_smfmac_f32_16x16x64_bf16 v[80:83], v[48:51], a[208:215], v154
    v_smfmac_f32_16x16x64_bf16 v[84:87], v[48:51], a[240:247], v154
    s_branch gdo_32
    .p2align 5
gso_131:
    s_mov_b64 exec, s[66:67]
glo_154:
    s_waitcnt vmcnt(4)
    v_cmp_eq_u32 vcc, -1, v52
    s_cbranch_vccz goo_155
    buffer_load_dwordx4 v[52:55], v2, s[8:11], s31 offen offset:3072 sc1
    s_waitcnt vmcnt(4)
    v_cmp_eq_u32 vcc, -1, v52
    s_cbranch_vccz goo_155
    buffer_load_dwordx4 v[52:55], v2, s[8:11], s31 offen offset:3072 sc1
    s_add_u32 s43, s43, 1
    s_cmp_lt_u32 s43, 0x20000
    s_cbranch_scc1 glo_154
    s_mov_b64 exec, -1
    s_branch L_exit
    .p2align 5
goo_155:
    s_mov_b64 exec, -1
    v_smfmac_f32_16x16x64_bf16 v[80:83], v[52:55], a[216:223], v154
    v_smfmac_f32_16x16x64_bf16 v[84:87], v[52:55], a[248:255], v154
    s_branch gdo_32
    .p2align 5
gso_134:
glo_156:
    s_mov_b64 exec, s[60:61]
    s_waitcnt vmcnt(4)
    v_cmp_eq_u32 vcc, -1, v40
    s_cbranch_vccz goo_157
    buffer_load_dwordx4 v[40:43], v2, s[8:11], s31 offen offset:0 sc1
    s_mov_b64 exec, s[62:63]
    s_waitcnt vmcnt(4)
    v_cmp_eq_u32 vcc, -1, v44
    s_cbranch_vccz goo_158
    buffer_load_dwordx4 v[44:47], v2, s[8:11], s31 offen offset:1024 sc1
    s_add_u32 s43, s43, 1
    s_cmp_lt_u32 s43, 0x20000
    s_cbranch_scc1 glo_156
    s_mov_b64 exec, -1
    s_branch L_exit
    .p2align 5
goo_157:
    s_mov_b64 exec, -1
    v_smfmac_f32_16x16x64_bf16 v[80:83], v[40:43], a[192:199], v154
    v_smfmac_f32_16x16x64_bf16 v[84:87], v[40:43], a[224:231], v154
    s_branch gso_128
    .p2align 5
goo_158:
    s_mov_b64 exec, -1
    v_smfmac_f32_16x16x64_bf16 v[80:83], v[44:47], a[200:207], v154
    v_smfmac_f32_16x16x64_bf16 v[84:87], v[44:47], a[232:239], v154
    s_branch gso_125
    .p2align 5
gso_136:
glo_159:
    s_mov_b64 exec, s[60:61]
    s_waitcnt vmcnt(4)
    v_cmp_eq_u32 vcc, -1, v40
    s_cbranch_vccz goo_160
    buffer_load_dwordx4 v[40:43], v2, s[8:11], s31 offen offset:0 sc1
    s_mov_b64 exec, s[64:65]
    s_waitcnt vmcnt(4)
    v_cmp_eq_u32 vcc, -1, v48
    s_cbranch_vccz goo_161
    buffer_load_dwordx4 v[48:51], v2, s[8:11], s31 offen offset:2048 sc1
    s_add_u32 s43, s43, 1
    s_cmp_lt_u32 s43, 0x20000
    s_cbranch_scc1 glo_159
    s_mov_b64 exec, -1
    s_branch L_exit
    .p2align 5
goo_160:
    s_mov_b64 exec, -1
    v_smfmac_f32_16x16x64_bf16 v[80:83], v[40:43], a[192:199], v154
    v_smfmac_f32_16x16x64_bf16 v[84:87], v[40:43], a[224:231], v154
    s_branch gso_130
    .p2align 5
goo_161:
    s_mov_b64 exec, -1
    v_smfmac_f32_16x16x64_bf16 v[80:83], v[48:51], a[208:215], v154
    v_smfmac_f32_16x16x64_bf16 v[84:87], v[48:51], a[240:247], v154
    s_branch gso_125
    .p2align 5
gso_137:
glo_162:
    s_mov_b64 exec, s[60:61]
    s_waitcnt vmcnt(4)
    v_cmp_eq_u32 vcc, -1, v40
    s_cbranch_vccz goo_163
    buffer_load_dwordx4 v[40:43], v2, s[8:11], s31 offen offset:0 sc1
    s_mov_b64 exec, s[66:67]
    s_waitcnt vmcnt(4)
    v_cmp_eq_u32 vcc, -1, v52
    s_cbranch_vccz goo_164
    buffer_load_dwordx4 v[52:55], v2, s[8:11], s31 offen offset:3072 sc1
    s_add_u32 s43, s43, 1
    s_cmp_lt_u32 s43, 0x20000
    s_cbranch_scc1 glo_162
    s_mov_b64 exec, -1
    s_branch L_exit
    .p2align 5
goo_163:
    s_mov_b64 exec, -1
    v_smfmac_f32_16x16x64_bf16 v[80:83], v[40:43], a[192:199], v154
    v_smfmac_f32_16x16x64_bf16 v[84:87], v[40:43], a[224:231], v154
    s_branch gso_131
    .p2align 5
goo_164:
    s_mov_b64 exec, -1
    v_smfmac_f32_16x16x64_bf16 v[80:83], v[52:55], a[216:223], v154
    v_smfmac_f32_16x16x64_bf16 v[84:87], v[52:55], a[248:255], v154
    s_branch gso_125
    .p2align 5
gso_139:
glo_165:
    s_mov_b64 exec, s[62:63]
    s_waitcnt vmcnt(4)
    v_cmp_eq_u32 vcc, -1, v44
    s_cbranch_vccz goo_166
    buffer_load_dwordx4 v[44:47], v2, s[8:11], s31 offen offset:1024 sc1
    s_mov_b64 exec, s[64:65]
    s_waitcnt vmcnt(4)
    v_cmp_eq_u32 vcc, -1, v48
    s_cbranch_vccz goo_167
    buffer_load_dwordx4 v[48:51], v2, s[8:11], s31 offen offset:2048 sc1
    s_add_u32 s43, s43, 1
    s_cmp_lt_u32 s43, 0x20000
    s_cbranch_scc1 glo_165
    s_mov_b64 exec, -1
    s_branch L_exit
    .p2align 5
goo_166:
    s_mov_b64 exec, -1
    v_smfmac_f32_16x16x64_bf16 v[80:83], v[44:47], a[200:207], v154
    v_smfmac_f32_16x16x64_bf16 v[84:87], v[44:47], a[232:239], v154
    s_branch gso_130
    .p2align 5
goo_167:
    s_mov_b64 exec, -1
    v_smfmac_f32_16x16x64_bf16 v[80:83], v[48:51], a[208:215], v154
    v_smfmac_f32_16x16x64_bf16 v[84:87], v[48:51], a[240:247], v154
    s_branch gso_128
    .p2align 5
gso_140:
glo_168:
    s_mov_b64 exec, s[62:63]
    s_waitcnt vmcnt(4)
    v_cmp_eq_u32 vcc, -1, v44
    s_cbranch_vccz goo_169
    buffer_load_dwordx4 v[44:47], v2, s[8:11], s31 offen offset:1024 sc1
    s_mov_b64 exec, s[66:67]
    s_waitcnt vmcnt(4)
    v_cmp_eq_u32 vcc, -1, v52
    s_cbranch_vccz goo_170
    buffer_load_dwordx4 v[52:55], v2, s[8:11], s31 offen offset:3072 sc1
    s_add_u32 s43, s43, 1
    s_cmp_lt_u32 s43, 0x20000
    s_cbranch_scc1 glo_168
    s_mov_b64 exec, -1
    s_branch L_exit
    .p2align 5
goo_169:
    s_mov_b64 exec, -1
    v_smfmac_f32_16x16x64_bf16 v[80:83], v[44:47], a[200:207], v154
    v_smfmac_f32_16x16x64_bf16 v[84:87], v[44:47], a[232:239], v154
    s_branch gso_131
    .p2align 5
goo_170:
    s_mov_b64 exec, -1
    v_smfmac_f32_16x16x64_bf16 v[80:83], v[52:55], a[216:223], v154
    v_smfmac_f32_16x16x64_bf16 v[84:87], v[52:55], a[248:255], v154
    s_branch gso_128
    .p2align 5
gso_141:
glo_171:
    s_mov_b64 exec, s[64:65]
    s_waitcnt vmcnt(4)
    v_cmp_eq_u32 vcc, -1, v48
    s_cbranch_vccz goo_172
    buffer_load_dwordx4 v[48:51], v2, s[8:11], s31 offen offset:2048 sc1
    s_mov_b64 exec, s[66:67]
    s_waitcnt vmcnt(4)
    v_cmp_eq_u32 vcc, -1, v52
    s_cbranch_vccz goo_173
    buffer_load_dwordx4 v[52:55], v2, s[8:11], s31 offen offset:3072 sc1
    s_add_u32 s43, s43, 1
    s_cmp_lt_u32 s43, 0x20000
    s_cbranch_scc1 glo_171
    s_mov_b64 exec, -1
    s_branch L_exit
    .p2align 5
goo_172:
    s_mov_b64 exec, -1
    v_smfmac_f32_16x16x64_bf16 v[80:83], v[48:51], a[208:215], v154
    v_smfmac_f32_16x16x64_bf16 v[84:87], v[48:51], a[240:247], v154
    s_branch gso_131
    .p2align 5
goo_173:
    s_mov_b64 exec, -1
    v_smfmac_f32_16x16x64_bf16 v[80:83], v[52:55], a[216:223], v154
    v_smfmac_f32_16x16x64_bf16 v[84:87], v[52:55], a[248:255], v154
    s_branch gso_130
    .p2align 5
gso_143:
glo_174:
    s_mov_b64 exec, s[60:61]
    s_waitcnt vmcnt(6)
    v_cmp_eq_u32 vcc, -1, v40
    s_cbranch_vccz goo_175
    buffer_load_dwordx4 v[40:43], v2, s[8:11], s31 offen offset:0 sc1
    s_mov_b64 exec, s[62:63]
    s_waitcnt vmcnt(6)
    v_cmp_eq_u32 vcc, -1, v44
    s_cbranch_vccz goo_176
    buffer_load_dwordx4 v[44:47], v2, s[8:11], s31 offen offset:1024 sc1
    s_mov_b64 exec, s[64:65]
    s_waitcnt vmcnt(6)
    v_cmp_eq_u32 vcc, -1, v48
    s_cbranch_vccz goo_177
    buffer_load_dwordx4 v[48:51], v2, s[8:11], s31 offen offset:2048 sc1
    s_add_u32 s43, s43, 1
    s_cmp_lt_u32 s43, 0x20000
    s_cbranch_scc1 glo_174
    s_mov_b64 exec, -1
    s_branch L_exit
    .p2align 5
goo_175:
    s_mov_b64 exec, -1
    v_smfmac_f32_16x16x64_bf16 v[80:83], v[40:43], a[192:199], v154
    v_smfmac_f32_16x16x64_bf16 v[84:87], v[40:43], a[224:231], v154
    s_branch gso_139
    .p2align 5
goo_176:
    s_mov_b64 exec, -1
    v_smfmac_f32_16x16x64_bf16 v[80:83], v[44:47], a[200:207], v154
    v_smfmac_f32_16x16x64_bf16 v[84:87], v[44:47], a[232:239], v154
    s_branch gso_136
    .p2align 5
goo_177:
    s_mov_b64 exec, -1
    v_smfmac_f32_16x16x64_bf16 v[80:83], v[48:51], a[208:215], v154
    v_smfmac_f32_16x16x64_bf16 v[84:87], v[48:51], a[240:247], v154
    s_branch gso_134
    .p2align 5
gso_144:
glo_178:
    s_mov_b64 exec, s[60:61]
    s_waitcnt vmcnt(6)
    v_cmp_eq_u32 vcc, -1, v40
    s_cbranch_vccz goo_179
    buffer_load_dwordx4 v[40:43], v2, s[8:11], s31 offen offset:0 sc1
    s_mov_b64 exec, s[62:63]
    s_waitcnt vmcnt(6)
    v_cmp_eq_u32 vcc, -1, v44
    s_cbranch_vccz goo_180
    buffer_load_dwordx4 v[44:47], v2, s[8:11], s31 offen offset:1024 sc1
    s_mov_b64 exec, s[66:67]
    s_waitcnt vmcnt(6)
    v_cmp_eq_u32 vcc, -1, v52
    s_cbranch_vccz goo_181
    buffer_load_dwordx4 v[52:55], v2, s[8:11], s31 offen offset:3072 sc1
    s_add_u32 s43, s43, 1
    s_cmp_lt_u32 s43, 0x20000
    s_cbranch_scc1 glo_178
    s_mov_b64 exec, -1
    s_branch L_exit
    .p2align 5
goo_179:
    s_mov_b64 exec, -1
    v_smfmac_f32_16x16x64_bf16 v[80:83], v[40:43], a[192:199], v154
    v_smfmac_f32_16x16x64_bf16 v[84:87], v[40:43], a[224:231], v154
    s_branch gso_140
    .p2align 5
goo_180:
    s_mov_b64 exec, -1
    v_smfmac_f32_16x16x64_bf16 v[80:83], v[44:47], a[200:207], v154
    v_smfmac_f32_16x16x64_bf16 v[84:87], v[44:47], a[232:239], v154
    s_branch gso_137
    .p2align 5
goo_181:
    s_mov_b64 exec, -1
    v_smfmac_f32_16x16x64_bf16 v[80:83], v[52:55], a[216:223], v154
    v_smfmac_f32_16x16x64_bf16 v[84:87], v[52:55], a[248:255], v154
    s_branch gso_134
    .p2align 5
gso_145:
glo_182:
    s_mov_b64 exec, s[60:61]
    s_waitcnt vmcnt(6)
    v_cmp_eq_u32 vcc, -1, v40
    s_cbranch_vccz goo_183
    buffer_load_dwordx4 v[40:43], v2, s[8:11], s31 offen offset:0 sc1
    s_mov_b64 exec, s[64:65]
    s_waitcnt vmcnt(6)
    v_cmp_eq_u32 vcc, -1, v48
    s_cbranch_vccz goo_184
    buffer_load_dwordx4 v[48:51], v2, s[8:11], s31 offen offset:2048 sc1
    s_mov_b64 exec, s[66:67]
    s_waitcnt vmcnt(6)
    v_cmp_eq_u32 vcc, -1, v52
    s_cbranch_vccz goo_185
    buffer_load_dwordx4 v[52:55], v2, s[8:11], s31 offen offset:3072 sc1
    s_add_u32 s43, s43, 1
    s_cmp_lt_u32 s43, 0x20000
    s_cbranch_scc1 glo_182
    s_mov_b64 exec, -1
    s_branch L_exit
    .p2align 5
goo_183:
    s_mov_b64 exec, -1
    v_smfmac_f32_16x16x64_bf16 v[80:83], v[40:43], a[192:199], v154
    v_smfmac_f32_16x16x64_bf16 v[84:87], v[40:43], a[224:231], v154
    s_branch gso_141
    .p2align 5
goo_184:
    s_mov_b64 exec, -1
    v_smfmac_f32_16x16x64_bf16 v[80:83], v[48:51], a[208:215], v154
    v_smfmac_f32_16x16x64_bf16 v[84:87], v[48:51], a[240:247], v154
    s_branch gso_137
    .p2align 5
goo_185:
    s_mov_b64 exec, -1
    v_smfmac_f32_16x16x64_bf16 v[80:83], v[52:55], a[216:223], v154
    v_smfmac_f32_16x16x64_bf16 v[84:87], v[52:55], a[248:255], v154
    s_branch gso_136
    .p2align 5
gso_146:
glo_186:
    s_mov_b64 exec, s[62:63]
    s_waitcnt vmcnt(6)
    v_cmp_eq_u32 vcc, -1, v44
    s_cbranch_vccz goo_187
    buffer_load_dwordx4 v[44:47], v2, s[8:11], s31 offen offset:1024 sc1
    s_mov_b64 exec, s[64:65]
    s_waitcnt vmcnt(6)
    v_cmp_eq_u32 vcc, -1, v48
    s_cbranch_vccz goo_188
    buffer_load_dwordx4 v[48:51], v2, s[8:11], s31 offen offset:2048 sc1
    s_mov_b64 exec, s[66:67]
    s_waitcnt vmcnt(6)
    v_cmp_eq_u32 vcc, -1, v52
    s_cbranch_vccz goo_189
    buffer_load_dwordx4 v[52:55], v2, s[8:11], s31 offen offset:3072 sc1
    s_add_u32 s43, s43, 1
    s_cmp_lt_u32 s43, 0x20000
    s_cbranch_scc1 glo_186
    s_mov_b64 exec, -1
    s_branch L_exit
    .p2align 5
goo_187:
    s_mov_b64 exec, -1
    v_smfmac_f32_16x16x64_bf16 v[80:83], v[44:47], a[200:207], v154
    v_smfmac_f32_16x16x64_bf16 v[84:87], v[44:47], a[232:239], v154
    s_branch gso_141
    .p2align 5
goo_188:
    s_mov_b64 exec, -1
    v_smfmac_f32_16x16x64_bf16 v[80:83], v[48:51], a[208:215], v154
    v_smfmac_f32_16x16x64_bf16 v[84:87], v[48:51], a[240:247], v154
    s_branch gso_140
    .p2align 5
goo_189:
    s_mov_b64 exec, -1
    v_smfmac_f32_16x16x64_bf16 v[80:83], v[52:55], a[216:223], v154
    v_smfmac_f32_16x16x64_bf16 v[84:87], v[52:55], a[248:255], v154
    s_branch gso_139
    .p2align 5
gso_147:
glo_190:
    s_mov_b64 exec, s[60:61]
    s_waitcnt vmcnt(8)
    v_cmp_eq_u32 vcc, -1, v40
    s_cbranch_vccz goo_191
    buffer_load_dwordx4 v[40:43], v2, s[8:11], s31 offen offset:0 sc1
    s_mov_b64 exec, s[62:63]
    s_waitcnt vmcnt(8)
    v_cmp_eq_u32 vcc, -1, v44
    s_cbranch_vccz goo_192
    buffer_load_dwordx4 v[44:47], v2, s[8:11], s31 offen offset:1024 sc1
    s_mov_b64 exec, s[64:65]
    s_waitcnt vmcnt(8)
    v_cmp_eq_u32 vcc, -1, v48
    s_cbranch_vccz goo_193
    buffer_load_dwordx4 v[48:51], v2, s[8:11], s31 offen offset:2048 sc1
    s_mov_b64 exec, s[66:67]
    s_waitcnt vmcnt(8)
    v_cmp_eq_u32 vcc, -1, v52
    s_cbranch_vccz goo_194
    buffer_load_dwordx4 v[52:55], v2, s[8:11], s31 offen offset:3072 sc1
    s_add_u32 s43, s43, 1
    s_cmp_lt_u32 s43, 0x20000
    s_cbranch_scc1 glo_190
    s_mov_b64 exec, -1
    s_branch L_exit
    .p2align 5
goo_191:
    s_mov_b64 exec, -1
    v_smfmac_f32_16x16x64_bf16 v[80:83], v[40:43], a[192:199], v154
    v_smfmac_f32_16x16x64_bf16 v[84:87], v[40:43], a[224:231], v154
    s_branch gso_146
    .p2align 5
goo_192:
    s_mov_b64 exec, -1
    v_smfmac_f32_16x16x64_bf16 v[80:83], v[44:47], a[200:207], v154
    v_smfmac_f32_16x16x64_bf16 v[84:87], v[44:47], a[232:239], v154
    s_branch gso_145
    .p2align 5
goo_193:
    s_mov_b64 exec, -1
    v_smfmac_f32_16x16x64_bf16 v[80:83], v[48:51], a[208:215], v154
    v_smfmac_f32_16x16x64_bf16 v[84:87], v[48:51], a[240:247], v154
    s_branch gso_144
    .p2align 5
goo_194:
    s_mov_b64 exec, -1
    v_smfmac_f32_16x16x64_bf16 v[80:83], v[52:55], a[216:223], v154
    v_smfmac_f32_16x16x64_bf16 v[84:87], v[52:55], a[248:255], v154
    s_branch gso_143
    .p2align 5
w1_38:
    buffer_load_dwordx2 v[112:113], v21, s[8:11], s32 offen offset:0 sc1
    buffer_load_dwordx2 v[114:115], v22, s[8:11], s32 offen offset:0 sc1
    buffer_load_dwordx2 v[116:117], v23, s[8:11], s32 offen offset:0 sc1
    s_add_u32 s43, s43, 1
    s_cmp_lt_u32 s43, 0x20000
    s_cbranch_scc1 w0_37
    s_branch L_exit
    .p2align 5
vr_47:
    s_mov_b32 s43, 0
vrl_195:
    ds_read_b32 v34, v19
    ds_read_b128 v[96:99], v3 offset:13568
    ds_read_b128 v[100:103], v3 offset:14592
    ds_read_b128 v[104:107], v3 offset:15616
    s_add_u32 s43, s43, 1
    s_cmp_ge_u32 s43, 0x80000
    s_cbranch_scc1 L_exit
    s_waitcnt lgkmcnt(0)
    v_cmp_ne_u32 vcc, s51, v34
    s_cbranch_vccnz vrl_195
    s_branch vm_46
    .p2align 5
L_exit:
    s_branch L_fb
    .p2align 5
L_done:
    s_load_dwordx2 s[58:59], s[0:1], 96
    s_lshr_b32 s52, s24, 1
    s_lshl_b32 s26, s23, 1
    s_add_u32 s26, s26, s52
    s_add_u32 s26, s26, 56
    s_and_b32 s52, s21, 28
    v_and_b32 v4, 3, v1
    v_add_u32 v4, s52, v4
    v_lshrrev_b32 v5, v4, s97
    v_and_b32 v5, 1, v5
    v_lshlrev_b32 v4, 20, v4
    v_lshl_add_u32 v4, v5, 13, v4
    s_lshl_b32 s36, s20, 2
    s_add_u32 s36, s36, 0xc008000
    v_mov_b32 v12, 56
    s_lshr_b32 s52, s21, 3
    s_lshl_b32 s52, s52, 4
    s_add_u32 s52, s52, 200
    v_mov_b32 v13, s52
    buffer_load_dword v5, v4, s[8:11], s36 offen sc1
    buffer_load_dwordx2 v[6:7], v12, s[16:19], 0 offen sc1
    buffer_load_dwordx2 v[8:9], v13, s[16:19], 0 offen sc1
    v_and_b32 v14, 7, v1
    v_lshlrev_b32 v14, 2, v14
    buffer_load_dword v15, v14, s[16:19], 0 offen sc1
    s_lshl_b32 s27, s26, 5
    s_add_u32 s27, s27, s22
    s_lshl_b32 s27, s27, 13
    s_add_u32 s52, s27, 0x1000000
    s_add_u32 s53, s52, 0x1000
    buffer_load_dwordx4 v[160:163], v3, s[8:11], s52 offen offset:0
    buffer_load_dwordx4 v[164:167], v3, s[8:11], s52 offen offset:1024
    buffer_load_dwordx4 v[168:171], v3, s[8:11], s52 offen offset:2048
    buffer_load_dwordx4 v[172:175], v3, s[8:11], s52 offen offset:3072
    buffer_load_dwordx4 v[176:179], v3, s[8:11], s53 offen offset:0
    buffer_load_dwordx4 v[180:183], v3, s[8:11], s53 offen offset:1024
    buffer_load_dwordx4 v[184:187], v3, s[8:11], s53 offen offset:2048
    buffer_load_dwordx4 v[188:191], v3, s[8:11], s53 offen offset:3072
    s_add_u32 s52, s27, 0x2200000
    s_add_u32 s53, s52, 0x1000
    buffer_load_dwordx4 v[208:211], v3, s[8:11], s52 offen offset:0
    buffer_load_dwordx4 v[212:215], v3, s[8:11], s52 offen offset:1024
    buffer_load_dwordx4 v[216:219], v3, s[8:11], s52 offen offset:2048
    buffer_load_dwordx4 v[220:223], v3, s[8:11], s52 offen offset:3072
    buffer_load_dwordx4 v[224:227], v3, s[8:11], s53 offen offset:0
    buffer_load_dwordx4 v[228:231], v3, s[8:11], s53 offen offset:1024
    buffer_load_dwordx4 v[232:235], v3, s[8:11], s53 offen offset:2048
    buffer_load_dwordx4 v[236:239], v3, s[8:11], s53 offen offset:3072
    v_and_b32 v10, 15, v1
    v_lshlrev_b32 v10, 2, v10
    s_lshl_b32 s52, s26, 7
    s_add_u32 s52, s52, 0x7000000
    buffer_load_dword v11, v10, s[8:11], s52 offen offset:64 sc1
    buffer_load_dword v10, v10, s[8:11], s52 offen sc1
    v_lshrrev_b32 v28, 4, v1
    v_and_b32 v29, 15, v1
    v_lshrrev_b32 v30, 2, v29
    v_and_b32 v31, 1, v29
    v_lshl_add_u32 v30, v30, 1, v31
    v_lshlrev_b32 v30, 4, v30
    v_lshl_add_u32 v124, v28, 7, v30
    v_lshlrev_b32 v125, 3, v1
    v_add_u32 v125, 512, v125
    v_lshlrev_b32 v30, 2, v28
    v_add_u32 v31, 0, v30
    v_cmp_le_u32 s[88:89], v31, v29
    v_mov_b32 v120, 0x3f803f80
    v_add_u32 v31, 1, v30
    v_cmp_le_u32 s[90:91], v31, v29
    v_mov_b32 v121, 0x3f803f80
    v_add_u32 v31, 2, v30
    v_cmp_le_u32 s[92:93], v31, v29
    v_mov_b32 v122, 0x3f803f80
    v_add_u32 v31, 3, v30
    v_cmp_le_u32 s[94:95], v31, v29
    v_mov_b32 v123, 0x3f803f80
    v_mov_b32 v126, 0xff800000
    s_mov_b32 s96, 0x3e0293ee
    s_cmp_ge_u32 s26, 62
    s_cselect_b32 s35, 64, 0
    s_lshl_b32 s52, s20, 3
    s_lshr_b32 s53, s26, 3
    s_add_u32 s52, s52, s53
    s_lshl_b32 s52, s52, 4
    s_and_b32 s54, s26, 7
    s_add_u32 s52, s52, s54
    s_lshl_b32 s52, s52, 10
    s_add_u32 s52, s52, 0xc010000
    v_readlane_b32 s28, v4, 0
    v_readlane_b32 s29, v4, 1
    v_readlane_b32 s30, v4, 2
    v_readlane_b32 s31, v4, 3
    s_add_u32 s28, s28, s52
    s_add_u32 s29, s29, s52
    s_add_u32 s30, s30, s52
    s_add_u32 s31, s31, s52
    s_lshl_b32 s32, s53, 5
    s_add_u32 s32, s32, s22
    s_lshl_b32 s32, s32, 4
    s_add_u32 s32, s32, s54
    s_lshl_b32 s32, s32, 12
    s_add_u32 s32, s32, 0x9000000
    s_add_u32 s33, s32, 0x8000
    s_waitcnt lgkmcnt(0)
    s_mov_b32 s40, s58
    s_mov_b32 s41, s59
    s_mov_b32 s42, 0x400000
    s_mov_b32 s43, 0x20000
    s_mov_b32 s34, 0
    s_waitcnt vmcnt(18)
    v_cmp_ne_u32 vcc, -1, v15
    s_cbranch_vccnz L_exit
tc_196:
    v_readfirstlane_b32 s52, v6
    v_readfirstlane_b32 s53, v7
    v_cmp_gt_u32 vcc, s35, v5
    s_cbranch_vccnz tr_197
    s_cmp_lt_u32 s53, 0x1000
    s_cbranch_scc1 tr_197
    s_add_u32 s52, s27, 0x3400000
    s_add_u32 s53, s52, 0x1000
    buffer_load_dwordx4 v[192:195], v124, s[8:11], s28 offen offset:0
    buffer_load_dwordx4 v[196:199], v124, s[8:11], s29 offen offset:0
    buffer_load_dwordx4 v[200:203], v124, s[8:11], s30 offen offset:0
    buffer_load_dwordx4 v[204:207], v124, s[8:11], s31 offen offset:0
    buffer_load_dwordx4 v[128:131], v3, s[8:11], s52 offen offset:0
    buffer_load_dwordx4 v[132:135], v3, s[8:11], s52 offen offset:1024
    buffer_load_dwordx4 v[136:139], v3, s[8:11], s52 offen offset:2048
    buffer_load_dwordx4 v[140:143], v3, s[8:11], s52 offen offset:3072
    buffer_load_dwordx4 v[144:147], v3, s[8:11], s53 offen offset:0
    buffer_load_dwordx4 v[148:151], v3, s[8:11], s53 offen offset:1024
    buffer_load_dwordx4 v[152:155], v3, s[8:11], s53 offen offset:2048
    buffer_load_dwordx4 v[156:159], v3, s[8:11], s53 offen offset:3072
    buffer_load_dwordx2 v[240:241], v125, s[8:11], s28 offen offset:0
    buffer_load_dwordx2 v[242:243], v125, s[8:11], s29 offen offset:0
    buffer_load_dwordx2 v[244:245], v125, s[8:11], s30 offen offset:0
    buffer_load_dwordx2 v[246:247], v125, s[8:11], s31 offen offset:0
    v_readfirstlane_b32 s44, v8
    v_readfirstlane_b32 s45, v9
    v_accvgpr_read_b32 v64, a192
    v_accvgpr_read_b32 v65, a193
    v_accvgpr_read_b32 v66, a194
    v_accvgpr_read_b32 v67, a195
    v_permlane16_swap_b32 v64, v65
    s_nop 0
    v_permlane16_swap_b32 v66, v67
    v_accvgpr_write_b32 a192, v64
    v_accvgpr_write_b32 a194, v65
    v_accvgpr_write_b32 a193, v66
    v_accvgpr_write_b32 a195, v67
    v_accvgpr_read_b32 v68, a196
    v_accvgpr_read_b32 v69, a197
    v_accvgpr_read_b32 v70, a198
    v_accvgpr_read_b32 v71, a199
    v_permlane16_swap_b32 v68, v69
    s_nop 0
    v_permlane16_swap_b32 v70, v71
    v_accvgpr_write_b32 a196, v68
    v_accvgpr_write_b32 a198, v69
    v_accvgpr_write_b32 a197, v70
    v_accvgpr_write_b32 a199, v71
    v_accvgpr_read_b32 v72, a200
    v_accvgpr_read_b32 v73, a201
    v_accvgpr_read_b32 v74, a202
    v_accvgpr_read_b32 v75, a203
    v_permlane16_swap_b32 v72, v73
    s_nop 0
    v_permlane16_swap_b32 v74, v75
    v_accvgpr_write_b32 a200, v72
    v_accvgpr_write_b32 a202, v73
    v_accvgpr_write_b32 a201, v74
    v_accvgpr_write_b32 a203, v75
    v_accvgpr_read_b32 v76, a204
    v_accvgpr_read_b32 v77, a205
    v_accvgpr_read_b32 v78, a206
    v_accvgpr_read_b32 v79, a207
    v_permlane16_swap_b32 v76, v77
    s_nop 0
    v_permlane16_swap_b32 v78, v79
    v_accvgpr_write_b32 a204, v76
    v_accvgpr_write_b32 a206, v77
    v_accvgpr_write_b32 a205, v78
    v_accvgpr_write_b32 a207, v79
    v_accvgpr_read_b32 v80, a208
    v_accvgpr_read_b32 v81, a209
    v_accvgpr_read_b32 v82, a210
    v_accvgpr_read_b32 v83, a211
    v_permlane16_swap_b32 v80, v81
    s_nop 0
    v_permlane16_swap_b32 v82, v83
    v_accvgpr_write_b32 a208, v80
    v_accvgpr_write_b32 a210, v81
    v_accvgpr_write_b32 a209, v82
    v_accvgpr_write_b32 a211, v83
    v_accvgpr_read_b32 v84, a212
    v_accvgpr_read_b32 v85, a213
    v_accvgpr_read_b32 v86, a214
    v_accvgpr_read_b32 v87, a215
    v_permlane16_swap_b32 v84, v85
    s_nop 0
    v_permlane16_swap_b32 v86, v87
    v_accvgpr_write_b32 a212, v84
    v_accvgpr_write_b32 a214, v85
    v_accvgpr_write_b32 a213, v86
    v_accvgpr_write_b32 a215, v87
    v_accvgpr_read_b32 v88, a216
    v_accvgpr_read_b32 v89, a217
    v_accvgpr_read_b32 v90, a218
    v_accvgpr_read_b32 v91, a219
    v_permlane16_swap_b32 v88, v89
    s_nop 0
    v_permlane16_swap_b32 v90, v91
    v_accvgpr_write_b32 a216, v88
    v_accvgpr_write_b32 a218, v89
    v_accvgpr_write_b32 a217, v90
    v_accvgpr_write_b32 a219, v91
    v_accvgpr_read_b32 v92, a220
    v_accvgpr_read_b32 v93, a221
    v_accvgpr_read_b32 v94, a222
    v_accvgpr_read_b32 v95, a223
    v_permlane16_swap_b32 v92, v93
    s_nop 0
    v_permlane16_swap_b32 v94, v95
    v_accvgpr_write_b32 a220, v92
    v_accvgpr_write_b32 a222, v93
    v_accvgpr_write_b32 a221, v94
    v_accvgpr_write_b32 a223, v95
    v_accvgpr_read_b32 v64, a224
    v_accvgpr_read_b32 v65, a225
    v_accvgpr_read_b32 v66, a226
    v_accvgpr_read_b32 v67, a227
    v_permlane16_swap_b32 v64, v65
    s_nop 0
    v_permlane16_swap_b32 v66, v67
    v_accvgpr_write_b32 a224, v64
    v_accvgpr_write_b32 a226, v65
    v_accvgpr_write_b32 a225, v66
    v_accvgpr_write_b32 a227, v67
    v_accvgpr_read_b32 v68, a228
    v_accvgpr_read_b32 v69, a229
    v_accvgpr_read_b32 v70, a230
    v_accvgpr_read_b32 v71, a231
    v_permlane16_swap_b32 v68, v69
    s_nop 0
    v_permlane16_swap_b32 v70, v71
    v_accvgpr_write_b32 a228, v68
    v_accvgpr_write_b32 a230, v69
    v_accvgpr_write_b32 a229, v70
    v_accvgpr_write_b32 a231, v71
    v_accvgpr_read_b32 v72, a232
    v_accvgpr_read_b32 v73, a233
    v_accvgpr_read_b32 v74, a234
    v_accvgpr_read_b32 v75, a235
    v_permlane16_swap_b32 v72, v73
    s_nop 0
    v_permlane16_swap_b32 v74, v75
    v_accvgpr_write_b32 a232, v72
    v_accvgpr_write_b32 a234, v73
    v_accvgpr_write_b32 a233, v74
    v_accvgpr_write_b32 a235, v75
    v_accvgpr_read_b32 v76, a236
    v_accvgpr_read_b32 v77, a237
    v_accvgpr_read_b32 v78, a238
    v_accvgpr_read_b32 v79, a239
    v_permlane16_swap_b32 v76, v77
    s_nop 0
    v_permlane16_swap_b32 v78, v79
    v_accvgpr_write_b32 a236, v76
    v_accvgpr_write_b32 a238, v77
    v_accvgpr_write_b32 a237, v78
    v_accvgpr_write_b32 a239, v79
    v_accvgpr_read_b32 v80, a240
    v_accvgpr_read_b32 v81, a241
    v_accvgpr_read_b32 v82, a242
    v_accvgpr_read_b32 v83, a243
    v_permlane16_swap_b32 v80, v81
    s_nop 0
    v_permlane16_swap_b32 v82, v83
    v_accvgpr_write_b32 a240, v80
    v_accvgpr_write_b32 a242, v81
    v_accvgpr_write_b32 a241, v82
    v_accvgpr_write_b32 a243, v83
    v_accvgpr_read_b32 v84, a244
    v_accvgpr_read_b32 v85, a245
    v_accvgpr_read_b32 v86, a246
    v_accvgpr_read_b32 v87, a247
    v_permlane16_swap_b32 v84, v85
    s_nop 0
    v_permlane16_swap_b32 v86, v87
    v_accvgpr_write_b32 a244, v84
    v_accvgpr_write_b32 a246, v85
    v_accvgpr_write_b32 a245, v86
    v_accvgpr_write_b32 a247, v87
    v_accvgpr_read_b32 v88, a248
    v_accvgpr_read_b32 v89, a249
    v_accvgpr_read_b32 v90, a250
    v_accvgpr_read_b32 v91, a251
    v_permlane16_swap_b32 v88, v89
    s_nop 0
    v_permlane16_swap_b32 v90, v91
    v_accvgpr_write_b32 a248, v88
    v_accvgpr_write_b32 a250, v89
    v_accvgpr_write_b32 a249, v90
    v_accvgpr_write_b32 a251, v91
    v_accvgpr_read_b32 v92, a252
    v_accvgpr_read_b32 v93, a253
    v_accvgpr_read_b32 v94, a254
    v_accvgpr_read_b32 v95, a255
    v_permlane16_swap_b32 v92, v93
    s_nop 0
    v_permlane16_swap_b32 v94, v95
    v_accvgpr_write_b32 a252, v92
    v_accvgpr_write_b32 a254, v93
    v_accvgpr_write_b32 a253, v94
    v_accvgpr_write_b32 a255, v95
    v_lshrrev_b32 v24, 2, v1
    v_and_b32 v25, 3, v1
    v_lshlrev_b32 v24, 6, v24
    v_lshl_add_u32 v24, v25, 3, v24
    s_lshl_b32 s52, s24, 14
    s_add_u32 s52, s52, 0x14000
    v_add_u32 v24, s52, v24
    ds_read_b64_tr_b16 a[128:129], v24 offset:0
    ds_read_b64_tr_b16 a[130:131], v24 offset:1024
    ds_read_b64_tr_b16 a[160:161], v24 offset:32
    ds_read_b64_tr_b16 a[162:163], v24 offset:1056
    ds_read_b64_tr_b16 a[132:133], v24 offset:2048
    ds_read_b64_tr_b16 a[134:135], v24 offset:3072
    ds_read_b64_tr_b16 a[164:165], v24 offset:2080
    ds_read_b64_tr_b16 a[166:167], v24 offset:3104
    s_waitcnt lgkmcnt(0)
    ds_read_b64_tr_b16 a[136:137], v24 offset:4096
    ds_read_b64_tr_b16 a[138:139], v24 offset:5120
    ds_read_b64_tr_b16 a[168:169], v24 offset:4128
    ds_read_b64_tr_b16 a[170:171], v24 offset:5152
    ds_read_b64_tr_b16 a[140:141], v24 offset:6144
    ds_read_b64_tr_b16 a[142:143], v24 offset:7168
    ds_read_b64_tr_b16 a[172:173], v24 offset:6176
    ds_read_b64_tr_b16 a[174:175], v24 offset:7200
    s_waitcnt lgkmcnt(0)
    ds_read_b64_tr_b16 a[144:145], v24 offset:8192
    ds_read_b64_tr_b16 a[146:147], v24 offset:9216
    ds_read_b64_tr_b16 a[176:177], v24 offset:8224
    ds_read_b64_tr_b16 a[178:179], v24 offset:9248
    ds_read_b64_tr_b16 a[148:149], v24 offset:10240
    ds_read_b64_tr_b16 a[150:151], v24 offset:11264
    ds_read_b64_tr_b16 a[180:181], v24 offset:10272
    ds_read_b64_tr_b16 a[182:183], v24 offset:11296
    s_waitcnt lgkmcnt(0)
    ds_read_b64_tr_b16 a[152:153], v24 offset:12288
    ds_read_b64_tr_b16 a[154:155], v24 offset:13312
    ds_read_b64_tr_b16 a[184:185], v24 offset:12320
    ds_read_b64_tr_b16 a[186:187], v24 offset:13344
    ds_read_b64_tr_b16 a[156:157], v24 offset:14336
    ds_read_b64_tr_b16 a[158:159], v24 offset:15360
    ds_read_b64_tr_b16 a[188:189], v24 offset:14368
    ds_read_b64_tr_b16 a[190:191], v24 offset:15392
    s_waitcnt lgkmcnt(0)
    s_lshr_b32 s52, s20, 1
    s_lshl_b32 s52, s52, 11
    v_add_u32 v14, s52, v3
    v_xor_b32 v15, 0x800, v14
    s_add_u32 s52, s24, 0
    s_and_b32 s52, s52, 3
    s_mul_i32 s52, s52, 0x6000
    v_add_u32 v21, s52, v3
    s_add_u32 s52, s24, 1
    s_and_b32 s52, s52, 3
    s_mul_i32 s52, s52, 0x6000
    v_add_u32 v18, s52, v3
    s_add_u32 s52, s24, 2
    s_and_b32 s52, s52, 3
    s_mul_i32 s52, s52, 0x6000
    s_add_u32 s52, s52, 0x2000
    v_add_u32 v19, s52, v3
    s_add_u32 s52, s24, 3
    s_and_b32 s52, s52, 3
    s_mul_i32 s52, s52, 0x6000
    s_add_u32 s52, s52, 0x4000
    v_add_u32 v20, s52, v3
    v_lshrrev_b32 v24, 4, v1
    v_and_b32 v22, 1, v24
    v_lshlrev_b32 v22, 5, v22
    v_lshrrev_b32 v24, 1, v24
    v_lshl_add_u32 v22, v24, 4, v22
    v_and_b32 v24, 15, v1
    v_lshl_add_u32 v22, v24, 11, v22
    s_waitcnt vmcnt(4)
    s_bitcmp1_b32 s24, 0
    s_cbranch_scc1 t1_198
    v_mfma_f32_16x16x32_bf16 v[32:35], v[192:195], v[128:131], 0
    v_mfma_f32_16x16x32_bf16 v[36:39], v[160:163], v[128:131], 0
    v_mfma_f32_16x16x32_bf16 v[32:35], v[196:199], v[132:135], v[32:35]
    v_mfma_f32_16x16x32_bf16 v[36:39], v[164:167], v[132:135], v[36:39]
    v_mfma_f32_16x16x32_bf16 v[32:35], v[200:203], v[136:139], v[32:35]
    v_mfma_f32_16x16x32_bf16 v[36:39], v[168:171], v[136:139], v[36:39]
    v_mfma_f32_16x16x32_bf16 v[32:35], v[204:207], v[140:143], v[32:35]
    v_mfma_f32_16x16x32_bf16 v[36:39], v[172:175], v[140:143], v[36:39]
    s_nop 7
    v_cndmask_b32 v36, v126, v36, s[88:89]
    v_cndmask_b32 v37, v126, v37, s[90:91]
    v_cndmask_b32 v38, v126, v38, s[92:93]
    v_cndmask_b32 v39, v126, v39, s[94:95]
    v_max3_f32 v28, v32, v33, v36
    v_max3_f32 v28, v28, v37, v38
    v_max_f32 v28, v28, v39
    v_mov_b32 v29, v28
    s_nop 1
    v_permlane16_swap_b32 v28, v29
    v_max_f32 v28, v28, v29
    v_mov_b32 v29, v28
    s_nop 1
    v_permlane32_swap_b32 v28, v29
    v_max_f32 v28, v28, v29
    v_mul_f32 v28, s96, v28
    v_fma_f32 v32, v32, s96, -v28
    v_fma_f32 v33, v33, s96, -v28
    v_fma_f32 v36, v36, s96, -v28
    v_fma_f32 v37, v37, s96, -v28
    v_fma_f32 v38, v38, s96, -v28
    v_fma_f32 v39, v39, s96, -v28
    v_exp_f32 v32, v32
    v_exp_f32 v33, v33
    v_exp_f32 v36, v36
    v_exp_f32 v37, v37
    v_exp_f32 v38, v38
    v_exp_f32 v39, v39
    v_mov_b32 v61, 0
    v_mov_b32 v62, 0
    v_cvt_pk_bf16_f32 v60, v32, v33
    v_cvt_pk_bf16_f32 v63, v32, v33
    v_cvt_pk_bf16_f32 v52, v36, v37
    v_cvt_pk_bf16_f32 v53, v38, v39
    s_waitcnt vmcnt(0)
    s_nop 0
    v_mfma_f32_16x16x16_bf16 v[252:255], v[120:121], v[52:53], 0
    v_mfma_f32_16x16x16_bf16 v[64:67], v[208:209], v[52:53], 0
    v_mfma_f32_16x16x16_bf16 v[68:71], v[212:213], v[52:53], 0
    v_mfma_f32_16x16x16_bf16 v[72:75], v[216:217], v[52:53], 0
    v_mfma_f32_16x16x16_bf16 v[76:79], v[220:221], v[52:53], 0
    v_mfma_f32_16x16x16_bf16 v[80:83], v[224:225], v[52:53], 0
    v_mfma_f32_16x16x16_bf16 v[84:87], v[228:229], v[52:53], 0
    v_mfma_f32_16x16x16_bf16 v[88:91], v[232:233], v[52:53], 0
    v_mfma_f32_16x16x16_bf16 v[92:95], v[236:237], v[52:53], 0
    v_mfma_f32_16x16x16_bf16 v[252:255], v[120:121], v[60:61], v[252:255]
    v_mfma_f32_16x16x16_bf16 v[64:67], v[240:241], v[60:61], v[64:67]
    v_mfma_f32_16x16x16_bf16 v[68:71], v[240:241], v[62:63], v[68:71]
    v_mfma_f32_16x16x16_bf16 v[72:75], v[242:243], v[60:61], v[72:75]
    v_mfma_f32_16x16x16_bf16 v[76:79], v[242:243], v[62:63], v[76:79]
    v_mfma_f32_16x16x16_bf16 v[80:83], v[244:245], v[60:61], v[80:83]
    v_mfma_f32_16x16x16_bf16 v[84:87], v[244:245], v[62:63], v[84:87]
    v_mfma_f32_16x16x16_bf16 v[88:91], v[246:247], v[60:61], v[88:91]
    v_mfma_f32_16x16x16_bf16 v[92:95], v[246:247], v[62:63], v[92:95]
    v_rcp_f32 v28, v252
    s_nop 0
    v_mul_f32 v28, v28, v10
    v_pk_mul_f32 v[64:65], v[64:65], v[28:29] op_sel_hi:[1,0]
    v_pk_mul_f32 v[66:67], v[66:67], v[28:29] op_sel_hi:[1,0]
    v_cvt_pk_bf16_f32 v96, v64, v65
    v_cvt_pk_bf16_f32 v97, v66, v67
    v_pk_mul_f32 v[68:69], v[68:69], v[28:29] op_sel_hi:[1,0]
    v_pk_mul_f32 v[70:71], v[70:71], v[28:29] op_sel_hi:[1,0]
    v_cvt_pk_bf16_f32 v98, v68, v69
    v_cvt_pk_bf16_f32 v99, v70, v71
    v_pk_mul_f32 v[72:73], v[72:73], v[28:29] op_sel_hi:[1,0]
    v_pk_mul_f32 v[74:75], v[74:75], v[28:29] op_sel_hi:[1,0]
    v_cvt_pk_bf16_f32 v100, v72, v73
    v_cvt_pk_bf16_f32 v101, v74, v75
    v_pk_mul_f32 v[76:77], v[76:77], v[28:29] op_sel_hi:[1,0]
    v_pk_mul_f32 v[78:79], v[78:79], v[28:29] op_sel_hi:[1,0]
    v_cvt_pk_bf16_f32 v102, v76, v77
    v_cvt_pk_bf16_f32 v103, v78, v79
    v_pk_mul_f32 v[80:81], v[80:81], v[28:29] op_sel_hi:[1,0]
    v_pk_mul_f32 v[82:83], v[82:83], v[28:29] op_sel_hi:[1,0]
    v_cvt_pk_bf16_f32 v104, v80, v81
    v_cvt_pk_bf16_f32 v105, v82, v83
    v_pk_mul_f32 v[84:85], v[84:85], v[28:29] op_sel_hi:[1,0]
    v_pk_mul_f32 v[86:87], v[86:87], v[28:29] op_sel_hi:[1,0]
    v_cvt_pk_bf16_f32 v106, v84, v85
    v_cvt_pk_bf16_f32 v107, v86, v87
    v_pk_mul_f32 v[88:89], v[88:89], v[28:29] op_sel_hi:[1,0]
    v_pk_mul_f32 v[90:91], v[90:91], v[28:29] op_sel_hi:[1,0]
    v_cvt_pk_bf16_f32 v108, v88, v89
    v_cvt_pk_bf16_f32 v109, v90, v91
    v_pk_mul_f32 v[92:93], v[92:93], v[28:29] op_sel_hi:[1,0]
    v_pk_mul_f32 v[94:95], v[94:95], v[28:29] op_sel_hi:[1,0]
    v_cvt_pk_bf16_f32 v110, v92, v93
    v_cvt_pk_bf16_f32 v111, v94, v95
    buffer_store_dwordx4 v[96:99], v3, s[8:11], s32 offen offset:0
    buffer_store_dwordx4 v[100:103], v3, s[8:11], s32 offen offset:1024
    buffer_store_dwordx4 v[104:107], v3, s[8:11], s33 offen offset:0
    buffer_store_dwordx4 v[108:111], v3, s[8:11], s33 offen offset:1024
    s_branch t2_199
    .p2align 5
t1_198:
    v_mfma_f32_16x16x32_bf16 v[40:43], v[192:195], v[144:147], 0
    v_mfma_f32_16x16x32_bf16 v[44:47], v[160:163], v[144:147], 0
    v_mfma_f32_16x16x32_bf16 v[48:51], v[176:179], v[144:147], 0
    v_mfma_f32_16x16x32_bf16 v[40:43], v[196:199], v[148:151], v[40:43]
    v_mfma_f32_16x16x32_bf16 v[44:47], v[164:167], v[148:151], v[44:47]
    v_mfma_f32_16x16x32_bf16 v[48:51], v[180:183], v[148:151], v[48:51]
    v_mfma_f32_16x16x32_bf16 v[40:43], v[200:203], v[152:155], v[40:43]
    v_mfma_f32_16x16x32_bf16 v[44:47], v[168:171], v[152:155], v[44:47]
    v_mfma_f32_16x16x32_bf16 v[48:51], v[184:187], v[152:155], v[48:51]
    v_mfma_f32_16x16x32_bf16 v[40:43], v[204:207], v[156:159], v[40:43]
    v_mfma_f32_16x16x32_bf16 v[44:47], v[172:175], v[156:159], v[44:47]
    v_mfma_f32_16x16x32_bf16 v[48:51], v[188:191], v[156:159], v[48:51]
    s_nop 7
    v_cndmask_b32 v48, v126, v48, s[88:89]
    v_cndmask_b32 v49, v126, v49, s[90:91]
    v_cndmask_b32 v50, v126, v50, s[92:93]
    v_cndmask_b32 v51, v126, v51, s[94:95]
    v_max3_f32 v30, v40, v41, v44
    v_max3_f32 v30, v30, v45, v46
    v_max3_f32 v30, v30, v47, v48
    v_max3_f32 v30, v30, v49, v50
    v_max_f32 v30, v30, v51
    v_mov_b32 v31, v30
    s_nop 1
    v_permlane16_swap_b32 v30, v31
    v_max_f32 v30, v30, v31
    v_mov_b32 v31, v30
    s_nop 1
    v_permlane32_swap_b32 v30, v31
    v_max_f32 v30, v30, v31
    v_mul_f32 v30, s96, v30
    v_fma_f32 v40, v40, s96, -v30
    v_fma_f32 v41, v41, s96, -v30
    v_fma_f32 v44, v44, s96, -v30
    v_fma_f32 v45, v45, s96, -v30
    v_fma_f32 v46, v46, s96, -v30
    v_fma_f32 v47, v47, s96, -v30
    v_fma_f32 v48, v48, s96, -v30
    v_fma_f32 v49, v49, s96, -v30
    v_fma_f32 v50, v50, s96, -v30
    v_fma_f32 v51, v51, s96, -v30
    v_exp_f32 v40, v40
    v_exp_f32 v41, v41
    v_exp_f32 v44, v44
    v_exp_f32 v45, v45
    v_exp_f32 v46, v46
    v_exp_f32 v47, v47
    v_exp_f32 v48, v48
    v_exp_f32 v49, v49
    v_exp_f32 v50, v50
    v_exp_f32 v51, v51
    v_mov_b32 v249, 0
    v_mov_b32 v250, 0
    v_cvt_pk_bf16_f32 v248, v40, v41
    v_cvt_pk_bf16_f32 v251, v40, v41
    v_cvt_pk_bf16_f32 v56, v44, v45
    v_cvt_pk_bf16_f32 v57, v46, v47
    v_cvt_pk_bf16_f32 v58, v48, v49
    v_cvt_pk_bf16_f32 v59, v50, v51
    s_waitcnt vmcnt(0)
    s_nop 0
    v_mfma_f32_16x16x32_bf16 v[252:255], v[120:123], v[56:59], 0
    v_mfma_f32_16x16x32_bf16 v[64:67], v[208:211], v[56:59], 0
    v_mfma_f32_16x16x32_bf16 v[68:71], v[212:215], v[56:59], 0
    v_mfma_f32_16x16x32_bf16 v[72:75], v[216:219], v[56:59], 0
    v_mfma_f32_16x16x32_bf16 v[76:79], v[220:223], v[56:59], 0
    v_mfma_f32_16x16x32_bf16 v[80:83], v[224:227], v[56:59], 0
    v_mfma_f32_16x16x32_bf16 v[84:87], v[228:231], v[56:59], 0
    v_mfma_f32_16x16x32_bf16 v[88:91], v[232:235], v[56:59], 0
    v_mfma_f32_16x16x32_bf16 v[92:95], v[236:239], v[56:59], 0
    v_mfma_f32_16x16x16_bf16 v[252:255], v[120:121], v[248:249], v[252:255]
    v_mfma_f32_16x16x16_bf16 v[64:67], v[240:241], v[248:249], v[64:67]
    v_mfma_f32_16x16x16_bf16 v[68:71], v[240:241], v[250:251], v[68:71]
    v_mfma_f32_16x16x16_bf16 v[72:75], v[242:243], v[248:249], v[72:75]
    v_mfma_f32_16x16x16_bf16 v[76:79], v[242:243], v[250:251], v[76:79]
    v_mfma_f32_16x16x16_bf16 v[80:83], v[244:245], v[248:249], v[80:83]
    v_mfma_f32_16x16x16_bf16 v[84:87], v[244:245], v[250:251], v[84:87]
    v_mfma_f32_16x16x16_bf16 v[88:91], v[246:247], v[248:249], v[88:91]
    v_mfma_f32_16x16x16_bf16 v[92:95], v[246:247], v[250:251], v[92:95]
    v_rcp_f32 v28, v252
    s_nop 0
    v_mul_f32 v28, v28, v11
    v_pk_mul_f32 v[64:65], v[64:65], v[28:29] op_sel_hi:[1,0]
    v_pk_mul_f32 v[66:67], v[66:67], v[28:29] op_sel_hi:[1,0]
    v_cvt_pk_bf16_f32 v96, v64, v65
    v_cvt_pk_bf16_f32 v97, v66, v67
    v_pk_mul_f32 v[68:69], v[68:69], v[28:29] op_sel_hi:[1,0]
    v_pk_mul_f32 v[70:71], v[70:71], v[28:29] op_sel_hi:[1,0]
    v_cvt_pk_bf16_f32 v98, v68, v69
    v_cvt_pk_bf16_f32 v99, v70, v71
    v_pk_mul_f32 v[72:73], v[72:73], v[28:29] op_sel_hi:[1,0]
    v_pk_mul_f32 v[74:75], v[74:75], v[28:29] op_sel_hi:[1,0]
    v_cvt_pk_bf16_f32 v100, v72, v73
    v_cvt_pk_bf16_f32 v101, v74, v75
    v_pk_mul_f32 v[76:77], v[76:77], v[28:29] op_sel_hi:[1,0]
    v_pk_mul_f32 v[78:79], v[78:79], v[28:29] op_sel_hi:[1,0]
    v_cvt_pk_bf16_f32 v102, v76, v77
    v_cvt_pk_bf16_f32 v103, v78, v79
    v_pk_mul_f32 v[80:81], v[80:81], v[28:29] op_sel_hi:[1,0]
    v_pk_mul_f32 v[82:83], v[82:83], v[28:29] op_sel_hi:[1,0]
    v_cvt_pk_bf16_f32 v104, v80, v81
    v_cvt_pk_bf16_f32 v105, v82, v83
    v_pk_mul_f32 v[84:85], v[84:85], v[28:29] op_sel_hi:[1,0]
    v_pk_mul_f32 v[86:87], v[86:87], v[28:29] op_sel_hi:[1,0]
    v_cvt_pk_bf16_f32 v106, v84, v85
    v_cvt_pk_bf16_f32 v107, v86, v87
    v_pk_mul_f32 v[88:89], v[88:89], v[28:29] op_sel_hi:[1,0]
    v_pk_mul_f32 v[90:91], v[90:91], v[28:29] op_sel_hi:[1,0]
    v_cvt_pk_bf16_f32 v108, v88, v89
    v_cvt_pk_bf16_f32 v109, v90, v91
    v_pk_mul_f32 v[92:93], v[92:93], v[28:29] op_sel_hi:[1,0]
    v_pk_mul_f32 v[94:95], v[94:95], v[28:29] op_sel_hi:[1,0]
    v_cvt_pk_bf16_f32 v110, v92, v93
    v_cvt_pk_bf16_f32 v111, v94, v95
    buffer_store_dwordx4 v[96:99], v3, s[8:11], s32 offen offset:2048
    buffer_store_dwordx4 v[100:103], v3, s[8:11], s32 offen offset:3072
    buffer_store_dwordx4 v[104:107], v3, s[8:11], s33 offen offset:2048
    buffer_store_dwordx4 v[108:111], v3, s[8:11], s33 offen offset:3072
t2_199:
    s_lshl_b32 s36, s20, 15
    s_add_u32 s36, s36, 0xb000000
    s_mov_b32 s52, 0x80
    v_mov_b32 v4, s52
    v_mov_b32 v5, 0
    s_cmp_lg_u32 s24, 0
    s_waitcnt vmcnt(0)
    s_barrier
    s_cbranch_scc1 ta_200
    s_mov_b64 exec, 1
    buffer_atomic_add v4, v5, s[8:11], s36 offen
    s_mov_b64 exec, -1
ta_200:
    s_lshl_b32 s52, s20, 2
    s_add_u32 s52, s52, s24
    s_lshl_b32 s52, s52, 3
    s_and_b32 s53, s21, 1
    s_add_u32 s52, s52, s53
    s_lshl_b32 s52, s52, 14
    s_add_u32 s64, s52, 0x9c00000
    s_add_u32 s65, s52, 0x9e00000
    v_readfirstlane_b32 s52, v6
    s_cmp_ge_u32 s52, 0x200000
    s_cbranch_scc1 t6_201
    s_mov_b32 s34, 0
tp_202:
    buffer_load_dword v4, v12, s[16:19], 0 offen sc1
    s_add_u32 s34, s34, 1
    s_cmp_ge_u32 s34, 0x20000
    s_cbranch_scc1 L_exit
    s_waitcnt vmcnt(0)
    v_readfirstlane_b32 s52, v4
    s_cmp_ge_u32 s52, 0x200000
    s_cbranch_scc0 tp_202
t6_201:
    s_add_u32 s52, s24, 0
    s_and_b32 s52, s52, 3
    s_lshl_b32 s52, s52, 12
    s_add_u32 s60, s52, s64
    s_add_u32 s61, s60, 0x8000
    s_add_u32 s62, s60, 0x10000
    s_add_u32 s63, s60, 0x18000
    buffer_load_dwordx4 v[128:131], v14, s[8:11], s60 offen offset:0
    buffer_load_dwordx4 v[132:135], v14, s[8:11], s60 offen offset:1024
    buffer_load_dwordx4 v[136:139], v14, s[8:11], s61 offen offset:0
    buffer_load_dwordx4 v[140:143], v14, s[8:11], s61 offen offset:1024
    buffer_load_dwordx4 v[144:147], v14, s[8:11], s62 offen offset:0
    buffer_load_dwordx4 v[148:151], v14, s[8:11], s62 offen offset:1024
    buffer_load_dwordx4 v[152:155], v14, s[8:11], s63 offen offset:0
    buffer_load_dwordx4 v[156:159], v14, s[8:11], s63 offen offset:1024
    buffer_load_dwordx4 v[160:163], v15, s[8:11], s60 offen offset:0
    buffer_load_dwordx4 v[164:167], v15, s[8:11], s60 offen offset:1024
    buffer_load_dwordx4 v[168:171], v15, s[8:11], s61 offen offset:0
    buffer_load_dwordx4 v[172:175], v15, s[8:11], s61 offen offset:1024
    buffer_load_dwordx4 v[176:179], v15, s[8:11], s62 offen offset:0
    buffer_load_dwordx4 v[180:183], v15, s[8:11], s62 offen offset:1024
    buffer_load_dwordx4 v[184:187], v15, s[8:11], s63 offen offset:0
    buffer_load_dwordx4 v[188:191], v15, s[8:11], s63 offen offset:1024
    s_add_u32 s52, s24, 1
    s_and_b32 s52, s52, 3
    s_lshl_b32 s52, s52, 12
    s_add_u32 s60, s52, s64
    s_add_u32 s61, s60, 0x8000
    s_add_u32 s62, s60, 0x10000
    s_add_u32 s63, s60, 0x18000
    buffer_load_dwordx4 v[192:195], v14, s[8:11], s60 offen offset:0
    buffer_load_dwordx4 v[196:199], v14, s[8:11], s60 offen offset:1024
    buffer_load_dwordx4 v[200:203], v14, s[8:11], s61 offen offset:0
    buffer_load_dwordx4 v[204:207], v14, s[8:11], s61 offen offset:1024
    buffer_load_dwordx4 v[208:211], v14, s[8:11], s62 offen offset:0
    buffer_load_dwordx4 v[212:215], v14, s[8:11], s62 offen offset:1024
    buffer_load_dwordx4 v[216:219], v14, s[8:11], s63 offen offset:0
    buffer_load_dwordx4 v[220:223], v14, s[8:11], s63 offen offset:1024
    buffer_load_dwordx4 v[224:227], v15, s[8:11], s60 offen offset:0
    buffer_load_dwordx4 v[228:231], v15, s[8:11], s60 offen offset:1024
    buffer_load_dwordx4 v[232:235], v15, s[8:11], s61 offen offset:0
    buffer_load_dwordx4 v[236:239], v15, s[8:11], s61 offen offset:1024
    buffer_load_dwordx4 v[240:243], v15, s[8:11], s62 offen offset:0
    buffer_load_dwordx4 v[244:247], v15, s[8:11], s62 offen offset:1024
    buffer_load_dwordx4 v[248:251], v15, s[8:11], s63 offen offset:0
    buffer_load_dwordx4 v[252:255], v15, s[8:11], s63 offen offset:1024
    s_waitcnt vmcnt(31)
    v_mfma_f32_16x16x32_bf16 a[0:3], a[192:195], v[128:131], 0
    v_mfma_f32_16x16x32_bf16 a[4:7], a[224:227], v[128:131], 0
    v_mfma_f32_16x16x32_bf16 a[8:11], a[128:131], v[128:131], 0
    v_mfma_f32_16x16x32_bf16 a[12:15], a[160:163], v[128:131], 0
    s_waitcnt vmcnt(30)
    v_mfma_f32_16x16x32_bf16 a[0:3], a[196:199], v[132:135], a[0:3]
    s_add_u32 s52, s24, 2
    s_and_b32 s52, s52, 3
    s_lshl_b32 s52, s52, 12
    s_add_u32 s60, s52, s64
    s_add_u32 s61, s60, 0x8000
    s_add_u32 s62, s60, 0x10000
    s_add_u32 s63, s60, 0x18000
    buffer_load_dwordx4 v[128:131], v14, s[8:11], s60 offen offset:0
    v_mfma_f32_16x16x32_bf16 a[4:7], a[228:231], v[132:135], a[4:7]
    v_mfma_f32_16x16x32_bf16 a[8:11], a[132:135], v[132:135], a[8:11]
    v_mfma_f32_16x16x32_bf16 a[12:15], a[164:167], v[132:135], a[12:15]
    s_waitcnt vmcnt(30)
    v_mfma_f32_16x16x32_bf16 a[0:3], a[200:203], v[136:139], a[0:3]
    buffer_load_dwordx4 v[132:135], v14, s[8:11], s60 offen offset:1024
    v_mfma_f32_16x16x32_bf16 a[4:7], a[232:235], v[136:139], a[4:7]
    v_mfma_f32_16x16x32_bf16 a[8:11], a[136:139], v[136:139], a[8:11]
    v_mfma_f32_16x16x32_bf16 a[12:15], a[168:171], v[136:139], a[12:15]
    s_waitcnt vmcnt(30)
    v_mfma_f32_16x16x32_bf16 a[0:3], a[204:207], v[140:143], a[0:3]
    buffer_load_dwordx4 v[136:139], v14, s[8:11], s61 offen offset:0
    v_mfma_f32_16x16x32_bf16 a[4:7], a[236:239], v[140:143], a[4:7]
    v_mfma_f32_16x16x32_bf16 a[8:11], a[140:143], v[140:143], a[8:11]
    v_mfma_f32_16x16x32_bf16 a[12:15], a[172:175], v[140:143], a[12:15]
    s_waitcnt vmcnt(30)
    v_mfma_f32_16x16x32_bf16 a[0:3], a[208:211], v[144:147], a[0:3]
    buffer_load_dwordx4 v[140:143], v14, s[8:11], s61 offen offset:1024
    v_mfma_f32_16x16x32_bf16 a[4:7], a[240:243], v[144:147], a[4:7]
    v_mfma_f32_16x16x32_bf16 a[8:11], a[144:147], v[144:147], a[8:11]
    v_mfma_f32_16x16x32_bf16 a[12:15], a[176:179], v[144:147], a[12:15]
    s_waitcnt vmcnt(30)
    v_mfma_f32_16x16x32_bf16 a[0:3], a[212:215], v[148:151], a[0:3]
    buffer_load_dwordx4 v[144:147], v14, s[8:11], s62 offen offset:0
    v_mfma_f32_16x16x32_bf16 a[4:7], a[244:247], v[148:151], a[4:7]
    v_mfma_f32_16x16x32_bf16 a[8:11], a[148:151], v[148:151], a[8:11]
    v_mfma_f32_16x16x32_bf16 a[12:15], a[180:183], v[148:151], a[12:15]
    s_waitcnt vmcnt(30)
    v_mfma_f32_16x16x32_bf16 a[0:3], a[216:219], v[152:155], a[0:3]
    buffer_load_dwordx4 v[148:151], v14, s[8:11], s62 offen offset:1024
    v_mfma_f32_16x16x32_bf16 a[4:7], a[248:251], v[152:155], a[4:7]
    v_mfma_f32_16x16x32_bf16 a[8:11], a[152:155], v[152:155], a[8:11]
    v_mfma_f32_16x16x32_bf16 a[12:15], a[184:187], v[152:155], a[12:15]
    s_waitcnt vmcnt(30)
    v_mfma_f32_16x16x32_bf16 a[0:3], a[220:223], v[156:159], a[0:3]
    buffer_load_dwordx4 v[152:155], v14, s[8:11], s63 offen offset:0
    v_mfma_f32_16x16x32_bf16 a[4:7], a[252:255], v[156:159], a[4:7]
    v_mfma_f32_16x16x32_bf16 a[8:11], a[156:159], v[156:159], a[8:11]
    v_mfma_f32_16x16x32_bf16 a[12:15], a[188:191], v[156:159], a[12:15]
    s_waitcnt vmcnt(30)
    v_mfma_f32_16x16x32_bf16 a[16:19], a[192:195], v[160:163], 0
    buffer_load_dwordx4 v[156:159], v14, s[8:11], s63 offen offset:1024
    v_mfma_f32_16x16x32_bf16 a[20:23], a[224:227], v[160:163], 0
    v_mfma_f32_16x16x32_bf16 a[24:27], a[128:131], v[160:163], 0
    v_mfma_f32_16x16x32_bf16 a[28:31], a[160:163], v[160:163], 0
    s_waitcnt vmcnt(30)
    v_mfma_f32_16x16x32_bf16 a[16:19], a[196:199], v[164:167], a[16:19]
    buffer_load_dwordx4 v[160:163], v15, s[8:11], s60 offen offset:0
    v_mfma_f32_16x16x32_bf16 a[20:23], a[228:231], v[164:167], a[20:23]
    v_mfma_f32_16x16x32_bf16 a[24:27], a[132:135], v[164:167], a[24:27]
    v_mfma_f32_16x16x32_bf16 a[28:31], a[164:167], v[164:167], a[28:31]
    s_waitcnt vmcnt(30)
    v_mfma_f32_16x16x32_bf16 a[16:19], a[200:203], v[168:171], a[16:19]
    buffer_load_dwordx4 v[164:167], v15, s[8:11], s60 offen offset:1024
    v_mfma_f32_16x16x32_bf16 a[20:23], a[232:235], v[168:171], a[20:23]
    v_mfma_f32_16x16x32_bf16 a[24:27], a[136:139], v[168:171], a[24:27]
    v_mfma_f32_16x16x32_bf16 a[28:31], a[168:171], v[168:171], a[28:31]
    s_waitcnt vmcnt(30)
    v_mfma_f32_16x16x32_bf16 a[16:19], a[204:207], v[172:175], a[16:19]
    buffer_load_dwordx4 v[168:171], v15, s[8:11], s61 offen offset:0
    v_mfma_f32_16x16x32_bf16 a[20:23], a[236:239], v[172:175], a[20:23]
    v_mfma_f32_16x16x32_bf16 a[24:27], a[140:143], v[172:175], a[24:27]
    v_mfma_f32_16x16x32_bf16 a[28:31], a[172:175], v[172:175], a[28:31]
    s_waitcnt vmcnt(30)
    v_mfma_f32_16x16x32_bf16 a[16:19], a[208:211], v[176:179], a[16:19]
    buffer_load_dwordx4 v[172:175], v15, s[8:11], s61 offen offset:1024
    v_mfma_f32_16x16x32_bf16 a[20:23], a[240:243], v[176:179], a[20:23]
    v_mfma_f32_16x16x32_bf16 a[24:27], a[144:147], v[176:179], a[24:27]
    v_mfma_f32_16x16x32_bf16 a[28:31], a[176:179], v[176:179], a[28:31]
    s_waitcnt vmcnt(30)
    v_mfma_f32_16x16x32_bf16 a[16:19], a[212:215], v[180:183], a[16:19]
    buffer_load_dwordx4 v[176:179], v15, s[8:11], s62 offen offset:0
    v_mfma_f32_16x16x32_bf16 a[20:23], a[244:247], v[180:183], a[20:23]
    v_mfma_f32_16x16x32_bf16 a[24:27], a[148:151], v[180:183], a[24:27]
    v_mfma_f32_16x16x32_bf16 a[28:31], a[180:183], v[180:183], a[28:31]
    s_waitcnt vmcnt(30)
    v_mfma_f32_16x16x32_bf16 a[16:19], a[216:219], v[184:187], a[16:19]
    buffer_load_dwordx4 v[180:183], v15, s[8:11], s62 offen offset:1024
    v_mfma_f32_16x16x32_bf16 a[20:23], a[248:251], v[184:187], a[20:23]
    v_mfma_f32_16x16x32_bf16 a[24:27], a[152:155], v[184:187], a[24:27]
    v_mfma_f32_16x16x32_bf16 a[28:31], a[184:187], v[184:187], a[28:31]
    s_waitcnt vmcnt(30)
    v_mfma_f32_16x16x32_bf16 a[16:19], a[220:223], v[188:191], a[16:19]
    buffer_load_dwordx4 v[184:187], v15, s[8:11], s63 offen offset:0
    v_mfma_f32_16x16x32_bf16 a[20:23], a[252:255], v[188:191], a[20:23]
    v_mfma_f32_16x16x32_bf16 a[24:27], a[156:159], v[188:191], a[24:27]
    v_mfma_f32_16x16x32_bf16 a[28:31], a[188:191], v[188:191], a[28:31]
    s_waitcnt vmcnt(30)
    v_mfma_f32_16x16x32_bf16 a[32:35], a[192:195], v[192:195], 0
    buffer_load_dwordx4 v[188:191], v15, s[8:11], s63 offen offset:1024
    v_mfma_f32_16x16x32_bf16 a[36:39], a[224:227], v[192:195], 0
    v_mfma_f32_16x16x32_bf16 a[40:43], a[128:131], v[192:195], 0
    v_mfma_f32_16x16x32_bf16 a[44:47], a[160:163], v[192:195], 0
    s_waitcnt vmcnt(30)
    v_mfma_f32_16x16x32_bf16 a[32:35], a[196:199], v[196:199], a[32:35]
    s_add_u32 s52, s24, 3
    s_and_b32 s52, s52, 3
    s_lshl_b32 s52, s52, 12
    s_add_u32 s60, s52, s64
    s_add_u32 s61, s60, 0x8000
    s_add_u32 s62, s60, 0x10000
    s_add_u32 s63, s60, 0x18000
    buffer_load_dwordx4 v[192:195], v14, s[8:11], s60 offen offset:0
    v_mfma_f32_16x16x32_bf16 a[36:39], a[228:231], v[196:199], a[36:39]
    v_mfma_f32_16x16x32_bf16 a[40:43], a[132:135], v[196:199], a[40:43]
    v_mfma_f32_16x16x32_bf16 a[44:47], a[164:167], v[196:199], a[44:47]
    s_waitcnt vmcnt(30)
    v_mfma_f32_16x16x32_bf16 a[32:35], a[200:203], v[200:203], a[32:35]
    buffer_load_dwordx4 v[196:199], v14, s[8:11], s60 offen offset:1024
    v_mfma_f32_16x16x32_bf16 a[36:39], a[232:235], v[200:203], a[36:39]
    v_mfma_f32_16x16x32_bf16 a[40:43], a[136:139], v[200:203], a[40:43]
    v_mfma_f32_16x16x32_bf16 a[44:47], a[168:171], v[200:203], a[44:47]
    s_waitcnt vmcnt(30)
    v_mfma_f32_16x16x32_bf16 a[32:35], a[204:207], v[204:207], a[32:35]
    buffer_load_dwordx4 v[200:203], v14, s[8:11], s61 offen offset:0
    v_mfma_f32_16x16x32_bf16 a[36:39], a[236:239], v[204:207], a[36:39]
    v_mfma_f32_16x16x32_bf16 a[40:43], a[140:143], v[204:207], a[40:43]
    v_mfma_f32_16x16x32_bf16 a[44:47], a[172:175], v[204:207], a[44:47]
    s_waitcnt vmcnt(30)
    v_mfma_f32_16x16x32_bf16 a[32:35], a[208:211], v[208:211], a[32:35]
    buffer_load_dwordx4 v[204:207], v14, s[8:11], s61 offen offset:1024
    v_mfma_f32_16x16x32_bf16 a[36:39], a[240:243], v[208:211], a[36:39]
    v_mfma_f32_16x16x32_bf16 a[40:43], a[144:147], v[208:211], a[40:43]
    v_mfma_f32_16x16x32_bf16 a[44:47], a[176:179], v[208:211], a[44:47]
    s_waitcnt vmcnt(30)
    v_mfma_f32_16x16x32_bf16 a[32:35], a[212:215], v[212:215], a[32:35]
    buffer_load_dwordx4 v[208:211], v14, s[8:11], s62 offen offset:0
    v_mfma_f32_16x16x32_bf16 a[36:39], a[244:247], v[212:215], a[36:39]
    v_mfma_f32_16x16x32_bf16 a[40:43], a[148:151], v[212:215], a[40:43]
    v_mfma_f32_16x16x32_bf16 a[44:47], a[180:183], v[212:215], a[44:47]
    s_waitcnt vmcnt(30)
    v_mfma_f32_16x16x32_bf16 a[32:35], a[216:219], v[216:219], a[32:35]
    buffer_load_dwordx4 v[212:215], v14, s[8:11], s62 offen offset:1024
    v_mfma_f32_16x16x32_bf16 a[36:39], a[248:251], v[216:219], a[36:39]
    v_mfma_f32_16x16x32_bf16 a[40:43], a[152:155], v[216:219], a[40:43]
    v_mfma_f32_16x16x32_bf16 a[44:47], a[184:187], v[216:219], a[44:47]
    s_waitcnt vmcnt(30)
    v_mfma_f32_16x16x32_bf16 a[32:35], a[220:223], v[220:223], a[32:35]
    buffer_load_dwordx4 v[216:219], v14, s[8:11], s63 offen offset:0
    v_mfma_f32_16x16x32_bf16 a[36:39], a[252:255], v[220:223], a[36:39]
    v_mfma_f32_16x16x32_bf16 a[40:43], a[156:159], v[220:223], a[40:43]
    v_mfma_f32_16x16x32_bf16 a[44:47], a[188:191], v[220:223], a[44:47]
    s_waitcnt vmcnt(30)
    v_mfma_f32_16x16x32_bf16 a[48:51], a[192:195], v[224:227], 0
    buffer_load_dwordx4 v[220:223], v14, s[8:11], s63 offen offset:1024
    v_mfma_f32_16x16x32_bf16 a[52:55], a[224:227], v[224:227], 0
    v_mfma_f32_16x16x32_bf16 a[56:59], a[128:131], v[224:227], 0
    v_mfma_f32_16x16x32_bf16 a[60:63], a[160:163], v[224:227], 0
    s_waitcnt vmcnt(30)
    v_mfma_f32_16x16x32_bf16 a[48:51], a[196:199], v[228:231], a[48:51]
    buffer_load_dwordx4 v[224:227], v15, s[8:11], s60 offen offset:0
    v_mfma_f32_16x16x32_bf16 a[52:55], a[228:231], v[228:231], a[52:55]
    v_mfma_f32_16x16x32_bf16 a[56:59], a[132:135], v[228:231], a[56:59]
    v_mfma_f32_16x16x32_bf16 a[60:63], a[164:167], v[228:231], a[60:63]
    s_waitcnt vmcnt(30)
    v_mfma_f32_16x16x32_bf16 a[48:51], a[200:203], v[232:235], a[48:51]
    buffer_load_dwordx4 v[228:231], v15, s[8:11], s60 offen offset:1024
    v_mfma_f32_16x16x32_bf16 a[52:55], a[232:235], v[232:235], a[52:55]
    v_mfma_f32_16x16x32_bf16 a[56:59], a[136:139], v[232:235], a[56:59]
    v_mfma_f32_16x16x32_bf16 a[60:63], a[168:171], v[232:235], a[60:63]
    s_waitcnt vmcnt(30)
    v_mfma_f32_16x16x32_bf16 a[48:51], a[204:207], v[236:239], a[48:51]
    buffer_load_dwordx4 v[232:235], v15, s[8:11], s61 offen offset:0
    v_mfma_f32_16x16x32_bf16 a[52:55], a[236:239], v[236:239], a[52:55]
    v_mfma_f32_16x16x32_bf16 a[56:59], a[140:143], v[236:239], a[56:59]
    v_mfma_f32_16x16x32_bf16 a[60:63], a[172:175], v[236:239], a[60:63]
    s_waitcnt vmcnt(30)
    v_mfma_f32_16x16x32_bf16 a[48:51], a[208:211], v[240:243], a[48:51]
    buffer_load_dwordx4 v[236:239], v15, s[8:11], s61 offen offset:1024
    v_mfma_f32_16x16x32_bf16 a[52:55], a[240:243], v[240:243], a[52:55]
    v_mfma_f32_16x16x32_bf16 a[56:59], a[144:147], v[240:243], a[56:59]
    v_mfma_f32_16x16x32_bf16 a[60:63], a[176:179], v[240:243], a[60:63]
    s_waitcnt vmcnt(30)
    v_mfma_f32_16x16x32_bf16 a[48:51], a[212:215], v[244:247], a[48:51]
    buffer_load_dwordx4 v[240:243], v15, s[8:11], s62 offen offset:0
    v_mfma_f32_16x16x32_bf16 a[52:55], a[244:247], v[244:247], a[52:55]
    v_mfma_f32_16x16x32_bf16 a[56:59], a[148:151], v[244:247], a[56:59]
    v_mfma_f32_16x16x32_bf16 a[60:63], a[180:183], v[244:247], a[60:63]
    s_waitcnt vmcnt(30)
    v_mfma_f32_16x16x32_bf16 a[48:51], a[216:219], v[248:251], a[48:51]
    buffer_load_dwordx4 v[244:247], v15, s[8:11], s62 offen offset:1024
    v_mfma_f32_16x16x32_bf16 a[52:55], a[248:251], v[248:251], a[52:55]
    v_mfma_f32_16x16x32_bf16 a[56:59], a[152:155], v[248:251], a[56:59]
    v_mfma_f32_16x16x32_bf16 a[60:63], a[184:187], v[248:251], a[60:63]
    s_waitcnt vmcnt(30)
    v_mfma_f32_16x16x32_bf16 a[48:51], a[220:223], v[252:255], a[48:51]
    buffer_load_dwordx4 v[248:251], v15, s[8:11], s63 offen offset:0
    v_mfma_f32_16x16x32_bf16 a[52:55], a[252:255], v[252:255], a[52:55]
    v_mfma_f32_16x16x32_bf16 a[56:59], a[156:159], v[252:255], a[56:59]
    v_mfma_f32_16x16x32_bf16 a[60:63], a[188:191], v[252:255], a[60:63]
    s_waitcnt vmcnt(30)
    v_mfma_f32_16x16x32_bf16 a[64:67], a[192:195], v[128:131], 0
    buffer_load_dwordx4 v[252:255], v15, s[8:11], s63 offen offset:1024
    v_mfma_f32_16x16x32_bf16 a[68:71], a[224:227], v[128:131], 0
    v_mfma_f32_16x16x32_bf16 a[72:75], a[128:131], v[128:131], 0
    ds_write_b128 v18, a[32:35] offset:0
    v_mfma_f32_16x16x32_bf16 a[76:79], a[160:163], v[128:131], 0
    s_waitcnt vmcnt(30)
    v_mfma_f32_16x16x32_bf16 a[64:67], a[196:199], v[132:135], a[64:67]
    v_mfma_f32_16x16x32_bf16 a[68:71], a[228:231], v[132:135], a[68:71]
    v_mfma_f32_16x16x32_bf16 a[72:75], a[132:135], v[132:135], a[72:75]
    v_mfma_f32_16x16x32_bf16 a[76:79], a[164:167], v[132:135], a[76:79]
    s_waitcnt vmcnt(29)
    v_mfma_f32_16x16x32_bf16 a[64:67], a[200:203], v[136:139], a[64:67]
    v_mfma_f32_16x16x32_bf16 a[68:71], a[232:235], v[136:139], a[68:71]
    v_mfma_f32_16x16x32_bf16 a[72:75], a[136:139], v[136:139], a[72:75]
    ds_write_b128 v18, a[36:39] offset:1024
    v_mfma_f32_16x16x32_bf16 a[76:79], a[168:171], v[136:139], a[76:79]
    s_waitcnt vmcnt(28)
    v_mfma_f32_16x16x32_bf16 a[64:67], a[204:207], v[140:143], a[64:67]
    v_mfma_f32_16x16x32_bf16 a[68:71], a[236:239], v[140:143], a[68:71]
    v_mfma_f32_16x16x32_bf16 a[72:75], a[140:143], v[140:143], a[72:75]
    v_mfma_f32_16x16x32_bf16 a[76:79], a[172:175], v[140:143], a[76:79]
    s_waitcnt vmcnt(27)
    v_mfma_f32_16x16x32_bf16 a[64:67], a[208:211], v[144:147], a[64:67]
    v_mfma_f32_16x16x32_bf16 a[68:71], a[240:243], v[144:147], a[68:71]
    v_mfma_f32_16x16x32_bf16 a[72:75], a[144:147], v[144:147], a[72:75]
    ds_write_b128 v18, a[40:43] offset:2048
    v_mfma_f32_16x16x32_bf16 a[76:79], a[176:179], v[144:147], a[76:79]
    s_waitcnt vmcnt(26)
    v_mfma_f32_16x16x32_bf16 a[64:67], a[212:215], v[148:151], a[64:67]
    v_mfma_f32_16x16x32_bf16 a[68:71], a[244:247], v[148:151], a[68:71]
    v_mfma_f32_16x16x32_bf16 a[72:75], a[148:151], v[148:151], a[72:75]
    v_mfma_f32_16x16x32_bf16 a[76:79], a[180:183], v[148:151], a[76:79]
    s_waitcnt vmcnt(25)
    v_mfma_f32_16x16x32_bf16 a[64:67], a[216:219], v[152:155], a[64:67]
    v_mfma_f32_16x16x32_bf16 a[68:71], a[248:251], v[152:155], a[68:71]
    v_mfma_f32_16x16x32_bf16 a[72:75], a[152:155], v[152:155], a[72:75]
    ds_write_b128 v18, a[44:47] offset:3072
    v_mfma_f32_16x16x32_bf16 a[76:79], a[184:187], v[152:155], a[76:79]
    s_waitcnt vmcnt(24)
    v_mfma_f32_16x16x32_bf16 a[64:67], a[220:223], v[156:159], a[64:67]
    v_mfma_f32_16x16x32_bf16 a[68:71], a[252:255], v[156:159], a[68:71]
    v_mfma_f32_16x16x32_bf16 a[72:75], a[156:159], v[156:159], a[72:75]
    v_mfma_f32_16x16x32_bf16 a[76:79], a[188:191], v[156:159], a[76:79]
    s_waitcnt vmcnt(23)
    v_mfma_f32_16x16x32_bf16 a[80:83], a[192:195], v[160:163], 0
    v_mfma_f32_16x16x32_bf16 a[84:87], a[224:227], v[160:163], 0
    v_mfma_f32_16x16x32_bf16 a[88:91], a[128:131], v[160:163], 0
    ds_write_b128 v18, a[48:51] offset:4096
    v_mfma_f32_16x16x32_bf16 a[92:95], a[160:163], v[160:163], 0
    s_waitcnt vmcnt(22)
    v_mfma_f32_16x16x32_bf16 a[80:83], a[196:199], v[164:167], a[80:83]
    v_mfma_f32_16x16x32_bf16 a[84:87], a[228:231], v[164:167], a[84:87]
    v_mfma_f32_16x16x32_bf16 a[88:91], a[132:135], v[164:167], a[88:91]
    v_mfma_f32_16x16x32_bf16 a[92:95], a[164:167], v[164:167], a[92:95]
    s_waitcnt vmcnt(21)
    v_mfma_f32_16x16x32_bf16 a[80:83], a[200:203], v[168:171], a[80:83]
    v_mfma_f32_16x16x32_bf16 a[84:87], a[232:235], v[168:171], a[84:87]
    v_mfma_f32_16x16x32_bf16 a[88:91], a[136:139], v[168:171], a[88:91]
    ds_write_b128 v18, a[52:55] offset:5120
    v_mfma_f32_16x16x32_bf16 a[92:95], a[168:171], v[168:171], a[92:95]
    s_waitcnt vmcnt(20)
    v_mfma_f32_16x16x32_bf16 a[80:83], a[204:207], v[172:175], a[80:83]
    v_mfma_f32_16x16x32_bf16 a[84:87], a[236:239], v[172:175], a[84:87]
    v_mfma_f32_16x16x32_bf16 a[88:91], a[140:143], v[172:175], a[88:91]
    v_mfma_f32_16x16x32_bf16 a[92:95], a[172:175], v[172:175], a[92:95]
    s_waitcnt vmcnt(19)
    v_mfma_f32_16x16x32_bf16 a[80:83], a[208:211], v[176:179], a[80:83]
    v_mfma_f32_16x16x32_bf16 a[84:87], a[240:243], v[176:179], a[84:87]
    v_mfma_f32_16x16x32_bf16 a[88:91], a[144:147], v[176:179], a[88:91]
    ds_write_b128 v18, a[56:59] offset:6144
    v_mfma_f32_16x16x32_bf16 a[92:95], a[176:179], v[176:179], a[92:95]
    buffer_load_dword v4, v5, s[8:11], s36 offen sc1
    s_waitcnt vmcnt(19)
    v_mfma_f32_16x16x32_bf16 a[80:83], a[212:215], v[180:183], a[80:83]
    v_mfma_f32_16x16x32_bf16 a[84:87], a[244:247], v[180:183], a[84:87]
    v_mfma_f32_16x16x32_bf16 a[88:91], a[148:151], v[180:183], a[88:91]
    v_mfma_f32_16x16x32_bf16 a[92:95], a[180:183], v[180:183], a[92:95]
    s_waitcnt vmcnt(18)
    v_mfma_f32_16x16x32_bf16 a[80:83], a[216:219], v[184:187], a[80:83]
    v_mfma_f32_16x16x32_bf16 a[84:87], a[248:251], v[184:187], a[84:87]
    v_mfma_f32_16x16x32_bf16 a[88:91], a[152:155], v[184:187], a[88:91]
    ds_write_b128 v18, a[60:63] offset:7168
    v_mfma_f32_16x16x32_bf16 a[92:95], a[184:187], v[184:187], a[92:95]
    s_waitcnt vmcnt(17)
    v_mfma_f32_16x16x32_bf16 a[80:83], a[220:223], v[188:191], a[80:83]
    v_mfma_f32_16x16x32_bf16 a[84:87], a[252:255], v[188:191], a[84:87]
    v_mfma_f32_16x16x32_bf16 a[88:91], a[156:159], v[188:191], a[88:91]
    v_mfma_f32_16x16x32_bf16 a[92:95], a[188:191], v[188:191], a[92:95]
    s_waitcnt vmcnt(16)
    v_mfma_f32_16x16x32_bf16 a[96:99], a[192:195], v[192:195], 0
    v_mfma_f32_16x16x32_bf16 a[100:103], a[224:227], v[192:195], 0
    v_mfma_f32_16x16x32_bf16 a[104:107], a[128:131], v[192:195], 0
    ds_write_b128 v19, a[64:67] offset:0
    v_mfma_f32_16x16x32_bf16 a[108:111], a[160:163], v[192:195], 0
    s_waitcnt vmcnt(15)
    v_mfma_f32_16x16x32_bf16 a[96:99], a[196:199], v[196:199], a[96:99]
    v_mfma_f32_16x16x32_bf16 a[100:103], a[228:231], v[196:199], a[100:103]
    v_mfma_f32_16x16x32_bf16 a[104:107], a[132:135], v[196:199], a[104:107]
    v_mfma_f32_16x16x32_bf16 a[108:111], a[164:167], v[196:199], a[108:111]
    s_waitcnt vmcnt(14)
    v_mfma_f32_16x16x32_bf16 a[96:99], a[200:203], v[200:203], a[96:99]
    v_mfma_f32_16x16x32_bf16 a[100:103], a[232:235], v[200:203], a[100:103]
    v_mfma_f32_16x16x32_bf16 a[104:107], a[136:139], v[200:203], a[104:107]
    ds_write_b128 v19, a[68:71] offset:1024
    v_mfma_f32_16x16x32_bf16 a[108:111], a[168:171], v[200:203], a[108:111]
    s_waitcnt vmcnt(13)
    v_mfma_f32_16x16x32_bf16 a[96:99], a[204:207], v[204:207], a[96:99]
    v_mfma_f32_16x16x32_bf16 a[100:103], a[236:239], v[204:207], a[100:103]
    v_mfma_f32_16x16x32_bf16 a[104:107], a[140:143], v[204:207], a[104:107]
    v_mfma_f32_16x16x32_bf16 a[108:111], a[172:175], v[204:207], a[108:111]
    s_waitcnt vmcnt(12)
    v_mfma_f32_16x16x32_bf16 a[96:99], a[208:211], v[208:211], a[96:99]
    v_mfma_f32_16x16x32_bf16 a[100:103], a[240:243], v[208:211], a[100:103]
    v_mfma_f32_16x16x32_bf16 a[104:107], a[144:147], v[208:211], a[104:107]
    ds_write_b128 v19, a[72:75] offset:2048
    v_mfma_f32_16x16x32_bf16 a[108:111], a[176:179], v[208:211], a[108:111]
    s_waitcnt vmcnt(11)
    v_mfma_f32_16x16x32_bf16 a[96:99], a[212:215], v[212:215], a[96:99]
    v_mfma_f32_16x16x32_bf16 a[100:103], a[244:247], v[212:215], a[100:103]
    v_mfma_f32_16x16x32_bf16 a[104:107], a[148:151], v[212:215], a[104:107]
    v_mfma_f32_16x16x32_bf16 a[108:111], a[180:183], v[212:215], a[108:111]
    s_waitcnt vmcnt(10)
    v_mfma_f32_16x16x32_bf16 a[96:99], a[216:219], v[216:219], a[96:99]
    v_mfma_f32_16x16x32_bf16 a[100:103], a[248:251], v[216:219], a[100:103]
    v_mfma_f32_16x16x32_bf16 a[104:107], a[152:155], v[216:219], a[104:107]
    ds_write_b128 v19, a[76:79] offset:3072
    v_mfma_f32_16x16x32_bf16 a[108:111], a[184:187], v[216:219], a[108:111]
    s_waitcnt vmcnt(9)
    v_mfma_f32_16x16x32_bf16 a[96:99], a[220:223], v[220:223], a[96:99]
    v_mfma_f32_16x16x32_bf16 a[100:103], a[252:255], v[220:223], a[100:103]
    v_mfma_f32_16x16x32_bf16 a[104:107], a[156:159], v[220:223], a[104:107]
    v_mfma_f32_16x16x32_bf16 a[108:111], a[188:191], v[220:223], a[108:111]
    s_waitcnt vmcnt(8)
    v_mfma_f32_16x16x32_bf16 a[112:115], a[192:195], v[224:227], 0
    v_mfma_f32_16x16x32_bf16 a[116:119], a[224:227], v[224:227], 0
    v_mfma_f32_16x16x32_bf16 a[120:123], a[128:131], v[224:227], 0
    ds_write_b128 v19, a[80:83] offset:4096
    v_mfma_f32_16x16x32_bf16 a[124:127], a[160:163], v[224:227], 0
    s_waitcnt vmcnt(7)
    v_mfma_f32_16x16x32_bf16 a[112:115], a[196:199], v[228:231], a[112:115]
    v_mfma_f32_16x16x32_bf16 a[116:119], a[228:231], v[228:231], a[116:119]
    v_mfma_f32_16x16x32_bf16 a[120:123], a[132:135], v[228:231], a[120:123]
    v_mfma_f32_16x16x32_bf16 a[124:127], a[164:167], v[228:231], a[124:127]
    s_waitcnt vmcnt(6)
    v_mfma_f32_16x16x32_bf16 a[112:115], a[200:203], v[232:235], a[112:115]
    v_mfma_f32_16x16x32_bf16 a[116:119], a[232:235], v[232:235], a[116:119]
    v_mfma_f32_16x16x32_bf16 a[120:123], a[136:139], v[232:235], a[120:123]
    ds_write_b128 v19, a[84:87] offset:5120
    v_mfma_f32_16x16x32_bf16 a[124:127], a[168:171], v[232:235], a[124:127]
    s_waitcnt vmcnt(5)
    v_mfma_f32_16x16x32_bf16 a[112:115], a[204:207], v[236:239], a[112:115]
    v_mfma_f32_16x16x32_bf16 a[116:119], a[236:239], v[236:239], a[116:119]
    v_mfma_f32_16x16x32_bf16 a[120:123], a[140:143], v[236:239], a[120:123]
    v_mfma_f32_16x16x32_bf16 a[124:127], a[172:175], v[236:239], a[124:127]
    s_waitcnt vmcnt(4)
    v_mfma_f32_16x16x32_bf16 a[112:115], a[208:211], v[240:243], a[112:115]
    v_mfma_f32_16x16x32_bf16 a[116:119], a[240:243], v[240:243], a[116:119]
    v_mfma_f32_16x16x32_bf16 a[120:123], a[144:147], v[240:243], a[120:123]
    ds_write_b128 v19, a[88:91] offset:6144
    v_mfma_f32_16x16x32_bf16 a[124:127], a[176:179], v[240:243], a[124:127]
    s_waitcnt vmcnt(3)
    v_mfma_f32_16x16x32_bf16 a[112:115], a[212:215], v[244:247], a[112:115]
    v_mfma_f32_16x16x32_bf16 a[116:119], a[244:247], v[244:247], a[116:119]
    v_mfma_f32_16x16x32_bf16 a[120:123], a[148:151], v[244:247], a[120:123]
    v_mfma_f32_16x16x32_bf16 a[124:127], a[180:183], v[244:247], a[124:127]
    s_waitcnt vmcnt(2)
    v_mfma_f32_16x16x32_bf16 a[112:115], a[216:219], v[248:251], a[112:115]
    v_mfma_f32_16x16x32_bf16 a[116:119], a[248:251], v[248:251], a[116:119]
    v_mfma_f32_16x16x32_bf16 a[120:123], a[152:155], v[248:251], a[120:123]
    ds_write_b128 v19, a[92:95] offset:7168
    v_mfma_f32_16x16x32_bf16 a[124:127], a[184:187], v[248:251], a[124:127]
    s_waitcnt vmcnt(1)
    v_mfma_f32_16x16x32_bf16 a[112:115], a[220:223], v[252:255], a[112:115]
    v_mfma_f32_16x16x32_bf16 a[116:119], a[252:255], v[252:255], a[116:119]
    v_mfma_f32_16x16x32_bf16 a[120:123], a[156:159], v[252:255], a[120:123]
    v_mfma_f32_16x16x32_bf16 a[124:127], a[188:191], v[252:255], a[124:127]
    ds_write_b128 v20, a[96:99] offset:0
    ds_write_b128 v20, a[100:103] offset:1024
    ds_write_b128 v20, a[104:107] offset:2048
    ds_write_b128 v20, a[108:111] offset:3072
    s_nop 0
    ds_write_b128 v20, a[112:115] offset:4096
    ds_write_b128 v20, a[116:119] offset:5120
    ds_write_b128 v20, a[120:123] offset:6144
    ds_write_b128 v20, a[124:127] offset:7168
    s_waitcnt vmcnt(0)
    v_readfirstlane_b32 s52, v4
    s_cmp_ge_u32 s52, 0x1000
    s_cbranch_scc1 t7_203
    s_mov_b32 s34, 0
tp_204:
    buffer_load_dword v4, v5, s[8:11], s36 offen sc1
    s_add_u32 s34, s34, 1
    s_cmp_ge_u32 s34, 0x20000
    s_cbranch_scc1 L_exit
    s_waitcnt vmcnt(0)
    v_readfirstlane_b32 s52, v4
    s_cmp_ge_u32 s52, 0x1000
    s_cbranch_scc0 tp_204
t7_203:
    s_add_u32 s52, s24, 0
    s_and_b32 s52, s52, 3
    s_lshl_b32 s52, s52, 12
    s_add_u32 s60, s52, s65
    s_add_u32 s61, s60, 0x8000
    s_add_u32 s62, s60, 0x10000
    s_add_u32 s63, s60, 0x18000
    buffer_load_dwordx4 v[128:131], v14, s[8:11], s60 offen offset:0
    buffer_load_dwordx4 v[132:135], v14, s[8:11], s60 offen offset:1024
    buffer_load_dwordx4 v[136:139], v14, s[8:11], s61 offen offset:0
    buffer_load_dwordx4 v[140:143], v14, s[8:11], s61 offen offset:1024
    buffer_load_dwordx4 v[144:147], v14, s[8:11], s62 offen offset:0
    buffer_load_dwordx4 v[148:151], v14, s[8:11], s62 offen offset:1024
    buffer_load_dwordx4 v[152:155], v14, s[8:11], s63 offen offset:0
    buffer_load_dwordx4 v[156:159], v14, s[8:11], s63 offen offset:1024
    buffer_load_dwordx4 v[160:163], v15, s[8:11], s60 offen offset:0
    buffer_load_dwordx4 v[164:167], v15, s[8:11], s60 offen offset:1024
    buffer_load_dwordx4 v[168:171], v15, s[8:11], s61 offen offset:0
    buffer_load_dwordx4 v[172:175], v15, s[8:11], s61 offen offset:1024
    buffer_load_dwordx4 v[176:179], v15, s[8:11], s62 offen offset:0
    buffer_load_dwordx4 v[180:183], v15, s[8:11], s62 offen offset:1024
    buffer_load_dwordx4 v[184:187], v15, s[8:11], s63 offen offset:0
    buffer_load_dwordx4 v[188:191], v15, s[8:11], s63 offen offset:1024
    s_add_u32 s52, s24, 1
    s_and_b32 s52, s52, 3
    s_lshl_b32 s52, s52, 12
    s_add_u32 s60, s52, s65
    s_add_u32 s61, s60, 0x8000
    s_add_u32 s62, s60, 0x10000
    s_add_u32 s63, s60, 0x18000
    buffer_load_dwordx4 v[192:195], v14, s[8:11], s60 offen offset:0
    buffer_load_dwordx4 v[196:199], v14, s[8:11], s60 offen offset:1024
    buffer_load_dwordx4 v[200:203], v14, s[8:11], s61 offen offset:0
    buffer_load_dwordx4 v[204:207], v14, s[8:11], s61 offen offset:1024
    buffer_load_dwordx4 v[208:211], v14, s[8:11], s62 offen offset:0
    buffer_load_dwordx4 v[212:215], v14, s[8:11], s62 offen offset:1024
    buffer_load_dwordx4 v[216:219], v14, s[8:11], s63 offen offset:0
    buffer_load_dwordx4 v[220:223], v14, s[8:11], s63 offen offset:1024
    buffer_load_dwordx4 v[224:227], v15, s[8:11], s60 offen offset:0
    buffer_load_dwordx4 v[228:231], v15, s[8:11], s60 offen offset:1024
    buffer_load_dwordx4 v[232:235], v15, s[8:11], s61 offen offset:0
    buffer_load_dwordx4 v[236:239], v15, s[8:11], s61 offen offset:1024
    buffer_load_dwordx4 v[240:243], v15, s[8:11], s62 offen offset:0
    buffer_load_dwordx4 v[244:247], v15, s[8:11], s62 offen offset:1024
    buffer_load_dwordx4 v[248:251], v15, s[8:11], s63 offen offset:0
    buffer_load_dwordx4 v[252:255], v15, s[8:11], s63 offen offset:1024
    v_accvgpr_read_b32 v64, a0
    v_accvgpr_read_b32 v65, a1
    v_accvgpr_read_b32 v66, a2
    v_accvgpr_read_b32 v67, a3
    v_accvgpr_read_b32 v68, a4
    v_accvgpr_read_b32 v69, a5
    v_accvgpr_read_b32 v70, a6
    v_accvgpr_read_b32 v71, a7
    v_accvgpr_read_b32 v72, a8
    v_accvgpr_read_b32 v73, a9
    v_accvgpr_read_b32 v74, a10
    v_accvgpr_read_b32 v75, a11
    v_accvgpr_read_b32 v76, a12
    v_accvgpr_read_b32 v77, a13
    v_accvgpr_read_b32 v78, a14
    v_accvgpr_read_b32 v79, a15
    v_accvgpr_read_b32 v80, a16
    v_accvgpr_read_b32 v81, a17
    v_accvgpr_read_b32 v82, a18
    v_accvgpr_read_b32 v83, a19
    v_accvgpr_read_b32 v84, a20
    v_accvgpr_read_b32 v85, a21
    v_accvgpr_read_b32 v86, a22
    v_accvgpr_read_b32 v87, a23
    v_accvgpr_read_b32 v88, a24
    v_accvgpr_read_b32 v89, a25
    v_accvgpr_read_b32 v90, a26
    v_accvgpr_read_b32 v91, a27
    v_accvgpr_read_b32 v92, a28
    v_accvgpr_read_b32 v93, a29
    v_accvgpr_read_b32 v94, a30
    v_accvgpr_read_b32 v95, a31
    s_waitcnt lgkmcnt(0)
    s_barrier
    ds_read_b128 v[32:35], v21 offset:0
    ds_read_b128 v[36:39], v21 offset:1024
    ds_read_b128 v[40:43], v21 offset:2048
    ds_read_b128 v[44:47], v21 offset:3072
    ds_read_b128 v[48:51], v21 offset:4096
    ds_read_b128 v[52:55], v21 offset:5120
    ds_read_b128 v[56:59], v21 offset:6144
    ds_read_b128 v[60:63], v21 offset:7168
    s_waitcnt lgkmcnt(7)
    v_pk_add_f32 v[64:65], v[64:65], v[32:33]
    v_pk_add_f32 v[66:67], v[66:67], v[34:35]
    s_waitcnt lgkmcnt(6)
    v_pk_add_f32 v[68:69], v[68:69], v[36:37]
    v_pk_add_f32 v[70:71], v[70:71], v[38:39]
    s_waitcnt lgkmcnt(5)
    v_pk_add_f32 v[72:73], v[72:73], v[40:41]
    v_pk_add_f32 v[74:75], v[74:75], v[42:43]
    s_waitcnt lgkmcnt(4)
    v_pk_add_f32 v[76:77], v[76:77], v[44:45]
    v_pk_add_f32 v[78:79], v[78:79], v[46:47]
    s_waitcnt lgkmcnt(3)
    v_pk_add_f32 v[80:81], v[80:81], v[48:49]
    v_pk_add_f32 v[82:83], v[82:83], v[50:51]
    s_waitcnt lgkmcnt(2)
    v_pk_add_f32 v[84:85], v[84:85], v[52:53]
    v_pk_add_f32 v[86:87], v[86:87], v[54:55]
    s_waitcnt lgkmcnt(1)
    v_pk_add_f32 v[88:89], v[88:89], v[56:57]
    v_pk_add_f32 v[90:91], v[90:91], v[58:59]
    s_waitcnt lgkmcnt(0)
    v_pk_add_f32 v[92:93], v[92:93], v[60:61]
    v_pk_add_f32 v[94:95], v[94:95], v[62:63]
    ds_read_b128 v[32:35], v21 offset:8192
    ds_read_b128 v[36:39], v21 offset:9216
    ds_read_b128 v[40:43], v21 offset:10240
    ds_read_b128 v[44:47], v21 offset:11264
    ds_read_b128 v[48:51], v21 offset:12288
    ds_read_b128 v[52:55], v21 offset:13312
    ds_read_b128 v[56:59], v21 offset:14336
    ds_read_b128 v[60:63], v21 offset:15360
    s_waitcnt lgkmcnt(7)
    v_pk_add_f32 v[64:65], v[64:65], v[32:33]
    v_pk_add_f32 v[66:67], v[66:67], v[34:35]
    s_waitcnt lgkmcnt(6)
    v_pk_add_f32 v[68:69], v[68:69], v[36:37]
    v_pk_add_f32 v[70:71], v[70:71], v[38:39]
    s_waitcnt lgkmcnt(5)
    v_pk_add_f32 v[72:73], v[72:73], v[40:41]
    v_pk_add_f32 v[74:75], v[74:75], v[42:43]
    s_waitcnt lgkmcnt(4)
    v_pk_add_f32 v[76:77], v[76:77], v[44:45]
    v_pk_add_f32 v[78:79], v[78:79], v[46:47]
    s_waitcnt lgkmcnt(3)
    v_pk_add_f32 v[80:81], v[80:81], v[48:49]
    v_pk_add_f32 v[82:83], v[82:83], v[50:51]
    s_waitcnt lgkmcnt(2)
    v_pk_add_f32 v[84:85], v[84:85], v[52:53]
    v_pk_add_f32 v[86:87], v[86:87], v[54:55]
    s_waitcnt lgkmcnt(1)
    v_pk_add_f32 v[88:89], v[88:89], v[56:57]
    v_pk_add_f32 v[90:91], v[90:91], v[58:59]
    s_waitcnt lgkmcnt(0)
    v_pk_add_f32 v[92:93], v[92:93], v[60:61]
    v_pk_add_f32 v[94:95], v[94:95], v[62:63]
    ds_read_b128 v[32:35], v21 offset:16384
    ds_read_b128 v[36:39], v21 offset:17408
    ds_read_b128 v[40:43], v21 offset:18432
    ds_read_b128 v[44:47], v21 offset:19456
    ds_read_b128 v[48:51], v21 offset:20480
    ds_read_b128 v[52:55], v21 offset:21504
    ds_read_b128 v[56:59], v21 offset:22528
    ds_read_b128 v[60:63], v21 offset:23552
    s_waitcnt lgkmcnt(7)
    v_pk_add_f32 v[64:65], v[64:65], v[32:33]
    v_pk_add_f32 v[66:67], v[66:67], v[34:35]
    s_waitcnt lgkmcnt(6)
    v_pk_add_f32 v[68:69], v[68:69], v[36:37]
    v_pk_add_f32 v[70:71], v[70:71], v[38:39]
    s_waitcnt lgkmcnt(5)
    v_pk_add_f32 v[72:73], v[72:73], v[40:41]
    v_pk_add_f32 v[74:75], v[74:75], v[42:43]
    s_waitcnt lgkmcnt(4)
    v_pk_add_f32 v[76:77], v[76:77], v[44:45]
    v_pk_add_f32 v[78:79], v[78:79], v[46:47]
    s_waitcnt lgkmcnt(3)
    v_pk_add_f32 v[80:81], v[80:81], v[48:49]
    v_pk_add_f32 v[82:83], v[82:83], v[50:51]
    s_waitcnt lgkmcnt(2)
    v_pk_add_f32 v[84:85], v[84:85], v[52:53]
    v_pk_add_f32 v[86:87], v[86:87], v[54:55]
    s_waitcnt lgkmcnt(1)
    v_pk_add_f32 v[88:89], v[88:89], v[56:57]
    v_pk_add_f32 v[90:91], v[90:91], v[58:59]
    s_waitcnt lgkmcnt(0)
    v_pk_add_f32 v[92:93], v[92:93], v[60:61]
    v_pk_add_f32 v[94:95], v[94:95], v[62:63]
    s_bitcmp1_b32 s20, 0
    s_cbranch_scc1 ro_205
    s_xor_b32 s53, s20, 1
    s_lshl_b32 s52, s21, 2
    s_add_u32 s52, s52, s53
    s_lshl_b32 s52, s52, 3
    s_add_u32 s52, s52, s24
    s_lshl_b32 s52, s52, 12
    s_add_u32 s52, s52, 0xb000000
    v_cvt_pk_bf16_f32 v36, v72, v73
    v_cvt_pk_bf16_f32 v37, v74, v75
    v_cvt_pk_bf16_f32 v38, v76, v77
    v_cvt_pk_bf16_f32 v39, v78, v79
    buffer_store_dwordx4 v[36:39], v3, s[8:11], s52 offen offset:1024 sc1
    s_xor_b32 s53, s20, 2
    s_lshl_b32 s52, s21, 2
    s_add_u32 s52, s52, s53
    s_lshl_b32 s52, s52, 3
    s_add_u32 s52, s52, s24
    s_lshl_b32 s52, s52, 12
    s_add_u32 s52, s52, 0xb000000
    v_cvt_pk_bf16_f32 v40, v80, v81
    v_cvt_pk_bf16_f32 v41, v82, v83
    v_cvt_pk_bf16_f32 v42, v84, v85
    v_cvt_pk_bf16_f32 v43, v86, v87
    buffer_store_dwordx4 v[40:43], v3, s[8:11], s52 offen offset:2048 sc1
    s_xor_b32 s53, s20, 3
    s_lshl_b32 s52, s21, 2
    s_add_u32 s52, s52, s53
    s_lshl_b32 s52, s52, 3
    s_add_u32 s52, s52, s24
    s_lshl_b32 s52, s52, 12
    s_add_u32 s52, s52, 0xb000000
    v_cvt_pk_bf16_f32 v44, v88, v89
    v_cvt_pk_bf16_f32 v45, v90, v91
    v_cvt_pk_bf16_f32 v46, v92, v93
    v_cvt_pk_bf16_f32 v47, v94, v95
    buffer_store_dwordx4 v[44:47], v3, s[8:11], s52 offen offset:3072 sc1
    s_branch re_206
    .p2align 5
ro_205:
    s_xor_b32 s53, s20, 1
    s_lshl_b32 s52, s21, 2
    s_add_u32 s52, s52, s53
    s_lshl_b32 s52, s52, 3
    s_add_u32 s52, s52, s24
    s_lshl_b32 s52, s52, 12
    s_add_u32 s52, s52, 0xb000000
    v_cvt_pk_bf16_f32 v36, v64, v65
    v_cvt_pk_bf16_f32 v37, v66, v67
    v_cvt_pk_bf16_f32 v38, v68, v69
    v_cvt_pk_bf16_f32 v39, v70, v71
    buffer_store_dwordx4 v[36:39], v3, s[8:11], s52 offen offset:1024 sc1
    s_xor_b32 s53, s20, 2
    s_lshl_b32 s52, s21, 2
    s_add_u32 s52, s52, s53
    s_lshl_b32 s52, s52, 3
    s_add_u32 s52, s52, s24
    s_lshl_b32 s52, s52, 12
    s_add_u32 s52, s52, 0xb000000
    v_cvt_pk_bf16_f32 v40, v88, v89
    v_cvt_pk_bf16_f32 v41, v90, v91
    v_cvt_pk_bf16_f32 v42, v92, v93
    v_cvt_pk_bf16_f32 v43, v94, v95
    buffer_store_dwordx4 v[40:43], v3, s[8:11], s52 offen offset:2048 sc1
    s_xor_b32 s53, s20, 3
    s_lshl_b32 s52, s21, 2
    s_add_u32 s52, s52, s53
    s_lshl_b32 s52, s52, 3
    s_add_u32 s52, s52, s24
    s_lshl_b32 s52, s52, 12
    s_add_u32 s52, s52, 0xb000000
    v_cvt_pk_bf16_f32 v44, v80, v81
    v_cvt_pk_bf16_f32 v45, v82, v83
    v_cvt_pk_bf16_f32 v46, v84, v85
    v_cvt_pk_bf16_f32 v47, v86, v87
    buffer_store_dwordx4 v[44:47], v3, s[8:11], s52 offen offset:3072 sc1
    v_mov_b32 v64, v72
    v_mov_b32 v65, v73
    v_mov_b32 v66, v74
    v_mov_b32 v67, v75
    v_mov_b32 v68, v76
    v_mov_b32 v69, v77
    v_mov_b32 v70, v78
    v_mov_b32 v71, v79
re_206:
    s_min_u32 s52, s44, s45
    s_cmp_ge_u32 s52, 0x400
    s_cbranch_scc1 tb_207
    s_mov_b32 s34, 0
tp_208:
    buffer_load_dword v4, v13, s[16:19], 0 offen offset:0 sc1
    s_add_u32 s34, s34, 1
    s_cmp_ge_u32 s34, 0x20000
    s_cbranch_scc1 L_exit
    s_waitcnt vmcnt(0)
    v_readfirstlane_b32 s52, v4
    s_cmp_ge_u32 s52, 0x400
    s_cbranch_scc0 tp_208
    s_mov_b32 s34, 0
tp_209:
    buffer_load_dword v4, v13, s[16:19], 0 offen offset:4 sc1
    s_add_u32 s34, s34, 1
    s_cmp_ge_u32 s34, 0x20000
    s_cbranch_scc1 L_exit
    s_waitcnt vmcnt(0)
    v_readfirstlane_b32 s52, v4
    s_cmp_ge_u32 s52, 0x400
    s_cbranch_scc0 tp_209
tb_207:
    s_and_b32 s52, s21, 1
    s_lshl_b32 s52, s52, 2
    s_add_u32 s52, s52, s24
    s_lshl_b32 s52, s52, 1
    s_lshr_b32 s53, s20, 1
    s_add_u32 s52, s52, s53
    s_lshl_b32 s52, s52, 15
    s_and_b32 s54, s20, 1
    s_xor_b32 s54, s54, s21
    s_lshl_b32 s53, s54, 10
    s_add_u32 s46, s52, s53
    s_add_u32 s46, s46, 0x6300000
    s_lshl_b32 s53, s54, 6
    s_add_u32 s47, s52, s53
    s_add_u32 s47, s47, 0x300000
    s_lshl_b32 s48, s21, 2
    s_add_u32 s48, s48, s20
    s_lshl_b32 s48, s48, 3
    s_add_u32 s48, s48, s24
    s_lshl_b32 s48, s48, 12
    s_add_u32 s48, s48, 0xb000000
    s_add_u32 s49, s48, 0x4000
    s_add_u32 s50, s46, 0x80000
    s_barrier
    s_waitcnt vmcnt(34)
    v_mfma_f32_16x16x32_bf16 a[0:3], a[192:195], v[128:131], 0
    v_mfma_f32_16x16x32_bf16 a[4:7], a[224:227], v[128:131], 0
    v_mfma_f32_16x16x32_bf16 a[8:11], a[128:131], v[128:131], 0
    v_mfma_f32_16x16x32_bf16 a[12:15], a[160:163], v[128:131], 0
    s_waitcnt vmcnt(33)
    v_mfma_f32_16x16x32_bf16 a[0:3], a[196:199], v[132:135], a[0:3]
    s_add_u32 s52, s24, 2
    s_and_b32 s52, s52, 3
    s_lshl_b32 s52, s52, 12
    s_add_u32 s60, s52, s65
    s_add_u32 s61, s60, 0x8000
    s_add_u32 s62, s60, 0x10000
    s_add_u32 s63, s60, 0x18000
    buffer_load_dwordx4 v[128:131], v14, s[8:11], s60 offen offset:0
    v_mfma_f32_16x16x32_bf16 a[4:7], a[228:231], v[132:135], a[4:7]
    v_mfma_f32_16x16x32_bf16 a[8:11], a[132:135], v[132:135], a[8:11]
    v_mfma_f32_16x16x32_bf16 a[12:15], a[164:167], v[132:135], a[12:15]
    s_waitcnt vmcnt(33)
    v_mfma_f32_16x16x32_bf16 a[0:3], a[200:203], v[136:139], a[0:3]
    buffer_load_dwordx4 v[132:135], v14, s[8:11], s60 offen offset:1024
    v_mfma_f32_16x16x32_bf16 a[4:7], a[232:235], v[136:139], a[4:7]
    v_mfma_f32_16x16x32_bf16 a[8:11], a[136:139], v[136:139], a[8:11]
    v_mfma_f32_16x16x32_bf16 a[12:15], a[168:171], v[136:139], a[12:15]
    s_waitcnt vmcnt(33)
    v_mfma_f32_16x16x32_bf16 a[0:3], a[204:207], v[140:143], a[0:3]
    buffer_load_dwordx4 v[136:139], v14, s[8:11], s61 offen offset:0
    v_mfma_f32_16x16x32_bf16 a[4:7], a[236:239], v[140:143], a[4:7]
    v_mfma_f32_16x16x32_bf16 a[8:11], a[140:143], v[140:143], a[8:11]
    v_mfma_f32_16x16x32_bf16 a[12:15], a[172:175], v[140:143], a[12:15]
    s_waitcnt vmcnt(33)
    v_mfma_f32_16x16x32_bf16 a[0:3], a[208:211], v[144:147], a[0:3]
    buffer_load_dwordx4 v[140:143], v14, s[8:11], s61 offen offset:1024
    v_mfma_f32_16x16x32_bf16 a[4:7], a[240:243], v[144:147], a[4:7]
    v_mfma_f32_16x16x32_bf16 a[8:11], a[144:147], v[144:147], a[8:11]
    v_mfma_f32_16x16x32_bf16 a[12:15], a[176:179], v[144:147], a[12:15]
    s_waitcnt vmcnt(33)
    v_mfma_f32_16x16x32_bf16 a[0:3], a[212:215], v[148:151], a[0:3]
    buffer_load_dwordx4 v[144:147], v14, s[8:11], s62 offen offset:0
    v_mfma_f32_16x16x32_bf16 a[4:7], a[244:247], v[148:151], a[4:7]
    v_mfma_f32_16x16x32_bf16 a[8:11], a[148:151], v[148:151], a[8:11]
    v_mfma_f32_16x16x32_bf16 a[12:15], a[180:183], v[148:151], a[12:15]
    s_waitcnt vmcnt(33)
    v_mfma_f32_16x16x32_bf16 a[0:3], a[216:219], v[152:155], a[0:3]
    buffer_load_dwordx4 v[148:151], v14, s[8:11], s62 offen offset:1024
    v_mfma_f32_16x16x32_bf16 a[4:7], a[248:251], v[152:155], a[4:7]
    v_mfma_f32_16x16x32_bf16 a[8:11], a[152:155], v[152:155], a[8:11]
    v_mfma_f32_16x16x32_bf16 a[12:15], a[184:187], v[152:155], a[12:15]
    s_waitcnt vmcnt(33)
    v_mfma_f32_16x16x32_bf16 a[0:3], a[220:223], v[156:159], a[0:3]
    buffer_load_dwordx4 v[152:155], v14, s[8:11], s63 offen offset:0
    v_mfma_f32_16x16x32_bf16 a[4:7], a[252:255], v[156:159], a[4:7]
    v_mfma_f32_16x16x32_bf16 a[8:11], a[156:159], v[156:159], a[8:11]
    v_mfma_f32_16x16x32_bf16 a[12:15], a[188:191], v[156:159], a[12:15]
    s_waitcnt vmcnt(33)
    v_mfma_f32_16x16x32_bf16 a[16:19], a[192:195], v[160:163], 0
    buffer_load_dwordx4 v[156:159], v14, s[8:11], s63 offen offset:1024
    v_mfma_f32_16x16x32_bf16 a[20:23], a[224:227], v[160:163], 0
    v_mfma_f32_16x16x32_bf16 a[24:27], a[128:131], v[160:163], 0
    v_mfma_f32_16x16x32_bf16 a[28:31], a[160:163], v[160:163], 0
    s_waitcnt vmcnt(33)
    v_mfma_f32_16x16x32_bf16 a[16:19], a[196:199], v[164:167], a[16:19]
    buffer_load_dwordx4 v[160:163], v15, s[8:11], s60 offen offset:0
    v_mfma_f32_16x16x32_bf16 a[20:23], a[228:231], v[164:167], a[20:23]
    v_mfma_f32_16x16x32_bf16 a[24:27], a[132:135], v[164:167], a[24:27]
    v_mfma_f32_16x16x32_bf16 a[28:31], a[164:167], v[164:167], a[28:31]
    s_waitcnt vmcnt(33)
    v_mfma_f32_16x16x32_bf16 a[16:19], a[200:203], v[168:171], a[16:19]
    buffer_load_dwordx4 v[164:167], v15, s[8:11], s60 offen offset:1024
    v_mfma_f32_16x16x32_bf16 a[20:23], a[232:235], v[168:171], a[20:23]
    v_mfma_f32_16x16x32_bf16 a[24:27], a[136:139], v[168:171], a[24:27]
    v_mfma_f32_16x16x32_bf16 a[28:31], a[168:171], v[168:171], a[28:31]
    s_waitcnt vmcnt(33)
    v_mfma_f32_16x16x32_bf16 a[16:19], a[204:207], v[172:175], a[16:19]
    buffer_load_dwordx4 v[168:171], v15, s[8:11], s61 offen offset:0
    v_mfma_f32_16x16x32_bf16 a[20:23], a[236:239], v[172:175], a[20:23]
    v_mfma_f32_16x16x32_bf16 a[24:27], a[140:143], v[172:175], a[24:27]
    v_mfma_f32_16x16x32_bf16 a[28:31], a[172:175], v[172:175], a[28:31]
    s_waitcnt vmcnt(33)
    v_mfma_f32_16x16x32_bf16 a[16:19], a[208:211], v[176:179], a[16:19]
    buffer_load_dwordx4 v[172:175], v15, s[8:11], s61 offen offset:1024
    v_mfma_f32_16x16x32_bf16 a[20:23], a[240:243], v[176:179], a[20:23]
    v_mfma_f32_16x16x32_bf16 a[24:27], a[144:147], v[176:179], a[24:27]
    v_mfma_f32_16x16x32_bf16 a[28:31], a[176:179], v[176:179], a[28:31]
    s_waitcnt vmcnt(33)
    v_mfma_f32_16x16x32_bf16 a[16:19], a[212:215], v[180:183], a[16:19]
    buffer_load_dwordx4 v[176:179], v15, s[8:11], s62 offen offset:0
    v_mfma_f32_16x16x32_bf16 a[20:23], a[244:247], v[180:183], a[20:23]
    v_mfma_f32_16x16x32_bf16 a[24:27], a[148:151], v[180:183], a[24:27]
    v_mfma_f32_16x16x32_bf16 a[28:31], a[180:183], v[180:183], a[28:31]
    s_waitcnt vmcnt(33)
    v_mfma_f32_16x16x32_bf16 a[16:19], a[216:219], v[184:187], a[16:19]
    buffer_load_dwordx4 v[180:183], v15, s[8:11], s62 offen offset:1024
    v_mfma_f32_16x16x32_bf16 a[20:23], a[248:251], v[184:187], a[20:23]
    v_mfma_f32_16x16x32_bf16 a[24:27], a[152:155], v[184:187], a[24:27]
    v_mfma_f32_16x16x32_bf16 a[28:31], a[184:187], v[184:187], a[28:31]
    s_waitcnt vmcnt(33)
    v_mfma_f32_16x16x32_bf16 a[16:19], a[220:223], v[188:191], a[16:19]
    buffer_load_dwordx4 v[184:187], v15, s[8:11], s63 offen offset:0
    v_mfma_f32_16x16x32_bf16 a[20:23], a[252:255], v[188:191], a[20:23]
    v_mfma_f32_16x16x32_bf16 a[24:27], a[156:159], v[188:191], a[24:27]
    v_mfma_f32_16x16x32_bf16 a[28:31], a[188:191], v[188:191], a[28:31]
    s_waitcnt vmcnt(33)
    v_mfma_f32_16x16x32_bf16 a[32:35], a[192:195], v[192:195], 0
    buffer_load_dwordx4 v[188:191], v15, s[8:11], s63 offen offset:1024
    v_mfma_f32_16x16x32_bf16 a[36:39], a[224:227], v[192:195], 0
    v_mfma_f32_16x16x32_bf16 a[40:43], a[128:131], v[192:195], 0
    v_mfma_f32_16x16x32_bf16 a[44:47], a[160:163], v[192:195], 0
    s_waitcnt vmcnt(33)
    v_mfma_f32_16x16x32_bf16 a[32:35], a[196:199], v[196:199], a[32:35]
    s_add_u32 s52, s24, 3
    s_and_b32 s52, s52, 3
    s_lshl_b32 s52, s52, 12
    s_add_u32 s60, s52, s65
    s_add_u32 s61, s60, 0x8000
    s_add_u32 s62, s60, 0x10000
    s_add_u32 s63, s60, 0x18000
    buffer_load_dwordx4 v[192:195], v14, s[8:11], s60 offen offset:0
    v_mfma_f32_16x16x32_bf16 a[36:39], a[228:231], v[196:199], a[36:39]
    v_mfma_f32_16x16x32_bf16 a[40:43], a[132:135], v[196:199], a[40:43]
    v_mfma_f32_16x16x32_bf16 a[44:47], a[164:167], v[196:199], a[44:47]
    s_waitcnt vmcnt(33)
    v_mfma_f32_16x16x32_bf16 a[32:35], a[200:203], v[200:203], a[32:35]
    buffer_load_dwordx4 v[196:199], v14, s[8:11], s60 offen offset:1024
    v_mfma_f32_16x16x32_bf16 a[36:39], a[232:235], v[200:203], a[36:39]
    v_mfma_f32_16x16x32_bf16 a[40:43], a[136:139], v[200:203], a[40:43]
    v_mfma_f32_16x16x32_bf16 a[44:47], a[168:171], v[200:203], a[44:47]
    s_waitcnt vmcnt(33)
    v_mfma_f32_16x16x32_bf16 a[32:35], a[204:207], v[204:207], a[32:35]
    buffer_load_dwordx4 v[200:203], v14, s[8:11], s61 offen offset:0
    v_mfma_f32_16x16x32_bf16 a[36:39], a[236:239], v[204:207], a[36:39]
    v_mfma_f32_16x16x32_bf16 a[40:43], a[140:143], v[204:207], a[40:43]
    v_mfma_f32_16x16x32_bf16 a[44:47], a[172:175], v[204:207], a[44:47]
    s_waitcnt vmcnt(33)
    v_mfma_f32_16x16x32_bf16 a[32:35], a[208:211], v[208:211], a[32:35]
    buffer_load_dwordx4 v[204:207], v14, s[8:11], s61 offen offset:1024
    v_mfma_f32_16x16x32_bf16 a[36:39], a[240:243], v[208:211], a[36:39]
    v_mfma_f32_16x16x32_bf16 a[40:43], a[144:147], v[208:211], a[40:43]
    v_mfma_f32_16x16x32_bf16 a[44:47], a[176:179], v[208:211], a[44:47]
    s_waitcnt vmcnt(33)
    v_mfma_f32_16x16x32_bf16 a[32:35], a[212:215], v[212:215], a[32:35]
    buffer_load_dwordx4 v[208:211], v14, s[8:11], s62 offen offset:0
    v_mfma_f32_16x16x32_bf16 a[36:39], a[244:247], v[212:215], a[36:39]
    v_mfma_f32_16x16x32_bf16 a[40:43], a[148:151], v[212:215], a[40:43]
    v_mfma_f32_16x16x32_bf16 a[44:47], a[180:183], v[212:215], a[44:47]
    s_waitcnt vmcnt(33)
    v_mfma_f32_16x16x32_bf16 a[32:35], a[216:219], v[216:219], a[32:35]
    buffer_load_dwordx4 v[212:215], v14, s[8:11], s62 offen offset:1024
    v_mfma_f32_16x16x32_bf16 a[36:39], a[248:251], v[216:219], a[36:39]
    v_mfma_f32_16x16x32_bf16 a[40:43], a[152:155], v[216:219], a[40:43]
    v_mfma_f32_16x16x32_bf16 a[44:47], a[184:187], v[216:219], a[44:47]
    s_waitcnt vmcnt(33)
    v_mfma_f32_16x16x32_bf16 a[32:35], a[220:223], v[220:223], a[32:35]
    buffer_load_dwordx4 v[216:219], v14, s[8:11], s63 offen offset:0
    v_mfma_f32_16x16x32_bf16 a[36:39], a[252:255], v[220:223], a[36:39]
    v_mfma_f32_16x16x32_bf16 a[40:43], a[156:159], v[220:223], a[40:43]
    v_mfma_f32_16x16x32_bf16 a[44:47], a[188:191], v[220:223], a[44:47]
    s_waitcnt vmcnt(33)
    v_mfma_f32_16x16x32_bf16 a[48:51], a[192:195], v[224:227], 0
    buffer_load_dwordx4 v[220:223], v14, s[8:11], s63 offen offset:1024
    v_mfma_f32_16x16x32_bf16 a[52:55], a[224:227], v[224:227], 0
    v_mfma_f32_16x16x32_bf16 a[56:59], a[128:131], v[224:227], 0
    v_mfma_f32_16x16x32_bf16 a[60:63], a[160:163], v[224:227], 0
    s_waitcnt vmcnt(33)
    v_mfma_f32_16x16x32_bf16 a[48:51], a[196:199], v[228:231], a[48:51]
    buffer_load_dwordx4 v[224:227], v15, s[8:11], s60 offen offset:0
    v_mfma_f32_16x16x32_bf16 a[52:55], a[228:231], v[228:231], a[52:55]
    v_mfma_f32_16x16x32_bf16 a[56:59], a[132:135], v[228:231], a[56:59]
    v_mfma_f32_16x16x32_bf16 a[60:63], a[164:167], v[228:231], a[60:63]
    s_waitcnt vmcnt(33)
    v_mfma_f32_16x16x32_bf16 a[48:51], a[200:203], v[232:235], a[48:51]
    buffer_load_dwordx4 v[228:231], v15, s[8:11], s60 offen offset:1024
    v_mfma_f32_16x16x32_bf16 a[52:55], a[232:235], v[232:235], a[52:55]
    v_mfma_f32_16x16x32_bf16 a[56:59], a[136:139], v[232:235], a[56:59]
    v_mfma_f32_16x16x32_bf16 a[60:63], a[168:171], v[232:235], a[60:63]
    s_waitcnt vmcnt(33)
    v_mfma_f32_16x16x32_bf16 a[48:51], a[204:207], v[236:239], a[48:51]
    buffer_load_dwordx4 v[232:235], v15, s[8:11], s61 offen offset:0
    v_mfma_f32_16x16x32_bf16 a[52:55], a[236:239], v[236:239], a[52:55]
    v_mfma_f32_16x16x32_bf16 a[56:59], a[140:143], v[236:239], a[56:59]
    v_mfma_f32_16x16x32_bf16 a[60:63], a[172:175], v[236:239], a[60:63]
    s_waitcnt vmcnt(33)
    v_mfma_f32_16x16x32_bf16 a[48:51], a[208:211], v[240:243], a[48:51]
    buffer_load_dwordx4 v[236:239], v15, s[8:11], s61 offen offset:1024
    v_mfma_f32_16x16x32_bf16 a[52:55], a[240:243], v[240:243], a[52:55]
    v_mfma_f32_16x16x32_bf16 a[56:59], a[144:147], v[240:243], a[56:59]
    v_mfma_f32_16x16x32_bf16 a[60:63], a[176:179], v[240:243], a[60:63]
    s_waitcnt vmcnt(33)
    v_mfma_f32_16x16x32_bf16 a[48:51], a[212:215], v[244:247], a[48:51]
    buffer_load_dwordx4 v[240:243], v15, s[8:11], s62 offen offset:0
    v_mfma_f32_16x16x32_bf16 a[52:55], a[244:247], v[244:247], a[52:55]
    v_mfma_f32_16x16x32_bf16 a[56:59], a[148:151], v[244:247], a[56:59]
    v_mfma_f32_16x16x32_bf16 a[60:63], a[180:183], v[244:247], a[60:63]
    s_waitcnt vmcnt(33)
    v_mfma_f32_16x16x32_bf16 a[48:51], a[216:219], v[248:251], a[48:51]
    buffer_load_dwordx4 v[244:247], v15, s[8:11], s62 offen offset:1024
    v_mfma_f32_16x16x32_bf16 a[52:55], a[248:251], v[248:251], a[52:55]
    v_mfma_f32_16x16x32_bf16 a[56:59], a[152:155], v[248:251], a[56:59]
    v_mfma_f32_16x16x32_bf16 a[60:63], a[184:187], v[248:251], a[60:63]
    s_waitcnt vmcnt(33)
    v_mfma_f32_16x16x32_bf16 a[48:51], a[220:223], v[252:255], a[48:51]
    buffer_load_dwordx4 v[248:251], v15, s[8:11], s63 offen offset:0
    v_mfma_f32_16x16x32_bf16 a[52:55], a[252:255], v[252:255], a[52:55]
    v_mfma_f32_16x16x32_bf16 a[56:59], a[156:159], v[252:255], a[56:59]
    v_mfma_f32_16x16x32_bf16 a[60:63], a[188:191], v[252:255], a[60:63]
    s_waitcnt vmcnt(30)
    v_mfma_f32_16x16x32_bf16 a[64:67], a[192:195], v[128:131], 0
    buffer_load_dwordx4 v[252:255], v15, s[8:11], s63 offen offset:1024
    v_mfma_f32_16x16x32_bf16 a[68:71], a[224:227], v[128:131], 0
    v_mfma_f32_16x16x32_bf16 a[72:75], a[128:131], v[128:131], 0
    ds_write_b128 v18, a[32:35] offset:0
    v_mfma_f32_16x16x32_bf16 a[76:79], a[160:163], v[128:131], 0
    s_waitcnt vmcnt(30)
    v_mfma_f32_16x16x32_bf16 a[64:67], a[196:199], v[132:135], a[64:67]
    v_mfma_f32_16x16x32_bf16 a[68:71], a[228:231], v[132:135], a[68:71]
    v_mfma_f32_16x16x32_bf16 a[72:75], a[132:135], v[132:135], a[72:75]
    v_mfma_f32_16x16x32_bf16 a[76:79], a[164:167], v[132:135], a[76:79]
    s_waitcnt vmcnt(29)
    v_mfma_f32_16x16x32_bf16 a[64:67], a[200:203], v[136:139], a[64:67]
    v_mfma_f32_16x16x32_bf16 a[68:71], a[232:235], v[136:139], a[68:71]
    v_mfma_f32_16x16x32_bf16 a[72:75], a[136:139], v[136:139], a[72:75]
    ds_write_b128 v18, a[36:39] offset:1024
    v_mfma_f32_16x16x32_bf16 a[76:79], a[168:171], v[136:139], a[76:79]
    s_waitcnt vmcnt(28)
    v_mfma_f32_16x16x32_bf16 a[64:67], a[204:207], v[140:143], a[64:67]
    v_mfma_f32_16x16x32_bf16 a[68:71], a[236:239], v[140:143], a[68:71]
    v_mfma_f32_16x16x32_bf16 a[72:75], a[140:143], v[140:143], a[72:75]
    v_mfma_f32_16x16x32_bf16 a[76:79], a[172:175], v[140:143], a[76:79]
    s_waitcnt vmcnt(27)
    v_mfma_f32_16x16x32_bf16 a[64:67], a[208:211], v[144:147], a[64:67]
    v_mfma_f32_16x16x32_bf16 a[68:71], a[240:243], v[144:147], a[68:71]
    v_mfma_f32_16x16x32_bf16 a[72:75], a[144:147], v[144:147], a[72:75]
    ds_write_b128 v18, a[40:43] offset:2048
    v_mfma_f32_16x16x32_bf16 a[76:79], a[176:179], v[144:147], a[76:79]
    s_waitcnt vmcnt(26)
    v_mfma_f32_16x16x32_bf16 a[64:67], a[212:215], v[148:151], a[64:67]
    v_mfma_f32_16x16x32_bf16 a[68:71], a[244:247], v[148:151], a[68:71]
    v_mfma_f32_16x16x32_bf16 a[72:75], a[148:151], v[148:151], a[72:75]
    v_mfma_f32_16x16x32_bf16 a[76:79], a[180:183], v[148:151], a[76:79]
    s_waitcnt vmcnt(25)
    v_mfma_f32_16x16x32_bf16 a[64:67], a[216:219], v[152:155], a[64:67]
    v_mfma_f32_16x16x32_bf16 a[68:71], a[248:251], v[152:155], a[68:71]
    v_mfma_f32_16x16x32_bf16 a[72:75], a[152:155], v[152:155], a[72:75]
    ds_write_b128 v18, a[44:47] offset:3072
    v_mfma_f32_16x16x32_bf16 a[76:79], a[184:187], v[152:155], a[76:79]
    s_waitcnt vmcnt(24)
    v_mfma_f32_16x16x32_bf16 a[64:67], a[220:223], v[156:159], a[64:67]
    v_mfma_f32_16x16x32_bf16 a[68:71], a[252:255], v[156:159], a[68:71]
    v_mfma_f32_16x16x32_bf16 a[72:75], a[156:159], v[156:159], a[72:75]
    v_mfma_f32_16x16x32_bf16 a[76:79], a[188:191], v[156:159], a[76:79]
    s_waitcnt vmcnt(23)
    v_mfma_f32_16x16x32_bf16 a[80:83], a[192:195], v[160:163], 0
    v_mfma_f32_16x16x32_bf16 a[84:87], a[224:227], v[160:163], 0
    v_mfma_f32_16x16x32_bf16 a[88:91], a[128:131], v[160:163], 0
    ds_write_b128 v18, a[48:51] offset:4096
    v_mfma_f32_16x16x32_bf16 a[92:95], a[160:163], v[160:163], 0
    buffer_load_dwordx4 v[84:87], v3, s[8:11], s46 offen sc1
    buffer_load_dwordx4 v[72:75], v3, s[8:11], s48 offen offset:1024 sc1
    buffer_load_dwordx4 v[76:79], v3, s[8:11], s48 offen offset:2048 sc1
    buffer_load_dwordx4 v[80:83], v3, s[8:11], s48 offen offset:3072 sc1
    buffer_load_dword v9, off, s[16:19], 0 offset:108 sc1
    buffer_load_dwordx4 v[28:31], v3, s[8:11], s50 offen sc1
    s_waitcnt vmcnt(28)
    v_mfma_f32_16x16x32_bf16 a[80:83], a[196:199], v[164:167], a[80:83]
    v_mfma_f32_16x16x32_bf16 a[84:87], a[228:231], v[164:167], a[84:87]
    v_mfma_f32_16x16x32_bf16 a[88:91], a[132:135], v[164:167], a[88:91]
    v_mfma_f32_16x16x32_bf16 a[92:95], a[164:167], v[164:167], a[92:95]
    s_waitcnt vmcnt(27)
    v_mfma_f32_16x16x32_bf16 a[80:83], a[200:203], v[168:171], a[80:83]
    v_mfma_f32_16x16x32_bf16 a[84:87], a[232:235], v[168:171], a[84:87]
    v_mfma_f32_16x16x32_bf16 a[88:91], a[136:139], v[168:171], a[88:91]
    ds_write_b128 v18, a[52:55] offset:5120
    v_mfma_f32_16x16x32_bf16 a[92:95], a[168:171], v[168:171], a[92:95]
    s_waitcnt vmcnt(26)
    v_mfma_f32_16x16x32_bf16 a[80:83], a[204:207], v[172:175], a[80:83]
    v_mfma_f32_16x16x32_bf16 a[84:87], a[236:239], v[172:175], a[84:87]
    v_mfma_f32_16x16x32_bf16 a[88:91], a[140:143], v[172:175], a[88:91]
    v_mfma_f32_16x16x32_bf16 a[92:95], a[172:175], v[172:175], a[92:95]
    s_waitcnt vmcnt(25)
    v_mfma_f32_16x16x32_bf16 a[80:83], a[208:211], v[176:179], a[80:83]
    v_mfma_f32_16x16x32_bf16 a[84:87], a[240:243], v[176:179], a[84:87]
    v_mfma_f32_16x16x32_bf16 a[88:91], a[144:147], v[176:179], a[88:91]
    ds_write_b128 v18, a[56:59] offset:6144
    v_mfma_f32_16x16x32_bf16 a[92:95], a[176:179], v[176:179], a[92:95]
    s_waitcnt vmcnt(24)
    v_mfma_f32_16x16x32_bf16 a[80:83], a[212:215], v[180:183], a[80:83]
    v_mfma_f32_16x16x32_bf16 a[84:87], a[244:247], v[180:183], a[84:87]
    v_mfma_f32_16x16x32_bf16 a[88:91], a[148:151], v[180:183], a[88:91]
    v_mfma_f32_16x16x32_bf16 a[92:95], a[180:183], v[180:183], a[92:95]
    s_waitcnt vmcnt(23)
    v_mfma_f32_16x16x32_bf16 a[80:83], a[216:219], v[184:187], a[80:83]
    v_mfma_f32_16x16x32_bf16 a[84:87], a[248:251], v[184:187], a[84:87]
    v_mfma_f32_16x16x32_bf16 a[88:91], a[152:155], v[184:187], a[88:91]
    ds_write_b128 v18, a[60:63] offset:7168
    v_mfma_f32_16x16x32_bf16 a[92:95], a[184:187], v[184:187], a[92:95]
    s_waitcnt vmcnt(22)
    v_mfma_f32_16x16x32_bf16 a[80:83], a[220:223], v[188:191], a[80:83]
    v_mfma_f32_16x16x32_bf16 a[84:87], a[252:255], v[188:191], a[84:87]
    v_mfma_f32_16x16x32_bf16 a[88:91], a[156:159], v[188:191], a[88:91]
    v_mfma_f32_16x16x32_bf16 a[92:95], a[188:191], v[188:191], a[92:95]
    s_waitcnt vmcnt(21)
    v_mfma_f32_16x16x32_bf16 a[96:99], a[192:195], v[192:195], 0
    v_mfma_f32_16x16x32_bf16 a[100:103], a[224:227], v[192:195], 0
    v_mfma_f32_16x16x32_bf16 a[104:107], a[128:131], v[192:195], 0
    ds_write_b128 v19, a[64:67] offset:0
    v_mfma_f32_16x16x32_bf16 a[108:111], a[160:163], v[192:195], 0
    s_waitcnt vmcnt(20)
    v_mfma_f32_16x16x32_bf16 a[96:99], a[196:199], v[196:199], a[96:99]
    v_mfma_f32_16x16x32_bf16 a[100:103], a[228:231], v[196:199], a[100:103]
    v_mfma_f32_16x16x32_bf16 a[104:107], a[132:135], v[196:199], a[104:107]
    v_mfma_f32_16x16x32_bf16 a[108:111], a[164:167], v[196:199], a[108:111]
    s_waitcnt vmcnt(19)
    v_mfma_f32_16x16x32_bf16 a[96:99], a[200:203], v[200:203], a[96:99]
    v_mfma_f32_16x16x32_bf16 a[100:103], a[232:235], v[200:203], a[100:103]
    v_mfma_f32_16x16x32_bf16 a[104:107], a[136:139], v[200:203], a[104:107]
    ds_write_b128 v19, a[68:71] offset:1024
    v_mfma_f32_16x16x32_bf16 a[108:111], a[168:171], v[200:203], a[108:111]
    s_waitcnt vmcnt(18)
    v_mfma_f32_16x16x32_bf16 a[96:99], a[204:207], v[204:207], a[96:99]
    v_mfma_f32_16x16x32_bf16 a[100:103], a[236:239], v[204:207], a[100:103]
    v_mfma_f32_16x16x32_bf16 a[104:107], a[140:143], v[204:207], a[104:107]
    v_mfma_f32_16x16x32_bf16 a[108:111], a[172:175], v[204:207], a[108:111]
    s_waitcnt vmcnt(17)
    v_mfma_f32_16x16x32_bf16 a[96:99], a[208:211], v[208:211], a[96:99]
    v_mfma_f32_16x16x32_bf16 a[100:103], a[240:243], v[208:211], a[100:103]
    v_mfma_f32_16x16x32_bf16 a[104:107], a[144:147], v[208:211], a[104:107]
    ds_write_b128 v19, a[72:75] offset:2048
    v_mfma_f32_16x16x32_bf16 a[108:111], a[176:179], v[208:211], a[108:111]
    s_waitcnt vmcnt(16)
    v_mfma_f32_16x16x32_bf16 a[96:99], a[212:215], v[212:215], a[96:99]
    v_mfma_f32_16x16x32_bf16 a[100:103], a[244:247], v[212:215], a[100:103]
    v_mfma_f32_16x16x32_bf16 a[104:107], a[148:151], v[212:215], a[104:107]
    v_mfma_f32_16x16x32_bf16 a[108:111], a[180:183], v[212:215], a[108:111]
    s_waitcnt vmcnt(15)
    v_mfma_f32_16x16x32_bf16 a[96:99], a[216:219], v[216:219], a[96:99]
    v_mfma_f32_16x16x32_bf16 a[100:103], a[248:251], v[216:219], a[100:103]
    v_mfma_f32_16x16x32_bf16 a[104:107], a[152:155], v[216:219], a[104:107]
    ds_write_b128 v19, a[76:79] offset:3072
    v_mfma_f32_16x16x32_bf16 a[108:111], a[184:187], v[216:219], a[108:111]
    s_waitcnt vmcnt(14)
    v_mfma_f32_16x16x32_bf16 a[96:99], a[220:223], v[220:223], a[96:99]
    v_mfma_f32_16x16x32_bf16 a[100:103], a[252:255], v[220:223], a[100:103]
    v_mfma_f32_16x16x32_bf16 a[104:107], a[156:159], v[220:223], a[104:107]
    v_mfma_f32_16x16x32_bf16 a[108:111], a[188:191], v[220:223], a[108:111]
    s_waitcnt vmcnt(13)
    v_mfma_f32_16x16x32_bf16 a[112:115], a[192:195], v[224:227], 0
    v_mfma_f32_16x16x32_bf16 a[116:119], a[224:227], v[224:227], 0
    v_mfma_f32_16x16x32_bf16 a[120:123], a[128:131], v[224:227], 0
    ds_write_b128 v19, a[80:83] offset:4096
    v_mfma_f32_16x16x32_bf16 a[124:127], a[160:163], v[224:227], 0
    s_waitcnt vmcnt(12)
    v_mfma_f32_16x16x32_bf16 a[112:115], a[196:199], v[228:231], a[112:115]
    v_mfma_f32_16x16x32_bf16 a[116:119], a[228:231], v[228:231], a[116:119]
    v_mfma_f32_16x16x32_bf16 a[120:123], a[132:135], v[228:231], a[120:123]
    v_mfma_f32_16x16x32_bf16 a[124:127], a[164:167], v[228:231], a[124:127]
    s_waitcnt vmcnt(11)
    v_mfma_f32_16x16x32_bf16 a[112:115], a[200:203], v[232:235], a[112:115]
    v_mfma_f32_16x16x32_bf16 a[116:119], a[232:235], v[232:235], a[116:119]
    v_mfma_f32_16x16x32_bf16 a[120:123], a[136:139], v[232:235], a[120:123]
    ds_write_b128 v19, a[84:87] offset:5120
    v_mfma_f32_16x16x32_bf16 a[124:127], a[168:171], v[232:235], a[124:127]
    s_waitcnt vmcnt(10)
    v_mfma_f32_16x16x32_bf16 a[112:115], a[204:207], v[236:239], a[112:115]
    v_mfma_f32_16x16x32_bf16 a[116:119], a[236:239], v[236:239], a[116:119]
    v_mfma_f32_16x16x32_bf16 a[120:123], a[140:143], v[236:239], a[120:123]
    v_mfma_f32_16x16x32_bf16 a[124:127], a[172:175], v[236:239], a[124:127]
    s_waitcnt vmcnt(9)
    v_mfma_f32_16x16x32_bf16 a[112:115], a[208:211], v[240:243], a[112:115]
    v_mfma_f32_16x16x32_bf16 a[116:119], a[240:243], v[240:243], a[116:119]
    v_mfma_f32_16x16x32_bf16 a[120:123], a[144:147], v[240:243], a[120:123]
    ds_write_b128 v19, a[88:91] offset:6144
    v_mfma_f32_16x16x32_bf16 a[124:127], a[176:179], v[240:243], a[124:127]
    s_waitcnt vmcnt(8)
    v_mfma_f32_16x16x32_bf16 a[112:115], a[212:215], v[244:247], a[112:115]
    v_mfma_f32_16x16x32_bf16 a[116:119], a[244:247], v[244:247], a[116:119]
    v_mfma_f32_16x16x32_bf16 a[120:123], a[148:151], v[244:247], a[120:123]
    v_mfma_f32_16x16x32_bf16 a[124:127], a[180:183], v[244:247], a[124:127]
    s_waitcnt vmcnt(7)
    v_mfma_f32_16x16x32_bf16 a[112:115], a[216:219], v[248:251], a[112:115]
    v_mfma_f32_16x16x32_bf16 a[116:119], a[248:251], v[248:251], a[116:119]
    v_mfma_f32_16x16x32_bf16 a[120:123], a[152:155], v[248:251], a[120:123]
    ds_write_b128 v19, a[92:95] offset:7168
    v_mfma_f32_16x16x32_bf16 a[124:127], a[184:187], v[248:251], a[124:127]
    s_waitcnt vmcnt(6)
    v_mfma_f32_16x16x32_bf16 a[112:115], a[220:223], v[252:255], a[112:115]
    v_mfma_f32_16x16x32_bf16 a[116:119], a[252:255], v[252:255], a[116:119]
    v_mfma_f32_16x16x32_bf16 a[120:123], a[156:159], v[252:255], a[120:123]
    v_mfma_f32_16x16x32_bf16 a[124:127], a[188:191], v[252:255], a[124:127]
    ds_write_b128 v20, a[96:99] offset:0
    ds_write_b128 v20, a[100:103] offset:1024
    ds_write_b128 v20, a[104:107] offset:2048
    ds_write_b128 v20, a[108:111] offset:3072
    s_nop 0
    ds_write_b128 v20, a[112:115] offset:4096
    ds_write_b128 v20, a[116:119] offset:5120
    ds_write_b128 v20, a[120:123] offset:6144
    ds_write_b128 v20, a[124:127] offset:7168
    s_waitcnt vmcnt(0)
    s_mov_b32 s34, 0
fp_211:
    v_max3_u32 v4, v72, v73, v74
    v_max3_u32 v4, v4, v75, v76
    v_max3_u32 v4, v4, v77, v78
    v_max3_u32 v4, v4, v79, v80
    v_max3_u32 v4, v4, v81, v82
    v_max_u32 v4, v4, v83
    v_cmp_eq_u32 vcc, -1, v4
    s_cbranch_vccz fq_210
    buffer_load_dwordx4 v[72:75], v3, s[8:11], s48 offen offset:1024 sc1
    buffer_load_dwordx4 v[76:79], v3, s[8:11], s48 offen offset:2048 sc1
    buffer_load_dwordx4 v[80:83], v3, s[8:11], s48 offen offset:3072 sc1
    buffer_load_dword v9, off, s[16:19], 0 offset:108 sc1
    s_add_u32 s34, s34, 1
    s_cmp_ge_u32 s34, 0x20000
    s_cbranch_scc1 L_exit
    s_waitcnt vmcnt(0)
    s_branch fp_211
    .p2align 5
fq_210:
    v_cmp_ne_u32 vcc, 0, v9
    s_cbranch_vccnz L_stop
    s_mov_b32 s55, 0xffff0000
    v_lshlrev_b32 v88, 16, v72
    v_and_b32 v89, s55, v72
    v_lshlrev_b32 v90, 16, v73
    v_and_b32 v91, s55, v73
    v_lshlrev_b32 v92, 16, v74
    v_and_b32 v93, s55, v74
    v_lshlrev_b32 v94, 16, v75
    v_and_b32 v95, s55, v75
    v_pk_add_f32 v[64:65], v[64:65], v[88:89]
    v_pk_add_f32 v[66:67], v[66:67], v[90:91]
    v_pk_add_f32 v[68:69], v[68:69], v[92:93]
    v_pk_add_f32 v[70:71], v[70:71], v[94:95]
    v_lshlrev_b32 v88, 16, v76
    v_and_b32 v89, s55, v76
    v_lshlrev_b32 v90, 16, v77
    v_and_b32 v91, s55, v77
    v_lshlrev_b32 v92, 16, v78
    v_and_b32 v93, s55, v78
    v_lshlrev_b32 v94, 16, v79
    v_and_b32 v95, s55, v79
    v_pk_add_f32 v[64:65], v[64:65], v[88:89]
    v_pk_add_f32 v[66:67], v[66:67], v[90:91]
    v_pk_add_f32 v[68:69], v[68:69], v[92:93]
    v_pk_add_f32 v[70:71], v[70:71], v[94:95]
    v_lshlrev_b32 v88, 16, v80
    v_and_b32 v89, s55, v80
    v_lshlrev_b32 v90, 16, v81
    v_and_b32 v91, s55, v81
    v_lshlrev_b32 v92, 16, v82
    v_and_b32 v93, s55, v82
    v_lshlrev_b32 v94, 16, v83
    v_and_b32 v95, s55, v83
    v_pk_add_f32 v[64:65], v[64:65], v[88:89]
    v_pk_add_f32 v[66:67], v[66:67], v[90:91]
    v_pk_add_f32 v[68:69], v[68:69], v[92:93]
    v_pk_add_f32 v[70:71], v[70:71], v[94:95]
    v_lshlrev_b32 v88, 16, v84
    v_and_b32 v89, s55, v84
    v_lshlrev_b32 v90, 16, v85
    v_and_b32 v91, s55, v85
    v_lshlrev_b32 v92, 16, v86
    v_and_b32 v93, s55, v86
    v_lshlrev_b32 v94, 16, v87
    v_and_b32 v95, s55, v87
    v_pk_add_f32 v[64:65], v[64:65], v[88:89]
    v_pk_add_f32 v[66:67], v[66:67], v[90:91]
    v_pk_add_f32 v[68:69], v[68:69], v[92:93]
    v_pk_add_f32 v[70:71], v[70:71], v[94:95]
    v_cvt_pk_bf16_f32 v64, v64, v65
    v_cvt_pk_bf16_f32 v65, v66, v67
    v_cvt_pk_bf16_f32 v66, v68, v69
    v_cvt_pk_bf16_f32 v67, v70, v71
    s_nop 0
    v_permlane16_swap_b32 v64, v66
    v_permlane16_swap_b32 v65, v67
    buffer_store_dwordx4 v[64:67], v22, s[40:43], s47 offen
    v_accvgpr_read_b32 v96, a0
    v_accvgpr_read_b32 v97, a1
    v_accvgpr_read_b32 v98, a2
    v_accvgpr_read_b32 v99, a3
    v_accvgpr_read_b32 v100, a4
    v_accvgpr_read_b32 v101, a5
    v_accvgpr_read_b32 v102, a6
    v_accvgpr_read_b32 v103, a7
    v_accvgpr_read_b32 v104, a8
    v_accvgpr_read_b32 v105, a9
    v_accvgpr_read_b32 v106, a10
    v_accvgpr_read_b32 v107, a11
    v_accvgpr_read_b32 v108, a12
    v_accvgpr_read_b32 v109, a13
    v_accvgpr_read_b32 v110, a14
    v_accvgpr_read_b32 v111, a15
    v_accvgpr_read_b32 v112, a16
    v_accvgpr_read_b32 v113, a17
    v_accvgpr_read_b32 v114, a18
    v_accvgpr_read_b32 v115, a19
    v_accvgpr_read_b32 v116, a20
    v_accvgpr_read_b32 v117, a21
    v_accvgpr_read_b32 v118, a22
    v_accvgpr_read_b32 v119, a23
    v_accvgpr_read_b32 v120, a24
    v_accvgpr_read_b32 v121, a25
    v_accvgpr_read_b32 v122, a26
    v_accvgpr_read_b32 v123, a27
    v_accvgpr_read_b32 v124, a28
    v_accvgpr_read_b32 v125, a29
    v_accvgpr_read_b32 v126, a30
    v_accvgpr_read_b32 v127, a31
    s_waitcnt lgkmcnt(0)
    s_barrier
    ds_read_b128 v[32:35], v21 offset:0
    ds_read_b128 v[36:39], v21 offset:1024
    ds_read_b128 v[40:43], v21 offset:2048
    ds_read_b128 v[44:47], v21 offset:3072
    ds_read_b128 v[48:51], v21 offset:4096
    ds_read_b128 v[52:55], v21 offset:5120
    ds_read_b128 v[56:59], v21 offset:6144
    ds_read_b128 v[60:63], v21 offset:7168
    s_waitcnt lgkmcnt(7)
    v_pk_add_f32 v[96:97], v[96:97], v[32:33]
    v_pk_add_f32 v[98:99], v[98:99], v[34:35]
    s_waitcnt lgkmcnt(6)
    v_pk_add_f32 v[100:101], v[100:101], v[36:37]
    v_pk_add_f32 v[102:103], v[102:103], v[38:39]
    s_waitcnt lgkmcnt(5)
    v_pk_add_f32 v[104:105], v[104:105], v[40:41]
    v_pk_add_f32 v[106:107], v[106:107], v[42:43]
    s_waitcnt lgkmcnt(4)
    v_pk_add_f32 v[108:109], v[108:109], v[44:45]
    v_pk_add_f32 v[110:111], v[110:111], v[46:47]
    s_waitcnt lgkmcnt(3)
    v_pk_add_f32 v[112:113], v[112:113], v[48:49]
    v_pk_add_f32 v[114:115], v[114:115], v[50:51]
    s_waitcnt lgkmcnt(2)
    v_pk_add_f32 v[116:117], v[116:117], v[52:53]
    v_pk_add_f32 v[118:119], v[118:119], v[54:55]
    s_waitcnt lgkmcnt(1)
    v_pk_add_f32 v[120:121], v[120:121], v[56:57]
    v_pk_add_f32 v[122:123], v[122:123], v[58:59]
    s_waitcnt lgkmcnt(0)
    v_pk_add_f32 v[124:125], v[124:125], v[60:61]
    v_pk_add_f32 v[126:127], v[126:127], v[62:63]
    ds_read_b128 v[32:35], v21 offset:8192
    ds_read_b128 v[36:39], v21 offset:9216
    ds_read_b128 v[40:43], v21 offset:10240
    ds_read_b128 v[44:47], v21 offset:11264
    ds_read_b128 v[48:51], v21 offset:12288
    ds_read_b128 v[52:55], v21 offset:13312
    ds_read_b128 v[56:59], v21 offset:14336
    ds_read_b128 v[60:63], v21 offset:15360
    s_waitcnt lgkmcnt(7)
    v_pk_add_f32 v[96:97], v[96:97], v[32:33]
    v_pk_add_f32 v[98:99], v[98:99], v[34:35]
    s_waitcnt lgkmcnt(6)
    v_pk_add_f32 v[100:101], v[100:101], v[36:37]
    v_pk_add_f32 v[102:103], v[102:103], v[38:39]
    s_waitcnt lgkmcnt(5)
    v_pk_add_f32 v[104:105], v[104:105], v[40:41]
    v_pk_add_f32 v[106:107], v[106:107], v[42:43]
    s_waitcnt lgkmcnt(4)
    v_pk_add_f32 v[108:109], v[108:109], v[44:45]
    v_pk_add_f32 v[110:111], v[110:111], v[46:47]
    s_waitcnt lgkmcnt(3)
    v_pk_add_f32 v[112:113], v[112:113], v[48:49]
    v_pk_add_f32 v[114:115], v[114:115], v[50:51]
    s_waitcnt lgkmcnt(2)
    v_pk_add_f32 v[116:117], v[116:117], v[52:53]
    v_pk_add_f32 v[118:119], v[118:119], v[54:55]
    s_waitcnt lgkmcnt(1)
    v_pk_add_f32 v[120:121], v[120:121], v[56:57]
    v_pk_add_f32 v[122:123], v[122:123], v[58:59]
    s_waitcnt lgkmcnt(0)
    v_pk_add_f32 v[124:125], v[124:125], v[60:61]
    v_pk_add_f32 v[126:127], v[126:127], v[62:63]
    ds_read_b128 v[32:35], v21 offset:16384
    ds_read_b128 v[36:39], v21 offset:17408
    ds_read_b128 v[40:43], v21 offset:18432
    ds_read_b128 v[44:47], v21 offset:19456
    ds_read_b128 v[48:51], v21 offset:20480
    ds_read_b128 v[52:55], v21 offset:21504
    ds_read_b128 v[56:59], v21 offset:22528
    ds_read_b128 v[60:63], v21 offset:23552
    s_waitcnt lgkmcnt(7)
    v_pk_add_f32 v[96:97], v[96:97], v[32:33]
    v_pk_add_f32 v[98:99], v[98:99], v[34:35]
    s_waitcnt lgkmcnt(6)
    v_pk_add_f32 v[100:101], v[100:101], v[36:37]
    v_pk_add_f32 v[102:103], v[102:103], v[38:39]
    s_waitcnt lgkmcnt(5)
    v_pk_add_f32 v[104:105], v[104:105], v[40:41]
    v_pk_add_f32 v[106:107], v[106:107], v[42:43]
    s_waitcnt lgkmcnt(4)
    v_pk_add_f32 v[108:109], v[108:109], v[44:45]
    v_pk_add_f32 v[110:111], v[110:111], v[46:47]
    s_waitcnt lgkmcnt(3)
    v_pk_add_f32 v[112:113], v[112:113], v[48:49]
    v_pk_add_f32 v[114:115], v[114:115], v[50:51]
    s_waitcnt lgkmcnt(2)
    v_pk_add_f32 v[116:117], v[116:117], v[52:53]
    v_pk_add_f32 v[118:119], v[118:119], v[54:55]
    s_waitcnt lgkmcnt(1)
    v_pk_add_f32 v[120:121], v[120:121], v[56:57]
    v_pk_add_f32 v[122:123], v[122:123], v[58:59]
    s_waitcnt lgkmcnt(0)
    v_pk_add_f32 v[124:125], v[124:125], v[60:61]
    v_pk_add_f32 v[126:127], v[126:127], v[62:63]
    s_bitcmp1_b32 s20, 0
    s_cbranch_scc1 ro_212
    s_xor_b32 s53, s20, 1
    s_lshl_b32 s52, s21, 2
    s_add_u32 s52, s52, s53
    s_lshl_b32 s52, s52, 3
    s_add_u32 s52, s52, s24
    s_lshl_b32 s52, s52, 12
    s_add_u32 s52, s52, 0xb004000
    v_cvt_pk_bf16_f32 v36, v104, v105
    v_cvt_pk_bf16_f32 v37, v106, v107
    v_cvt_pk_bf16_f32 v38, v108, v109
    v_cvt_pk_bf16_f32 v39, v110, v111
    buffer_store_dwordx4 v[36:39], v3, s[8:11], s52 offen offset:1024 sc1
    s_xor_b32 s53, s20, 2
    s_lshl_b32 s52, s21, 2
    s_add_u32 s52, s52, s53
    s_lshl_b32 s52, s52, 3
    s_add_u32 s52, s52, s24
    s_lshl_b32 s52, s52, 12
    s_add_u32 s52, s52, 0xb004000
    v_cvt_pk_bf16_f32 v40, v112, v113
    v_cvt_pk_bf16_f32 v41, v114, v115
    v_cvt_pk_bf16_f32 v42, v116, v117
    v_cvt_pk_bf16_f32 v43, v118, v119
    buffer_store_dwordx4 v[40:43], v3, s[8:11], s52 offen offset:2048 sc1
    s_xor_b32 s53, s20, 3
    s_lshl_b32 s52, s21, 2
    s_add_u32 s52, s52, s53
    s_lshl_b32 s52, s52, 3
    s_add_u32 s52, s52, s24
    s_lshl_b32 s52, s52, 12
    s_add_u32 s52, s52, 0xb004000
    v_cvt_pk_bf16_f32 v44, v120, v121
    v_cvt_pk_bf16_f32 v45, v122, v123
    v_cvt_pk_bf16_f32 v46, v124, v125
    v_cvt_pk_bf16_f32 v47, v126, v127
    buffer_store_dwordx4 v[44:47], v3, s[8:11], s52 offen offset:3072 sc1
    s_branch re_213
    .p2align 5
ro_212:
    s_xor_b32 s53, s20, 1
    s_lshl_b32 s52, s21, 2
    s_add_u32 s52, s52, s53
    s_lshl_b32 s52, s52, 3
    s_add_u32 s52, s52, s24
    s_lshl_b32 s52, s52, 12
    s_add_u32 s52, s52, 0xb004000
    v_cvt_pk_bf16_f32 v36, v96, v97
    v_cvt_pk_bf16_f32 v37, v98, v99
    v_cvt_pk_bf16_f32 v38, v100, v101
    v_cvt_pk_bf16_f32 v39, v102, v103
    buffer_store_dwordx4 v[36:39], v3, s[8:11], s52 offen offset:1024 sc1
    s_xor_b32 s53, s20, 2
    s_lshl_b32 s52, s21, 2
    s_add_u32 s52, s52, s53
    s_lshl_b32 s52, s52, 3
    s_add_u32 s52, s52, s24
    s_lshl_b32 s52, s52, 12
    s_add_u32 s52, s52, 0xb004000
    v_cvt_pk_bf16_f32 v40, v120, v121
    v_cvt_pk_bf16_f32 v41, v122, v123
    v_cvt_pk_bf16_f32 v42, v124, v125
    v_cvt_pk_bf16_f32 v43, v126, v127
    buffer_store_dwordx4 v[40:43], v3, s[8:11], s52 offen offset:2048 sc1
    s_xor_b32 s53, s20, 3
    s_lshl_b32 s52, s21, 2
    s_add_u32 s52, s52, s53
    s_lshl_b32 s52, s52, 3
    s_add_u32 s52, s52, s24
    s_lshl_b32 s52, s52, 12
    s_add_u32 s52, s52, 0xb004000
    v_cvt_pk_bf16_f32 v44, v112, v113
    v_cvt_pk_bf16_f32 v45, v114, v115
    v_cvt_pk_bf16_f32 v46, v116, v117
    v_cvt_pk_bf16_f32 v47, v118, v119
    buffer_store_dwordx4 v[44:47], v3, s[8:11], s52 offen offset:3072 sc1
    v_mov_b32 v96, v104
    v_mov_b32 v97, v105
    v_mov_b32 v98, v106
    v_mov_b32 v99, v107
    v_mov_b32 v100, v108
    v_mov_b32 v101, v109
    v_mov_b32 v102, v110
    v_mov_b32 v103, v111
re_213:
    buffer_load_dwordx4 v[104:107], v3, s[8:11], s49 offen offset:1024 sc1
    buffer_load_dwordx4 v[108:111], v3, s[8:11], s49 offen offset:2048 sc1
    buffer_load_dwordx4 v[112:115], v3, s[8:11], s49 offen offset:3072 sc1
    buffer_load_dword v9, off, s[16:19], 0 offset:108 sc1
    s_waitcnt vmcnt(0)
    s_mov_b32 s34, 0
fp_215:
    v_max3_u32 v4, v104, v105, v106
    v_max3_u32 v4, v4, v107, v108
    v_max3_u32 v4, v4, v109, v110
    v_max3_u32 v4, v4, v111, v112
    v_max3_u32 v4, v4, v113, v114
    v_max_u32 v4, v4, v115
    v_cmp_eq_u32 vcc, -1, v4
    s_cbranch_vccz fq_214
    buffer_load_dwordx4 v[104:107], v3, s[8:11], s49 offen offset:1024 sc1
    buffer_load_dwordx4 v[108:111], v3, s[8:11], s49 offen offset:2048 sc1
    buffer_load_dwordx4 v[112:115], v3, s[8:11], s49 offen offset:3072 sc1
    buffer_load_dword v9, off, s[16:19], 0 offset:108 sc1
    s_add_u32 s34, s34, 1
    s_cmp_ge_u32 s34, 0x20000
    s_cbranch_scc1 L_exit
    s_waitcnt vmcnt(0)
    s_branch fp_215
    .p2align 5
fq_214:
    v_cmp_ne_u32 vcc, 0, v9
    s_cbranch_vccnz L_stop
    s_mov_b32 s55, 0xffff0000
    v_lshlrev_b32 v120, 16, v104
    v_and_b32 v121, s55, v104
    v_lshlrev_b32 v122, 16, v105
    v_and_b32 v123, s55, v105
    v_lshlrev_b32 v124, 16, v106
    v_and_b32 v125, s55, v106
    v_lshlrev_b32 v126, 16, v107
    v_and_b32 v127, s55, v107
    v_pk_add_f32 v[96:97], v[96:97], v[120:121]
    v_pk_add_f32 v[98:99], v[98:99], v[122:123]
    v_pk_add_f32 v[100:101], v[100:101], v[124:125]
    v_pk_add_f32 v[102:103], v[102:103], v[126:127]
    v_lshlrev_b32 v120, 16, v108
    v_and_b32 v121, s55, v108
    v_lshlrev_b32 v122, 16, v109
    v_and_b32 v123, s55, v109
    v_lshlrev_b32 v124, 16, v110
    v_and_b32 v125, s55, v110
    v_lshlrev_b32 v126, 16, v111
    v_and_b32 v127, s55, v111
    v_pk_add_f32 v[96:97], v[96:97], v[120:121]
    v_pk_add_f32 v[98:99], v[98:99], v[122:123]
    v_pk_add_f32 v[100:101], v[100:101], v[124:125]
    v_pk_add_f32 v[102:103], v[102:103], v[126:127]
    v_lshlrev_b32 v120, 16, v112
    v_and_b32 v121, s55, v112
    v_lshlrev_b32 v122, 16, v113
    v_and_b32 v123, s55, v113
    v_lshlrev_b32 v124, 16, v114
    v_and_b32 v125, s55, v114
    v_lshlrev_b32 v126, 16, v115
    v_and_b32 v127, s55, v115
    v_pk_add_f32 v[96:97], v[96:97], v[120:121]
    v_pk_add_f32 v[98:99], v[98:99], v[122:123]
    v_pk_add_f32 v[100:101], v[100:101], v[124:125]
    v_pk_add_f32 v[102:103], v[102:103], v[126:127]
    v_lshlrev_b32 v120, 16, v28
    v_and_b32 v121, s55, v28
    v_lshlrev_b32 v122, 16, v29
    v_and_b32 v123, s55, v29
    v_lshlrev_b32 v124, 16, v30
    v_and_b32 v125, s55, v30
    v_lshlrev_b32 v126, 16, v31
    v_and_b32 v127, s55, v31
    v_pk_add_f32 v[96:97], v[96:97], v[120:121]
    v_pk_add_f32 v[98:99], v[98:99], v[122:123]
    v_pk_add_f32 v[100:101], v[100:101], v[124:125]
    v_pk_add_f32 v[102:103], v[102:103], v[126:127]
    v_cvt_pk_bf16_f32 v96, v96, v97
    v_cvt_pk_bf16_f32 v97, v98, v99
    v_cvt_pk_bf16_f32 v98, v100, v101
    v_cvt_pk_bf16_f32 v99, v102, v103
    s_nop 0
    v_permlane16_swap_b32 v96, v98
    v_permlane16_swap_b32 v97, v99
    s_add_u32 s47, s47, 0x80000
    buffer_store_dwordx4 v[96:99], v22, s[40:43], s47 offen
    s_branch te_216
    .p2align 5
tr_197:
    buffer_load_dword v5, v4, s[8:11], s36 offen sc1
    buffer_load_dwordx2 v[6:7], v12, s[16:19], 0 offen sc1
    s_add_u32 s34, s34, 1
    s_cmp_ge_u32 s34, 0x20000
    s_cbranch_scc1 L_exit
    s_waitcnt vmcnt(0)
    s_branch tc_196
    .p2align 5
te_216:
L_stop:
    s_endpgm
    .p2align 5
L_other:
    s_sub_u32 s64, s20, 4
    s_mov_b32 s65, s21
    s_load_dwordx2 s[52:53], s[0:1], 0
    s_load_dwordx2 s[54:55], s[0:1], 16
    s_load_dwordx2 s[56:57], s[0:1], 64
    s_load_dwordx2 s[58:59], s[0:1], 72
    s_load_dwordx2 s[60:61], s[0:1], 24
    s_load_dwordx2 s[62:63], s[0:1], 32
    s_load_dwordx2 s[74:75], s[0:1], 96
    s_mov_b32 s48, s4
    s_mov_b32 s49, s5
    s_mov_b32 s50, 0x100
    s_mov_b32 s51, 0x20000
    v_and_b32 v1, 63, v0
    v_lshrrev_b32 v28, 6, v0
    s_nop 0
    v_readfirstlane_b32 s20, v28
    s_and_b32 s21, s20, 1
    s_lshr_b32 s22, s20, 1
    s_lshl_b32 s28, s20, 13
    s_lshl_b32 s29, s20, 12
    s_add_u32 s29, s29, 0x10000
    v_lshrrev_b32 v25, 4, v1
    v_and_b32 v24, 15, v1
    v_lshlrev_b32 v26, 4, v1
    v_lshrrev_b32 v28, 4, v1
    v_and_b32 v29, 15, v1
    v_lshrrev_b32 v30, 2, v29
    v_and_b32 v31, 1, v29
    v_lshl_add_u32 v30, v30, 1, v31
    v_lshlrev_b32 v30, 4, v30
    v_lshl_add_u32 v124, v28, 7, v30
    v_lshlrev_b32 v125, 3, v1
    v_add_u32 v125, 512, v125
    v_lshlrev_b32 v30, 2, v28
    v_add_u32 v31, 0, v30
    v_cmp_le_u32 s[88:89], v31, v29
    v_mov_b32 v120, 0x3f803f80
    v_add_u32 v31, 1, v30
    v_cmp_le_u32 s[90:91], v31, v29
    v_mov_b32 v121, 0x3f803f80
    v_add_u32 v31, 2, v30
    v_cmp_le_u32 s[92:93], v31, v29
    v_mov_b32 v122, 0x3f803f80
    v_add_u32 v31, 3, v30
    v_cmp_le_u32 s[94:95], v31, v29
    v_mov_b32 v123, 0x3f803f80
    v_mov_b32 v126, 0xff800000
    s_mov_b32 s96, 0x3e0293ee
    s_mov_b32 s97, 0
    s_mov_b32 s46, 0
    s_waitcnt lgkmcnt(0)
    s_mov_b32 s84, s74
    s_mov_b32 s85, s75
    s_mov_b32 s86, 0x400000
    s_mov_b32 s87, 0x20000
    s_mov_b32 s66, 0
    s_cmp_lg_u32 s66, 0
    s_cbranch_scc1 d1g_218
    s_and_b32 s71, s65, 3
    s_add_u32 s71, s71, 1
    s_lshr_b32 s74, s65, 2
dkvg_225:
    s_lshl_b32 s72, s64, 3
    s_add_u32 s72, s72, s74
    s_lshr_b32 s70, s72, 4
    s_and_b32 s72, s72, 15
    s_branch ddg_227
d1g_218:
    s_cmp_lg_u32 s66, 1
    s_cbranch_scc1 d2g_219
    s_mul_i32 s74, s65, 43
    s_lshr_b32 s74, s74, 7
    s_mul_i32 s75, s74, 3
    s_sub_u32 s71, s65, s75
    s_add_u32 s71, s71, 5
    s_cmp_lt_u32 s65, 24
    s_cbranch_scc1 dkvg_225
    s_mov_b32 s72, s64
    s_branch d6g_223
d2g_219:
    s_lshr_b32 s74, s65, 3
    s_cmp_lg_u32 s66, 2
    s_cbranch_scc1 d3g_220
    s_lshl_b32 s72, s64, 2
    s_add_u32 s74, s74, 4
    s_add_u32 s72, s72, s74
    s_branch d6g_223
d3g_220:
    s_cmp_lg_u32 s66, 3
    s_cbranch_scc1 d4g_221
    s_bitcmp1_b32 s64, 0
    s_cbranch_scc1 dqg_226
    s_lshl_b32 s72, s64, 1
    s_add_u32 s74, s74, 20
    s_add_u32 s72, s72, s74
d6g_223:
    s_and_b32 s71, s65, 7
    s_mov_b32 s70, 4
    s_branch ddg_227
dqg_226:
    s_lshr_b32 s72, s64, 1
    s_lshl_b32 s72, s72, 3
    s_lshr_b32 s74, s65, 2
    s_add_u32 s72, s72, s74
    s_and_b32 s71, s65, 3
    s_mov_b32 s70, 3
    s_branch ddg_227
d4g_221:
    s_cmp_lg_u32 s66, 4
    s_cbranch_scc1 dng_228
    s_cmp_ge_u32 s64, 2
    s_cbranch_scc1 dng_228
    s_and_b32 s72, s65, 15
    s_lshr_b32 s74, s65, 4
    s_lshl_b32 s71, s64, 1
    s_add_u32 s74, s74, 4
    s_add_u32 s71, s71, s74
    s_cmp_eq_u32 s64, 0
    s_cselect_b32 s70, 3, 2
    s_branch ddg_227
dng_228:
    s_mov_b32 s70, 5
ddg_227:
    s_mov_b32 s12, s52
    s_mov_b32 s13, s53
    s_mov_b32 s14, 0x400000
    s_mov_b32 s15, 0x20000
    s_lshl_b32 s74, s71, 8
    s_lshl_b32 s30, s20, 6
    s_add_u32 s30, s30, s74
    v_lshrrev_b32 v28, 3, v1
    v_add_u32 v28, s30, v28
    v_lshlrev_b32 v28, 11, v28
    v_and_b32 v29, 7, v1
    v_xor_b32 v29, v29, v25
    v_xor_b32 v30, 0, v29
    v_lshl_add_u32 v12, v30, 4, v28
    v_xor_b32 v30, 4, v29
    v_lshl_add_u32 v13, v30, 4, v28
    v_add_u32 v13, 0x3c00, v13
    v_xor_b32 v30, 0, v29
    v_lshl_add_u32 v14, v30, 4, v28
    v_add_u32 v14, 0x7800, v14
    v_xor_b32 v30, 4, v29
    v_lshl_add_u32 v15, v30, 4, v28
    v_add_u32 v15, 0xb400, v15
    v_xor_b32 v30, 0, v29
    v_lshl_add_u32 v16, v30, 4, v28
    v_add_u32 v16, 0x10000, v16
    v_xor_b32 v30, 4, v29
    v_lshl_add_u32 v17, v30, 4, v28
    v_add_u32 v17, 0x13c00, v17
    v_xor_b32 v30, 0, v29
    v_lshl_add_u32 v18, v30, 4, v28
    v_add_u32 v18, 0x17800, v18
    v_xor_b32 v30, 4, v29
    v_lshl_add_u32 v19, v30, 4, v28
    v_add_u32 v19, 0x1b400, v19
    s_mov_b32 s25, 128
    s_mov_b32 s23, 0
    s_mov_b32 s24, 0
    s_cmp_eq_u32 s70, 4
    s_cbranch_scc1 thg_229
    s_mov_b32 s16, s54
    s_mov_b32 s17, s55
    s_mov_b32 s18, 0x800000
    s_mov_b32 s19, 0x20000
    s_cmp_ge_u32 s70, 2
    s_cbranch_scc1 twg_232
    s_mov_b32 s16, s60
    s_mov_b32 s17, s61
    s_mov_b32 s18, 0x800000
    s_mov_b32 s19, 0x20000
    s_cmp_eq_u32 s70, 0
    s_cbranch_scc1 twg_232
    s_mov_b32 s16, s62
    s_mov_b32 s17, s63
    s_mov_b32 s18, 0x800000
    s_mov_b32 s19, 0x20000
twg_232:
    s_lshl_b32 s74, s72, 9
    s_lshl_b32 s75, s22, 8
    s_add_u32 s74, s74, s75
    v_lshlrev_b32 v30, 1, v25
    v_xor_b32 v29, v24, v30
    s_lshl_b32 s30, s21, 4
    v_add_u32 v28, s30, v25
    s_mov_b32 s30, 8192
    v_mul_lo_u32 v28, v28, s30
    v_add_u32 v28, s74, v28
    v_xor_b32 v30, 0, v29
    v_lshl_add_u32 v20, v30, 4, v28
    v_xor_b32 v30, 0, v29
    v_lshl_add_u32 v21, v30, 4, v28
    v_add_u32 v21, 0x7c00, v21
    v_xor_b32 v30, 8, v29
    v_lshl_add_u32 v22, v30, 4, v28
    v_add_u32 v22, 0xf800, v22
    v_xor_b32 v30, 8, v29
    v_lshl_add_u32 v23, v30, 4, v28
    v_add_u32 v23, 0x17400, v23
    s_mov_b32 s26, 262144
    s_branch tdg_231
thg_229:
    s_mov_b32 s16, s56
    s_mov_b32 s17, s57
    s_mov_b32 s18, 0x700000
    s_mov_b32 s19, 0x20000
    s_cmp_eq_u32 s22, 0
    s_cbranch_scc1 tug_230
    s_mov_b32 s16, s58
    s_mov_b32 s17, s59
    s_mov_b32 s18, 0x700000
    s_mov_b32 s19, 0x20000
tug_230:
    s_lshl_b32 s74, s72, 8
    v_lshlrev_b32 v30, 1, v25
    v_xor_b32 v29, v24, v30
    s_lshl_b32 s30, s21, 4
    v_add_u32 v28, s30, v25
    s_mov_b32 s30, 7168
    v_mul_lo_u32 v28, v28, s30
    v_add_u32 v28, s74, v28
    v_xor_b32 v30, 0, v29
    v_lshl_add_u32 v20, v30, 4, v28
    v_xor_b32 v30, 0, v29
    v_lshl_add_u32 v21, v30, 4, v28
    v_add_u32 v21, 0x6c00, v21
    v_xor_b32 v30, 8, v29
    v_lshl_add_u32 v22, v30, 4, v28
    v_add_u32 v22, 0xd800, v22
    v_xor_b32 v30, 8, v29
    v_lshl_add_u32 v23, v30, 4, v28
    v_add_u32 v23, 0x14400, v23
    s_mov_b32 s26, 229376
tdg_231:
    s_add_u32 m0, s29, 0x0
    s_nop 0
    buffer_load_dwordx4 v20, s[16:19], s24 offen offset:0 lds
    buffer_load_dwordx4 v21, s[16:19], s24 offen offset:1024 lds
    buffer_load_dwordx4 v22, s[16:19], s24 offen offset:2048 lds
    buffer_load_dwordx4 v23, s[16:19], s24 offen offset:3072 lds
    s_add_u32 s24, s24, s26
    s_add_u32 m0, s28, 0x0
    s_nop 0
    buffer_load_dwordx4 v12, s[12:15], s23 offen offset:0 lds
    buffer_load_dwordx4 v13, s[12:15], s23 offen offset:1024 lds
    buffer_load_dwordx4 v14, s[12:15], s23 offen offset:2048 lds
    buffer_load_dwordx4 v15, s[12:15], s23 offen offset:3072 lds
    s_add_u32 m0, s28, 0x1000
    s_nop 0
    buffer_load_dwordx4 v16, s[12:15], s23 offen offset:0 lds
    buffer_load_dwordx4 v17, s[12:15], s23 offen offset:1024 lds
    buffer_load_dwordx4 v18, s[12:15], s23 offen offset:2048 lds
    buffer_load_dwordx4 v19, s[12:15], s23 offen offset:3072 lds
    s_add_u32 s23, s23, s25
    s_add_u32 m0, s29, 0x4000
    s_nop 0
    buffer_load_dwordx4 v20, s[16:19], s24 offen offset:0 lds
    buffer_load_dwordx4 v21, s[16:19], s24 offen offset:1024 lds
    buffer_load_dwordx4 v22, s[16:19], s24 offen offset:2048 lds
    buffer_load_dwordx4 v23, s[16:19], s24 offen offset:3072 lds
    s_add_u32 s24, s24, s26
    s_add_u32 m0, s29, 0x8000
    s_nop 0
    buffer_load_dwordx4 v20, s[16:19], s24 offen offset:0 lds
    buffer_load_dwordx4 v21, s[16:19], s24 offen offset:1024 lds
    buffer_load_dwordx4 v22, s[16:19], s24 offen offset:2048 lds
    buffer_load_dwordx4 v23, s[16:19], s24 offen offset:3072 lds
    s_add_u32 s24, s24, s26
    s_add_u32 m0, s28, 0x8000
    s_nop 0
    buffer_load_dwordx4 v12, s[12:15], s23 offen offset:0 lds
    buffer_load_dwordx4 v13, s[12:15], s23 offen offset:1024 lds
    buffer_load_dwordx4 v14, s[12:15], s23 offen offset:2048 lds
    buffer_load_dwordx4 v15, s[12:15], s23 offen offset:3072 lds
    s_add_u32 m0, s28, 0x9000
    s_nop 0
    buffer_load_dwordx4 v16, s[12:15], s23 offen offset:0 lds
    buffer_load_dwordx4 v17, s[12:15], s23 offen offset:1024 lds
    buffer_load_dwordx4 v18, s[12:15], s23 offen offset:2048 lds
    buffer_load_dwordx4 v19, s[12:15], s23 offen offset:3072 lds
    s_add_u32 s23, s23, s25
    s_add_u32 m0, s29, 0xc000
    s_nop 0
    buffer_load_dwordx4 v20, s[16:19], s24 offen offset:0 lds
    buffer_load_dwordx4 v21, s[16:19], s24 offen offset:1024 lds
    buffer_load_dwordx4 v22, s[16:19], s24 offen offset:2048 lds
    buffer_load_dwordx4 v23, s[16:19], s24 offen offset:3072 lds
    s_add_u32 s24, s24, s26
    s_waitcnt vmcnt(20)
    s_barrier
jobg_234:
    s_mov_b32 s67, s70
    s_mov_b32 s68, s71
    s_mov_b32 s69, s72
    s_add_u32 s66, s66, 1
    s_mov_b32 s27, 8
    v_lshrrev_b32 v28, 1, v24
    v_xor_b32 v28, v28, v25
    v_lshlrev_b32 v29, 7, v24
    s_lshl_b32 s30, s22, 14
    v_add_u32 v29, s30, v29
    v_xor_b32 v2, 0, v28
    v_lshl_add_u32 v2, v2, 4, v29
    v_xor_b32 v3, 4, v28
    v_lshl_add_u32 v3, v3, 4, v29
    s_cmp_eq_u32 s67, 4
    s_cbranch_scc1 jhg_235
    v_bfe_u32 v28, v1, 2, 2
    v_lshl_add_u32 v29, v25, 3, v28
    v_lshlrev_b32 v29, 8, v29
    v_and_b32 v30, 3, v1
    v_lshl_add_u32 v29, v30, 3, v29
    v_and_b32 v31, 1, v25
    v_lshl_or_b32 v31, v31, 2, v28
    s_lshl_b32 s30, s21, 13
    s_add_u32 s30, s30, 0x10000
    v_add_u32 v29, s30, v29
    v_xor_b32 v30, 0, v31
    v_lshl_add_u32 v4, v30, 5, v29
    v_xor_b32 v30, 1, v31
    v_lshl_add_u32 v5, v30, 5, v29
    v_xor_b32 v30, 2, v31
    v_lshl_add_u32 v6, v30, 5, v29
    v_xor_b32 v30, 3, v31
    v_lshl_add_u32 v7, v30, 5, v29
    v_xor_b32 v30, 4, v31
    v_lshl_add_u32 v8, v30, 5, v29
    v_xor_b32 v30, 5, v31
    v_lshl_add_u32 v9, v30, 5, v29
    v_xor_b32 v30, 6, v31
    v_lshl_add_u32 v10, v30, 5, v29
    v_xor_b32 v30, 7, v31
    v_lshl_add_u32 v11, v30, 5, v29
    s_lshl_b32 s74, s68, 1
    s_add_u32 s74, s74, s22
    s_lshl_b32 s74, s74, 6
    s_add_u32 s74, s74, s69
    s_lshl_b32 s74, s74, 1
    s_add_u32 s74, s74, s21
    s_lshl_b32 s73, s74, 13
    s_branch jmg_236
jhg_235:
    v_bfe_u32 v28, v1, 2, 2
    v_lshl_add_u32 v29, v25, 3, v28
    v_lshlrev_b32 v29, 8, v29
    v_and_b32 v30, 3, v1
    v_lshl_add_u32 v29, v30, 3, v29
    v_and_b32 v31, 1, v25
    v_lshl_or_b32 v31, v31, 2, v28
    s_lshl_b32 s30, s21, 2
    v_xor_b32 v31, s30, v31
    v_add_u32 v29, 0x10000, v29
    v_xor_b32 v30, 0, v31
    v_lshl_add_u32 v4, v30, 5, v29
    v_xor_b32 v30, 1, v31
    v_lshl_add_u32 v5, v30, 5, v29
    v_xor_b32 v30, 2, v31
    v_lshl_add_u32 v6, v30, 5, v29
    v_xor_b32 v30, 3, v31
    v_lshl_add_u32 v7, v30, 5, v29
    v_xor_b32 v30, 0, v31
    v_lshl_add_u32 v8, v30, 5, v29
    v_add_u32 v8, 0x2000, v8
    v_xor_b32 v30, 1, v31
    v_lshl_add_u32 v9, v30, 5, v29
    v_add_u32 v9, 0x2000, v9
    v_xor_b32 v30, 2, v31
    v_lshl_add_u32 v10, v30, 5, v29
    v_add_u32 v10, 0x2000, v10
    v_xor_b32 v30, 3, v31
    v_lshl_add_u32 v11, v30, 5, v29
    v_add_u32 v11, 0x2000, v11
    s_mul_i32 s74, s68, 28
    s_add_u32 s74, s74, s69
    s_lshl_b32 s74, s74, 1
    s_add_u32 s74, s74, s21
    s_lshl_b32 s74, s74, 1
    s_add_u32 s74, s74, s22
    s_lshl_b32 s74, s74, 14
    s_add_u32 s73, s74, 0x5000000
jmg_236:
    ds_read_b128 v[192:195], v2 offset:0
    ds_read_b64_tr_b16 v[128:129], v4 offset:0
    ds_read_b64_tr_b16 v[130:131], v4 offset:1024
    ds_read_b128 v[196:199], v2 offset:2048
    ds_read_b64_tr_b16 v[132:133], v5 offset:0
    ds_read_b64_tr_b16 v[134:135], v5 offset:1024
    ds_read_b128 v[200:203], v2 offset:4096
    ds_read_b64_tr_b16 v[136:137], v6 offset:0
    ds_read_b64_tr_b16 v[138:139], v6 offset:1024
    ds_read_b128 v[204:207], v2 offset:6144
    ds_read_b64_tr_b16 v[140:141], v7 offset:0
    ds_read_b64_tr_b16 v[142:143], v7 offset:1024
    ds_read_b128 v[208:211], v2 offset:8192
    ds_read_b64_tr_b16 v[144:145], v8 offset:0
    ds_read_b64_tr_b16 v[146:147], v8 offset:1024
    ds_read_b128 v[212:215], v2 offset:10240
    ds_read_b64_tr_b16 v[148:149], v9 offset:0
    ds_read_b64_tr_b16 v[150:151], v9 offset:1024
    ds_read_b128 v[216:219], v2 offset:12288
    ds_read_b64_tr_b16 v[152:153], v10 offset:0
    ds_read_b64_tr_b16 v[154:155], v10 offset:1024
    ds_read_b128 v[220:223], v2 offset:14336
    ds_read_b64_tr_b16 v[156:157], v11 offset:0
    ds_read_b64_tr_b16 v[158:159], v11 offset:1024
    s_waitcnt vmcnt(16) lgkmcnt(0)
    s_barrier
    s_cmp_eq_u32 s67, 1
    s_cbranch_scc1 jvg_237
    v_mfma_f32_16x16x32_bf16 a[0:3], v[128:131], v[192:195], 0
    ds_read_b128 v[224:227], v3 offset:0
    v_mfma_f32_16x16x32_bf16 a[8:11], v[128:131], v[196:199], 0
    s_add_u32 m0, s29, 0x0
    v_mfma_f32_16x16x32_bf16 a[16:19], v[128:131], v[200:203], 0
    ds_read_b64_tr_b16 v[160:161], v4 offset:16384
    v_mfma_f32_16x16x32_bf16 a[24:27], v[128:131], v[204:207], 0
    buffer_load_dwordx4 v20, s[16:19], s24 offen offset:0 lds
    v_mfma_f32_16x16x32_bf16 a[32:35], v[128:131], v[208:211], 0
    ds_read_b64_tr_b16 v[162:163], v4 offset:17408
    v_mfma_f32_16x16x32_bf16 a[40:43], v[128:131], v[212:215], 0
    v_mfma_f32_16x16x32_bf16 a[48:51], v[128:131], v[216:219], 0
    ds_read_b128 v[228:231], v3 offset:2048
    v_mfma_f32_16x16x32_bf16 a[56:59], v[128:131], v[220:223], 0
    buffer_load_dwordx4 v21, s[16:19], s24 offen offset:1024 lds
    v_mfma_f32_16x16x32_bf16 a[4:7], v[132:135], v[192:195], 0
    ds_read_b64_tr_b16 v[164:165], v5 offset:16384
    v_mfma_f32_16x16x32_bf16 a[12:15], v[132:135], v[196:199], 0
    v_mfma_f32_16x16x32_bf16 a[20:23], v[132:135], v[200:203], 0
    ds_read_b64_tr_b16 v[166:167], v5 offset:17408
    v_mfma_f32_16x16x32_bf16 a[28:31], v[132:135], v[204:207], 0
    buffer_load_dwordx4 v22, s[16:19], s24 offen offset:2048 lds
    v_mfma_f32_16x16x32_bf16 a[36:39], v[132:135], v[208:211], 0
    ds_read_b128 v[232:235], v3 offset:4096
    v_mfma_f32_16x16x32_bf16 a[44:47], v[132:135], v[212:215], 0
    v_mfma_f32_16x16x32_bf16 a[52:55], v[132:135], v[216:219], 0
    ds_read_b64_tr_b16 v[168:169], v6 offset:16384
    v_mfma_f32_16x16x32_bf16 a[60:63], v[132:135], v[220:223], 0
    buffer_load_dwordx4 v23, s[16:19], s24 offen offset:3072 lds
    v_mfma_f32_16x16x32_bf16 a[64:67], v[136:139], v[192:195], 0
    ds_read_b64_tr_b16 v[170:171], v6 offset:17408
    v_mfma_f32_16x16x32_bf16 a[72:75], v[136:139], v[196:199], 0
    s_add_u32 s24, s24, s26
    v_mfma_f32_16x16x32_bf16 a[80:83], v[136:139], v[200:203], 0
    ds_read_b128 v[236:239], v3 offset:6144
    v_mfma_f32_16x16x32_bf16 a[88:91], v[136:139], v[204:207], 0
    v_mfma_f32_16x16x32_bf16 a[96:99], v[136:139], v[208:211], 0
    ds_read_b64_tr_b16 v[172:173], v7 offset:16384
    v_mfma_f32_16x16x32_bf16 a[104:107], v[136:139], v[212:215], 0
    v_mfma_f32_16x16x32_bf16 a[112:115], v[136:139], v[216:219], 0
    ds_read_b64_tr_b16 v[174:175], v7 offset:17408
    v_mfma_f32_16x16x32_bf16 a[120:123], v[136:139], v[220:223], 0
    v_mfma_f32_16x16x32_bf16 a[68:71], v[140:143], v[192:195], 0
    ds_read_b128 v[240:243], v3 offset:8192
    v_mfma_f32_16x16x32_bf16 a[76:79], v[140:143], v[196:199], 0
    v_mfma_f32_16x16x32_bf16 a[84:87], v[140:143], v[200:203], 0
    ds_read_b64_tr_b16 v[176:177], v8 offset:16384
    v_mfma_f32_16x16x32_bf16 a[92:95], v[140:143], v[204:207], 0
    v_mfma_f32_16x16x32_bf16 a[100:103], v[140:143], v[208:211], 0
    ds_read_b64_tr_b16 v[178:179], v8 offset:17408
    v_mfma_f32_16x16x32_bf16 a[108:111], v[140:143], v[212:215], 0
    v_mfma_f32_16x16x32_bf16 a[116:119], v[140:143], v[216:219], 0
    ds_read_b128 v[244:247], v3 offset:10240
    v_mfma_f32_16x16x32_bf16 a[124:127], v[140:143], v[220:223], 0
    v_mfma_f32_16x16x32_bf16 a[128:131], v[144:147], v[192:195], 0
    ds_read_b64_tr_b16 v[180:181], v9 offset:16384
    v_mfma_f32_16x16x32_bf16 a[136:139], v[144:147], v[196:199], 0
    v_mfma_f32_16x16x32_bf16 a[144:147], v[144:147], v[200:203], 0
    ds_read_b64_tr_b16 v[182:183], v9 offset:17408
    v_mfma_f32_16x16x32_bf16 a[152:155], v[144:147], v[204:207], 0
    v_mfma_f32_16x16x32_bf16 a[160:163], v[144:147], v[208:211], 0
    ds_read_b128 v[248:251], v3 offset:12288
    v_mfma_f32_16x16x32_bf16 a[168:171], v[144:147], v[212:215], 0
    v_mfma_f32_16x16x32_bf16 a[176:179], v[144:147], v[216:219], 0
    ds_read_b64_tr_b16 v[184:185], v10 offset:16384
    v_mfma_f32_16x16x32_bf16 a[184:187], v[144:147], v[220:223], 0
    v_mfma_f32_16x16x32_bf16 a[132:135], v[148:151], v[192:195], 0
    ds_read_b64_tr_b16 v[186:187], v10 offset:17408
    v_mfma_f32_16x16x32_bf16 a[140:143], v[148:151], v[196:199], 0
    v_mfma_f32_16x16x32_bf16 a[148:151], v[148:151], v[200:203], 0
    ds_read_b128 v[252:255], v3 offset:14336
    v_mfma_f32_16x16x32_bf16 a[156:159], v[148:151], v[204:207], 0
    v_mfma_f32_16x16x32_bf16 a[164:167], v[148:151], v[208:211], 0
    ds_read_b64_tr_b16 v[188:189], v11 offset:16384
    v_mfma_f32_16x16x32_bf16 a[172:175], v[148:151], v[212:215], 0
    v_mfma_f32_16x16x32_bf16 a[180:183], v[148:151], v[216:219], 0
    ds_read_b64_tr_b16 v[190:191], v11 offset:17408
    v_mfma_f32_16x16x32_bf16 a[188:191], v[148:151], v[220:223], 0
    v_mfma_f32_16x16x32_bf16 a[192:195], v[152:155], v[192:195], 0
    v_mfma_f32_16x16x32_bf16 a[200:203], v[152:155], v[196:199], 0
    v_mfma_f32_16x16x32_bf16 a[208:211], v[152:155], v[200:203], 0
    v_mfma_f32_16x16x32_bf16 a[216:219], v[152:155], v[204:207], 0
    v_mfma_f32_16x16x32_bf16 a[224:227], v[152:155], v[208:211], 0
    v_mfma_f32_16x16x32_bf16 a[232:235], v[152:155], v[212:215], 0
    v_mfma_f32_16x16x32_bf16 a[240:243], v[152:155], v[216:219], 0
    v_mfma_f32_16x16x32_bf16 a[248:251], v[152:155], v[220:223], 0
    v_mfma_f32_16x16x32_bf16 a[196:199], v[156:159], v[192:195], 0
    v_mfma_f32_16x16x32_bf16 a[204:207], v[156:159], v[196:199], 0
    v_mfma_f32_16x16x32_bf16 a[212:215], v[156:159], v[200:203], 0
    v_mfma_f32_16x16x32_bf16 a[220:223], v[156:159], v[204:207], 0
    v_mfma_f32_16x16x32_bf16 a[228:231], v[156:159], v[208:211], 0
    v_mfma_f32_16x16x32_bf16 a[236:239], v[156:159], v[212:215], 0
    v_mfma_f32_16x16x32_bf16 a[244:247], v[156:159], v[216:219], 0
    s_waitcnt vmcnt(8) lgkmcnt(0)
    s_barrier
    v_mfma_f32_16x16x32_bf16 a[252:255], v[156:159], v[220:223], 0
    s_branch g1_244
g0_245:
    s_cmp_lg_u32 s27, 2
    s_cbranch_scc1 ge_247
    v_mov_b32 v102, 64
    buffer_load_dwordx2 v[100:101], v102, s[48:51], 0 offen sc1
ge_247:
    s_cmp_lg_u32 s27, 1
    s_cbranch_scc1 gns_246
    s_cmp_lt_u32 s67, 3
    s_cbranch_scc1 sqg_250
    s_mov_b32 s77, 0
psg_251:
    v_readfirstlane_b32 s76, v100
    v_readfirstlane_b32 s46, v101
    s_cmp_ge_u32 s76, 128
    s_cbranch_scc1 pkg_252
    v_mov_b32 v102, 64
    buffer_load_dwordx2 v[100:101], v102, s[48:51], 0 offen sc1
    s_add_u32 s77, s77, 1
    s_cmp_ge_u32 s77, 0x20000
    s_cbranch_scc1 L_fb
    s_waitcnt vmcnt(0)
    s_branch psg_251
pkg_252:
    s_lshl_b32 s74, s68, 1
    s_add_u32 s74, s74, s22
    s_lshl_b32 s74, s74, 9
    s_add_u32 s74, s74, 0x7000000
    v_lshlrev_b32 v28, 2, v24
    buffer_load_dword v112, v28, s[8:11], s74 offen offset:0 sc1
    buffer_load_dword v113, v28, s[8:11], s74 offen offset:64 sc1
    buffer_load_dword v114, v28, s[8:11], s74 offen offset:128 sc1
    buffer_load_dword v115, v28, s[8:11], s74 offen offset:192 sc1
    buffer_load_dword v116, v28, s[8:11], s74 offen offset:256 sc1
    buffer_load_dword v117, v28, s[8:11], s74 offen offset:320 sc1
    buffer_load_dword v118, v28, s[8:11], s74 offen offset:384 sc1
    buffer_load_dword v119, v28, s[8:11], s74 offen offset:448 sc1
sqg_250:
    s_cmp_lg_u32 s66, 0
    s_cbranch_scc1 d1g_254
    s_and_b32 s71, s65, 3
    s_add_u32 s71, s71, 1
    s_lshr_b32 s74, s65, 2
dkvg_261:
    s_lshl_b32 s72, s64, 3
    s_add_u32 s72, s72, s74
    s_lshr_b32 s70, s72, 4
    s_and_b32 s72, s72, 15
    s_branch ddg_263
d1g_254:
    s_cmp_lg_u32 s66, 1
    s_cbranch_scc1 d2g_255
    s_mul_i32 s74, s65, 43
    s_lshr_b32 s74, s74, 7
    s_mul_i32 s75, s74, 3
    s_sub_u32 s71, s65, s75
    s_add_u32 s71, s71, 5
    s_cmp_lt_u32 s65, 24
    s_cbranch_scc1 dkvg_261
    s_mov_b32 s72, s64
    s_branch d6g_259
d2g_255:
    s_lshr_b32 s74, s65, 3
    s_cmp_lg_u32 s66, 2
    s_cbranch_scc1 d3g_256
    s_lshl_b32 s72, s64, 2
    s_add_u32 s74, s74, 4
    s_add_u32 s72, s72, s74
    s_branch d6g_259
d3g_256:
    s_cmp_lg_u32 s66, 3
    s_cbranch_scc1 d4g_257
    s_bitcmp1_b32 s64, 0
    s_cbranch_scc1 dqg_262
    s_lshl_b32 s72, s64, 1
    s_add_u32 s74, s74, 20
    s_add_u32 s72, s72, s74
d6g_259:
    s_and_b32 s71, s65, 7
    s_mov_b32 s70, 4
    s_branch ddg_263
dqg_262:
    s_lshr_b32 s72, s64, 1
    s_lshl_b32 s72, s72, 3
    s_lshr_b32 s74, s65, 2
    s_add_u32 s72, s72, s74
    s_and_b32 s71, s65, 3
    s_mov_b32 s70, 3
    s_branch ddg_263
d4g_257:
    s_cmp_lg_u32 s66, 4
    s_cbranch_scc1 dng_264
    s_cmp_ge_u32 s64, 2
    s_cbranch_scc1 dng_264
    s_and_b32 s72, s65, 15
    s_lshr_b32 s74, s65, 4
    s_lshl_b32 s71, s64, 1
    s_add_u32 s74, s74, 4
    s_add_u32 s71, s71, s74
    s_cmp_eq_u32 s64, 0
    s_cselect_b32 s70, 3, 2
    s_branch ddg_263
dng_264:
    s_mov_b32 s70, 5
ddg_263:
    s_cmp_eq_u32 s70, 5
    s_cbranch_scc1 sng_248
    s_mov_b32 s12, s52
    s_mov_b32 s13, s53
    s_mov_b32 s14, 0x400000
    s_mov_b32 s15, 0x20000
    s_lshl_b32 s74, s71, 8
    s_lshl_b32 s30, s20, 6
    s_add_u32 s30, s30, s74
    v_lshrrev_b32 v28, 3, v1
    v_add_u32 v28, s30, v28
    v_lshlrev_b32 v28, 11, v28
    v_and_b32 v29, 7, v1
    v_xor_b32 v29, v29, v25
    v_xor_b32 v30, 0, v29
    v_lshl_add_u32 v12, v30, 4, v28
    v_xor_b32 v30, 4, v29
    v_lshl_add_u32 v13, v30, 4, v28
    v_add_u32 v13, 0x3c00, v13
    v_xor_b32 v30, 0, v29
    v_lshl_add_u32 v14, v30, 4, v28
    v_add_u32 v14, 0x7800, v14
    v_xor_b32 v30, 4, v29
    v_lshl_add_u32 v15, v30, 4, v28
    v_add_u32 v15, 0xb400, v15
    v_xor_b32 v30, 0, v29
    v_lshl_add_u32 v16, v30, 4, v28
    v_add_u32 v16, 0x10000, v16
    v_xor_b32 v30, 4, v29
    v_lshl_add_u32 v17, v30, 4, v28
    v_add_u32 v17, 0x13c00, v17
    v_xor_b32 v30, 0, v29
    v_lshl_add_u32 v18, v30, 4, v28
    v_add_u32 v18, 0x17800, v18
    v_xor_b32 v30, 4, v29
    v_lshl_add_u32 v19, v30, 4, v28
    v_add_u32 v19, 0x1b400, v19
    s_mov_b32 s25, 128
    s_mov_b32 s23, 0
    s_mov_b32 s24, 0
    s_cmp_eq_u32 s70, 4
    s_cbranch_scc1 thg_265
    s_mov_b32 s16, s54
    s_mov_b32 s17, s55
    s_mov_b32 s18, 0x800000
    s_mov_b32 s19, 0x20000
    s_cmp_ge_u32 s70, 2
    s_cbranch_scc1 twg_268
    s_mov_b32 s16, s60
    s_mov_b32 s17, s61
    s_mov_b32 s18, 0x800000
    s_mov_b32 s19, 0x20000
    s_cmp_eq_u32 s70, 0
    s_cbranch_scc1 twg_268
    s_mov_b32 s16, s62
    s_mov_b32 s17, s63
    s_mov_b32 s18, 0x800000
    s_mov_b32 s19, 0x20000
twg_268:
    s_lshl_b32 s74, s72, 9
    s_lshl_b32 s75, s22, 8
    s_add_u32 s74, s74, s75
    v_lshlrev_b32 v30, 1, v25
    v_xor_b32 v29, v24, v30
    s_lshl_b32 s30, s21, 4
    v_add_u32 v28, s30, v25
    s_mov_b32 s30, 8192
    v_mul_lo_u32 v28, v28, s30
    v_add_u32 v28, s74, v28
    v_xor_b32 v30, 0, v29
    v_lshl_add_u32 v20, v30, 4, v28
    v_xor_b32 v30, 0, v29
    v_lshl_add_u32 v21, v30, 4, v28
    v_add_u32 v21, 0x7c00, v21
    v_xor_b32 v30, 8, v29
    v_lshl_add_u32 v22, v30, 4, v28
    v_add_u32 v22, 0xf800, v22
    v_xor_b32 v30, 8, v29
    v_lshl_add_u32 v23, v30, 4, v28
    v_add_u32 v23, 0x17400, v23
    s_mov_b32 s26, 262144
    s_branch tdg_267
thg_265:
    s_mov_b32 s16, s56
    s_mov_b32 s17, s57
    s_mov_b32 s18, 0x700000
    s_mov_b32 s19, 0x20000
    s_cmp_eq_u32 s22, 0
    s_cbranch_scc1 tug_266
    s_mov_b32 s16, s58
    s_mov_b32 s17, s59
    s_mov_b32 s18, 0x700000
    s_mov_b32 s19, 0x20000
tug_266:
    s_lshl_b32 s74, s72, 8
    v_lshlrev_b32 v30, 1, v25
    v_xor_b32 v29, v24, v30
    s_lshl_b32 s30, s21, 4
    v_add_u32 v28, s30, v25
    s_mov_b32 s30, 7168
    v_mul_lo_u32 v28, v28, s30
    v_add_u32 v28, s74, v28
    v_xor_b32 v30, 0, v29
    v_lshl_add_u32 v20, v30, 4, v28
    v_xor_b32 v30, 0, v29
    v_lshl_add_u32 v21, v30, 4, v28
    v_add_u32 v21, 0x6c00, v21
    v_xor_b32 v30, 8, v29
    v_lshl_add_u32 v22, v30, 4, v28
    v_add_u32 v22, 0xd800, v22
    v_xor_b32 v30, 8, v29
    v_lshl_add_u32 v23, v30, 4, v28
    v_add_u32 v23, 0x14400, v23
    s_mov_b32 s26, 229376
tdg_267:
    s_branch ssg_249
sng_248:
    s_mov_b32 s14, 0
    s_mov_b32 s18, 0
ssg_249:
gns_246:
    v_mfma_f32_16x16x32_bf16 a[0:3], v[128:131], v[192:195], a[0:3]
    ds_read_b128 v[224:227], v3 offset:0
    v_mfma_f32_16x16x32_bf16 a[8:11], v[128:131], v[196:199], a[8:11]
    s_add_u32 m0, s29, 0x0
    v_mfma_f32_16x16x32_bf16 a[16:19], v[128:131], v[200:203], a[16:19]
    ds_read_b64_tr_b16 v[160:161], v4 offset:16384
    v_mfma_f32_16x16x32_bf16 a[24:27], v[128:131], v[204:207], a[24:27]
    buffer_load_dwordx4 v20, s[16:19], s24 offen offset:0 lds
    v_mfma_f32_16x16x32_bf16 a[32:35], v[128:131], v[208:211], a[32:35]
    ds_read_b64_tr_b16 v[162:163], v4 offset:17408
    v_mfma_f32_16x16x32_bf16 a[40:43], v[128:131], v[212:215], a[40:43]
    v_mfma_f32_16x16x32_bf16 a[48:51], v[128:131], v[216:219], a[48:51]
    ds_read_b128 v[228:231], v3 offset:2048
    v_mfma_f32_16x16x32_bf16 a[56:59], v[128:131], v[220:223], a[56:59]
    buffer_load_dwordx4 v21, s[16:19], s24 offen offset:1024 lds
    v_mfma_f32_16x16x32_bf16 a[4:7], v[132:135], v[192:195], a[4:7]
    ds_read_b64_tr_b16 v[164:165], v5 offset:16384
    v_mfma_f32_16x16x32_bf16 a[12:15], v[132:135], v[196:199], a[12:15]
    v_mfma_f32_16x16x32_bf16 a[20:23], v[132:135], v[200:203], a[20:23]
    ds_read_b64_tr_b16 v[166:167], v5 offset:17408
    v_mfma_f32_16x16x32_bf16 a[28:31], v[132:135], v[204:207], a[28:31]
    buffer_load_dwordx4 v22, s[16:19], s24 offen offset:2048 lds
    v_mfma_f32_16x16x32_bf16 a[36:39], v[132:135], v[208:211], a[36:39]
    ds_read_b128 v[232:235], v3 offset:4096
    v_mfma_f32_16x16x32_bf16 a[44:47], v[132:135], v[212:215], a[44:47]
    v_mfma_f32_16x16x32_bf16 a[52:55], v[132:135], v[216:219], a[52:55]
    ds_read_b64_tr_b16 v[168:169], v6 offset:16384
    v_mfma_f32_16x16x32_bf16 a[60:63], v[132:135], v[220:223], a[60:63]
    buffer_load_dwordx4 v23, s[16:19], s24 offen offset:3072 lds
    v_mfma_f32_16x16x32_bf16 a[64:67], v[136:139], v[192:195], a[64:67]
    ds_read_b64_tr_b16 v[170:171], v6 offset:17408
    v_mfma_f32_16x16x32_bf16 a[72:75], v[136:139], v[196:199], a[72:75]
    s_add_u32 s24, s24, s26
    v_mfma_f32_16x16x32_bf16 a[80:83], v[136:139], v[200:203], a[80:83]
    ds_read_b128 v[236:239], v3 offset:6144
    v_mfma_f32_16x16x32_bf16 a[88:91], v[136:139], v[204:207], a[88:91]
    v_mfma_f32_16x16x32_bf16 a[96:99], v[136:139], v[208:211], a[96:99]
    ds_read_b64_tr_b16 v[172:173], v7 offset:16384
    v_mfma_f32_16x16x32_bf16 a[104:107], v[136:139], v[212:215], a[104:107]
    v_mfma_f32_16x16x32_bf16 a[112:115], v[136:139], v[216:219], a[112:115]
    ds_read_b64_tr_b16 v[174:175], v7 offset:17408
    v_mfma_f32_16x16x32_bf16 a[120:123], v[136:139], v[220:223], a[120:123]
    v_mfma_f32_16x16x32_bf16 a[68:71], v[140:143], v[192:195], a[68:71]
    ds_read_b128 v[240:243], v3 offset:8192
    v_mfma_f32_16x16x32_bf16 a[76:79], v[140:143], v[196:199], a[76:79]
    v_mfma_f32_16x16x32_bf16 a[84:87], v[140:143], v[200:203], a[84:87]
    ds_read_b64_tr_b16 v[176:177], v8 offset:16384
    v_mfma_f32_16x16x32_bf16 a[92:95], v[140:143], v[204:207], a[92:95]
    v_mfma_f32_16x16x32_bf16 a[100:103], v[140:143], v[208:211], a[100:103]
    ds_read_b64_tr_b16 v[178:179], v8 offset:17408
    v_mfma_f32_16x16x32_bf16 a[108:111], v[140:143], v[212:215], a[108:111]
    v_mfma_f32_16x16x32_bf16 a[116:119], v[140:143], v[216:219], a[116:119]
    ds_read_b128 v[244:247], v3 offset:10240
    v_mfma_f32_16x16x32_bf16 a[124:127], v[140:143], v[220:223], a[124:127]
    v_mfma_f32_16x16x32_bf16 a[128:131], v[144:147], v[192:195], a[128:131]
    ds_read_b64_tr_b16 v[180:181], v9 offset:16384
    v_mfma_f32_16x16x32_bf16 a[136:139], v[144:147], v[196:199], a[136:139]
    v_mfma_f32_16x16x32_bf16 a[144:147], v[144:147], v[200:203], a[144:147]
    ds_read_b64_tr_b16 v[182:183], v9 offset:17408
    v_mfma_f32_16x16x32_bf16 a[152:155], v[144:147], v[204:207], a[152:155]
    v_mfma_f32_16x16x32_bf16 a[160:163], v[144:147], v[208:211], a[160:163]
    ds_read_b128 v[248:251], v3 offset:12288
    v_mfma_f32_16x16x32_bf16 a[168:171], v[144:147], v[212:215], a[168:171]
    v_mfma_f32_16x16x32_bf16 a[176:179], v[144:147], v[216:219], a[176:179]
    ds_read_b64_tr_b16 v[184:185], v10 offset:16384
    v_mfma_f32_16x16x32_bf16 a[184:187], v[144:147], v[220:223], a[184:187]
    v_mfma_f32_16x16x32_bf16 a[132:135], v[148:151], v[192:195], a[132:135]
    ds_read_b64_tr_b16 v[186:187], v10 offset:17408
    v_mfma_f32_16x16x32_bf16 a[140:143], v[148:151], v[196:199], a[140:143]
    v_mfma_f32_16x16x32_bf16 a[148:151], v[148:151], v[200:203], a[148:151]
    ds_read_b128 v[252:255], v3 offset:14336
    v_mfma_f32_16x16x32_bf16 a[156:159], v[148:151], v[204:207], a[156:159]
    v_mfma_f32_16x16x32_bf16 a[164:167], v[148:151], v[208:211], a[164:167]
    ds_read_b64_tr_b16 v[188:189], v11 offset:16384
    v_mfma_f32_16x16x32_bf16 a[172:175], v[148:151], v[212:215], a[172:175]
    v_mfma_f32_16x16x32_bf16 a[180:183], v[148:151], v[216:219], a[180:183]
    ds_read_b64_tr_b16 v[190:191], v11 offset:17408
    v_mfma_f32_16x16x32_bf16 a[188:191], v[148:151], v[220:223], a[188:191]
    v_mfma_f32_16x16x32_bf16 a[192:195], v[152:155], v[192:195], a[192:195]
    v_mfma_f32_16x16x32_bf16 a[200:203], v[152:155], v[196:199], a[200:203]
    v_mfma_f32_16x16x32_bf16 a[208:211], v[152:155], v[200:203], a[208:211]
    v_mfma_f32_16x16x32_bf16 a[216:219], v[152:155], v[204:207], a[216:219]
    v_mfma_f32_16x16x32_bf16 a[224:227], v[152:155], v[208:211], a[224:227]
    v_mfma_f32_16x16x32_bf16 a[232:235], v[152:155], v[212:215], a[232:235]
    v_mfma_f32_16x16x32_bf16 a[240:243], v[152:155], v[216:219], a[240:243]
    v_mfma_f32_16x16x32_bf16 a[248:251], v[152:155], v[220:223], a[248:251]
    v_mfma_f32_16x16x32_bf16 a[196:199], v[156:159], v[192:195], a[196:199]
    v_mfma_f32_16x16x32_bf16 a[204:207], v[156:159], v[196:199], a[204:207]
    v_mfma_f32_16x16x32_bf16 a[212:215], v[156:159], v[200:203], a[212:215]
    v_mfma_f32_16x16x32_bf16 a[220:223], v[156:159], v[204:207], a[220:223]
    v_mfma_f32_16x16x32_bf16 a[228:231], v[156:159], v[208:211], a[228:231]
    v_mfma_f32_16x16x32_bf16 a[236:239], v[156:159], v[212:215], a[236:239]
    v_mfma_f32_16x16x32_bf16 a[244:247], v[156:159], v[216:219], a[244:247]
    s_waitcnt vmcnt(8) lgkmcnt(0)
    s_barrier
    v_mfma_f32_16x16x32_bf16 a[252:255], v[156:159], v[220:223], a[252:255]
g1_244:
    v_mfma_f32_16x16x32_bf16 a[0:3], v[160:163], v[224:227], a[0:3]
    ds_read_b128 v[192:195], v2 offset:32768
    v_mfma_f32_16x16x32_bf16 a[8:11], v[160:163], v[228:231], a[8:11]
    s_add_u32 m0, s28, 0x0
    v_mfma_f32_16x16x32_bf16 a[16:19], v[160:163], v[232:235], a[16:19]
    ds_read_b64_tr_b16 v[128:129], v4 offset:32768
    v_mfma_f32_16x16x32_bf16 a[24:27], v[160:163], v[236:239], a[24:27]
    buffer_load_dwordx4 v12, s[12:15], s23 offen offset:0 lds
    v_mfma_f32_16x16x32_bf16 a[32:35], v[160:163], v[240:243], a[32:35]
    ds_read_b64_tr_b16 v[130:131], v4 offset:33792
    v_mfma_f32_16x16x32_bf16 a[40:43], v[160:163], v[244:247], a[40:43]
    v_mfma_f32_16x16x32_bf16 a[48:51], v[160:163], v[248:251], a[48:51]
    ds_read_b128 v[196:199], v2 offset:34816
    v_mfma_f32_16x16x32_bf16 a[56:59], v[160:163], v[252:255], a[56:59]
    buffer_load_dwordx4 v13, s[12:15], s23 offen offset:1024 lds
    v_mfma_f32_16x16x32_bf16 a[4:7], v[164:167], v[224:227], a[4:7]
    ds_read_b64_tr_b16 v[132:133], v5 offset:32768
    v_mfma_f32_16x16x32_bf16 a[12:15], v[164:167], v[228:231], a[12:15]
    v_mfma_f32_16x16x32_bf16 a[20:23], v[164:167], v[232:235], a[20:23]
    ds_read_b64_tr_b16 v[134:135], v5 offset:33792
    v_mfma_f32_16x16x32_bf16 a[28:31], v[164:167], v[236:239], a[28:31]
    buffer_load_dwordx4 v14, s[12:15], s23 offen offset:2048 lds
    v_mfma_f32_16x16x32_bf16 a[36:39], v[164:167], v[240:243], a[36:39]
    ds_read_b128 v[200:203], v2 offset:36864
    v_mfma_f32_16x16x32_bf16 a[44:47], v[164:167], v[244:247], a[44:47]
    v_mfma_f32_16x16x32_bf16 a[52:55], v[164:167], v[248:251], a[52:55]
    ds_read_b64_tr_b16 v[136:137], v6 offset:32768
    v_mfma_f32_16x16x32_bf16 a[60:63], v[164:167], v[252:255], a[60:63]
    buffer_load_dwordx4 v15, s[12:15], s23 offen offset:3072 lds
    v_mfma_f32_16x16x32_bf16 a[64:67], v[168:171], v[224:227], a[64:67]
    ds_read_b64_tr_b16 v[138:139], v6 offset:33792
    v_mfma_f32_16x16x32_bf16 a[72:75], v[168:171], v[228:231], a[72:75]
    s_add_u32 m0, s28, 0x1000
    v_mfma_f32_16x16x32_bf16 a[80:83], v[168:171], v[232:235], a[80:83]
    ds_read_b128 v[204:207], v2 offset:38912
    v_mfma_f32_16x16x32_bf16 a[88:91], v[168:171], v[236:239], a[88:91]
    buffer_load_dwordx4 v16, s[12:15], s23 offen offset:0 lds
    v_mfma_f32_16x16x32_bf16 a[96:99], v[168:171], v[240:243], a[96:99]
    ds_read_b64_tr_b16 v[140:141], v7 offset:32768
    v_mfma_f32_16x16x32_bf16 a[104:107], v[168:171], v[244:247], a[104:107]
    v_mfma_f32_16x16x32_bf16 a[112:115], v[168:171], v[248:251], a[112:115]
    ds_read_b64_tr_b16 v[142:143], v7 offset:33792
    v_mfma_f32_16x16x32_bf16 a[120:123], v[168:171], v[252:255], a[120:123]
    buffer_load_dwordx4 v17, s[12:15], s23 offen offset:1024 lds
    v_mfma_f32_16x16x32_bf16 a[68:71], v[172:175], v[224:227], a[68:71]
    ds_read_b128 v[208:211], v2 offset:40960
    v_mfma_f32_16x16x32_bf16 a[76:79], v[172:175], v[228:231], a[76:79]
    v_mfma_f32_16x16x32_bf16 a[84:87], v[172:175], v[232:235], a[84:87]
    ds_read_b64_tr_b16 v[144:145], v8 offset:32768
    v_mfma_f32_16x16x32_bf16 a[92:95], v[172:175], v[236:239], a[92:95]
    buffer_load_dwordx4 v18, s[12:15], s23 offen offset:2048 lds
    v_mfma_f32_16x16x32_bf16 a[100:103], v[172:175], v[240:243], a[100:103]
    ds_read_b64_tr_b16 v[146:147], v8 offset:33792
    v_mfma_f32_16x16x32_bf16 a[108:111], v[172:175], v[244:247], a[108:111]
    v_mfma_f32_16x16x32_bf16 a[116:119], v[172:175], v[248:251], a[116:119]
    ds_read_b128 v[212:215], v2 offset:43008
    v_mfma_f32_16x16x32_bf16 a[124:127], v[172:175], v[252:255], a[124:127]
    buffer_load_dwordx4 v19, s[12:15], s23 offen offset:3072 lds
    v_mfma_f32_16x16x32_bf16 a[128:131], v[176:179], v[224:227], a[128:131]
    ds_read_b64_tr_b16 v[148:149], v9 offset:32768
    v_mfma_f32_16x16x32_bf16 a[136:139], v[176:179], v[228:231], a[136:139]
    s_add_u32 s23, s23, s25
    s_add_u32 m0, s29, 0x4000
    v_mfma_f32_16x16x32_bf16 a[144:147], v[176:179], v[232:235], a[144:147]
    ds_read_b64_tr_b16 v[150:151], v9 offset:33792
    v_mfma_f32_16x16x32_bf16 a[152:155], v[176:179], v[236:239], a[152:155]
    buffer_load_dwordx4 v20, s[16:19], s24 offen offset:0 lds
    v_mfma_f32_16x16x32_bf16 a[160:163], v[176:179], v[240:243], a[160:163]
    ds_read_b128 v[216:219], v2 offset:45056
    v_mfma_f32_16x16x32_bf16 a[168:171], v[176:179], v[244:247], a[168:171]
    v_mfma_f32_16x16x32_bf16 a[176:179], v[176:179], v[248:251], a[176:179]
    ds_read_b64_tr_b16 v[152:153], v10 offset:32768
    v_mfma_f32_16x16x32_bf16 a[184:187], v[176:179], v[252:255], a[184:187]
    buffer_load_dwordx4 v21, s[16:19], s24 offen offset:1024 lds
    v_mfma_f32_16x16x32_bf16 a[132:135], v[180:183], v[224:227], a[132:135]
    ds_read_b64_tr_b16 v[154:155], v10 offset:33792
    v_mfma_f32_16x16x32_bf16 a[140:143], v[180:183], v[228:231], a[140:143]
    v_mfma_f32_16x16x32_bf16 a[148:151], v[180:183], v[232:235], a[148:151]
    ds_read_b128 v[220:223], v2 offset:47104
    v_mfma_f32_16x16x32_bf16 a[156:159], v[180:183], v[236:239], a[156:159]
    buffer_load_dwordx4 v22, s[16:19], s24 offen offset:2048 lds
    v_mfma_f32_16x16x32_bf16 a[164:167], v[180:183], v[240:243], a[164:167]
    ds_read_b64_tr_b16 v[156:157], v11 offset:32768
    v_mfma_f32_16x16x32_bf16 a[172:175], v[180:183], v[244:247], a[172:175]
    v_mfma_f32_16x16x32_bf16 a[180:183], v[180:183], v[248:251], a[180:183]
    ds_read_b64_tr_b16 v[158:159], v11 offset:33792
    v_mfma_f32_16x16x32_bf16 a[188:191], v[180:183], v[252:255], a[188:191]
    buffer_load_dwordx4 v23, s[16:19], s24 offen offset:3072 lds
    v_mfma_f32_16x16x32_bf16 a[192:195], v[184:187], v[224:227], a[192:195]
    v_mfma_f32_16x16x32_bf16 a[200:203], v[184:187], v[228:231], a[200:203]
    s_add_u32 s24, s24, s26
    v_mfma_f32_16x16x32_bf16 a[208:211], v[184:187], v[232:235], a[208:211]
    v_mfma_f32_16x16x32_bf16 a[216:219], v[184:187], v[236:239], a[216:219]
    v_mfma_f32_16x16x32_bf16 a[224:227], v[184:187], v[240:243], a[224:227]
    v_mfma_f32_16x16x32_bf16 a[232:235], v[184:187], v[244:247], a[232:235]
    v_mfma_f32_16x16x32_bf16 a[240:243], v[184:187], v[248:251], a[240:243]
    v_mfma_f32_16x16x32_bf16 a[248:251], v[184:187], v[252:255], a[248:251]
    v_mfma_f32_16x16x32_bf16 a[196:199], v[188:191], v[224:227], a[196:199]
    v_mfma_f32_16x16x32_bf16 a[204:207], v[188:191], v[228:231], a[204:207]
    v_mfma_f32_16x16x32_bf16 a[212:215], v[188:191], v[232:235], a[212:215]
    v_mfma_f32_16x16x32_bf16 a[220:223], v[188:191], v[236:239], a[220:223]
    v_mfma_f32_16x16x32_bf16 a[228:231], v[188:191], v[240:243], a[228:231]
    v_mfma_f32_16x16x32_bf16 a[236:239], v[188:191], v[244:247], a[236:239]
    v_mfma_f32_16x16x32_bf16 a[244:247], v[188:191], v[248:251], a[244:247]
    s_waitcnt vmcnt(16) lgkmcnt(0)
    s_barrier
    v_mfma_f32_16x16x32_bf16 a[252:255], v[188:191], v[252:255], a[252:255]
    v_mfma_f32_16x16x32_bf16 a[0:3], v[128:131], v[192:195], a[0:3]
    ds_read_b128 v[224:227], v3 offset:32768
    v_mfma_f32_16x16x32_bf16 a[8:11], v[128:131], v[196:199], a[8:11]
    s_add_u32 m0, s29, 0x8000
    v_mfma_f32_16x16x32_bf16 a[16:19], v[128:131], v[200:203], a[16:19]
    ds_read_b64_tr_b16 v[160:161], v4 offset:49152
    v_mfma_f32_16x16x32_bf16 a[24:27], v[128:131], v[204:207], a[24:27]
    buffer_load_dwordx4 v20, s[16:19], s24 offen offset:0 lds
    v_mfma_f32_16x16x32_bf16 a[32:35], v[128:131], v[208:211], a[32:35]
    ds_read_b64_tr_b16 v[162:163], v4 offset:50176
    v_mfma_f32_16x16x32_bf16 a[40:43], v[128:131], v[212:215], a[40:43]
    v_mfma_f32_16x16x32_bf16 a[48:51], v[128:131], v[216:219], a[48:51]
    ds_read_b128 v[228:231], v3 offset:34816
    v_mfma_f32_16x16x32_bf16 a[56:59], v[128:131], v[220:223], a[56:59]
    buffer_load_dwordx4 v21, s[16:19], s24 offen offset:1024 lds
    v_mfma_f32_16x16x32_bf16 a[4:7], v[132:135], v[192:195], a[4:7]
    ds_read_b64_tr_b16 v[164:165], v5 offset:49152
    v_mfma_f32_16x16x32_bf16 a[12:15], v[132:135], v[196:199], a[12:15]
    v_mfma_f32_16x16x32_bf16 a[20:23], v[132:135], v[200:203], a[20:23]
    ds_read_b64_tr_b16 v[166:167], v5 offset:50176
    v_mfma_f32_16x16x32_bf16 a[28:31], v[132:135], v[204:207], a[28:31]
    buffer_load_dwordx4 v22, s[16:19], s24 offen offset:2048 lds
    v_mfma_f32_16x16x32_bf16 a[36:39], v[132:135], v[208:211], a[36:39]
    ds_read_b128 v[232:235], v3 offset:36864
    v_mfma_f32_16x16x32_bf16 a[44:47], v[132:135], v[212:215], a[44:47]
    v_mfma_f32_16x16x32_bf16 a[52:55], v[132:135], v[216:219], a[52:55]
    ds_read_b64_tr_b16 v[168:169], v6 offset:49152
    v_mfma_f32_16x16x32_bf16 a[60:63], v[132:135], v[220:223], a[60:63]
    buffer_load_dwordx4 v23, s[16:19], s24 offen offset:3072 lds
    v_mfma_f32_16x16x32_bf16 a[64:67], v[136:139], v[192:195], a[64:67]
    ds_read_b64_tr_b16 v[170:171], v6 offset:50176
    v_mfma_f32_16x16x32_bf16 a[72:75], v[136:139], v[196:199], a[72:75]
    s_add_u32 s24, s24, s26
    v_mfma_f32_16x16x32_bf16 a[80:83], v[136:139], v[200:203], a[80:83]
    ds_read_b128 v[236:239], v3 offset:38912
    v_mfma_f32_16x16x32_bf16 a[88:91], v[136:139], v[204:207], a[88:91]
    v_mfma_f32_16x16x32_bf16 a[96:99], v[136:139], v[208:211], a[96:99]
    ds_read_b64_tr_b16 v[172:173], v7 offset:49152
    v_mfma_f32_16x16x32_bf16 a[104:107], v[136:139], v[212:215], a[104:107]
    v_mfma_f32_16x16x32_bf16 a[112:115], v[136:139], v[216:219], a[112:115]
    ds_read_b64_tr_b16 v[174:175], v7 offset:50176
    v_mfma_f32_16x16x32_bf16 a[120:123], v[136:139], v[220:223], a[120:123]
    v_mfma_f32_16x16x32_bf16 a[68:71], v[140:143], v[192:195], a[68:71]
    ds_read_b128 v[240:243], v3 offset:40960
    v_mfma_f32_16x16x32_bf16 a[76:79], v[140:143], v[196:199], a[76:79]
    v_mfma_f32_16x16x32_bf16 a[84:87], v[140:143], v[200:203], a[84:87]
    ds_read_b64_tr_b16 v[176:177], v8 offset:49152
    v_mfma_f32_16x16x32_bf16 a[92:95], v[140:143], v[204:207], a[92:95]
    v_mfma_f32_16x16x32_bf16 a[100:103], v[140:143], v[208:211], a[100:103]
    ds_read_b64_tr_b16 v[178:179], v8 offset:50176
    v_mfma_f32_16x16x32_bf16 a[108:111], v[140:143], v[212:215], a[108:111]
    v_mfma_f32_16x16x32_bf16 a[116:119], v[140:143], v[216:219], a[116:119]
    ds_read_b128 v[244:247], v3 offset:43008
    v_mfma_f32_16x16x32_bf16 a[124:127], v[140:143], v[220:223], a[124:127]
    v_mfma_f32_16x16x32_bf16 a[128:131], v[144:147], v[192:195], a[128:131]
    ds_read_b64_tr_b16 v[180:181], v9 offset:49152
    v_mfma_f32_16x16x32_bf16 a[136:139], v[144:147], v[196:199], a[136:139]
    v_mfma_f32_16x16x32_bf16 a[144:147], v[144:147], v[200:203], a[144:147]
    ds_read_b64_tr_b16 v[182:183], v9 offset:50176
    v_mfma_f32_16x16x32_bf16 a[152:155], v[144:147], v[204:207], a[152:155]
    v_mfma_f32_16x16x32_bf16 a[160:163], v[144:147], v[208:211], a[160:163]
    ds_read_b128 v[248:251], v3 offset:45056
    v_mfma_f32_16x16x32_bf16 a[168:171], v[144:147], v[212:215], a[168:171]
    v_mfma_f32_16x16x32_bf16 a[176:179], v[144:147], v[216:219], a[176:179]
    ds_read_b64_tr_b16 v[184:185], v10 offset:49152
    v_mfma_f32_16x16x32_bf16 a[184:187], v[144:147], v[220:223], a[184:187]
    v_mfma_f32_16x16x32_bf16 a[132:135], v[148:151], v[192:195], a[132:135]
    ds_read_b64_tr_b16 v[186:187], v10 offset:50176
    v_mfma_f32_16x16x32_bf16 a[140:143], v[148:151], v[196:199], a[140:143]
    v_mfma_f32_16x16x32_bf16 a[148:151], v[148:151], v[200:203], a[148:151]
    ds_read_b128 v[252:255], v3 offset:47104
    v_mfma_f32_16x16x32_bf16 a[156:159], v[148:151], v[204:207], a[156:159]
    v_mfma_f32_16x16x32_bf16 a[164:167], v[148:151], v[208:211], a[164:167]
    ds_read_b64_tr_b16 v[188:189], v11 offset:49152
    v_mfma_f32_16x16x32_bf16 a[172:175], v[148:151], v[212:215], a[172:175]
    v_mfma_f32_16x16x32_bf16 a[180:183], v[148:151], v[216:219], a[180:183]
    ds_read_b64_tr_b16 v[190:191], v11 offset:50176
    v_mfma_f32_16x16x32_bf16 a[188:191], v[148:151], v[220:223], a[188:191]
    v_mfma_f32_16x16x32_bf16 a[192:195], v[152:155], v[192:195], a[192:195]
    v_mfma_f32_16x16x32_bf16 a[200:203], v[152:155], v[196:199], a[200:203]
    v_mfma_f32_16x16x32_bf16 a[208:211], v[152:155], v[200:203], a[208:211]
    v_mfma_f32_16x16x32_bf16 a[216:219], v[152:155], v[204:207], a[216:219]
    v_mfma_f32_16x16x32_bf16 a[224:227], v[152:155], v[208:211], a[224:227]
    v_mfma_f32_16x16x32_bf16 a[232:235], v[152:155], v[212:215], a[232:235]
    v_mfma_f32_16x16x32_bf16 a[240:243], v[152:155], v[216:219], a[240:243]
    v_mfma_f32_16x16x32_bf16 a[248:251], v[152:155], v[220:223], a[248:251]
    v_mfma_f32_16x16x32_bf16 a[196:199], v[156:159], v[192:195], a[196:199]
    v_mfma_f32_16x16x32_bf16 a[204:207], v[156:159], v[196:199], a[204:207]
    v_mfma_f32_16x16x32_bf16 a[212:215], v[156:159], v[200:203], a[212:215]
    v_mfma_f32_16x16x32_bf16 a[220:223], v[156:159], v[204:207], a[220:223]
    v_mfma_f32_16x16x32_bf16 a[228:231], v[156:159], v[208:211], a[228:231]
    v_mfma_f32_16x16x32_bf16 a[236:239], v[156:159], v[212:215], a[236:239]
    v_mfma_f32_16x16x32_bf16 a[244:247], v[156:159], v[216:219], a[244:247]
    s_waitcnt vmcnt(8) lgkmcnt(0)
    s_barrier
    v_mfma_f32_16x16x32_bf16 a[252:255], v[156:159], v[220:223], a[252:255]
    s_sub_u32 s27, s27, 1
    v_mfma_f32_16x16x32_bf16 a[0:3], v[160:163], v[224:227], a[0:3]
    ds_read_b128 v[192:195], v2 offset:0
    v_mfma_f32_16x16x32_bf16 a[8:11], v[160:163], v[228:231], a[8:11]
    s_add_u32 m0, s28, 0x8000
    v_mfma_f32_16x16x32_bf16 a[16:19], v[160:163], v[232:235], a[16:19]
    ds_read_b64_tr_b16 v[128:129], v4 offset:0
    v_mfma_f32_16x16x32_bf16 a[24:27], v[160:163], v[236:239], a[24:27]
    buffer_load_dwordx4 v12, s[12:15], s23 offen offset:0 lds
    v_mfma_f32_16x16x32_bf16 a[32:35], v[160:163], v[240:243], a[32:35]
    ds_read_b64_tr_b16 v[130:131], v4 offset:1024
    v_mfma_f32_16x16x32_bf16 a[40:43], v[160:163], v[244:247], a[40:43]
    v_mfma_f32_16x16x32_bf16 a[48:51], v[160:163], v[248:251], a[48:51]
    ds_read_b128 v[196:199], v2 offset:2048
    v_mfma_f32_16x16x32_bf16 a[56:59], v[160:163], v[252:255], a[56:59]
    buffer_load_dwordx4 v13, s[12:15], s23 offen offset:1024 lds
    v_mfma_f32_16x16x32_bf16 a[4:7], v[164:167], v[224:227], a[4:7]
    ds_read_b64_tr_b16 v[132:133], v5 offset:0
    v_mfma_f32_16x16x32_bf16 a[12:15], v[164:167], v[228:231], a[12:15]
    v_mfma_f32_16x16x32_bf16 a[20:23], v[164:167], v[232:235], a[20:23]
    ds_read_b64_tr_b16 v[134:135], v5 offset:1024
    v_mfma_f32_16x16x32_bf16 a[28:31], v[164:167], v[236:239], a[28:31]
    buffer_load_dwordx4 v14, s[12:15], s23 offen offset:2048 lds
    v_mfma_f32_16x16x32_bf16 a[36:39], v[164:167], v[240:243], a[36:39]
    ds_read_b128 v[200:203], v2 offset:4096
    v_mfma_f32_16x16x32_bf16 a[44:47], v[164:167], v[244:247], a[44:47]
    v_mfma_f32_16x16x32_bf16 a[52:55], v[164:167], v[248:251], a[52:55]
    ds_read_b64_tr_b16 v[136:137], v6 offset:0
    v_mfma_f32_16x16x32_bf16 a[60:63], v[164:167], v[252:255], a[60:63]
    buffer_load_dwordx4 v15, s[12:15], s23 offen offset:3072 lds
    v_mfma_f32_16x16x32_bf16 a[64:67], v[168:171], v[224:227], a[64:67]
    ds_read_b64_tr_b16 v[138:139], v6 offset:1024
    v_mfma_f32_16x16x32_bf16 a[72:75], v[168:171], v[228:231], a[72:75]
    s_add_u32 m0, s28, 0x9000
    v_mfma_f32_16x16x32_bf16 a[80:83], v[168:171], v[232:235], a[80:83]
    ds_read_b128 v[204:207], v2 offset:6144
    v_mfma_f32_16x16x32_bf16 a[88:91], v[168:171], v[236:239], a[88:91]
    buffer_load_dwordx4 v16, s[12:15], s23 offen offset:0 lds
    v_mfma_f32_16x16x32_bf16 a[96:99], v[168:171], v[240:243], a[96:99]
    ds_read_b64_tr_b16 v[140:141], v7 offset:0
    v_mfma_f32_16x16x32_bf16 a[104:107], v[168:171], v[244:247], a[104:107]
    v_mfma_f32_16x16x32_bf16 a[112:115], v[168:171], v[248:251], a[112:115]
    ds_read_b64_tr_b16 v[142:143], v7 offset:1024
    v_mfma_f32_16x16x32_bf16 a[120:123], v[168:171], v[252:255], a[120:123]
    buffer_load_dwordx4 v17, s[12:15], s23 offen offset:1024 lds
    v_mfma_f32_16x16x32_bf16 a[68:71], v[172:175], v[224:227], a[68:71]
    ds_read_b128 v[208:211], v2 offset:8192
    v_mfma_f32_16x16x32_bf16 a[76:79], v[172:175], v[228:231], a[76:79]
    v_mfma_f32_16x16x32_bf16 a[84:87], v[172:175], v[232:235], a[84:87]
    ds_read_b64_tr_b16 v[144:145], v8 offset:0
    v_mfma_f32_16x16x32_bf16 a[92:95], v[172:175], v[236:239], a[92:95]
    buffer_load_dwordx4 v18, s[12:15], s23 offen offset:2048 lds
    v_mfma_f32_16x16x32_bf16 a[100:103], v[172:175], v[240:243], a[100:103]
    ds_read_b64_tr_b16 v[146:147], v8 offset:1024
    v_mfma_f32_16x16x32_bf16 a[108:111], v[172:175], v[244:247], a[108:111]
    v_mfma_f32_16x16x32_bf16 a[116:119], v[172:175], v[248:251], a[116:119]
    ds_read_b128 v[212:215], v2 offset:10240
    v_mfma_f32_16x16x32_bf16 a[124:127], v[172:175], v[252:255], a[124:127]
    buffer_load_dwordx4 v19, s[12:15], s23 offen offset:3072 lds
    v_mfma_f32_16x16x32_bf16 a[128:131], v[176:179], v[224:227], a[128:131]
    ds_read_b64_tr_b16 v[148:149], v9 offset:0
    v_mfma_f32_16x16x32_bf16 a[136:139], v[176:179], v[228:231], a[136:139]
    s_add_u32 s23, s23, s25
    s_add_u32 m0, s29, 0xc000
    v_mfma_f32_16x16x32_bf16 a[144:147], v[176:179], v[232:235], a[144:147]
    ds_read_b64_tr_b16 v[150:151], v9 offset:1024
    v_mfma_f32_16x16x32_bf16 a[152:155], v[176:179], v[236:239], a[152:155]
    buffer_load_dwordx4 v20, s[16:19], s24 offen offset:0 lds
    v_mfma_f32_16x16x32_bf16 a[160:163], v[176:179], v[240:243], a[160:163]
    ds_read_b128 v[216:219], v2 offset:12288
    v_mfma_f32_16x16x32_bf16 a[168:171], v[176:179], v[244:247], a[168:171]
    v_mfma_f32_16x16x32_bf16 a[176:179], v[176:179], v[248:251], a[176:179]
    ds_read_b64_tr_b16 v[152:153], v10 offset:0
    v_mfma_f32_16x16x32_bf16 a[184:187], v[176:179], v[252:255], a[184:187]
    buffer_load_dwordx4 v21, s[16:19], s24 offen offset:1024 lds
    v_mfma_f32_16x16x32_bf16 a[132:135], v[180:183], v[224:227], a[132:135]
    ds_read_b64_tr_b16 v[154:155], v10 offset:1024
    v_mfma_f32_16x16x32_bf16 a[140:143], v[180:183], v[228:231], a[140:143]
    v_mfma_f32_16x16x32_bf16 a[148:151], v[180:183], v[232:235], a[148:151]
    ds_read_b128 v[220:223], v2 offset:14336
    v_mfma_f32_16x16x32_bf16 a[156:159], v[180:183], v[236:239], a[156:159]
    buffer_load_dwordx4 v22, s[16:19], s24 offen offset:2048 lds
    v_mfma_f32_16x16x32_bf16 a[164:167], v[180:183], v[240:243], a[164:167]
    ds_read_b64_tr_b16 v[156:157], v11 offset:0
    v_mfma_f32_16x16x32_bf16 a[172:175], v[180:183], v[244:247], a[172:175]
    v_mfma_f32_16x16x32_bf16 a[180:183], v[180:183], v[248:251], a[180:183]
    ds_read_b64_tr_b16 v[158:159], v11 offset:1024
    v_mfma_f32_16x16x32_bf16 a[188:191], v[180:183], v[252:255], a[188:191]
    buffer_load_dwordx4 v23, s[16:19], s24 offen offset:3072 lds
    v_mfma_f32_16x16x32_bf16 a[192:195], v[184:187], v[224:227], a[192:195]
    v_mfma_f32_16x16x32_bf16 a[200:203], v[184:187], v[228:231], a[200:203]
    s_add_u32 s24, s24, s26
    v_mfma_f32_16x16x32_bf16 a[208:211], v[184:187], v[232:235], a[208:211]
    v_mfma_f32_16x16x32_bf16 a[216:219], v[184:187], v[236:239], a[216:219]
    v_mfma_f32_16x16x32_bf16 a[224:227], v[184:187], v[240:243], a[224:227]
    v_mfma_f32_16x16x32_bf16 a[232:235], v[184:187], v[244:247], a[232:235]
    v_mfma_f32_16x16x32_bf16 a[240:243], v[184:187], v[248:251], a[240:243]
    v_mfma_f32_16x16x32_bf16 a[248:251], v[184:187], v[252:255], a[248:251]
    v_mfma_f32_16x16x32_bf16 a[196:199], v[188:191], v[224:227], a[196:199]
    v_mfma_f32_16x16x32_bf16 a[204:207], v[188:191], v[228:231], a[204:207]
    v_mfma_f32_16x16x32_bf16 a[212:215], v[188:191], v[232:235], a[212:215]
    v_mfma_f32_16x16x32_bf16 a[220:223], v[188:191], v[236:239], a[220:223]
    v_mfma_f32_16x16x32_bf16 a[228:231], v[188:191], v[240:243], a[228:231]
    v_mfma_f32_16x16x32_bf16 a[236:239], v[188:191], v[244:247], a[236:239]
    v_mfma_f32_16x16x32_bf16 a[244:247], v[188:191], v[248:251], a[244:247]
    s_waitcnt vmcnt(16) lgkmcnt(0)
    s_barrier
    v_mfma_f32_16x16x32_bf16 a[252:255], v[188:191], v[252:255], a[252:255]
    s_cmp_lg_u32 s27, 0
    s_cbranch_scc1 g0_245
    s_cmp_eq_u32 s67, 4
    s_cbranch_scc1 ehg_238
    s_cmp_eq_u32 s67, 3
    s_cbranch_scc1 eag_239
    s_cmp_eq_u32 s67, 0
    s_mov_b32 s74, 0x3400000
    s_cselect_b32 s74, 0x1000000, s74
    s_add_u32 s74, s74, s73
    s_add_u32 s30, s74, 0x0
    v_accvgpr_read_b32 v28, a0
    v_accvgpr_read_b32 v29, a1
    v_accvgpr_read_b32 v30, a2
    v_accvgpr_read_b32 v31, a3
    v_accvgpr_read_b32 v32, a4
    v_accvgpr_read_b32 v33, a5
    v_accvgpr_read_b32 v34, a6
    v_accvgpr_read_b32 v35, a7
    v_cvt_pk_bf16_f32 v44, v28, v29
    v_cvt_pk_bf16_f32 v45, v30, v31
    v_cvt_pk_bf16_f32 v46, v32, v33
    v_cvt_pk_bf16_f32 v47, v34, v35
    buffer_store_dwordx4 v[44:47], v26, s[8:11], s30 offen offset:0 sc1
    v_accvgpr_read_b32 v36, a64
    v_accvgpr_read_b32 v37, a65
    v_accvgpr_read_b32 v38, a66
    v_accvgpr_read_b32 v39, a67
    v_accvgpr_read_b32 v40, a68
    v_accvgpr_read_b32 v41, a69
    v_accvgpr_read_b32 v42, a70
    v_accvgpr_read_b32 v43, a71
    v_cvt_pk_bf16_f32 v48, v36, v37
    v_cvt_pk_bf16_f32 v49, v38, v39
    v_cvt_pk_bf16_f32 v50, v40, v41
    v_cvt_pk_bf16_f32 v51, v42, v43
    buffer_store_dwordx4 v[48:51], v26, s[8:11], s30 offen offset:1024 sc1
    v_accvgpr_read_b32 v28, a128
    v_accvgpr_read_b32 v29, a129
    v_accvgpr_read_b32 v30, a130
    v_accvgpr_read_b32 v31, a131
    v_accvgpr_read_b32 v32, a132
    v_accvgpr_read_b32 v33, a133
    v_accvgpr_read_b32 v34, a134
    v_accvgpr_read_b32 v35, a135
    v_cvt_pk_bf16_f32 v52, v28, v29
    v_cvt_pk_bf16_f32 v53, v30, v31
    v_cvt_pk_bf16_f32 v54, v32, v33
    v_cvt_pk_bf16_f32 v55, v34, v35
    buffer_store_dwordx4 v[52:55], v26, s[8:11], s30 offen offset:2048 sc1
    v_accvgpr_read_b32 v36, a192
    v_accvgpr_read_b32 v37, a193
    v_accvgpr_read_b32 v38, a194
    v_accvgpr_read_b32 v39, a195
    v_accvgpr_read_b32 v40, a196
    v_accvgpr_read_b32 v41, a197
    v_accvgpr_read_b32 v42, a198
    v_accvgpr_read_b32 v43, a199
    v_cvt_pk_bf16_f32 v56, v36, v37
    v_cvt_pk_bf16_f32 v57, v38, v39
    v_cvt_pk_bf16_f32 v58, v40, v41
    v_cvt_pk_bf16_f32 v59, v42, v43
    buffer_store_dwordx4 v[56:59], v26, s[8:11], s30 offen offset:3072 sc1
    s_add_u32 s30, s74, 0x1000
    v_accvgpr_read_b32 v28, a8
    v_accvgpr_read_b32 v29, a9
    v_accvgpr_read_b32 v30, a10
    v_accvgpr_read_b32 v31, a11
    v_accvgpr_read_b32 v32, a12
    v_accvgpr_read_b32 v33, a13
    v_accvgpr_read_b32 v34, a14
    v_accvgpr_read_b32 v35, a15
    v_cvt_pk_bf16_f32 v60, v28, v29
    v_cvt_pk_bf16_f32 v61, v30, v31
    v_cvt_pk_bf16_f32 v62, v32, v33
    v_cvt_pk_bf16_f32 v63, v34, v35
    buffer_store_dwordx4 v[60:63], v26, s[8:11], s30 offen offset:0 sc1
    v_accvgpr_read_b32 v36, a72
    v_accvgpr_read_b32 v37, a73
    v_accvgpr_read_b32 v38, a74
    v_accvgpr_read_b32 v39, a75
    v_accvgpr_read_b32 v40, a76
    v_accvgpr_read_b32 v41, a77
    v_accvgpr_read_b32 v42, a78
    v_accvgpr_read_b32 v43, a79
    v_cvt_pk_bf16_f32 v64, v36, v37
    v_cvt_pk_bf16_f32 v65, v38, v39
    v_cvt_pk_bf16_f32 v66, v40, v41
    v_cvt_pk_bf16_f32 v67, v42, v43
    buffer_store_dwordx4 v[64:67], v26, s[8:11], s30 offen offset:1024 sc1
    v_accvgpr_read_b32 v28, a136
    v_accvgpr_read_b32 v29, a137
    v_accvgpr_read_b32 v30, a138
    v_accvgpr_read_b32 v31, a139
    v_accvgpr_read_b32 v32, a140
    v_accvgpr_read_b32 v33, a141
    v_accvgpr_read_b32 v34, a142
    v_accvgpr_read_b32 v35, a143
    v_cvt_pk_bf16_f32 v68, v28, v29
    v_cvt_pk_bf16_f32 v69, v30, v31
    v_cvt_pk_bf16_f32 v70, v32, v33
    v_cvt_pk_bf16_f32 v71, v34, v35
    buffer_store_dwordx4 v[68:71], v26, s[8:11], s30 offen offset:2048 sc1
    v_accvgpr_read_b32 v36, a200
    v_accvgpr_read_b32 v37, a201
    v_accvgpr_read_b32 v38, a202
    v_accvgpr_read_b32 v39, a203
    v_accvgpr_read_b32 v40, a204
    v_accvgpr_read_b32 v41, a205
    v_accvgpr_read_b32 v42, a206
    v_accvgpr_read_b32 v43, a207
    v_cvt_pk_bf16_f32 v72, v36, v37
    v_cvt_pk_bf16_f32 v73, v38, v39
    v_cvt_pk_bf16_f32 v74, v40, v41
    v_cvt_pk_bf16_f32 v75, v42, v43
    buffer_store_dwordx4 v[72:75], v26, s[8:11], s30 offen offset:3072 sc1
    s_add_u32 s30, s74, 0x40000
    v_accvgpr_read_b32 v28, a16
    v_accvgpr_read_b32 v29, a17
    v_accvgpr_read_b32 v30, a18
    v_accvgpr_read_b32 v31, a19
    v_accvgpr_read_b32 v32, a20
    v_accvgpr_read_b32 v33, a21
    v_accvgpr_read_b32 v34, a22
    v_accvgpr_read_b32 v35, a23
    v_cvt_pk_bf16_f32 v44, v28, v29
    v_cvt_pk_bf16_f32 v45, v30, v31
    v_cvt_pk_bf16_f32 v46, v32, v33
    v_cvt_pk_bf16_f32 v47, v34, v35
    buffer_store_dwordx4 v[44:47], v26, s[8:11], s30 offen offset:0 sc1
    v_accvgpr_read_b32 v36, a80
    v_accvgpr_read_b32 v37, a81
    v_accvgpr_read_b32 v38, a82
    v_accvgpr_read_b32 v39, a83
    v_accvgpr_read_b32 v40, a84
    v_accvgpr_read_b32 v41, a85
    v_accvgpr_read_b32 v42, a86
    v_accvgpr_read_b32 v43, a87
    v_cvt_pk_bf16_f32 v48, v36, v37
    v_cvt_pk_bf16_f32 v49, v38, v39
    v_cvt_pk_bf16_f32 v50, v40, v41
    v_cvt_pk_bf16_f32 v51, v42, v43
    buffer_store_dwordx4 v[48:51], v26, s[8:11], s30 offen offset:1024 sc1
    v_accvgpr_read_b32 v28, a144
    v_accvgpr_read_b32 v29, a145
    v_accvgpr_read_b32 v30, a146
    v_accvgpr_read_b32 v31, a147
    v_accvgpr_read_b32 v32, a148
    v_accvgpr_read_b32 v33, a149
    v_accvgpr_read_b32 v34, a150
    v_accvgpr_read_b32 v35, a151
    v_cvt_pk_bf16_f32 v52, v28, v29
    v_cvt_pk_bf16_f32 v53, v30, v31
    v_cvt_pk_bf16_f32 v54, v32, v33
    v_cvt_pk_bf16_f32 v55, v34, v35
    buffer_store_dwordx4 v[52:55], v26, s[8:11], s30 offen offset:2048 sc1
    v_accvgpr_read_b32 v36, a208
    v_accvgpr_read_b32 v37, a209
    v_accvgpr_read_b32 v38, a210
    v_accvgpr_read_b32 v39, a211
    v_accvgpr_read_b32 v40, a212
    v_accvgpr_read_b32 v41, a213
    v_accvgpr_read_b32 v42, a214
    v_accvgpr_read_b32 v43, a215
    v_cvt_pk_bf16_f32 v56, v36, v37
    v_cvt_pk_bf16_f32 v57, v38, v39
    v_cvt_pk_bf16_f32 v58, v40, v41
    v_cvt_pk_bf16_f32 v59, v42, v43
    buffer_store_dwordx4 v[56:59], v26, s[8:11], s30 offen offset:3072 sc1
    s_add_u32 s30, s74, 0x41000
    v_accvgpr_read_b32 v28, a24
    v_accvgpr_read_b32 v29, a25
    v_accvgpr_read_b32 v30, a26
    v_accvgpr_read_b32 v31, a27
    v_accvgpr_read_b32 v32, a28
    v_accvgpr_read_b32 v33, a29
    v_accvgpr_read_b32 v34, a30
    v_accvgpr_read_b32 v35, a31
    v_cvt_pk_bf16_f32 v60, v28, v29
    v_cvt_pk_bf16_f32 v61, v30, v31
    v_cvt_pk_bf16_f32 v62, v32, v33
    v_cvt_pk_bf16_f32 v63, v34, v35
    buffer_store_dwordx4 v[60:63], v26, s[8:11], s30 offen offset:0 sc1
    v_accvgpr_read_b32 v36, a88
    v_accvgpr_read_b32 v37, a89
    v_accvgpr_read_b32 v38, a90
    v_accvgpr_read_b32 v39, a91
    v_accvgpr_read_b32 v40, a92
    v_accvgpr_read_b32 v41, a93
    v_accvgpr_read_b32 v42, a94
    v_accvgpr_read_b32 v43, a95
    v_cvt_pk_bf16_f32 v64, v36, v37
    v_cvt_pk_bf16_f32 v65, v38, v39
    v_cvt_pk_bf16_f32 v66, v40, v41
    v_cvt_pk_bf16_f32 v67, v42, v43
    buffer_store_dwordx4 v[64:67], v26, s[8:11], s30 offen offset:1024 sc1
    v_accvgpr_read_b32 v28, a152
    v_accvgpr_read_b32 v29, a153
    v_accvgpr_read_b32 v30, a154
    v_accvgpr_read_b32 v31, a155
    v_accvgpr_read_b32 v32, a156
    v_accvgpr_read_b32 v33, a157
    v_accvgpr_read_b32 v34, a158
    v_accvgpr_read_b32 v35, a159
    v_cvt_pk_bf16_f32 v68, v28, v29
    v_cvt_pk_bf16_f32 v69, v30, v31
    v_cvt_pk_bf16_f32 v70, v32, v33
    v_cvt_pk_bf16_f32 v71, v34, v35
    buffer_store_dwordx4 v[68:71], v26, s[8:11], s30 offen offset:2048 sc1
    v_accvgpr_read_b32 v36, a216
    v_accvgpr_read_b32 v37, a217
    v_accvgpr_read_b32 v38, a218
    v_accvgpr_read_b32 v39, a219
    v_accvgpr_read_b32 v40, a220
    v_accvgpr_read_b32 v41, a221
    v_accvgpr_read_b32 v42, a222
    v_accvgpr_read_b32 v43, a223
    v_cvt_pk_bf16_f32 v72, v36, v37
    v_cvt_pk_bf16_f32 v73, v38, v39
    v_cvt_pk_bf16_f32 v74, v40, v41
    v_cvt_pk_bf16_f32 v75, v42, v43
    buffer_store_dwordx4 v[72:75], v26, s[8:11], s30 offen offset:3072 sc1
    s_add_u32 s30, s74, 0x80000
    v_accvgpr_read_b32 v28, a32
    v_accvgpr_read_b32 v29, a33
    v_accvgpr_read_b32 v30, a34
    v_accvgpr_read_b32 v31, a35
    v_accvgpr_read_b32 v32, a36
    v_accvgpr_read_b32 v33, a37
    v_accvgpr_read_b32 v34, a38
    v_accvgpr_read_b32 v35, a39
    v_cvt_pk_bf16_f32 v44, v28, v29
    v_cvt_pk_bf16_f32 v45, v30, v31
    v_cvt_pk_bf16_f32 v46, v32, v33
    v_cvt_pk_bf16_f32 v47, v34, v35
    buffer_store_dwordx4 v[44:47], v26, s[8:11], s30 offen offset:0 sc1
    v_accvgpr_read_b32 v36, a96
    v_accvgpr_read_b32 v37, a97
    v_accvgpr_read_b32 v38, a98
    v_accvgpr_read_b32 v39, a99
    v_accvgpr_read_b32 v40, a100
    v_accvgpr_read_b32 v41, a101
    v_accvgpr_read_b32 v42, a102
    v_accvgpr_read_b32 v43, a103
    v_cvt_pk_bf16_f32 v48, v36, v37
    v_cvt_pk_bf16_f32 v49, v38, v39
    v_cvt_pk_bf16_f32 v50, v40, v41
    v_cvt_pk_bf16_f32 v51, v42, v43
    buffer_store_dwordx4 v[48:51], v26, s[8:11], s30 offen offset:1024 sc1
    v_accvgpr_read_b32 v28, a160
    v_accvgpr_read_b32 v29, a161
    v_accvgpr_read_b32 v30, a162
    v_accvgpr_read_b32 v31, a163
    v_accvgpr_read_b32 v32, a164
    v_accvgpr_read_b32 v33, a165
    v_accvgpr_read_b32 v34, a166
    v_accvgpr_read_b32 v35, a167
    v_cvt_pk_bf16_f32 v52, v28, v29
    v_cvt_pk_bf16_f32 v53, v30, v31
    v_cvt_pk_bf16_f32 v54, v32, v33
    v_cvt_pk_bf16_f32 v55, v34, v35
    buffer_store_dwordx4 v[52:55], v26, s[8:11], s30 offen offset:2048 sc1
    v_accvgpr_read_b32 v36, a224
    v_accvgpr_read_b32 v37, a225
    v_accvgpr_read_b32 v38, a226
    v_accvgpr_read_b32 v39, a227
    v_accvgpr_read_b32 v40, a228
    v_accvgpr_read_b32 v41, a229
    v_accvgpr_read_b32 v42, a230
    v_accvgpr_read_b32 v43, a231
    v_cvt_pk_bf16_f32 v56, v36, v37
    v_cvt_pk_bf16_f32 v57, v38, v39
    v_cvt_pk_bf16_f32 v58, v40, v41
    v_cvt_pk_bf16_f32 v59, v42, v43
    buffer_store_dwordx4 v[56:59], v26, s[8:11], s30 offen offset:3072 sc1
    s_add_u32 s30, s74, 0x81000
    v_accvgpr_read_b32 v28, a40
    v_accvgpr_read_b32 v29, a41
    v_accvgpr_read_b32 v30, a42
    v_accvgpr_read_b32 v31, a43
    v_accvgpr_read_b32 v32, a44
    v_accvgpr_read_b32 v33, a45
    v_accvgpr_read_b32 v34, a46
    v_accvgpr_read_b32 v35, a47
    v_cvt_pk_bf16_f32 v60, v28, v29
    v_cvt_pk_bf16_f32 v61, v30, v31
    v_cvt_pk_bf16_f32 v62, v32, v33
    v_cvt_pk_bf16_f32 v63, v34, v35
    buffer_store_dwordx4 v[60:63], v26, s[8:11], s30 offen offset:0 sc1
    v_accvgpr_read_b32 v36, a104
    v_accvgpr_read_b32 v37, a105
    v_accvgpr_read_b32 v38, a106
    v_accvgpr_read_b32 v39, a107
    v_accvgpr_read_b32 v40, a108
    v_accvgpr_read_b32 v41, a109
    v_accvgpr_read_b32 v42, a110
    v_accvgpr_read_b32 v43, a111
    v_cvt_pk_bf16_f32 v64, v36, v37
    v_cvt_pk_bf16_f32 v65, v38, v39
    v_cvt_pk_bf16_f32 v66, v40, v41
    v_cvt_pk_bf16_f32 v67, v42, v43
    buffer_store_dwordx4 v[64:67], v26, s[8:11], s30 offen offset:1024 sc1
    v_accvgpr_read_b32 v28, a168
    v_accvgpr_read_b32 v29, a169
    v_accvgpr_read_b32 v30, a170
    v_accvgpr_read_b32 v31, a171
    v_accvgpr_read_b32 v32, a172
    v_accvgpr_read_b32 v33, a173
    v_accvgpr_read_b32 v34, a174
    v_accvgpr_read_b32 v35, a175
    v_cvt_pk_bf16_f32 v68, v28, v29
    v_cvt_pk_bf16_f32 v69, v30, v31
    v_cvt_pk_bf16_f32 v70, v32, v33
    v_cvt_pk_bf16_f32 v71, v34, v35
    buffer_store_dwordx4 v[68:71], v26, s[8:11], s30 offen offset:2048 sc1
    v_accvgpr_read_b32 v36, a232
    v_accvgpr_read_b32 v37, a233
    v_accvgpr_read_b32 v38, a234
    v_accvgpr_read_b32 v39, a235
    v_accvgpr_read_b32 v40, a236
    v_accvgpr_read_b32 v41, a237
    v_accvgpr_read_b32 v42, a238
    v_accvgpr_read_b32 v43, a239
    v_cvt_pk_bf16_f32 v72, v36, v37
    v_cvt_pk_bf16_f32 v73, v38, v39
    v_cvt_pk_bf16_f32 v74, v40, v41
    v_cvt_pk_bf16_f32 v75, v42, v43
    buffer_store_dwordx4 v[72:75], v26, s[8:11], s30 offen offset:3072 sc1
    s_add_u32 s30, s74, 0xc0000
    v_accvgpr_read_b32 v28, a48
    v_accvgpr_read_b32 v29, a49
    v_accvgpr_read_b32 v30, a50
    v_accvgpr_read_b32 v31, a51
    v_accvgpr_read_b32 v32, a52
    v_accvgpr_read_b32 v33, a53
    v_accvgpr_read_b32 v34, a54
    v_accvgpr_read_b32 v35, a55
    v_cvt_pk_bf16_f32 v44, v28, v29
    v_cvt_pk_bf16_f32 v45, v30, v31
    v_cvt_pk_bf16_f32 v46, v32, v33
    v_cvt_pk_bf16_f32 v47, v34, v35
    buffer_store_dwordx4 v[44:47], v26, s[8:11], s30 offen offset:0 sc1
    v_accvgpr_read_b32 v36, a112
    v_accvgpr_read_b32 v37, a113
    v_accvgpr_read_b32 v38, a114
    v_accvgpr_read_b32 v39, a115
    v_accvgpr_read_b32 v40, a116
    v_accvgpr_read_b32 v41, a117
    v_accvgpr_read_b32 v42, a118
    v_accvgpr_read_b32 v43, a119
    v_cvt_pk_bf16_f32 v48, v36, v37
    v_cvt_pk_bf16_f32 v49, v38, v39
    v_cvt_pk_bf16_f32 v50, v40, v41
    v_cvt_pk_bf16_f32 v51, v42, v43
    buffer_store_dwordx4 v[48:51], v26, s[8:11], s30 offen offset:1024 sc1
    v_accvgpr_read_b32 v28, a176
    v_accvgpr_read_b32 v29, a177
    v_accvgpr_read_b32 v30, a178
    v_accvgpr_read_b32 v31, a179
    v_accvgpr_read_b32 v32, a180
    v_accvgpr_read_b32 v33, a181
    v_accvgpr_read_b32 v34, a182
    v_accvgpr_read_b32 v35, a183
    v_cvt_pk_bf16_f32 v52, v28, v29
    v_cvt_pk_bf16_f32 v53, v30, v31
    v_cvt_pk_bf16_f32 v54, v32, v33
    v_cvt_pk_bf16_f32 v55, v34, v35
    buffer_store_dwordx4 v[52:55], v26, s[8:11], s30 offen offset:2048 sc1
    v_accvgpr_read_b32 v36, a240
    v_accvgpr_read_b32 v37, a241
    v_accvgpr_read_b32 v38, a242
    v_accvgpr_read_b32 v39, a243
    v_accvgpr_read_b32 v40, a244
    v_accvgpr_read_b32 v41, a245
    v_accvgpr_read_b32 v42, a246
    v_accvgpr_read_b32 v43, a247
    v_cvt_pk_bf16_f32 v56, v36, v37
    v_cvt_pk_bf16_f32 v57, v38, v39
    v_cvt_pk_bf16_f32 v58, v40, v41
    v_cvt_pk_bf16_f32 v59, v42, v43
    buffer_store_dwordx4 v[56:59], v26, s[8:11], s30 offen offset:3072 sc1
    s_add_u32 s30, s74, 0xc1000
    v_accvgpr_read_b32 v28, a56
    v_accvgpr_read_b32 v29, a57
    v_accvgpr_read_b32 v30, a58
    v_accvgpr_read_b32 v31, a59
    v_accvgpr_read_b32 v32, a60
    v_accvgpr_read_b32 v33, a61
    v_accvgpr_read_b32 v34, a62
    v_accvgpr_read_b32 v35, a63
    v_cvt_pk_bf16_f32 v60, v28, v29
    v_cvt_pk_bf16_f32 v61, v30, v31
    v_cvt_pk_bf16_f32 v62, v32, v33
    v_cvt_pk_bf16_f32 v63, v34, v35
    buffer_store_dwordx4 v[60:63], v26, s[8:11], s30 offen offset:0 sc1
    v_accvgpr_read_b32 v36, a120
    v_accvgpr_read_b32 v37, a121
    v_accvgpr_read_b32 v38, a122
    v_accvgpr_read_b32 v39, a123
    v_accvgpr_read_b32 v40, a124
    v_accvgpr_read_b32 v41, a125
    v_accvgpr_read_b32 v42, a126
    v_accvgpr_read_b32 v43, a127
    v_cvt_pk_bf16_f32 v64, v36, v37
    v_cvt_pk_bf16_f32 v65, v38, v39
    v_cvt_pk_bf16_f32 v66, v40, v41
    v_cvt_pk_bf16_f32 v67, v42, v43
    buffer_store_dwordx4 v[64:67], v26, s[8:11], s30 offen offset:1024 sc1
    v_accvgpr_read_b32 v28, a184
    v_accvgpr_read_b32 v29, a185
    v_accvgpr_read_b32 v30, a186
    v_accvgpr_read_b32 v31, a187
    v_accvgpr_read_b32 v32, a188
    v_accvgpr_read_b32 v33, a189
    v_accvgpr_read_b32 v34, a190
    v_accvgpr_read_b32 v35, a191
    v_cvt_pk_bf16_f32 v68, v28, v29
    v_cvt_pk_bf16_f32 v69, v30, v31
    v_cvt_pk_bf16_f32 v70, v32, v33
    v_cvt_pk_bf16_f32 v71, v34, v35
    buffer_store_dwordx4 v[68:71], v26, s[8:11], s30 offen offset:2048 sc1
    v_accvgpr_read_b32 v36, a248
    v_accvgpr_read_b32 v37, a249
    v_accvgpr_read_b32 v38, a250
    v_accvgpr_read_b32 v39, a251
    v_accvgpr_read_b32 v40, a252
    v_accvgpr_read_b32 v41, a253
    v_accvgpr_read_b32 v42, a254
    v_accvgpr_read_b32 v43, a255
    v_cvt_pk_bf16_f32 v72, v36, v37
    v_cvt_pk_bf16_f32 v73, v38, v39
    v_cvt_pk_bf16_f32 v74, v40, v41
    v_cvt_pk_bf16_f32 v75, v42, v43
    buffer_store_dwordx4 v[72:75], v26, s[8:11], s30 offen offset:3072 sc1
    s_branch kvg_241
eag_239:
    s_lshl_b32 s74, s69, 1
    s_add_u32 s74, s74, s21
    s_lshl_b32 s80, s22, 2
    s_lshr_b32 s75, s74, 3
    s_and_b32 s76, s74, 7
    s_lshl_b32 s76, s76, 2
    v_and_b32 v28, 3, v1
    v_add_u32 v28, s76, v28
    v_lshrrev_b32 v29, v28, s46
    v_and_b32 v29, 1, v29
    v_lshlrev_b32 v28, 20, v28
    v_lshl_add_u32 v28, v29, 13, v28
    s_lshl_b32 s77, s75, 2
    s_add_u32 s77, s77, 0xc008000
    s_lshl_b32 s78, s68, 3
    s_add_u32 s78, s78, 8
    s_mov_b32 s79, 0
pgg_270:
    buffer_load_dword v29, v28, s[8:11], s77 offen sc1
    s_add_u32 s79, s79, 1
    s_cmp_ge_u32 s79, 0x20000
    s_cbranch_scc1 L_fb
    s_waitcnt vmcnt(0)
    v_cmp_gt_u32 vcc, s78, v29
    s_cbranch_vccnz pgg_270
    s_lshl_b32 s77, s75, 3
    s_add_u32 s77, s77, s68
    s_lshl_b32 s77, s77, 4
    s_add_u32 s77, s77, s80
    s_lshl_b32 s77, s77, 10
    s_add_u32 s77, s77, 0xc010000
    v_readlane_b32 s98, v28, 0
    v_readlane_b32 s99, v28, 1
    v_readlane_b32 s100, v28, 2
    v_readlane_b32 s101, v28, 3
    s_add_u32 s98, s98, s77
    s_add_u32 s99, s99, s77
    s_add_u32 s100, s100, s77
    s_add_u32 s101, s101, s77
    s_lshl_b32 s78, s68, 5
    s_add_u32 s78, s78, s74
    s_lshl_b32 s78, s78, 4
    s_add_u32 s78, s78, s80
    s_lshl_b32 s78, s78, 12
    s_add_u32 s78, s78, 0x9000000
    s_add_u32 s30, s73, 0x1000000
    s_add_u32 s31, s30, 0x1000
    buffer_load_dwordx4 v[192:195], v124, s[8:11], s98 offen offset:0
    buffer_load_dwordx4 v[196:199], v124, s[8:11], s99 offen offset:0
    buffer_load_dwordx4 v[200:203], v124, s[8:11], s100 offen offset:0
    buffer_load_dwordx4 v[204:207], v124, s[8:11], s101 offen offset:0
    buffer_load_dwordx4 v[160:163], v26, s[8:11], s30 offen offset:0
    buffer_load_dwordx4 v[164:167], v26, s[8:11], s30 offen offset:1024
    buffer_load_dwordx4 v[168:171], v26, s[8:11], s30 offen offset:2048
    buffer_load_dwordx4 v[172:175], v26, s[8:11], s30 offen offset:3072
    buffer_load_dwordx4 v[176:179], v26, s[8:11], s31 offen offset:0
    buffer_load_dwordx4 v[180:183], v26, s[8:11], s31 offen offset:1024
    buffer_load_dwordx4 v[184:187], v26, s[8:11], s31 offen offset:2048
    buffer_load_dwordx4 v[188:191], v26, s[8:11], s31 offen offset:3072
    s_add_u32 s30, s73, 0x2200000
    s_add_u32 s31, s30, 0x1000
    buffer_load_dwordx4 v[208:211], v26, s[8:11], s30 offen offset:0
    buffer_load_dwordx4 v[212:215], v26, s[8:11], s30 offen offset:1024
    buffer_load_dwordx4 v[216:219], v26, s[8:11], s30 offen offset:2048
    buffer_load_dwordx4 v[220:223], v26, s[8:11], s30 offen offset:3072
    buffer_load_dwordx4 v[224:227], v26, s[8:11], s31 offen offset:0
    buffer_load_dwordx4 v[228:231], v26, s[8:11], s31 offen offset:1024
    buffer_load_dwordx4 v[232:235], v26, s[8:11], s31 offen offset:2048
    buffer_load_dwordx4 v[236:239], v26, s[8:11], s31 offen offset:3072
    buffer_load_dwordx2 v[240:241], v125, s[8:11], s98 offen offset:0
    buffer_load_dwordx2 v[242:243], v125, s[8:11], s99 offen offset:0
    buffer_load_dwordx2 v[244:245], v125, s[8:11], s100 offen offset:0
    buffer_load_dwordx2 v[246:247], v125, s[8:11], s101 offen offset:0
    v_accvgpr_read_b32 v64, a0
    v_accvgpr_read_b32 v65, a1
    v_accvgpr_read_b32 v66, a2
    v_accvgpr_read_b32 v67, a3
    v_accvgpr_read_b32 v68, a4
    v_accvgpr_read_b32 v69, a5
    v_accvgpr_read_b32 v70, a6
    v_accvgpr_read_b32 v71, a7
    v_cvt_pk_bf16_f32 v128, v64, v65
    v_cvt_pk_bf16_f32 v129, v66, v67
    v_cvt_pk_bf16_f32 v130, v68, v69
    v_cvt_pk_bf16_f32 v131, v70, v71
    v_accvgpr_read_b32 v72, a64
    v_accvgpr_read_b32 v73, a65
    v_accvgpr_read_b32 v74, a66
    v_accvgpr_read_b32 v75, a67
    v_accvgpr_read_b32 v76, a68
    v_accvgpr_read_b32 v77, a69
    v_accvgpr_read_b32 v78, a70
    v_accvgpr_read_b32 v79, a71
    v_cvt_pk_bf16_f32 v132, v72, v73
    v_cvt_pk_bf16_f32 v133, v74, v75
    v_cvt_pk_bf16_f32 v134, v76, v77
    v_cvt_pk_bf16_f32 v135, v78, v79
    v_accvgpr_read_b32 v80, a128
    v_accvgpr_read_b32 v81, a129
    v_accvgpr_read_b32 v82, a130
    v_accvgpr_read_b32 v83, a131
    v_accvgpr_read_b32 v84, a132
    v_accvgpr_read_b32 v85, a133
    v_accvgpr_read_b32 v86, a134
    v_accvgpr_read_b32 v87, a135
    v_cvt_pk_bf16_f32 v136, v80, v81
    v_cvt_pk_bf16_f32 v137, v82, v83
    v_cvt_pk_bf16_f32 v138, v84, v85
    v_cvt_pk_bf16_f32 v139, v86, v87
    v_accvgpr_read_b32 v88, a192
    v_accvgpr_read_b32 v89, a193
    v_accvgpr_read_b32 v90, a194
    v_accvgpr_read_b32 v91, a195
    v_accvgpr_read_b32 v92, a196
    v_accvgpr_read_b32 v93, a197
    v_accvgpr_read_b32 v94, a198
    v_accvgpr_read_b32 v95, a199
    v_cvt_pk_bf16_f32 v140, v88, v89
    v_cvt_pk_bf16_f32 v141, v90, v91
    v_cvt_pk_bf16_f32 v142, v92, v93
    v_cvt_pk_bf16_f32 v143, v94, v95
    v_accvgpr_read_b32 v64, a8
    v_accvgpr_read_b32 v65, a9
    v_accvgpr_read_b32 v66, a10
    v_accvgpr_read_b32 v67, a11
    v_accvgpr_read_b32 v68, a12
    v_accvgpr_read_b32 v69, a13
    v_accvgpr_read_b32 v70, a14
    v_accvgpr_read_b32 v71, a15
    v_cvt_pk_bf16_f32 v144, v64, v65
    v_cvt_pk_bf16_f32 v145, v66, v67
    v_cvt_pk_bf16_f32 v146, v68, v69
    v_cvt_pk_bf16_f32 v147, v70, v71
    v_accvgpr_read_b32 v72, a72
    v_accvgpr_read_b32 v73, a73
    v_accvgpr_read_b32 v74, a74
    v_accvgpr_read_b32 v75, a75
    v_accvgpr_read_b32 v76, a76
    v_accvgpr_read_b32 v77, a77
    v_accvgpr_read_b32 v78, a78
    v_accvgpr_read_b32 v79, a79
    v_cvt_pk_bf16_f32 v148, v72, v73
    v_cvt_pk_bf16_f32 v149, v74, v75
    v_cvt_pk_bf16_f32 v150, v76, v77
    v_cvt_pk_bf16_f32 v151, v78, v79
    v_accvgpr_read_b32 v80, a136
    v_accvgpr_read_b32 v81, a137
    v_accvgpr_read_b32 v82, a138
    v_accvgpr_read_b32 v83, a139
    v_accvgpr_read_b32 v84, a140
    v_accvgpr_read_b32 v85, a141
    v_accvgpr_read_b32 v86, a142
    v_accvgpr_read_b32 v87, a143
    v_cvt_pk_bf16_f32 v152, v80, v81
    v_cvt_pk_bf16_f32 v153, v82, v83
    v_cvt_pk_bf16_f32 v154, v84, v85
    v_cvt_pk_bf16_f32 v155, v86, v87
    v_accvgpr_read_b32 v88, a200
    v_accvgpr_read_b32 v89, a201
    v_accvgpr_read_b32 v90, a202
    v_accvgpr_read_b32 v91, a203
    v_accvgpr_read_b32 v92, a204
    v_accvgpr_read_b32 v93, a205
    v_accvgpr_read_b32 v94, a206
    v_accvgpr_read_b32 v95, a207
    v_cvt_pk_bf16_f32 v156, v88, v89
    v_cvt_pk_bf16_f32 v157, v90, v91
    v_cvt_pk_bf16_f32 v158, v92, v93
    v_cvt_pk_bf16_f32 v159, v94, v95
    s_waitcnt vmcnt(12)
    v_mfma_f32_16x16x32_bf16 v[32:35], v[192:195], v[128:131], 0
    v_mfma_f32_16x16x32_bf16 v[36:39], v[160:163], v[128:131], 0
    v_mfma_f32_16x16x32_bf16 v[40:43], v[192:195], v[144:147], 0
    v_mfma_f32_16x16x32_bf16 v[44:47], v[160:163], v[144:147], 0
    v_mfma_f32_16x16x32_bf16 v[48:51], v[176:179], v[144:147], 0
    v_mfma_f32_16x16x32_bf16 v[32:35], v[196:199], v[132:135], v[32:35]
    v_mfma_f32_16x16x32_bf16 v[36:39], v[164:167], v[132:135], v[36:39]
    v_mfma_f32_16x16x32_bf16 v[40:43], v[196:199], v[148:151], v[40:43]
    v_mfma_f32_16x16x32_bf16 v[44:47], v[164:167], v[148:151], v[44:47]
    v_mfma_f32_16x16x32_bf16 v[48:51], v[180:183], v[148:151], v[48:51]
    v_mfma_f32_16x16x32_bf16 v[32:35], v[200:203], v[136:139], v[32:35]
    v_mfma_f32_16x16x32_bf16 v[36:39], v[168:171], v[136:139], v[36:39]
    v_mfma_f32_16x16x32_bf16 v[40:43], v[200:203], v[152:155], v[40:43]
    v_mfma_f32_16x16x32_bf16 v[44:47], v[168:171], v[152:155], v[44:47]
    v_mfma_f32_16x16x32_bf16 v[48:51], v[184:187], v[152:155], v[48:51]
    v_mfma_f32_16x16x32_bf16 v[32:35], v[204:207], v[140:143], v[32:35]
    v_mfma_f32_16x16x32_bf16 v[36:39], v[172:175], v[140:143], v[36:39]
    v_mfma_f32_16x16x32_bf16 v[40:43], v[204:207], v[156:159], v[40:43]
    v_mfma_f32_16x16x32_bf16 v[44:47], v[172:175], v[156:159], v[44:47]
    v_mfma_f32_16x16x32_bf16 v[48:51], v[188:191], v[156:159], v[48:51]
    s_add_u32 s30, s73, 0x1040000
    s_add_u32 s31, s30, 0x1000
    buffer_load_dwordx4 v[192:195], v124, s[8:11], s98 offen offset:1024
    buffer_load_dwordx4 v[196:199], v124, s[8:11], s99 offen offset:1024
    buffer_load_dwordx4 v[200:203], v124, s[8:11], s100 offen offset:1024
    buffer_load_dwordx4 v[204:207], v124, s[8:11], s101 offen offset:1024
    buffer_load_dwordx4 v[160:163], v26, s[8:11], s30 offen offset:0
    buffer_load_dwordx4 v[164:167], v26, s[8:11], s30 offen offset:1024
    buffer_load_dwordx4 v[168:171], v26, s[8:11], s30 offen offset:2048
    buffer_load_dwordx4 v[172:175], v26, s[8:11], s30 offen offset:3072
    buffer_load_dwordx4 v[176:179], v26, s[8:11], s31 offen offset:0
    buffer_load_dwordx4 v[180:183], v26, s[8:11], s31 offen offset:1024
    buffer_load_dwordx4 v[184:187], v26, s[8:11], s31 offen offset:2048
    buffer_load_dwordx4 v[188:191], v26, s[8:11], s31 offen offset:3072
    v_cndmask_b32 v36, v126, v36, s[88:89]
    v_cndmask_b32 v48, v126, v48, s[88:89]
    v_cndmask_b32 v37, v126, v37, s[90:91]
    v_cndmask_b32 v49, v126, v49, s[90:91]
    v_cndmask_b32 v38, v126, v38, s[92:93]
    v_cndmask_b32 v50, v126, v50, s[92:93]
    v_cndmask_b32 v39, v126, v39, s[94:95]
    v_cndmask_b32 v51, v126, v51, s[94:95]
    v_max3_f32 v28, v32, v33, v36
    v_max3_f32 v30, v40, v41, v44
    v_max3_f32 v28, v28, v37, v38
    v_max3_f32 v30, v30, v45, v46
    v_max_f32 v28, v28, v39
    v_max3_f32 v30, v30, v47, v48
    v_mov_b32 v29, v28
    v_max3_f32 v30, v30, v49, v50
    s_nop 0
    v_permlane16_swap_b32 v28, v29
    v_max_f32 v30, v30, v51
    v_max_f32 v28, v28, v29
    v_mov_b32 v31, v30
    v_mov_b32 v29, v28
    s_nop 0
    v_permlane16_swap_b32 v30, v31
    v_permlane32_swap_b32 v28, v29
    v_max_f32 v30, v30, v31
    v_max_f32 v28, v28, v29
    v_mov_b32 v31, v30
    v_mul_f32 v28, s96, v28
    s_nop 0
    v_permlane32_swap_b32 v30, v31
    v_fma_f32 v32, v32, s96, -v28
    v_max_f32 v30, v30, v31
    v_fma_f32 v33, v33, s96, -v28
    v_mul_f32 v30, s96, v30
    v_fma_f32 v36, v36, s96, -v28
    v_fma_f32 v40, v40, s96, -v30
    v_fma_f32 v37, v37, s96, -v28
    v_fma_f32 v41, v41, s96, -v30
    v_fma_f32 v38, v38, s96, -v28
    v_fma_f32 v44, v44, s96, -v30
    v_fma_f32 v39, v39, s96, -v28
    v_fma_f32 v45, v45, s96, -v30
    v_exp_f32 v32, v32
    v_fma_f32 v46, v46, s96, -v30
    v_exp_f32 v33, v33
    v_fma_f32 v47, v47, s96, -v30
    v_exp_f32 v36, v36
    v_fma_f32 v48, v48, s96, -v30
    v_exp_f32 v37, v37
    v_fma_f32 v49, v49, s96, -v30
    v_exp_f32 v38, v38
    v_fma_f32 v50, v50, s96, -v30
    v_exp_f32 v39, v39
    v_fma_f32 v51, v51, s96, -v30
    v_mov_b32 v61, 0
    v_exp_f32 v40, v40
    v_mov_b32 v62, 0
    v_exp_f32 v41, v41
    v_cvt_pk_bf16_f32 v60, v32, v33
    v_exp_f32 v44, v44
    v_cvt_pk_bf16_f32 v63, v32, v33
    v_exp_f32 v45, v45
    v_cvt_pk_bf16_f32 v52, v36, v37
    v_exp_f32 v46, v46
    v_cvt_pk_bf16_f32 v53, v38, v39
    v_exp_f32 v47, v47
    v_exp_f32 v48, v48
    v_exp_f32 v49, v49
    v_exp_f32 v50, v50
    v_exp_f32 v51, v51
    v_mov_b32 v249, 0
    v_mov_b32 v250, 0
    v_cvt_pk_bf16_f32 v248, v40, v41
    v_cvt_pk_bf16_f32 v251, v40, v41
    v_cvt_pk_bf16_f32 v56, v44, v45
    v_cvt_pk_bf16_f32 v57, v46, v47
    v_cvt_pk_bf16_f32 v58, v48, v49
    v_cvt_pk_bf16_f32 v59, v50, v51
    s_add_u32 s32, s78, 0x0
    s_add_u32 s33, s78, 0x8000
    s_waitcnt vmcnt(12)
    v_mfma_f32_16x16x16_bf16 v[252:255], v[120:121], v[52:53], 0
    v_mfma_f32_16x16x16_bf16 v[64:67], v[208:209], v[52:53], 0
    v_mfma_f32_16x16x16_bf16 v[68:71], v[212:213], v[52:53], 0
    v_mfma_f32_16x16x16_bf16 v[72:75], v[216:217], v[52:53], 0
    v_mfma_f32_16x16x16_bf16 v[76:79], v[220:221], v[52:53], 0
    v_mfma_f32_16x16x16_bf16 v[80:83], v[224:225], v[52:53], 0
    v_mfma_f32_16x16x16_bf16 v[84:87], v[228:229], v[52:53], 0
    v_mfma_f32_16x16x16_bf16 v[88:91], v[232:233], v[52:53], 0
    v_mfma_f32_16x16x16_bf16 v[92:95], v[236:237], v[52:53], 0
    v_mfma_f32_16x16x16_bf16 v[252:255], v[120:121], v[60:61], v[252:255]
    v_mfma_f32_16x16x16_bf16 v[64:67], v[240:241], v[60:61], v[64:67]
    v_mfma_f32_16x16x16_bf16 v[68:71], v[240:241], v[62:63], v[68:71]
    v_mfma_f32_16x16x16_bf16 v[72:75], v[242:243], v[60:61], v[72:75]
    v_mfma_f32_16x16x16_bf16 v[76:79], v[242:243], v[62:63], v[76:79]
    v_mfma_f32_16x16x16_bf16 v[80:83], v[244:245], v[60:61], v[80:83]
    v_mfma_f32_16x16x16_bf16 v[84:87], v[244:245], v[62:63], v[84:87]
    v_mfma_f32_16x16x16_bf16 v[88:91], v[246:247], v[60:61], v[88:91]
    v_mfma_f32_16x16x16_bf16 v[92:95], v[246:247], v[62:63], v[92:95]
    v_rcp_f32 v28, v252
    s_nop 0
    v_mul_f32 v28, v28, v112
    v_pk_mul_f32 v[64:65], v[64:65], v[28:29] op_sel_hi:[1,0]
    v_pk_mul_f32 v[66:67], v[66:67], v[28:29] op_sel_hi:[1,0]
    v_cvt_pk_bf16_f32 v96, v64, v65
    v_cvt_pk_bf16_f32 v97, v66, v67
    v_pk_mul_f32 v[68:69], v[68:69], v[28:29] op_sel_hi:[1,0]
    v_pk_mul_f32 v[70:71], v[70:71], v[28:29] op_sel_hi:[1,0]
    v_cvt_pk_bf16_f32 v98, v68, v69
    v_cvt_pk_bf16_f32 v99, v70, v71
    v_pk_mul_f32 v[72:73], v[72:73], v[28:29] op_sel_hi:[1,0]
    v_pk_mul_f32 v[74:75], v[74:75], v[28:29] op_sel_hi:[1,0]
    v_cvt_pk_bf16_f32 v100, v72, v73
    v_cvt_pk_bf16_f32 v101, v74, v75
    v_pk_mul_f32 v[76:77], v[76:77], v[28:29] op_sel_hi:[1,0]
    v_pk_mul_f32 v[78:79], v[78:79], v[28:29] op_sel_hi:[1,0]
    v_cvt_pk_bf16_f32 v102, v76, v77
    v_cvt_pk_bf16_f32 v103, v78, v79
    v_pk_mul_f32 v[80:81], v[80:81], v[28:29] op_sel_hi:[1,0]
    v_pk_mul_f32 v[82:83], v[82:83], v[28:29] op_sel_hi:[1,0]
    v_cvt_pk_bf16_f32 v104, v80, v81
    v_cvt_pk_bf16_f32 v105, v82, v83
    v_pk_mul_f32 v[84:85], v[84:85], v[28:29] op_sel_hi:[1,0]
    v_pk_mul_f32 v[86:87], v[86:87], v[28:29] op_sel_hi:[1,0]
    v_cvt_pk_bf16_f32 v106, v84, v85
    v_cvt_pk_bf16_f32 v107, v86, v87
    v_pk_mul_f32 v[88:89], v[88:89], v[28:29] op_sel_hi:[1,0]
    v_pk_mul_f32 v[90:91], v[90:91], v[28:29] op_sel_hi:[1,0]
    v_cvt_pk_bf16_f32 v108, v88, v89
    v_cvt_pk_bf16_f32 v109, v90, v91
    v_pk_mul_f32 v[92:93], v[92:93], v[28:29] op_sel_hi:[1,0]
    v_pk_mul_f32 v[94:95], v[94:95], v[28:29] op_sel_hi:[1,0]
    v_cvt_pk_bf16_f32 v110, v92, v93
    v_cvt_pk_bf16_f32 v111, v94, v95
    buffer_store_dwordx4 v[96:99], v26, s[8:11], s32 offen offset:0 sc1
    buffer_store_dwordx4 v[100:103], v26, s[8:11], s32 offen offset:1024 sc1
    buffer_store_dwordx4 v[104:107], v26, s[8:11], s33 offen offset:0 sc1
    buffer_store_dwordx4 v[108:111], v26, s[8:11], s33 offen offset:1024 sc1
    v_mfma_f32_16x16x32_bf16 v[252:255], v[120:123], v[56:59], 0
    v_mfma_f32_16x16x32_bf16 v[64:67], v[208:211], v[56:59], 0
    v_mfma_f32_16x16x32_bf16 v[68:71], v[212:215], v[56:59], 0
    v_mfma_f32_16x16x32_bf16 v[72:75], v[216:219], v[56:59], 0
    v_mfma_f32_16x16x32_bf16 v[76:79], v[220:223], v[56:59], 0
    v_mfma_f32_16x16x32_bf16 v[80:83], v[224:227], v[56:59], 0
    v_mfma_f32_16x16x32_bf16 v[84:87], v[228:231], v[56:59], 0
    v_mfma_f32_16x16x32_bf16 v[88:91], v[232:235], v[56:59], 0
    v_mfma_f32_16x16x32_bf16 v[92:95], v[236:239], v[56:59], 0
    v_mfma_f32_16x16x16_bf16 v[252:255], v[120:121], v[248:249], v[252:255]
    v_mfma_f32_16x16x16_bf16 v[64:67], v[240:241], v[248:249], v[64:67]
    v_mfma_f32_16x16x16_bf16 v[68:71], v[240:241], v[250:251], v[68:71]
    v_mfma_f32_16x16x16_bf16 v[72:75], v[242:243], v[248:249], v[72:75]
    v_mfma_f32_16x16x16_bf16 v[76:79], v[242:243], v[250:251], v[76:79]
    v_mfma_f32_16x16x16_bf16 v[80:83], v[244:245], v[248:249], v[80:83]
    v_mfma_f32_16x16x16_bf16 v[84:87], v[244:245], v[250:251], v[84:87]
    v_mfma_f32_16x16x16_bf16 v[88:91], v[246:247], v[248:249], v[88:91]
    v_mfma_f32_16x16x16_bf16 v[92:95], v[246:247], v[250:251], v[92:95]
    s_add_u32 s30, s73, 0x2240000
    s_add_u32 s31, s30, 0x1000
    buffer_load_dwordx4 v[208:211], v26, s[8:11], s30 offen offset:0
    buffer_load_dwordx4 v[212:215], v26, s[8:11], s30 offen offset:1024
    buffer_load_dwordx4 v[216:219], v26, s[8:11], s30 offen offset:2048
    buffer_load_dwordx4 v[220:223], v26, s[8:11], s30 offen offset:3072
    buffer_load_dwordx4 v[224:227], v26, s[8:11], s31 offen offset:0
    buffer_load_dwordx4 v[228:231], v26, s[8:11], s31 offen offset:1024
    buffer_load_dwordx4 v[232:235], v26, s[8:11], s31 offen offset:2048
    buffer_load_dwordx4 v[236:239], v26, s[8:11], s31 offen offset:3072
    buffer_load_dwordx2 v[240:241], v125, s[8:11], s98 offen offset:1024
    buffer_load_dwordx2 v[242:243], v125, s[8:11], s99 offen offset:1024
    buffer_load_dwordx2 v[244:245], v125, s[8:11], s100 offen offset:1024
    buffer_load_dwordx2 v[246:247], v125, s[8:11], s101 offen offset:1024
    v_rcp_f32 v28, v252
    s_nop 0
    v_mul_f32 v28, v28, v113
    v_pk_mul_f32 v[64:65], v[64:65], v[28:29] op_sel_hi:[1,0]
    v_pk_mul_f32 v[66:67], v[66:67], v[28:29] op_sel_hi:[1,0]
    v_cvt_pk_bf16_f32 v96, v64, v65
    v_cvt_pk_bf16_f32 v97, v66, v67
    v_pk_mul_f32 v[68:69], v[68:69], v[28:29] op_sel_hi:[1,0]
    v_pk_mul_f32 v[70:71], v[70:71], v[28:29] op_sel_hi:[1,0]
    v_cvt_pk_bf16_f32 v98, v68, v69
    v_cvt_pk_bf16_f32 v99, v70, v71
    v_pk_mul_f32 v[72:73], v[72:73], v[28:29] op_sel_hi:[1,0]
    v_pk_mul_f32 v[74:75], v[74:75], v[28:29] op_sel_hi:[1,0]
    v_cvt_pk_bf16_f32 v100, v72, v73
    v_cvt_pk_bf16_f32 v101, v74, v75
    v_pk_mul_f32 v[76:77], v[76:77], v[28:29] op_sel_hi:[1,0]
    v_pk_mul_f32 v[78:79], v[78:79], v[28:29] op_sel_hi:[1,0]
    v_cvt_pk_bf16_f32 v102, v76, v77
    v_cvt_pk_bf16_f32 v103, v78, v79
    v_pk_mul_f32 v[80:81], v[80:81], v[28:29] op_sel_hi:[1,0]
    v_pk_mul_f32 v[82:83], v[82:83], v[28:29] op_sel_hi:[1,0]
    v_cvt_pk_bf16_f32 v104, v80, v81
    v_cvt_pk_bf16_f32 v105, v82, v83
    v_pk_mul_f32 v[84:85], v[84:85], v[28:29] op_sel_hi:[1,0]
    v_pk_mul_f32 v[86:87], v[86:87], v[28:29] op_sel_hi:[1,0]
    v_cvt_pk_bf16_f32 v106, v84, v85
    v_cvt_pk_bf16_f32 v107, v86, v87
    v_pk_mul_f32 v[88:89], v[88:89], v[28:29] op_sel_hi:[1,0]
    v_pk_mul_f32 v[90:91], v[90:91], v[28:29] op_sel_hi:[1,0]
    v_cvt_pk_bf16_f32 v108, v88, v89
    v_cvt_pk_bf16_f32 v109, v90, v91
    v_pk_mul_f32 v[92:93], v[92:93], v[28:29] op_sel_hi:[1,0]
    v_pk_mul_f32 v[94:95], v[94:95], v[28:29] op_sel_hi:[1,0]
    v_cvt_pk_bf16_f32 v110, v92, v93
    v_cvt_pk_bf16_f32 v111, v94, v95
    buffer_store_dwordx4 v[96:99], v26, s[8:11], s32 offen offset:2048 sc1
    buffer_store_dwordx4 v[100:103], v26, s[8:11], s32 offen offset:3072 sc1
    buffer_store_dwordx4 v[104:107], v26, s[8:11], s33 offen offset:2048 sc1
    buffer_store_dwordx4 v[108:111], v26, s[8:11], s33 offen offset:3072 sc1
    v_accvgpr_read_b32 v64, a16
    v_accvgpr_read_b32 v65, a17
    v_accvgpr_read_b32 v66, a18
    v_accvgpr_read_b32 v67, a19
    v_accvgpr_read_b32 v68, a20
    v_accvgpr_read_b32 v69, a21
    v_accvgpr_read_b32 v70, a22
    v_accvgpr_read_b32 v71, a23
    v_cvt_pk_bf16_f32 v128, v64, v65
    v_cvt_pk_bf16_f32 v129, v66, v67
    v_cvt_pk_bf16_f32 v130, v68, v69
    v_cvt_pk_bf16_f32 v131, v70, v71
    v_accvgpr_read_b32 v72, a80
    v_accvgpr_read_b32 v73, a81
    v_accvgpr_read_b32 v74, a82
    v_accvgpr_read_b32 v75, a83
    v_accvgpr_read_b32 v76, a84
    v_accvgpr_read_b32 v77, a85
    v_accvgpr_read_b32 v78, a86
    v_accvgpr_read_b32 v79, a87
    v_cvt_pk_bf16_f32 v132, v72, v73
    v_cvt_pk_bf16_f32 v133, v74, v75
    v_cvt_pk_bf16_f32 v134, v76, v77
    v_cvt_pk_bf16_f32 v135, v78, v79
    v_accvgpr_read_b32 v80, a144
    v_accvgpr_read_b32 v81, a145
    v_accvgpr_read_b32 v82, a146
    v_accvgpr_read_b32 v83, a147
    v_accvgpr_read_b32 v84, a148
    v_accvgpr_read_b32 v85, a149
    v_accvgpr_read_b32 v86, a150
    v_accvgpr_read_b32 v87, a151
    v_cvt_pk_bf16_f32 v136, v80, v81
    v_cvt_pk_bf16_f32 v137, v82, v83
    v_cvt_pk_bf16_f32 v138, v84, v85
    v_cvt_pk_bf16_f32 v139, v86, v87
    v_accvgpr_read_b32 v88, a208
    v_accvgpr_read_b32 v89, a209
    v_accvgpr_read_b32 v90, a210
    v_accvgpr_read_b32 v91, a211
    v_accvgpr_read_b32 v92, a212
    v_accvgpr_read_b32 v93, a213
    v_accvgpr_read_b32 v94, a214
    v_accvgpr_read_b32 v95, a215
    v_cvt_pk_bf16_f32 v140, v88, v89
    v_cvt_pk_bf16_f32 v141, v90, v91
    v_cvt_pk_bf16_f32 v142, v92, v93
    v_cvt_pk_bf16_f32 v143, v94, v95
    v_accvgpr_read_b32 v64, a24
    v_accvgpr_read_b32 v65, a25
    v_accvgpr_read_b32 v66, a26
    v_accvgpr_read_b32 v67, a27
    v_accvgpr_read_b32 v68, a28
    v_accvgpr_read_b32 v69, a29
    v_accvgpr_read_b32 v70, a30
    v_accvgpr_read_b32 v71, a31
    v_cvt_pk_bf16_f32 v144, v64, v65
    v_cvt_pk_bf16_f32 v145, v66, v67
    v_cvt_pk_bf16_f32 v146, v68, v69
    v_cvt_pk_bf16_f32 v147, v70, v71
    v_accvgpr_read_b32 v72, a88
    v_accvgpr_read_b32 v73, a89
    v_accvgpr_read_b32 v74, a90
    v_accvgpr_read_b32 v75, a91
    v_accvgpr_read_b32 v76, a92
    v_accvgpr_read_b32 v77, a93
    v_accvgpr_read_b32 v78, a94
    v_accvgpr_read_b32 v79, a95
    v_cvt_pk_bf16_f32 v148, v72, v73
    v_cvt_pk_bf16_f32 v149, v74, v75
    v_cvt_pk_bf16_f32 v150, v76, v77
    v_cvt_pk_bf16_f32 v151, v78, v79
    v_accvgpr_read_b32 v80, a152
    v_accvgpr_read_b32 v81, a153
    v_accvgpr_read_b32 v82, a154
    v_accvgpr_read_b32 v83, a155
    v_accvgpr_read_b32 v84, a156
    v_accvgpr_read_b32 v85, a157
    v_accvgpr_read_b32 v86, a158
    v_accvgpr_read_b32 v87, a159
    v_cvt_pk_bf16_f32 v152, v80, v81
    v_cvt_pk_bf16_f32 v153, v82, v83
    v_cvt_pk_bf16_f32 v154, v84, v85
    v_cvt_pk_bf16_f32 v155, v86, v87
    v_accvgpr_read_b32 v88, a216
    v_accvgpr_read_b32 v89, a217
    v_accvgpr_read_b32 v90, a218
    v_accvgpr_read_b32 v91, a219
    v_accvgpr_read_b32 v92, a220
    v_accvgpr_read_b32 v93, a221
    v_accvgpr_read_b32 v94, a222
    v_accvgpr_read_b32 v95, a223
    v_cvt_pk_bf16_f32 v156, v88, v89
    v_cvt_pk_bf16_f32 v157, v90, v91
    v_cvt_pk_bf16_f32 v158, v92, v93
    v_cvt_pk_bf16_f32 v159, v94, v95
    s_waitcnt vmcnt(20)
    v_mfma_f32_16x16x32_bf16 v[32:35], v[192:195], v[128:131], 0
    v_mfma_f32_16x16x32_bf16 v[36:39], v[160:163], v[128:131], 0
    v_mfma_f32_16x16x32_bf16 v[40:43], v[192:195], v[144:147], 0
    v_mfma_f32_16x16x32_bf16 v[44:47], v[160:163], v[144:147], 0
    v_mfma_f32_16x16x32_bf16 v[48:51], v[176:179], v[144:147], 0
    v_mfma_f32_16x16x32_bf16 v[32:35], v[196:199], v[132:135], v[32:35]
    v_mfma_f32_16x16x32_bf16 v[36:39], v[164:167], v[132:135], v[36:39]
    v_mfma_f32_16x16x32_bf16 v[40:43], v[196:199], v[148:151], v[40:43]
    v_mfma_f32_16x16x32_bf16 v[44:47], v[164:167], v[148:151], v[44:47]
    v_mfma_f32_16x16x32_bf16 v[48:51], v[180:183], v[148:151], v[48:51]
    v_mfma_f32_16x16x32_bf16 v[32:35], v[200:203], v[136:139], v[32:35]
    v_mfma_f32_16x16x32_bf16 v[36:39], v[168:171], v[136:139], v[36:39]
    v_mfma_f32_16x16x32_bf16 v[40:43], v[200:203], v[152:155], v[40:43]
    v_mfma_f32_16x16x32_bf16 v[44:47], v[168:171], v[152:155], v[44:47]
    v_mfma_f32_16x16x32_bf16 v[48:51], v[184:187], v[152:155], v[48:51]
    v_mfma_f32_16x16x32_bf16 v[32:35], v[204:207], v[140:143], v[32:35]
    v_mfma_f32_16x16x32_bf16 v[36:39], v[172:175], v[140:143], v[36:39]
    v_mfma_f32_16x16x32_bf16 v[40:43], v[204:207], v[156:159], v[40:43]
    v_mfma_f32_16x16x32_bf16 v[44:47], v[172:175], v[156:159], v[44:47]
    v_mfma_f32_16x16x32_bf16 v[48:51], v[188:191], v[156:159], v[48:51]
    s_add_u32 s30, s73, 0x1080000
    s_add_u32 s31, s30, 0x1000
    buffer_load_dwordx4 v[192:195], v124, s[8:11], s98 offen offset:2048
    buffer_load_dwordx4 v[196:199], v124, s[8:11], s99 offen offset:2048
    buffer_load_dwordx4 v[200:203], v124, s[8:11], s100 offen offset:2048
    buffer_load_dwordx4 v[204:207], v124, s[8:11], s101 offen offset:2048
    buffer_load_dwordx4 v[160:163], v26, s[8:11], s30 offen offset:0
    buffer_load_dwordx4 v[164:167], v26, s[8:11], s30 offen offset:1024
    buffer_load_dwordx4 v[168:171], v26, s[8:11], s30 offen offset:2048
    buffer_load_dwordx4 v[172:175], v26, s[8:11], s30 offen offset:3072
    buffer_load_dwordx4 v[176:179], v26, s[8:11], s31 offen offset:0
    buffer_load_dwordx4 v[180:183], v26, s[8:11], s31 offen offset:1024
    buffer_load_dwordx4 v[184:187], v26, s[8:11], s31 offen offset:2048
    buffer_load_dwordx4 v[188:191], v26, s[8:11], s31 offen offset:3072
    v_cndmask_b32 v36, v126, v36, s[88:89]
    v_cndmask_b32 v48, v126, v48, s[88:89]
    v_cndmask_b32 v37, v126, v37, s[90:91]
    v_cndmask_b32 v49, v126, v49, s[90:91]
    v_cndmask_b32 v38, v126, v38, s[92:93]
    v_cndmask_b32 v50, v126, v50, s[92:93]
    v_cndmask_b32 v39, v126, v39, s[94:95]
    v_cndmask_b32 v51, v126, v51, s[94:95]
    v_max3_f32 v28, v32, v33, v36
    v_max3_f32 v30, v40, v41, v44
    v_max3_f32 v28, v28, v37, v38
    v_max3_f32 v30, v30, v45, v46
    v_max_f32 v28, v28, v39
    v_max3_f32 v30, v30, v47, v48
    v_mov_b32 v29, v28
    v_max3_f32 v30, v30, v49, v50
    s_nop 0
    v_permlane16_swap_b32 v28, v29
    v_max_f32 v30, v30, v51
    v_max_f32 v28, v28, v29
    v_mov_b32 v31, v30
    v_mov_b32 v29, v28
    s_nop 0
    v_permlane16_swap_b32 v30, v31
    v_permlane32_swap_b32 v28, v29
    v_max_f32 v30, v30, v31
    v_max_f32 v28, v28, v29
    v_mov_b32 v31, v30
    v_mul_f32 v28, s96, v28
    s_nop 0
    v_permlane32_swap_b32 v30, v31
    v_fma_f32 v32, v32, s96, -v28
    v_max_f32 v30, v30, v31
    v_fma_f32 v33, v33, s96, -v28
    v_mul_f32 v30, s96, v30
    v_fma_f32 v36, v36, s96, -v28
    v_fma_f32 v40, v40, s96, -v30
    v_fma_f32 v37, v37, s96, -v28
    v_fma_f32 v41, v41, s96, -v30
    v_fma_f32 v38, v38, s96, -v28
    v_fma_f32 v44, v44, s96, -v30
    v_fma_f32 v39, v39, s96, -v28
    v_fma_f32 v45, v45, s96, -v30
    v_exp_f32 v32, v32
    v_fma_f32 v46, v46, s96, -v30
    v_exp_f32 v33, v33
    v_fma_f32 v47, v47, s96, -v30
    v_exp_f32 v36, v36
    v_fma_f32 v48, v48, s96, -v30
    v_exp_f32 v37, v37
    v_fma_f32 v49, v49, s96, -v30
    v_exp_f32 v38, v38
    v_fma_f32 v50, v50, s96, -v30
    v_exp_f32 v39, v39
    v_fma_f32 v51, v51, s96, -v30
    v_mov_b32 v61, 0
    v_exp_f32 v40, v40
    v_mov_b32 v62, 0
    v_exp_f32 v41, v41
    v_cvt_pk_bf16_f32 v60, v32, v33
    v_exp_f32 v44, v44
    v_cvt_pk_bf16_f32 v63, v32, v33
    v_exp_f32 v45, v45
    v_cvt_pk_bf16_f32 v52, v36, v37
    v_exp_f32 v46, v46
    v_cvt_pk_bf16_f32 v53, v38, v39
    v_exp_f32 v47, v47
    v_exp_f32 v48, v48
    v_exp_f32 v49, v49
    v_exp_f32 v50, v50
    v_exp_f32 v51, v51
    v_mov_b32 v249, 0
    v_mov_b32 v250, 0
    v_cvt_pk_bf16_f32 v248, v40, v41
    v_cvt_pk_bf16_f32 v251, v40, v41
    v_cvt_pk_bf16_f32 v56, v44, v45
    v_cvt_pk_bf16_f32 v57, v46, v47
    v_cvt_pk_bf16_f32 v58, v48, v49
    v_cvt_pk_bf16_f32 v59, v50, v51
    s_add_u32 s32, s78, 0x1000
    s_add_u32 s33, s78, 0x9000
    s_waitcnt vmcnt(16)
    v_mfma_f32_16x16x16_bf16 v[252:255], v[120:121], v[52:53], 0
    v_mfma_f32_16x16x16_bf16 v[64:67], v[208:209], v[52:53], 0
    v_mfma_f32_16x16x16_bf16 v[68:71], v[212:213], v[52:53], 0
    v_mfma_f32_16x16x16_bf16 v[72:75], v[216:217], v[52:53], 0
    v_mfma_f32_16x16x16_bf16 v[76:79], v[220:221], v[52:53], 0
    v_mfma_f32_16x16x16_bf16 v[80:83], v[224:225], v[52:53], 0
    v_mfma_f32_16x16x16_bf16 v[84:87], v[228:229], v[52:53], 0
    v_mfma_f32_16x16x16_bf16 v[88:91], v[232:233], v[52:53], 0
    v_mfma_f32_16x16x16_bf16 v[92:95], v[236:237], v[52:53], 0
    v_mfma_f32_16x16x16_bf16 v[252:255], v[120:121], v[60:61], v[252:255]
    v_mfma_f32_16x16x16_bf16 v[64:67], v[240:241], v[60:61], v[64:67]
    v_mfma_f32_16x16x16_bf16 v[68:71], v[240:241], v[62:63], v[68:71]
    v_mfma_f32_16x16x16_bf16 v[72:75], v[242:243], v[60:61], v[72:75]
    v_mfma_f32_16x16x16_bf16 v[76:79], v[242:243], v[62:63], v[76:79]
    v_mfma_f32_16x16x16_bf16 v[80:83], v[244:245], v[60:61], v[80:83]
    v_mfma_f32_16x16x16_bf16 v[84:87], v[244:245], v[62:63], v[84:87]
    v_mfma_f32_16x16x16_bf16 v[88:91], v[246:247], v[60:61], v[88:91]
    v_mfma_f32_16x16x16_bf16 v[92:95], v[246:247], v[62:63], v[92:95]
    v_rcp_f32 v28, v252
    s_nop 0
    v_mul_f32 v28, v28, v114
    v_pk_mul_f32 v[64:65], v[64:65], v[28:29] op_sel_hi:[1,0]
    v_pk_mul_f32 v[66:67], v[66:67], v[28:29] op_sel_hi:[1,0]
    v_cvt_pk_bf16_f32 v96, v64, v65
    v_cvt_pk_bf16_f32 v97, v66, v67
    v_pk_mul_f32 v[68:69], v[68:69], v[28:29] op_sel_hi:[1,0]
    v_pk_mul_f32 v[70:71], v[70:71], v[28:29] op_sel_hi:[1,0]
    v_cvt_pk_bf16_f32 v98, v68, v69
    v_cvt_pk_bf16_f32 v99, v70, v71
    v_pk_mul_f32 v[72:73], v[72:73], v[28:29] op_sel_hi:[1,0]
    v_pk_mul_f32 v[74:75], v[74:75], v[28:29] op_sel_hi:[1,0]
    v_cvt_pk_bf16_f32 v100, v72, v73
    v_cvt_pk_bf16_f32 v101, v74, v75
    v_pk_mul_f32 v[76:77], v[76:77], v[28:29] op_sel_hi:[1,0]
    v_pk_mul_f32 v[78:79], v[78:79], v[28:29] op_sel_hi:[1,0]
    v_cvt_pk_bf16_f32 v102, v76, v77
    v_cvt_pk_bf16_f32 v103, v78, v79
    v_pk_mul_f32 v[80:81], v[80:81], v[28:29] op_sel_hi:[1,0]
    v_pk_mul_f32 v[82:83], v[82:83], v[28:29] op_sel_hi:[1,0]
    v_cvt_pk_bf16_f32 v104, v80, v81
    v_cvt_pk_bf16_f32 v105, v82, v83
    v_pk_mul_f32 v[84:85], v[84:85], v[28:29] op_sel_hi:[1,0]
    v_pk_mul_f32 v[86:87], v[86:87], v[28:29] op_sel_hi:[1,0]
    v_cvt_pk_bf16_f32 v106, v84, v85
    v_cvt_pk_bf16_f32 v107, v86, v87
    v_pk_mul_f32 v[88:89], v[88:89], v[28:29] op_sel_hi:[1,0]
    v_pk_mul_f32 v[90:91], v[90:91], v[28:29] op_sel_hi:[1,0]
    v_cvt_pk_bf16_f32 v108, v88, v89
    v_cvt_pk_bf16_f32 v109, v90, v91
    v_pk_mul_f32 v[92:93], v[92:93], v[28:29] op_sel_hi:[1,0]
    v_pk_mul_f32 v[94:95], v[94:95], v[28:29] op_sel_hi:[1,0]
    v_cvt_pk_bf16_f32 v110, v92, v93
    v_cvt_pk_bf16_f32 v111, v94, v95
    buffer_store_dwordx4 v[96:99], v26, s[8:11], s32 offen offset:0 sc1
    buffer_store_dwordx4 v[100:103], v26, s[8:11], s32 offen offset:1024 sc1
    buffer_store_dwordx4 v[104:107], v26, s[8:11], s33 offen offset:0 sc1
    buffer_store_dwordx4 v[108:111], v26, s[8:11], s33 offen offset:1024 sc1
    v_mfma_f32_16x16x32_bf16 v[252:255], v[120:123], v[56:59], 0
    v_mfma_f32_16x16x32_bf16 v[64:67], v[208:211], v[56:59], 0
    v_mfma_f32_16x16x32_bf16 v[68:71], v[212:215], v[56:59], 0
    v_mfma_f32_16x16x32_bf16 v[72:75], v[216:219], v[56:59], 0
    v_mfma_f32_16x16x32_bf16 v[76:79], v[220:223], v[56:59], 0
    v_mfma_f32_16x16x32_bf16 v[80:83], v[224:227], v[56:59], 0
    v_mfma_f32_16x16x32_bf16 v[84:87], v[228:231], v[56:59], 0
    v_mfma_f32_16x16x32_bf16 v[88:91], v[232:235], v[56:59], 0
    v_mfma_f32_16x16x32_bf16 v[92:95], v[236:239], v[56:59], 0
    v_mfma_f32_16x16x16_bf16 v[252:255], v[120:121], v[248:249], v[252:255]
    v_mfma_f32_16x16x16_bf16 v[64:67], v[240:241], v[248:249], v[64:67]
    v_mfma_f32_16x16x16_bf16 v[68:71], v[240:241], v[250:251], v[68:71]
    v_mfma_f32_16x16x16_bf16 v[72:75], v[242:243], v[248:249], v[72:75]
    v_mfma_f32_16x16x16_bf16 v[76:79], v[242:243], v[250:251], v[76:79]
    v_mfma_f32_16x16x16_bf16 v[80:83], v[244:245], v[248:249], v[80:83]
    v_mfma_f32_16x16x16_bf16 v[84:87], v[244:245], v[250:251], v[84:87]
    v_mfma_f32_16x16x16_bf16 v[88:91], v[246:247], v[248:249], v[88:91]
    v_mfma_f32_16x16x16_bf16 v[92:95], v[246:247], v[250:251], v[92:95]
    s_add_u32 s30, s73, 0x2280000
    s_add_u32 s31, s30, 0x1000
    buffer_load_dwordx4 v[208:211], v26, s[8:11], s30 offen offset:0
    buffer_load_dwordx4 v[212:215], v26, s[8:11], s30 offen offset:1024
    buffer_load_dwordx4 v[216:219], v26, s[8:11], s30 offen offset:2048
    buffer_load_dwordx4 v[220:223], v26, s[8:11], s30 offen offset:3072
    buffer_load_dwordx4 v[224:227], v26, s[8:11], s31 offen offset:0
    buffer_load_dwordx4 v[228:231], v26, s[8:11], s31 offen offset:1024
    buffer_load_dwordx4 v[232:235], v26, s[8:11], s31 offen offset:2048
    buffer_load_dwordx4 v[236:239], v26, s[8:11], s31 offen offset:3072
    buffer_load_dwordx2 v[240:241], v125, s[8:11], s98 offen offset:2048
    buffer_load_dwordx2 v[242:243], v125, s[8:11], s99 offen offset:2048
    buffer_load_dwordx2 v[244:245], v125, s[8:11], s100 offen offset:2048
    buffer_load_dwordx2 v[246:247], v125, s[8:11], s101 offen offset:2048
    v_rcp_f32 v28, v252
    s_nop 0
    v_mul_f32 v28, v28, v115
    v_pk_mul_f32 v[64:65], v[64:65], v[28:29] op_sel_hi:[1,0]
    v_pk_mul_f32 v[66:67], v[66:67], v[28:29] op_sel_hi:[1,0]
    v_cvt_pk_bf16_f32 v96, v64, v65
    v_cvt_pk_bf16_f32 v97, v66, v67
    v_pk_mul_f32 v[68:69], v[68:69], v[28:29] op_sel_hi:[1,0]
    v_pk_mul_f32 v[70:71], v[70:71], v[28:29] op_sel_hi:[1,0]
    v_cvt_pk_bf16_f32 v98, v68, v69
    v_cvt_pk_bf16_f32 v99, v70, v71
    v_pk_mul_f32 v[72:73], v[72:73], v[28:29] op_sel_hi:[1,0]
    v_pk_mul_f32 v[74:75], v[74:75], v[28:29] op_sel_hi:[1,0]
    v_cvt_pk_bf16_f32 v100, v72, v73
    v_cvt_pk_bf16_f32 v101, v74, v75
    v_pk_mul_f32 v[76:77], v[76:77], v[28:29] op_sel_hi:[1,0]
    v_pk_mul_f32 v[78:79], v[78:79], v[28:29] op_sel_hi:[1,0]
    v_cvt_pk_bf16_f32 v102, v76, v77
    v_cvt_pk_bf16_f32 v103, v78, v79
    v_pk_mul_f32 v[80:81], v[80:81], v[28:29] op_sel_hi:[1,0]
    v_pk_mul_f32 v[82:83], v[82:83], v[28:29] op_sel_hi:[1,0]
    v_cvt_pk_bf16_f32 v104, v80, v81
    v_cvt_pk_bf16_f32 v105, v82, v83
    v_pk_mul_f32 v[84:85], v[84:85], v[28:29] op_sel_hi:[1,0]
    v_pk_mul_f32 v[86:87], v[86:87], v[28:29] op_sel_hi:[1,0]
    v_cvt_pk_bf16_f32 v106, v84, v85
    v_cvt_pk_bf16_f32 v107, v86, v87
    v_pk_mul_f32 v[88:89], v[88:89], v[28:29] op_sel_hi:[1,0]
    v_pk_mul_f32 v[90:91], v[90:91], v[28:29] op_sel_hi:[1,0]
    v_cvt_pk_bf16_f32 v108, v88, v89
    v_cvt_pk_bf16_f32 v109, v90, v91
    v_pk_mul_f32 v[92:93], v[92:93], v[28:29] op_sel_hi:[1,0]
    v_pk_mul_f32 v[94:95], v[94:95], v[28:29] op_sel_hi:[1,0]
    v_cvt_pk_bf16_f32 v110, v92, v93
    v_cvt_pk_bf16_f32 v111, v94, v95
    buffer_store_dwordx4 v[96:99], v26, s[8:11], s32 offen offset:2048 sc1
    buffer_store_dwordx4 v[100:103], v26, s[8:11], s32 offen offset:3072 sc1
    buffer_store_dwordx4 v[104:107], v26, s[8:11], s33 offen offset:2048 sc1
    buffer_store_dwordx4 v[108:111], v26, s[8:11], s33 offen offset:3072 sc1
    v_accvgpr_read_b32 v64, a32
    v_accvgpr_read_b32 v65, a33
    v_accvgpr_read_b32 v66, a34
    v_accvgpr_read_b32 v67, a35
    v_accvgpr_read_b32 v68, a36
    v_accvgpr_read_b32 v69, a37
    v_accvgpr_read_b32 v70, a38
    v_accvgpr_read_b32 v71, a39
    v_cvt_pk_bf16_f32 v128, v64, v65
    v_cvt_pk_bf16_f32 v129, v66, v67
    v_cvt_pk_bf16_f32 v130, v68, v69
    v_cvt_pk_bf16_f32 v131, v70, v71
    v_accvgpr_read_b32 v72, a96
    v_accvgpr_read_b32 v73, a97
    v_accvgpr_read_b32 v74, a98
    v_accvgpr_read_b32 v75, a99
    v_accvgpr_read_b32 v76, a100
    v_accvgpr_read_b32 v77, a101
    v_accvgpr_read_b32 v78, a102
    v_accvgpr_read_b32 v79, a103
    v_cvt_pk_bf16_f32 v132, v72, v73
    v_cvt_pk_bf16_f32 v133, v74, v75
    v_cvt_pk_bf16_f32 v134, v76, v77
    v_cvt_pk_bf16_f32 v135, v78, v79
    v_accvgpr_read_b32 v80, a160
    v_accvgpr_read_b32 v81, a161
    v_accvgpr_read_b32 v82, a162
    v_accvgpr_read_b32 v83, a163
    v_accvgpr_read_b32 v84, a164
    v_accvgpr_read_b32 v85, a165
    v_accvgpr_read_b32 v86, a166
    v_accvgpr_read_b32 v87, a167
    v_cvt_pk_bf16_f32 v136, v80, v81
    v_cvt_pk_bf16_f32 v137, v82, v83
    v_cvt_pk_bf16_f32 v138, v84, v85
    v_cvt_pk_bf16_f32 v139, v86, v87
    v_accvgpr_read_b32 v88, a224
    v_accvgpr_read_b32 v89, a225
    v_accvgpr_read_b32 v90, a226
    v_accvgpr_read_b32 v91, a227
    v_accvgpr_read_b32 v92, a228
    v_accvgpr_read_b32 v93, a229
    v_accvgpr_read_b32 v94, a230
    v_accvgpr_read_b32 v95, a231
    v_cvt_pk_bf16_f32 v140, v88, v89
    v_cvt_pk_bf16_f32 v141, v90, v91
    v_cvt_pk_bf16_f32 v142, v92, v93
    v_cvt_pk_bf16_f32 v143, v94, v95
    v_accvgpr_read_b32 v64, a40
    v_accvgpr_read_b32 v65, a41
    v_accvgpr_read_b32 v66, a42
    v_accvgpr_read_b32 v67, a43
    v_accvgpr_read_b32 v68, a44
    v_accvgpr_read_b32 v69, a45
    v_accvgpr_read_b32 v70, a46
    v_accvgpr_read_b32 v71, a47
    v_cvt_pk_bf16_f32 v144, v64, v65
    v_cvt_pk_bf16_f32 v145, v66, v67
    v_cvt_pk_bf16_f32 v146, v68, v69
    v_cvt_pk_bf16_f32 v147, v70, v71
    v_accvgpr_read_b32 v72, a104
    v_accvgpr_read_b32 v73, a105
    v_accvgpr_read_b32 v74, a106
    v_accvgpr_read_b32 v75, a107
    v_accvgpr_read_b32 v76, a108
    v_accvgpr_read_b32 v77, a109
    v_accvgpr_read_b32 v78, a110
    v_accvgpr_read_b32 v79, a111
    v_cvt_pk_bf16_f32 v148, v72, v73
    v_cvt_pk_bf16_f32 v149, v74, v75
    v_cvt_pk_bf16_f32 v150, v76, v77
    v_cvt_pk_bf16_f32 v151, v78, v79
    v_accvgpr_read_b32 v80, a168
    v_accvgpr_read_b32 v81, a169
    v_accvgpr_read_b32 v82, a170
    v_accvgpr_read_b32 v83, a171
    v_accvgpr_read_b32 v84, a172
    v_accvgpr_read_b32 v85, a173
    v_accvgpr_read_b32 v86, a174
    v_accvgpr_read_b32 v87, a175
    v_cvt_pk_bf16_f32 v152, v80, v81
    v_cvt_pk_bf16_f32 v153, v82, v83
    v_cvt_pk_bf16_f32 v154, v84, v85
    v_cvt_pk_bf16_f32 v155, v86, v87
    v_accvgpr_read_b32 v88, a232
    v_accvgpr_read_b32 v89, a233
    v_accvgpr_read_b32 v90, a234
    v_accvgpr_read_b32 v91, a235
    v_accvgpr_read_b32 v92, a236
    v_accvgpr_read_b32 v93, a237
    v_accvgpr_read_b32 v94, a238
    v_accvgpr_read_b32 v95, a239
    v_cvt_pk_bf16_f32 v156, v88, v89
    v_cvt_pk_bf16_f32 v157, v90, v91
    v_cvt_pk_bf16_f32 v158, v92, v93
    v_cvt_pk_bf16_f32 v159, v94, v95
    s_waitcnt vmcnt(20)
    v_mfma_f32_16x16x32_bf16 v[32:35], v[192:195], v[128:131], 0
    v_mfma_f32_16x16x32_bf16 v[36:39], v[160:163], v[128:131], 0
    v_mfma_f32_16x16x32_bf16 v[40:43], v[192:195], v[144:147], 0
    v_mfma_f32_16x16x32_bf16 v[44:47], v[160:163], v[144:147], 0
    v_mfma_f32_16x16x32_bf16 v[48:51], v[176:179], v[144:147], 0
    v_mfma_f32_16x16x32_bf16 v[32:35], v[196:199], v[132:135], v[32:35]
    v_mfma_f32_16x16x32_bf16 v[36:39], v[164:167], v[132:135], v[36:39]
    v_mfma_f32_16x16x32_bf16 v[40:43], v[196:199], v[148:151], v[40:43]
    v_mfma_f32_16x16x32_bf16 v[44:47], v[164:167], v[148:151], v[44:47]
    v_mfma_f32_16x16x32_bf16 v[48:51], v[180:183], v[148:151], v[48:51]
    v_mfma_f32_16x16x32_bf16 v[32:35], v[200:203], v[136:139], v[32:35]
    v_mfma_f32_16x16x32_bf16 v[36:39], v[168:171], v[136:139], v[36:39]
    v_mfma_f32_16x16x32_bf16 v[40:43], v[200:203], v[152:155], v[40:43]
    v_mfma_f32_16x16x32_bf16 v[44:47], v[168:171], v[152:155], v[44:47]
    v_mfma_f32_16x16x32_bf16 v[48:51], v[184:187], v[152:155], v[48:51]
    v_mfma_f32_16x16x32_bf16 v[32:35], v[204:207], v[140:143], v[32:35]
    v_mfma_f32_16x16x32_bf16 v[36:39], v[172:175], v[140:143], v[36:39]
    v_mfma_f32_16x16x32_bf16 v[40:43], v[204:207], v[156:159], v[40:43]
    v_mfma_f32_16x16x32_bf16 v[44:47], v[172:175], v[156:159], v[44:47]
    v_mfma_f32_16x16x32_bf16 v[48:51], v[188:191], v[156:159], v[48:51]
    s_add_u32 s30, s73, 0x10c0000
    s_add_u32 s31, s30, 0x1000
    buffer_load_dwordx4 v[192:195], v124, s[8:11], s98 offen offset:3072
    buffer_load_dwordx4 v[196:199], v124, s[8:11], s99 offen offset:3072
    buffer_load_dwordx4 v[200:203], v124, s[8:11], s100 offen offset:3072
    buffer_load_dwordx4 v[204:207], v124, s[8:11], s101 offen offset:3072
    buffer_load_dwordx4 v[160:163], v26, s[8:11], s30 offen offset:0
    buffer_load_dwordx4 v[164:167], v26, s[8:11], s30 offen offset:1024
    buffer_load_dwordx4 v[168:171], v26, s[8:11], s30 offen offset:2048
    buffer_load_dwordx4 v[172:175], v26, s[8:11], s30 offen offset:3072
    buffer_load_dwordx4 v[176:179], v26, s[8:11], s31 offen offset:0
    buffer_load_dwordx4 v[180:183], v26, s[8:11], s31 offen offset:1024
    buffer_load_dwordx4 v[184:187], v26, s[8:11], s31 offen offset:2048
    buffer_load_dwordx4 v[188:191], v26, s[8:11], s31 offen offset:3072
    v_cndmask_b32 v36, v126, v36, s[88:89]
    v_cndmask_b32 v48, v126, v48, s[88:89]
    v_cndmask_b32 v37, v126, v37, s[90:91]
    v_cndmask_b32 v49, v126, v49, s[90:91]
    v_cndmask_b32 v38, v126, v38, s[92:93]
    v_cndmask_b32 v50, v126, v50, s[92:93]
    v_cndmask_b32 v39, v126, v39, s[94:95]
    v_cndmask_b32 v51, v126, v51, s[94:95]
    v_max3_f32 v28, v32, v33, v36
    v_max3_f32 v30, v40, v41, v44
    v_max3_f32 v28, v28, v37, v38
    v_max3_f32 v30, v30, v45, v46
    v_max_f32 v28, v28, v39
    v_max3_f32 v30, v30, v47, v48
    v_mov_b32 v29, v28
    v_max3_f32 v30, v30, v49, v50
    s_nop 0
    v_permlane16_swap_b32 v28, v29
    v_max_f32 v30, v30, v51
    v_max_f32 v28, v28, v29
    v_mov_b32 v31, v30
    v_mov_b32 v29, v28
    s_nop 0
    v_permlane16_swap_b32 v30, v31
    v_permlane32_swap_b32 v28, v29
    v_max_f32 v30, v30, v31
    v_max_f32 v28, v28, v29
    v_mov_b32 v31, v30
    v_mul_f32 v28, s96, v28
    s_nop 0
    v_permlane32_swap_b32 v30, v31
    v_fma_f32 v32, v32, s96, -v28
    v_max_f32 v30, v30, v31
    v_fma_f32 v33, v33, s96, -v28
    v_mul_f32 v30, s96, v30
    v_fma_f32 v36, v36, s96, -v28
    v_fma_f32 v40, v40, s96, -v30
    v_fma_f32 v37, v37, s96, -v28
    v_fma_f32 v41, v41, s96, -v30
    v_fma_f32 v38, v38, s96, -v28
    v_fma_f32 v44, v44, s96, -v30
    v_fma_f32 v39, v39, s96, -v28
    v_fma_f32 v45, v45, s96, -v30
    v_exp_f32 v32, v32
    v_fma_f32 v46, v46, s96, -v30
    v_exp_f32 v33, v33
    v_fma_f32 v47, v47, s96, -v30
    v_exp_f32 v36, v36
    v_fma_f32 v48, v48, s96, -v30
    v_exp_f32 v37, v37
    v_fma_f32 v49, v49, s96, -v30
    v_exp_f32 v38, v38
    v_fma_f32 v50, v50, s96, -v30
    v_exp_f32 v39, v39
    v_fma_f32 v51, v51, s96, -v30
    v_mov_b32 v61, 0
    v_exp_f32 v40, v40
    v_mov_b32 v62, 0
    v_exp_f32 v41, v41
    v_cvt_pk_bf16_f32 v60, v32, v33
    v_exp_f32 v44, v44
    v_cvt_pk_bf16_f32 v63, v32, v33
    v_exp_f32 v45, v45
    v_cvt_pk_bf16_f32 v52, v36, v37
    v_exp_f32 v46, v46
    v_cvt_pk_bf16_f32 v53, v38, v39
    v_exp_f32 v47, v47
    v_exp_f32 v48, v48
    v_exp_f32 v49, v49
    v_exp_f32 v50, v50
    v_exp_f32 v51, v51
    v_mov_b32 v249, 0
    v_mov_b32 v250, 0
    v_cvt_pk_bf16_f32 v248, v40, v41
    v_cvt_pk_bf16_f32 v251, v40, v41
    v_cvt_pk_bf16_f32 v56, v44, v45
    v_cvt_pk_bf16_f32 v57, v46, v47
    v_cvt_pk_bf16_f32 v58, v48, v49
    v_cvt_pk_bf16_f32 v59, v50, v51
    s_add_u32 s32, s78, 0x2000
    s_add_u32 s33, s78, 0xa000
    s_waitcnt vmcnt(16)
    v_mfma_f32_16x16x16_bf16 v[252:255], v[120:121], v[52:53], 0
    v_mfma_f32_16x16x16_bf16 v[64:67], v[208:209], v[52:53], 0
    v_mfma_f32_16x16x16_bf16 v[68:71], v[212:213], v[52:53], 0
    v_mfma_f32_16x16x16_bf16 v[72:75], v[216:217], v[52:53], 0
    v_mfma_f32_16x16x16_bf16 v[76:79], v[220:221], v[52:53], 0
    v_mfma_f32_16x16x16_bf16 v[80:83], v[224:225], v[52:53], 0
    v_mfma_f32_16x16x16_bf16 v[84:87], v[228:229], v[52:53], 0
    v_mfma_f32_16x16x16_bf16 v[88:91], v[232:233], v[52:53], 0
    v_mfma_f32_16x16x16_bf16 v[92:95], v[236:237], v[52:53], 0
    v_mfma_f32_16x16x16_bf16 v[252:255], v[120:121], v[60:61], v[252:255]
    v_mfma_f32_16x16x16_bf16 v[64:67], v[240:241], v[60:61], v[64:67]
    v_mfma_f32_16x16x16_bf16 v[68:71], v[240:241], v[62:63], v[68:71]
    v_mfma_f32_16x16x16_bf16 v[72:75], v[242:243], v[60:61], v[72:75]
    v_mfma_f32_16x16x16_bf16 v[76:79], v[242:243], v[62:63], v[76:79]
    v_mfma_f32_16x16x16_bf16 v[80:83], v[244:245], v[60:61], v[80:83]
    v_mfma_f32_16x16x16_bf16 v[84:87], v[244:245], v[62:63], v[84:87]
    v_mfma_f32_16x16x16_bf16 v[88:91], v[246:247], v[60:61], v[88:91]
    v_mfma_f32_16x16x16_bf16 v[92:95], v[246:247], v[62:63], v[92:95]
    v_rcp_f32 v28, v252
    s_nop 0
    v_mul_f32 v28, v28, v116
    v_pk_mul_f32 v[64:65], v[64:65], v[28:29] op_sel_hi:[1,0]
    v_pk_mul_f32 v[66:67], v[66:67], v[28:29] op_sel_hi:[1,0]
    v_cvt_pk_bf16_f32 v96, v64, v65
    v_cvt_pk_bf16_f32 v97, v66, v67
    v_pk_mul_f32 v[68:69], v[68:69], v[28:29] op_sel_hi:[1,0]
    v_pk_mul_f32 v[70:71], v[70:71], v[28:29] op_sel_hi:[1,0]
    v_cvt_pk_bf16_f32 v98, v68, v69
    v_cvt_pk_bf16_f32 v99, v70, v71
    v_pk_mul_f32 v[72:73], v[72:73], v[28:29] op_sel_hi:[1,0]
    v_pk_mul_f32 v[74:75], v[74:75], v[28:29] op_sel_hi:[1,0]
    v_cvt_pk_bf16_f32 v100, v72, v73
    v_cvt_pk_bf16_f32 v101, v74, v75
    v_pk_mul_f32 v[76:77], v[76:77], v[28:29] op_sel_hi:[1,0]
    v_pk_mul_f32 v[78:79], v[78:79], v[28:29] op_sel_hi:[1,0]
    v_cvt_pk_bf16_f32 v102, v76, v77
    v_cvt_pk_bf16_f32 v103, v78, v79
    v_pk_mul_f32 v[80:81], v[80:81], v[28:29] op_sel_hi:[1,0]
    v_pk_mul_f32 v[82:83], v[82:83], v[28:29] op_sel_hi:[1,0]
    v_cvt_pk_bf16_f32 v104, v80, v81
    v_cvt_pk_bf16_f32 v105, v82, v83
    v_pk_mul_f32 v[84:85], v[84:85], v[28:29] op_sel_hi:[1,0]
    v_pk_mul_f32 v[86:87], v[86:87], v[28:29] op_sel_hi:[1,0]
    v_cvt_pk_bf16_f32 v106, v84, v85
    v_cvt_pk_bf16_f32 v107, v86, v87
    v_pk_mul_f32 v[88:89], v[88:89], v[28:29] op_sel_hi:[1,0]
    v_pk_mul_f32 v[90:91], v[90:91], v[28:29] op_sel_hi:[1,0]
    v_cvt_pk_bf16_f32 v108, v88, v89
    v_cvt_pk_bf16_f32 v109, v90, v91
    v_pk_mul_f32 v[92:93], v[92:93], v[28:29] op_sel_hi:[1,0]
    v_pk_mul_f32 v[94:95], v[94:95], v[28:29] op_sel_hi:[1,0]
    v_cvt_pk_bf16_f32 v110, v92, v93
    v_cvt_pk_bf16_f32 v111, v94, v95
    buffer_store_dwordx4 v[96:99], v26, s[8:11], s32 offen offset:0 sc1
    buffer_store_dwordx4 v[100:103], v26, s[8:11], s32 offen offset:1024 sc1
    buffer_store_dwordx4 v[104:107], v26, s[8:11], s33 offen offset:0 sc1
    buffer_store_dwordx4 v[108:111], v26, s[8:11], s33 offen offset:1024 sc1
    v_mfma_f32_16x16x32_bf16 v[252:255], v[120:123], v[56:59], 0
    v_mfma_f32_16x16x32_bf16 v[64:67], v[208:211], v[56:59], 0
    v_mfma_f32_16x16x32_bf16 v[68:71], v[212:215], v[56:59], 0
    v_mfma_f32_16x16x32_bf16 v[72:75], v[216:219], v[56:59], 0
    v_mfma_f32_16x16x32_bf16 v[76:79], v[220:223], v[56:59], 0
    v_mfma_f32_16x16x32_bf16 v[80:83], v[224:227], v[56:59], 0
    v_mfma_f32_16x16x32_bf16 v[84:87], v[228:231], v[56:59], 0
    v_mfma_f32_16x16x32_bf16 v[88:91], v[232:235], v[56:59], 0
    v_mfma_f32_16x16x32_bf16 v[92:95], v[236:239], v[56:59], 0
    v_mfma_f32_16x16x16_bf16 v[252:255], v[120:121], v[248:249], v[252:255]
    v_mfma_f32_16x16x16_bf16 v[64:67], v[240:241], v[248:249], v[64:67]
    v_mfma_f32_16x16x16_bf16 v[68:71], v[240:241], v[250:251], v[68:71]
    v_mfma_f32_16x16x16_bf16 v[72:75], v[242:243], v[248:249], v[72:75]
    v_mfma_f32_16x16x16_bf16 v[76:79], v[242:243], v[250:251], v[76:79]
    v_mfma_f32_16x16x16_bf16 v[80:83], v[244:245], v[248:249], v[80:83]
    v_mfma_f32_16x16x16_bf16 v[84:87], v[244:245], v[250:251], v[84:87]
    v_mfma_f32_16x16x16_bf16 v[88:91], v[246:247], v[248:249], v[88:91]
    v_mfma_f32_16x16x16_bf16 v[92:95], v[246:247], v[250:251], v[92:95]
    s_add_u32 s30, s73, 0x22c0000
    s_add_u32 s31, s30, 0x1000
    buffer_load_dwordx4 v[208:211], v26, s[8:11], s30 offen offset:0
    buffer_load_dwordx4 v[212:215], v26, s[8:11], s30 offen offset:1024
    buffer_load_dwordx4 v[216:219], v26, s[8:11], s30 offen offset:2048
    buffer_load_dwordx4 v[220:223], v26, s[8:11], s30 offen offset:3072
    buffer_load_dwordx4 v[224:227], v26, s[8:11], s31 offen offset:0
    buffer_load_dwordx4 v[228:231], v26, s[8:11], s31 offen offset:1024
    buffer_load_dwordx4 v[232:235], v26, s[8:11], s31 offen offset:2048
    buffer_load_dwordx4 v[236:239], v26, s[8:11], s31 offen offset:3072
    buffer_load_dwordx2 v[240:241], v125, s[8:11], s98 offen offset:3072
    buffer_load_dwordx2 v[242:243], v125, s[8:11], s99 offen offset:3072
    buffer_load_dwordx2 v[244:245], v125, s[8:11], s100 offen offset:3072
    buffer_load_dwordx2 v[246:247], v125, s[8:11], s101 offen offset:3072
    v_rcp_f32 v28, v252
    s_nop 0
    v_mul_f32 v28, v28, v117
    v_pk_mul_f32 v[64:65], v[64:65], v[28:29] op_sel_hi:[1,0]
    v_pk_mul_f32 v[66:67], v[66:67], v[28:29] op_sel_hi:[1,0]
    v_cvt_pk_bf16_f32 v96, v64, v65
    v_cvt_pk_bf16_f32 v97, v66, v67
    v_pk_mul_f32 v[68:69], v[68:69], v[28:29] op_sel_hi:[1,0]
    v_pk_mul_f32 v[70:71], v[70:71], v[28:29] op_sel_hi:[1,0]
    v_cvt_pk_bf16_f32 v98, v68, v69
    v_cvt_pk_bf16_f32 v99, v70, v71
    v_pk_mul_f32 v[72:73], v[72:73], v[28:29] op_sel_hi:[1,0]
    v_pk_mul_f32 v[74:75], v[74:75], v[28:29] op_sel_hi:[1,0]
    v_cvt_pk_bf16_f32 v100, v72, v73
    v_cvt_pk_bf16_f32 v101, v74, v75
    v_pk_mul_f32 v[76:77], v[76:77], v[28:29] op_sel_hi:[1,0]
    v_pk_mul_f32 v[78:79], v[78:79], v[28:29] op_sel_hi:[1,0]
    v_cvt_pk_bf16_f32 v102, v76, v77
    v_cvt_pk_bf16_f32 v103, v78, v79
    v_pk_mul_f32 v[80:81], v[80:81], v[28:29] op_sel_hi:[1,0]
    v_pk_mul_f32 v[82:83], v[82:83], v[28:29] op_sel_hi:[1,0]
    v_cvt_pk_bf16_f32 v104, v80, v81
    v_cvt_pk_bf16_f32 v105, v82, v83
    v_pk_mul_f32 v[84:85], v[84:85], v[28:29] op_sel_hi:[1,0]
    v_pk_mul_f32 v[86:87], v[86:87], v[28:29] op_sel_hi:[1,0]
    v_cvt_pk_bf16_f32 v106, v84, v85
    v_cvt_pk_bf16_f32 v107, v86, v87
    v_pk_mul_f32 v[88:89], v[88:89], v[28:29] op_sel_hi:[1,0]
    v_pk_mul_f32 v[90:91], v[90:91], v[28:29] op_sel_hi:[1,0]
    v_cvt_pk_bf16_f32 v108, v88, v89
    v_cvt_pk_bf16_f32 v109, v90, v91
    v_pk_mul_f32 v[92:93], v[92:93], v[28:29] op_sel_hi:[1,0]
    v_pk_mul_f32 v[94:95], v[94:95], v[28:29] op_sel_hi:[1,0]
    v_cvt_pk_bf16_f32 v110, v92, v93
    v_cvt_pk_bf16_f32 v111, v94, v95
    buffer_store_dwordx4 v[96:99], v26, s[8:11], s32 offen offset:2048 sc1
    buffer_store_dwordx4 v[100:103], v26, s[8:11], s32 offen offset:3072 sc1
    buffer_store_dwordx4 v[104:107], v26, s[8:11], s33 offen offset:2048 sc1
    buffer_store_dwordx4 v[108:111], v26, s[8:11], s33 offen offset:3072 sc1
    v_accvgpr_read_b32 v64, a48
    v_accvgpr_read_b32 v65, a49
    v_accvgpr_read_b32 v66, a50
    v_accvgpr_read_b32 v67, a51
    v_accvgpr_read_b32 v68, a52
    v_accvgpr_read_b32 v69, a53
    v_accvgpr_read_b32 v70, a54
    v_accvgpr_read_b32 v71, a55
    v_cvt_pk_bf16_f32 v128, v64, v65
    v_cvt_pk_bf16_f32 v129, v66, v67
    v_cvt_pk_bf16_f32 v130, v68, v69
    v_cvt_pk_bf16_f32 v131, v70, v71
    v_accvgpr_read_b32 v72, a112
    v_accvgpr_read_b32 v73, a113
    v_accvgpr_read_b32 v74, a114
    v_accvgpr_read_b32 v75, a115
    v_accvgpr_read_b32 v76, a116
    v_accvgpr_read_b32 v77, a117
    v_accvgpr_read_b32 v78, a118
    v_accvgpr_read_b32 v79, a119
    v_cvt_pk_bf16_f32 v132, v72, v73
    v_cvt_pk_bf16_f32 v133, v74, v75
    v_cvt_pk_bf16_f32 v134, v76, v77
    v_cvt_pk_bf16_f32 v135, v78, v79
    v_accvgpr_read_b32 v80, a176
    v_accvgpr_read_b32 v81, a177
    v_accvgpr_read_b32 v82, a178
    v_accvgpr_read_b32 v83, a179
    v_accvgpr_read_b32 v84, a180
    v_accvgpr_read_b32 v85, a181
    v_accvgpr_read_b32 v86, a182
    v_accvgpr_read_b32 v87, a183
    v_cvt_pk_bf16_f32 v136, v80, v81
    v_cvt_pk_bf16_f32 v137, v82, v83
    v_cvt_pk_bf16_f32 v138, v84, v85
    v_cvt_pk_bf16_f32 v139, v86, v87
    v_accvgpr_read_b32 v88, a240
    v_accvgpr_read_b32 v89, a241
    v_accvgpr_read_b32 v90, a242
    v_accvgpr_read_b32 v91, a243
    v_accvgpr_read_b32 v92, a244
    v_accvgpr_read_b32 v93, a245
    v_accvgpr_read_b32 v94, a246
    v_accvgpr_read_b32 v95, a247
    v_cvt_pk_bf16_f32 v140, v88, v89
    v_cvt_pk_bf16_f32 v141, v90, v91
    v_cvt_pk_bf16_f32 v142, v92, v93
    v_cvt_pk_bf16_f32 v143, v94, v95
    v_accvgpr_read_b32 v64, a56
    v_accvgpr_read_b32 v65, a57
    v_accvgpr_read_b32 v66, a58
    v_accvgpr_read_b32 v67, a59
    v_accvgpr_read_b32 v68, a60
    v_accvgpr_read_b32 v69, a61
    v_accvgpr_read_b32 v70, a62
    v_accvgpr_read_b32 v71, a63
    v_cvt_pk_bf16_f32 v144, v64, v65
    v_cvt_pk_bf16_f32 v145, v66, v67
    v_cvt_pk_bf16_f32 v146, v68, v69
    v_cvt_pk_bf16_f32 v147, v70, v71
    v_accvgpr_read_b32 v72, a120
    v_accvgpr_read_b32 v73, a121
    v_accvgpr_read_b32 v74, a122
    v_accvgpr_read_b32 v75, a123
    v_accvgpr_read_b32 v76, a124
    v_accvgpr_read_b32 v77, a125
    v_accvgpr_read_b32 v78, a126
    v_accvgpr_read_b32 v79, a127
    v_cvt_pk_bf16_f32 v148, v72, v73
    v_cvt_pk_bf16_f32 v149, v74, v75
    v_cvt_pk_bf16_f32 v150, v76, v77
    v_cvt_pk_bf16_f32 v151, v78, v79
    v_accvgpr_read_b32 v80, a184
    v_accvgpr_read_b32 v81, a185
    v_accvgpr_read_b32 v82, a186
    v_accvgpr_read_b32 v83, a187
    v_accvgpr_read_b32 v84, a188
    v_accvgpr_read_b32 v85, a189
    v_accvgpr_read_b32 v86, a190
    v_accvgpr_read_b32 v87, a191
    v_cvt_pk_bf16_f32 v152, v80, v81
    v_cvt_pk_bf16_f32 v153, v82, v83
    v_cvt_pk_bf16_f32 v154, v84, v85
    v_cvt_pk_bf16_f32 v155, v86, v87
    v_accvgpr_read_b32 v88, a248
    v_accvgpr_read_b32 v89, a249
    v_accvgpr_read_b32 v90, a250
    v_accvgpr_read_b32 v91, a251
    v_accvgpr_read_b32 v92, a252
    v_accvgpr_read_b32 v93, a253
    v_accvgpr_read_b32 v94, a254
    v_accvgpr_read_b32 v95, a255
    v_cvt_pk_bf16_f32 v156, v88, v89
    v_cvt_pk_bf16_f32 v157, v90, v91
    v_cvt_pk_bf16_f32 v158, v92, v93
    v_cvt_pk_bf16_f32 v159, v94, v95
    s_waitcnt vmcnt(20)
    v_mfma_f32_16x16x32_bf16 v[32:35], v[192:195], v[128:131], 0
    v_mfma_f32_16x16x32_bf16 v[36:39], v[160:163], v[128:131], 0
    v_mfma_f32_16x16x32_bf16 v[40:43], v[192:195], v[144:147], 0
    v_mfma_f32_16x16x32_bf16 v[44:47], v[160:163], v[144:147], 0
    v_mfma_f32_16x16x32_bf16 v[48:51], v[176:179], v[144:147], 0
    v_mfma_f32_16x16x32_bf16 v[32:35], v[196:199], v[132:135], v[32:35]
    v_mfma_f32_16x16x32_bf16 v[36:39], v[164:167], v[132:135], v[36:39]
    v_mfma_f32_16x16x32_bf16 v[40:43], v[196:199], v[148:151], v[40:43]
    v_mfma_f32_16x16x32_bf16 v[44:47], v[164:167], v[148:151], v[44:47]
    v_mfma_f32_16x16x32_bf16 v[48:51], v[180:183], v[148:151], v[48:51]
    v_mfma_f32_16x16x32_bf16 v[32:35], v[200:203], v[136:139], v[32:35]
    v_mfma_f32_16x16x32_bf16 v[36:39], v[168:171], v[136:139], v[36:39]
    v_mfma_f32_16x16x32_bf16 v[40:43], v[200:203], v[152:155], v[40:43]
    v_mfma_f32_16x16x32_bf16 v[44:47], v[168:171], v[152:155], v[44:47]
    v_mfma_f32_16x16x32_bf16 v[48:51], v[184:187], v[152:155], v[48:51]
    v_mfma_f32_16x16x32_bf16 v[32:35], v[204:207], v[140:143], v[32:35]
    v_mfma_f32_16x16x32_bf16 v[36:39], v[172:175], v[140:143], v[36:39]
    v_mfma_f32_16x16x32_bf16 v[40:43], v[204:207], v[156:159], v[40:43]
    v_mfma_f32_16x16x32_bf16 v[44:47], v[172:175], v[156:159], v[44:47]
    v_mfma_f32_16x16x32_bf16 v[48:51], v[188:191], v[156:159], v[48:51]
    s_nop 4
    v_cndmask_b32 v36, v126, v36, s[88:89]
    s_nop 1
    v_cndmask_b32 v48, v126, v48, s[88:89]
    v_cndmask_b32 v37, v126, v37, s[90:91]
    v_cndmask_b32 v49, v126, v49, s[90:91]
    v_cndmask_b32 v38, v126, v38, s[92:93]
    v_cndmask_b32 v50, v126, v50, s[92:93]
    v_cndmask_b32 v39, v126, v39, s[94:95]
    v_cndmask_b32 v51, v126, v51, s[94:95]
    v_max3_f32 v28, v32, v33, v36
    v_max3_f32 v30, v40, v41, v44
    v_max3_f32 v28, v28, v37, v38
    v_max3_f32 v30, v30, v45, v46
    v_max_f32 v28, v28, v39
    v_max3_f32 v30, v30, v47, v48
    v_mov_b32 v29, v28
    v_max3_f32 v30, v30, v49, v50
    s_nop 0
    v_permlane16_swap_b32 v28, v29
    v_max_f32 v30, v30, v51
    v_max_f32 v28, v28, v29
    v_mov_b32 v31, v30
    v_mov_b32 v29, v28
    s_nop 0
    v_permlane16_swap_b32 v30, v31
    v_permlane32_swap_b32 v28, v29
    v_max_f32 v30, v30, v31
    v_max_f32 v28, v28, v29
    v_mov_b32 v31, v30
    v_mul_f32 v28, s96, v28
    s_nop 0
    v_permlane32_swap_b32 v30, v31
    v_fma_f32 v32, v32, s96, -v28
    v_max_f32 v30, v30, v31
    v_fma_f32 v33, v33, s96, -v28
    v_mul_f32 v30, s96, v30
    v_fma_f32 v36, v36, s96, -v28
    v_fma_f32 v40, v40, s96, -v30
    v_fma_f32 v37, v37, s96, -v28
    v_fma_f32 v41, v41, s96, -v30
    v_fma_f32 v38, v38, s96, -v28
    v_fma_f32 v44, v44, s96, -v30
    v_fma_f32 v39, v39, s96, -v28
    v_fma_f32 v45, v45, s96, -v30
    v_exp_f32 v32, v32
    v_fma_f32 v46, v46, s96, -v30
    v_exp_f32 v33, v33
    v_fma_f32 v47, v47, s96, -v30
    v_exp_f32 v36, v36
    v_fma_f32 v48, v48, s96, -v30
    v_exp_f32 v37, v37
    v_fma_f32 v49, v49, s96, -v30
    v_exp_f32 v38, v38
    v_fma_f32 v50, v50, s96, -v30
    v_exp_f32 v39, v39
    v_fma_f32 v51, v51, s96, -v30
    v_mov_b32 v61, 0
    v_exp_f32 v40, v40
    v_mov_b32 v62, 0
    v_exp_f32 v41, v41
    v_cvt_pk_bf16_f32 v60, v32, v33
    v_exp_f32 v44, v44
    v_cvt_pk_bf16_f32 v63, v32, v33
    v_exp_f32 v45, v45
    v_cvt_pk_bf16_f32 v52, v36, v37
    v_exp_f32 v46, v46
    v_cvt_pk_bf16_f32 v53, v38, v39
    v_exp_f32 v47, v47
    v_exp_f32 v48, v48
    v_exp_f32 v49, v49
    v_exp_f32 v50, v50
    v_exp_f32 v51, v51
    v_mov_b32 v249, 0
    v_mov_b32 v250, 0
    v_cvt_pk_bf16_f32 v248, v40, v41
    v_cvt_pk_bf16_f32 v251, v40, v41
    v_cvt_pk_bf16_f32 v56, v44, v45
    v_cvt_pk_bf16_f32 v57, v46, v47
    v_cvt_pk_bf16_f32 v58, v48, v49
    v_cvt_pk_bf16_f32 v59, v50, v51
    s_add_u32 s32, s78, 0x3000
    s_add_u32 s33, s78, 0xb000
    s_waitcnt vmcnt(4)
    v_mfma_f32_16x16x16_bf16 v[252:255], v[120:121], v[52:53], 0
    v_mfma_f32_16x16x16_bf16 v[64:67], v[208:209], v[52:53], 0
    v_mfma_f32_16x16x16_bf16 v[68:71], v[212:213], v[52:53], 0
    v_mfma_f32_16x16x16_bf16 v[72:75], v[216:217], v[52:53], 0
    v_mfma_f32_16x16x16_bf16 v[76:79], v[220:221], v[52:53], 0
    v_mfma_f32_16x16x16_bf16 v[80:83], v[224:225], v[52:53], 0
    v_mfma_f32_16x16x16_bf16 v[84:87], v[228:229], v[52:53], 0
    v_mfma_f32_16x16x16_bf16 v[88:91], v[232:233], v[52:53], 0
    v_mfma_f32_16x16x16_bf16 v[92:95], v[236:237], v[52:53], 0
    v_mfma_f32_16x16x16_bf16 v[252:255], v[120:121], v[60:61], v[252:255]
    v_mfma_f32_16x16x16_bf16 v[64:67], v[240:241], v[60:61], v[64:67]
    v_mfma_f32_16x16x16_bf16 v[68:71], v[240:241], v[62:63], v[68:71]
    v_mfma_f32_16x16x16_bf16 v[72:75], v[242:243], v[60:61], v[72:75]
    v_mfma_f32_16x16x16_bf16 v[76:79], v[242:243], v[62:63], v[76:79]
    v_mfma_f32_16x16x16_bf16 v[80:83], v[244:245], v[60:61], v[80:83]
    v_mfma_f32_16x16x16_bf16 v[84:87], v[244:245], v[62:63], v[84:87]
    v_mfma_f32_16x16x16_bf16 v[88:91], v[246:247], v[60:61], v[88:91]
    v_mfma_f32_16x16x16_bf16 v[92:95], v[246:247], v[62:63], v[92:95]
    v_rcp_f32 v28, v252
    s_nop 0
    v_mul_f32 v28, v28, v118
    v_pk_mul_f32 v[64:65], v[64:65], v[28:29] op_sel_hi:[1,0]
    v_pk_mul_f32 v[66:67], v[66:67], v[28:29] op_sel_hi:[1,0]
    v_cvt_pk_bf16_f32 v96, v64, v65
    v_cvt_pk_bf16_f32 v97, v66, v67
    v_pk_mul_f32 v[68:69], v[68:69], v[28:29] op_sel_hi:[1,0]
    v_pk_mul_f32 v[70:71], v[70:71], v[28:29] op_sel_hi:[1,0]
    v_cvt_pk_bf16_f32 v98, v68, v69
    v_cvt_pk_bf16_f32 v99, v70, v71
    v_pk_mul_f32 v[72:73], v[72:73], v[28:29] op_sel_hi:[1,0]
    v_pk_mul_f32 v[74:75], v[74:75], v[28:29] op_sel_hi:[1,0]
    v_cvt_pk_bf16_f32 v100, v72, v73
    v_cvt_pk_bf16_f32 v101, v74, v75
    v_pk_mul_f32 v[76:77], v[76:77], v[28:29] op_sel_hi:[1,0]
    v_pk_mul_f32 v[78:79], v[78:79], v[28:29] op_sel_hi:[1,0]
    v_cvt_pk_bf16_f32 v102, v76, v77
    v_cvt_pk_bf16_f32 v103, v78, v79
    v_pk_mul_f32 v[80:81], v[80:81], v[28:29] op_sel_hi:[1,0]
    v_pk_mul_f32 v[82:83], v[82:83], v[28:29] op_sel_hi:[1,0]
    v_cvt_pk_bf16_f32 v104, v80, v81
    v_cvt_pk_bf16_f32 v105, v82, v83
    v_pk_mul_f32 v[84:85], v[84:85], v[28:29] op_sel_hi:[1,0]
    v_pk_mul_f32 v[86:87], v[86:87], v[28:29] op_sel_hi:[1,0]
    v_cvt_pk_bf16_f32 v106, v84, v85
    v_cvt_pk_bf16_f32 v107, v86, v87
    v_pk_mul_f32 v[88:89], v[88:89], v[28:29] op_sel_hi:[1,0]
    v_pk_mul_f32 v[90:91], v[90:91], v[28:29] op_sel_hi:[1,0]
    v_cvt_pk_bf16_f32 v108, v88, v89
    v_cvt_pk_bf16_f32 v109, v90, v91
    v_pk_mul_f32 v[92:93], v[92:93], v[28:29] op_sel_hi:[1,0]
    v_pk_mul_f32 v[94:95], v[94:95], v[28:29] op_sel_hi:[1,0]
    v_cvt_pk_bf16_f32 v110, v92, v93
    v_cvt_pk_bf16_f32 v111, v94, v95
    buffer_store_dwordx4 v[96:99], v26, s[8:11], s32 offen offset:0 sc1
    buffer_store_dwordx4 v[100:103], v26, s[8:11], s32 offen offset:1024 sc1
    buffer_store_dwordx4 v[104:107], v26, s[8:11], s33 offen offset:0 sc1
    buffer_store_dwordx4 v[108:111], v26, s[8:11], s33 offen offset:1024 sc1
    v_mfma_f32_16x16x32_bf16 v[252:255], v[120:123], v[56:59], 0
    v_mfma_f32_16x16x32_bf16 v[64:67], v[208:211], v[56:59], 0
    v_mfma_f32_16x16x32_bf16 v[68:71], v[212:215], v[56:59], 0
    v_mfma_f32_16x16x32_bf16 v[72:75], v[216:219], v[56:59], 0
    v_mfma_f32_16x16x32_bf16 v[76:79], v[220:223], v[56:59], 0
    v_mfma_f32_16x16x32_bf16 v[80:83], v[224:227], v[56:59], 0
    v_mfma_f32_16x16x32_bf16 v[84:87], v[228:231], v[56:59], 0
    v_mfma_f32_16x16x32_bf16 v[88:91], v[232:235], v[56:59], 0
    v_mfma_f32_16x16x32_bf16 v[92:95], v[236:239], v[56:59], 0
    v_mfma_f32_16x16x16_bf16 v[252:255], v[120:121], v[248:249], v[252:255]
    v_mfma_f32_16x16x16_bf16 v[64:67], v[240:241], v[248:249], v[64:67]
    v_mfma_f32_16x16x16_bf16 v[68:71], v[240:241], v[250:251], v[68:71]
    v_mfma_f32_16x16x16_bf16 v[72:75], v[242:243], v[248:249], v[72:75]
    v_mfma_f32_16x16x16_bf16 v[76:79], v[242:243], v[250:251], v[76:79]
    v_mfma_f32_16x16x16_bf16 v[80:83], v[244:245], v[248:249], v[80:83]
    v_mfma_f32_16x16x16_bf16 v[84:87], v[244:245], v[250:251], v[84:87]
    v_mfma_f32_16x16x16_bf16 v[88:91], v[246:247], v[248:249], v[88:91]
    v_mfma_f32_16x16x16_bf16 v[92:95], v[246:247], v[250:251], v[92:95]
    v_rcp_f32 v28, v252
    s_nop 0
    v_mul_f32 v28, v28, v119
    v_pk_mul_f32 v[64:65], v[64:65], v[28:29] op_sel_hi:[1,0]
    v_pk_mul_f32 v[66:67], v[66:67], v[28:29] op_sel_hi:[1,0]
    v_cvt_pk_bf16_f32 v96, v64, v65
    v_cvt_pk_bf16_f32 v97, v66, v67
    v_pk_mul_f32 v[68:69], v[68:69], v[28:29] op_sel_hi:[1,0]
    v_pk_mul_f32 v[70:71], v[70:71], v[28:29] op_sel_hi:[1,0]
    v_cvt_pk_bf16_f32 v98, v68, v69
    v_cvt_pk_bf16_f32 v99, v70, v71
    v_pk_mul_f32 v[72:73], v[72:73], v[28:29] op_sel_hi:[1,0]
    v_pk_mul_f32 v[74:75], v[74:75], v[28:29] op_sel_hi:[1,0]
    v_cvt_pk_bf16_f32 v100, v72, v73
    v_cvt_pk_bf16_f32 v101, v74, v75
    v_pk_mul_f32 v[76:77], v[76:77], v[28:29] op_sel_hi:[1,0]
    v_pk_mul_f32 v[78:79], v[78:79], v[28:29] op_sel_hi:[1,0]
    v_cvt_pk_bf16_f32 v102, v76, v77
    v_cvt_pk_bf16_f32 v103, v78, v79
    v_pk_mul_f32 v[80:81], v[80:81], v[28:29] op_sel_hi:[1,0]
    v_pk_mul_f32 v[82:83], v[82:83], v[28:29] op_sel_hi:[1,0]
    v_cvt_pk_bf16_f32 v104, v80, v81
    v_cvt_pk_bf16_f32 v105, v82, v83
    v_pk_mul_f32 v[84:85], v[84:85], v[28:29] op_sel_hi:[1,0]
    v_pk_mul_f32 v[86:87], v[86:87], v[28:29] op_sel_hi:[1,0]
    v_cvt_pk_bf16_f32 v106, v84, v85
    v_cvt_pk_bf16_f32 v107, v86, v87
    v_pk_mul_f32 v[88:89], v[88:89], v[28:29] op_sel_hi:[1,0]
    v_pk_mul_f32 v[90:91], v[90:91], v[28:29] op_sel_hi:[1,0]
    v_cvt_pk_bf16_f32 v108, v88, v89
    v_cvt_pk_bf16_f32 v109, v90, v91
    v_pk_mul_f32 v[92:93], v[92:93], v[28:29] op_sel_hi:[1,0]
    v_pk_mul_f32 v[94:95], v[94:95], v[28:29] op_sel_hi:[1,0]
    v_cvt_pk_bf16_f32 v110, v92, v93
    v_cvt_pk_bf16_f32 v111, v94, v95
    buffer_store_dwordx4 v[96:99], v26, s[8:11], s32 offen offset:2048 sc1
    buffer_store_dwordx4 v[100:103], v26, s[8:11], s32 offen offset:3072 sc1
    buffer_store_dwordx4 v[104:107], v26, s[8:11], s33 offen offset:2048 sc1
    buffer_store_dwordx4 v[108:111], v26, s[8:11], s33 offen offset:3072 sc1
    s_branch kvg_241
jvg_237:
    v_mfma_f32_16x16x32_bf16 a[0:3], v[192:195], v[128:131], 0
    ds_read_b128 v[224:227], v3 offset:0
    v_mfma_f32_16x16x32_bf16 a[4:7], v[196:199], v[128:131], 0
    s_add_u32 m0, s29, 0x0
    v_mfma_f32_16x16x32_bf16 a[8:11], v[200:203], v[128:131], 0
    ds_read_b64_tr_b16 v[160:161], v4 offset:16384
    v_mfma_f32_16x16x32_bf16 a[12:15], v[204:207], v[128:131], 0
    buffer_load_dwordx4 v20, s[16:19], s24 offen offset:0 lds
    v_mfma_f32_16x16x32_bf16 a[16:19], v[208:211], v[128:131], 0
    ds_read_b64_tr_b16 v[162:163], v4 offset:17408
    v_mfma_f32_16x16x32_bf16 a[20:23], v[212:215], v[128:131], 0
    v_mfma_f32_16x16x32_bf16 a[24:27], v[216:219], v[128:131], 0
    ds_read_b128 v[228:231], v3 offset:2048
    v_mfma_f32_16x16x32_bf16 a[28:31], v[220:223], v[128:131], 0
    buffer_load_dwordx4 v21, s[16:19], s24 offen offset:1024 lds
    v_mfma_f32_16x16x32_bf16 a[32:35], v[192:195], v[132:135], 0
    ds_read_b64_tr_b16 v[164:165], v5 offset:16384
    v_mfma_f32_16x16x32_bf16 a[36:39], v[196:199], v[132:135], 0
    v_mfma_f32_16x16x32_bf16 a[40:43], v[200:203], v[132:135], 0
    ds_read_b64_tr_b16 v[166:167], v5 offset:17408
    v_mfma_f32_16x16x32_bf16 a[44:47], v[204:207], v[132:135], 0
    buffer_load_dwordx4 v22, s[16:19], s24 offen offset:2048 lds
    v_mfma_f32_16x16x32_bf16 a[48:51], v[208:211], v[132:135], 0
    ds_read_b128 v[232:235], v3 offset:4096
    v_mfma_f32_16x16x32_bf16 a[52:55], v[212:215], v[132:135], 0
    v_mfma_f32_16x16x32_bf16 a[56:59], v[216:219], v[132:135], 0
    ds_read_b64_tr_b16 v[168:169], v6 offset:16384
    v_mfma_f32_16x16x32_bf16 a[60:63], v[220:223], v[132:135], 0
    buffer_load_dwordx4 v23, s[16:19], s24 offen offset:3072 lds
    v_mfma_f32_16x16x32_bf16 a[64:67], v[192:195], v[136:139], 0
    ds_read_b64_tr_b16 v[170:171], v6 offset:17408
    v_mfma_f32_16x16x32_bf16 a[68:71], v[196:199], v[136:139], 0
    s_add_u32 s24, s24, s26
    v_mfma_f32_16x16x32_bf16 a[72:75], v[200:203], v[136:139], 0
    ds_read_b128 v[236:239], v3 offset:6144
    v_mfma_f32_16x16x32_bf16 a[76:79], v[204:207], v[136:139], 0
    v_mfma_f32_16x16x32_bf16 a[80:83], v[208:211], v[136:139], 0
    ds_read_b64_tr_b16 v[172:173], v7 offset:16384
    v_mfma_f32_16x16x32_bf16 a[84:87], v[212:215], v[136:139], 0
    v_mfma_f32_16x16x32_bf16 a[88:91], v[216:219], v[136:139], 0
    ds_read_b64_tr_b16 v[174:175], v7 offset:17408
    v_mfma_f32_16x16x32_bf16 a[92:95], v[220:223], v[136:139], 0
    v_mfma_f32_16x16x32_bf16 a[96:99], v[192:195], v[140:143], 0
    ds_read_b128 v[240:243], v3 offset:8192
    v_mfma_f32_16x16x32_bf16 a[100:103], v[196:199], v[140:143], 0
    v_mfma_f32_16x16x32_bf16 a[104:107], v[200:203], v[140:143], 0
    ds_read_b64_tr_b16 v[176:177], v8 offset:16384
    v_mfma_f32_16x16x32_bf16 a[108:111], v[204:207], v[140:143], 0
    v_mfma_f32_16x16x32_bf16 a[112:115], v[208:211], v[140:143], 0
    ds_read_b64_tr_b16 v[178:179], v8 offset:17408
    v_mfma_f32_16x16x32_bf16 a[116:119], v[212:215], v[140:143], 0
    v_mfma_f32_16x16x32_bf16 a[120:123], v[216:219], v[140:143], 0
    ds_read_b128 v[244:247], v3 offset:10240
    v_mfma_f32_16x16x32_bf16 a[124:127], v[220:223], v[140:143], 0
    v_mfma_f32_16x16x32_bf16 a[128:131], v[192:195], v[144:147], 0
    ds_read_b64_tr_b16 v[180:181], v9 offset:16384
    v_mfma_f32_16x16x32_bf16 a[132:135], v[196:199], v[144:147], 0
    v_mfma_f32_16x16x32_bf16 a[136:139], v[200:203], v[144:147], 0
    ds_read_b64_tr_b16 v[182:183], v9 offset:17408
    v_mfma_f32_16x16x32_bf16 a[140:143], v[204:207], v[144:147], 0
    v_mfma_f32_16x16x32_bf16 a[144:147], v[208:211], v[144:147], 0
    ds_read_b128 v[248:251], v3 offset:12288
    v_mfma_f32_16x16x32_bf16 a[148:151], v[212:215], v[144:147], 0
    v_mfma_f32_16x16x32_bf16 a[152:155], v[216:219], v[144:147], 0
    ds_read_b64_tr_b16 v[184:185], v10 offset:16384
    v_mfma_f32_16x16x32_bf16 a[156:159], v[220:223], v[144:147], 0
    v_mfma_f32_16x16x32_bf16 a[160:163], v[192:195], v[148:151], 0
    ds_read_b64_tr_b16 v[186:187], v10 offset:17408
    v_mfma_f32_16x16x32_bf16 a[164:167], v[196:199], v[148:151], 0
    v_mfma_f32_16x16x32_bf16 a[168:171], v[200:203], v[148:151], 0
    ds_read_b128 v[252:255], v3 offset:14336
    v_mfma_f32_16x16x32_bf16 a[172:175], v[204:207], v[148:151], 0
    v_mfma_f32_16x16x32_bf16 a[176:179], v[208:211], v[148:151], 0
    ds_read_b64_tr_b16 v[188:189], v11 offset:16384
    v_mfma_f32_16x16x32_bf16 a[180:183], v[212:215], v[148:151], 0
    v_mfma_f32_16x16x32_bf16 a[184:187], v[216:219], v[148:151], 0
    ds_read_b64_tr_b16 v[190:191], v11 offset:17408
    v_mfma_f32_16x16x32_bf16 a[188:191], v[220:223], v[148:151], 0
    v_mfma_f32_16x16x32_bf16 a[192:195], v[192:195], v[152:155], 0
    v_mfma_f32_16x16x32_bf16 a[196:199], v[196:199], v[152:155], 0
    v_mfma_f32_16x16x32_bf16 a[200:203], v[200:203], v[152:155], 0
    v_mfma_f32_16x16x32_bf16 a[204:207], v[204:207], v[152:155], 0
    v_mfma_f32_16x16x32_bf16 a[208:211], v[208:211], v[152:155], 0
    v_mfma_f32_16x16x32_bf16 a[212:215], v[212:215], v[152:155], 0
    v_mfma_f32_16x16x32_bf16 a[216:219], v[216:219], v[152:155], 0
    v_mfma_f32_16x16x32_bf16 a[220:223], v[220:223], v[152:155], 0
    v_mfma_f32_16x16x32_bf16 a[224:227], v[192:195], v[156:159], 0
    v_mfma_f32_16x16x32_bf16 a[228:231], v[196:199], v[156:159], 0
    v_mfma_f32_16x16x32_bf16 a[232:235], v[200:203], v[156:159], 0
    v_mfma_f32_16x16x32_bf16 a[236:239], v[204:207], v[156:159], 0
    v_mfma_f32_16x16x32_bf16 a[240:243], v[208:211], v[156:159], 0
    v_mfma_f32_16x16x32_bf16 a[244:247], v[212:215], v[156:159], 0
    v_mfma_f32_16x16x32_bf16 a[248:251], v[216:219], v[156:159], 0
    s_waitcnt vmcnt(8) lgkmcnt(0)
    s_barrier
    v_mfma_f32_16x16x32_bf16 a[252:255], v[220:223], v[156:159], 0
    s_branch g1_271
g0_272:
    s_cmp_lg_u32 s27, 1
    s_cbranch_scc1 gns_273
    s_cmp_lg_u32 s66, 0
    s_cbranch_scc1 d1g_277
    s_and_b32 s71, s65, 3
    s_add_u32 s71, s71, 1
    s_lshr_b32 s74, s65, 2
dkvg_284:
    s_lshl_b32 s72, s64, 3
    s_add_u32 s72, s72, s74
    s_lshr_b32 s70, s72, 4
    s_and_b32 s72, s72, 15
    s_branch ddg_286
d1g_277:
    s_cmp_lg_u32 s66, 1
    s_cbranch_scc1 d2g_278
    s_mul_i32 s74, s65, 43
    s_lshr_b32 s74, s74, 7
    s_mul_i32 s75, s74, 3
    s_sub_u32 s71, s65, s75
    s_add_u32 s71, s71, 5
    s_cmp_lt_u32 s65, 24
    s_cbranch_scc1 dkvg_284
    s_mov_b32 s72, s64
    s_branch d6g_282
d2g_278:
    s_lshr_b32 s74, s65, 3
    s_cmp_lg_u32 s66, 2
    s_cbranch_scc1 d3g_279
    s_lshl_b32 s72, s64, 2
    s_add_u32 s74, s74, 4
    s_add_u32 s72, s72, s74
    s_branch d6g_282
d3g_279:
    s_cmp_lg_u32 s66, 3
    s_cbranch_scc1 d4g_280
    s_bitcmp1_b32 s64, 0
    s_cbranch_scc1 dqg_285
    s_lshl_b32 s72, s64, 1
    s_add_u32 s74, s74, 20
    s_add_u32 s72, s72, s74
d6g_282:
    s_and_b32 s71, s65, 7
    s_mov_b32 s70, 4
    s_branch ddg_286
dqg_285:
    s_lshr_b32 s72, s64, 1
    s_lshl_b32 s72, s72, 3
    s_lshr_b32 s74, s65, 2
    s_add_u32 s72, s72, s74
    s_and_b32 s71, s65, 3
    s_mov_b32 s70, 3
    s_branch ddg_286
d4g_280:
    s_cmp_lg_u32 s66, 4
    s_cbranch_scc1 dng_287
    s_cmp_ge_u32 s64, 2
    s_cbranch_scc1 dng_287
    s_and_b32 s72, s65, 15
    s_lshr_b32 s74, s65, 4
    s_lshl_b32 s71, s64, 1
    s_add_u32 s74, s74, 4
    s_add_u32 s71, s71, s74
    s_cmp_eq_u32 s64, 0
    s_cselect_b32 s70, 3, 2
    s_branch ddg_286
dng_287:
    s_mov_b32 s70, 5
ddg_286:
    s_cmp_eq_u32 s70, 5
    s_cbranch_scc1 sng_274
    s_mov_b32 s12, s52
    s_mov_b32 s13, s53
    s_mov_b32 s14, 0x400000
    s_mov_b32 s15, 0x20000
    s_lshl_b32 s74, s71, 8
    s_lshl_b32 s30, s20, 6
    s_add_u32 s30, s30, s74
    v_lshrrev_b32 v28, 3, v1
    v_add_u32 v28, s30, v28
    v_lshlrev_b32 v28, 11, v28
    v_and_b32 v29, 7, v1
    v_xor_b32 v29, v29, v25
    v_xor_b32 v30, 0, v29
    v_lshl_add_u32 v12, v30, 4, v28
    v_xor_b32 v30, 4, v29
    v_lshl_add_u32 v13, v30, 4, v28
    v_add_u32 v13, 0x3c00, v13
    v_xor_b32 v30, 0, v29
    v_lshl_add_u32 v14, v30, 4, v28
    v_add_u32 v14, 0x7800, v14
    v_xor_b32 v30, 4, v29
    v_lshl_add_u32 v15, v30, 4, v28
    v_add_u32 v15, 0xb400, v15
    v_xor_b32 v30, 0, v29
    v_lshl_add_u32 v16, v30, 4, v28
    v_add_u32 v16, 0x10000, v16
    v_xor_b32 v30, 4, v29
    v_lshl_add_u32 v17, v30, 4, v28
    v_add_u32 v17, 0x13c00, v17
    v_xor_b32 v30, 0, v29
    v_lshl_add_u32 v18, v30, 4, v28
    v_add_u32 v18, 0x17800, v18
    v_xor_b32 v30, 4, v29
    v_lshl_add_u32 v19, v30, 4, v28
    v_add_u32 v19, 0x1b400, v19
    s_mov_b32 s25, 128
    s_mov_b32 s23, 0
    s_mov_b32 s24, 0
    s_cmp_eq_u32 s70, 4
    s_cbranch_scc1 thg_288
    s_mov_b32 s16, s54
    s_mov_b32 s17, s55
    s_mov_b32 s18, 0x800000
    s_mov_b32 s19, 0x20000
    s_cmp_ge_u32 s70, 2
    s_cbranch_scc1 twg_291
    s_mov_b32 s16, s60
    s_mov_b32 s17, s61
    s_mov_b32 s18, 0x800000
    s_mov_b32 s19, 0x20000
    s_cmp_eq_u32 s70, 0
    s_cbranch_scc1 twg_291
    s_mov_b32 s16, s62
    s_mov_b32 s17, s63
    s_mov_b32 s18, 0x800000
    s_mov_b32 s19, 0x20000
twg_291:
    s_lshl_b32 s74, s72, 9
    s_lshl_b32 s75, s22, 8
    s_add_u32 s74, s74, s75
    v_lshlrev_b32 v30, 1, v25
    v_xor_b32 v29, v24, v30
    s_lshl_b32 s30, s21, 4
    v_add_u32 v28, s30, v25
    s_mov_b32 s30, 8192
    v_mul_lo_u32 v28, v28, s30
    v_add_u32 v28, s74, v28
    v_xor_b32 v30, 0, v29
    v_lshl_add_u32 v20, v30, 4, v28
    v_xor_b32 v30, 0, v29
    v_lshl_add_u32 v21, v30, 4, v28
    v_add_u32 v21, 0x7c00, v21
    v_xor_b32 v30, 8, v29
    v_lshl_add_u32 v22, v30, 4, v28
    v_add_u32 v22, 0xf800, v22
    v_xor_b32 v30, 8, v29
    v_lshl_add_u32 v23, v30, 4, v28
    v_add_u32 v23, 0x17400, v23
    s_mov_b32 s26, 262144
    s_branch tdg_290
thg_288:
    s_mov_b32 s16, s56
    s_mov_b32 s17, s57
    s_mov_b32 s18, 0x700000
    s_mov_b32 s19, 0x20000
    s_cmp_eq_u32 s22, 0
    s_cbranch_scc1 tug_289
    s_mov_b32 s16, s58
    s_mov_b32 s17, s59
    s_mov_b32 s18, 0x700000
    s_mov_b32 s19, 0x20000
tug_289:
    s_lshl_b32 s74, s72, 8
    v_lshlrev_b32 v30, 1, v25
    v_xor_b32 v29, v24, v30
    s_lshl_b32 s30, s21, 4
    v_add_u32 v28, s30, v25
    s_mov_b32 s30, 7168
    v_mul_lo_u32 v28, v28, s30
    v_add_u32 v28, s74, v28
    v_xor_b32 v30, 0, v29
    v_lshl_add_u32 v20, v30, 4, v28
    v_xor_b32 v30, 0, v29
    v_lshl_add_u32 v21, v30, 4, v28
    v_add_u32 v21, 0x6c00, v21
    v_xor_b32 v30, 8, v29
    v_lshl_add_u32 v22, v30, 4, v28
    v_add_u32 v22, 0xd800, v22
    v_xor_b32 v30, 8, v29
    v_lshl_add_u32 v23, v30, 4, v28
    v_add_u32 v23, 0x14400, v23
    s_mov_b32 s26, 229376
tdg_290:
    s_branch ssg_275
sng_274:
    s_mov_b32 s14, 0
    s_mov_b32 s18, 0
ssg_275:
gns_273:
    v_mfma_f32_16x16x32_bf16 a[0:3], v[192:195], v[128:131], a[0:3]
    ds_read_b128 v[224:227], v3 offset:0
    v_mfma_f32_16x16x32_bf16 a[4:7], v[196:199], v[128:131], a[4:7]
    s_add_u32 m0, s29, 0x0
    v_mfma_f32_16x16x32_bf16 a[8:11], v[200:203], v[128:131], a[8:11]
    ds_read_b64_tr_b16 v[160:161], v4 offset:16384
    v_mfma_f32_16x16x32_bf16 a[12:15], v[204:207], v[128:131], a[12:15]
    buffer_load_dwordx4 v20, s[16:19], s24 offen offset:0 lds
    v_mfma_f32_16x16x32_bf16 a[16:19], v[208:211], v[128:131], a[16:19]
    ds_read_b64_tr_b16 v[162:163], v4 offset:17408
    v_mfma_f32_16x16x32_bf16 a[20:23], v[212:215], v[128:131], a[20:23]
    v_mfma_f32_16x16x32_bf16 a[24:27], v[216:219], v[128:131], a[24:27]
    ds_read_b128 v[228:231], v3 offset:2048
    v_mfma_f32_16x16x32_bf16 a[28:31], v[220:223], v[128:131], a[28:31]
    buffer_load_dwordx4 v21, s[16:19], s24 offen offset:1024 lds
    v_mfma_f32_16x16x32_bf16 a[32:35], v[192:195], v[132:135], a[32:35]
    ds_read_b64_tr_b16 v[164:165], v5 offset:16384
    v_mfma_f32_16x16x32_bf16 a[36:39], v[196:199], v[132:135], a[36:39]
    v_mfma_f32_16x16x32_bf16 a[40:43], v[200:203], v[132:135], a[40:43]
    ds_read_b64_tr_b16 v[166:167], v5 offset:17408
    v_mfma_f32_16x16x32_bf16 a[44:47], v[204:207], v[132:135], a[44:47]
    buffer_load_dwordx4 v22, s[16:19], s24 offen offset:2048 lds
    v_mfma_f32_16x16x32_bf16 a[48:51], v[208:211], v[132:135], a[48:51]
    ds_read_b128 v[232:235], v3 offset:4096
    v_mfma_f32_16x16x32_bf16 a[52:55], v[212:215], v[132:135], a[52:55]
    v_mfma_f32_16x16x32_bf16 a[56:59], v[216:219], v[132:135], a[56:59]
    ds_read_b64_tr_b16 v[168:169], v6 offset:16384
    v_mfma_f32_16x16x32_bf16 a[60:63], v[220:223], v[132:135], a[60:63]
    buffer_load_dwordx4 v23, s[16:19], s24 offen offset:3072 lds
    v_mfma_f32_16x16x32_bf16 a[64:67], v[192:195], v[136:139], a[64:67]
    ds_read_b64_tr_b16 v[170:171], v6 offset:17408
    v_mfma_f32_16x16x32_bf16 a[68:71], v[196:199], v[136:139], a[68:71]
    s_add_u32 s24, s24, s26
    v_mfma_f32_16x16x32_bf16 a[72:75], v[200:203], v[136:139], a[72:75]
    ds_read_b128 v[236:239], v3 offset:6144
    v_mfma_f32_16x16x32_bf16 a[76:79], v[204:207], v[136:139], a[76:79]
    v_mfma_f32_16x16x32_bf16 a[80:83], v[208:211], v[136:139], a[80:83]
    ds_read_b64_tr_b16 v[172:173], v7 offset:16384
    v_mfma_f32_16x16x32_bf16 a[84:87], v[212:215], v[136:139], a[84:87]
    v_mfma_f32_16x16x32_bf16 a[88:91], v[216:219], v[136:139], a[88:91]
    ds_read_b64_tr_b16 v[174:175], v7 offset:17408
    v_mfma_f32_16x16x32_bf16 a[92:95], v[220:223], v[136:139], a[92:95]
    v_mfma_f32_16x16x32_bf16 a[96:99], v[192:195], v[140:143], a[96:99]
    ds_read_b128 v[240:243], v3 offset:8192
    v_mfma_f32_16x16x32_bf16 a[100:103], v[196:199], v[140:143], a[100:103]
    v_mfma_f32_16x16x32_bf16 a[104:107], v[200:203], v[140:143], a[104:107]
    ds_read_b64_tr_b16 v[176:177], v8 offset:16384
    v_mfma_f32_16x16x32_bf16 a[108:111], v[204:207], v[140:143], a[108:111]
    v_mfma_f32_16x16x32_bf16 a[112:115], v[208:211], v[140:143], a[112:115]
    ds_read_b64_tr_b16 v[178:179], v8 offset:17408
    v_mfma_f32_16x16x32_bf16 a[116:119], v[212:215], v[140:143], a[116:119]
    v_mfma_f32_16x16x32_bf16 a[120:123], v[216:219], v[140:143], a[120:123]
    ds_read_b128 v[244:247], v3 offset:10240
    v_mfma_f32_16x16x32_bf16 a[124:127], v[220:223], v[140:143], a[124:127]
    v_mfma_f32_16x16x32_bf16 a[128:131], v[192:195], v[144:147], a[128:131]
    ds_read_b64_tr_b16 v[180:181], v9 offset:16384
    v_mfma_f32_16x16x32_bf16 a[132:135], v[196:199], v[144:147], a[132:135]
    v_mfma_f32_16x16x32_bf16 a[136:139], v[200:203], v[144:147], a[136:139]
    ds_read_b64_tr_b16 v[182:183], v9 offset:17408
    v_mfma_f32_16x16x32_bf16 a[140:143], v[204:207], v[144:147], a[140:143]
    v_mfma_f32_16x16x32_bf16 a[144:147], v[208:211], v[144:147], a[144:147]
    ds_read_b128 v[248:251], v3 offset:12288
    v_mfma_f32_16x16x32_bf16 a[148:151], v[212:215], v[144:147], a[148:151]
    v_mfma_f32_16x16x32_bf16 a[152:155], v[216:219], v[144:147], a[152:155]
    ds_read_b64_tr_b16 v[184:185], v10 offset:16384
    v_mfma_f32_16x16x32_bf16 a[156:159], v[220:223], v[144:147], a[156:159]
    v_mfma_f32_16x16x32_bf16 a[160:163], v[192:195], v[148:151], a[160:163]
    ds_read_b64_tr_b16 v[186:187], v10 offset:17408
    v_mfma_f32_16x16x32_bf16 a[164:167], v[196:199], v[148:151], a[164:167]
    v_mfma_f32_16x16x32_bf16 a[168:171], v[200:203], v[148:151], a[168:171]
    ds_read_b128 v[252:255], v3 offset:14336
    v_mfma_f32_16x16x32_bf16 a[172:175], v[204:207], v[148:151], a[172:175]
    v_mfma_f32_16x16x32_bf16 a[176:179], v[208:211], v[148:151], a[176:179]
    ds_read_b64_tr_b16 v[188:189], v11 offset:16384
    v_mfma_f32_16x16x32_bf16 a[180:183], v[212:215], v[148:151], a[180:183]
    v_mfma_f32_16x16x32_bf16 a[184:187], v[216:219], v[148:151], a[184:187]
    ds_read_b64_tr_b16 v[190:191], v11 offset:17408
    v_mfma_f32_16x16x32_bf16 a[188:191], v[220:223], v[148:151], a[188:191]
    v_mfma_f32_16x16x32_bf16 a[192:195], v[192:195], v[152:155], a[192:195]
    v_mfma_f32_16x16x32_bf16 a[196:199], v[196:199], v[152:155], a[196:199]
    v_mfma_f32_16x16x32_bf16 a[200:203], v[200:203], v[152:155], a[200:203]
    v_mfma_f32_16x16x32_bf16 a[204:207], v[204:207], v[152:155], a[204:207]
    v_mfma_f32_16x16x32_bf16 a[208:211], v[208:211], v[152:155], a[208:211]
    v_mfma_f32_16x16x32_bf16 a[212:215], v[212:215], v[152:155], a[212:215]
    v_mfma_f32_16x16x32_bf16 a[216:219], v[216:219], v[152:155], a[216:219]
    v_mfma_f32_16x16x32_bf16 a[220:223], v[220:223], v[152:155], a[220:223]
    v_mfma_f32_16x16x32_bf16 a[224:227], v[192:195], v[156:159], a[224:227]
    v_mfma_f32_16x16x32_bf16 a[228:231], v[196:199], v[156:159], a[228:231]
    v_mfma_f32_16x16x32_bf16 a[232:235], v[200:203], v[156:159], a[232:235]
    v_mfma_f32_16x16x32_bf16 a[236:239], v[204:207], v[156:159], a[236:239]
    v_mfma_f32_16x16x32_bf16 a[240:243], v[208:211], v[156:159], a[240:243]
    v_mfma_f32_16x16x32_bf16 a[244:247], v[212:215], v[156:159], a[244:247]
    v_mfma_f32_16x16x32_bf16 a[248:251], v[216:219], v[156:159], a[248:251]
    s_waitcnt vmcnt(8) lgkmcnt(0)
    s_barrier
    v_mfma_f32_16x16x32_bf16 a[252:255], v[220:223], v[156:159], a[252:255]
g1_271:
    v_mfma_f32_16x16x32_bf16 a[0:3], v[224:227], v[160:163], a[0:3]
    ds_read_b128 v[192:195], v2 offset:32768
    v_mfma_f32_16x16x32_bf16 a[4:7], v[228:231], v[160:163], a[4:7]
    s_add_u32 m0, s28, 0x0
    v_mfma_f32_16x16x32_bf16 a[8:11], v[232:235], v[160:163], a[8:11]
    ds_read_b64_tr_b16 v[128:129], v4 offset:32768
    v_mfma_f32_16x16x32_bf16 a[12:15], v[236:239], v[160:163], a[12:15]
    buffer_load_dwordx4 v12, s[12:15], s23 offen offset:0 lds
    v_mfma_f32_16x16x32_bf16 a[16:19], v[240:243], v[160:163], a[16:19]
    ds_read_b64_tr_b16 v[130:131], v4 offset:33792
    v_mfma_f32_16x16x32_bf16 a[20:23], v[244:247], v[160:163], a[20:23]
    v_mfma_f32_16x16x32_bf16 a[24:27], v[248:251], v[160:163], a[24:27]
    ds_read_b128 v[196:199], v2 offset:34816
    v_mfma_f32_16x16x32_bf16 a[28:31], v[252:255], v[160:163], a[28:31]
    buffer_load_dwordx4 v13, s[12:15], s23 offen offset:1024 lds
    v_mfma_f32_16x16x32_bf16 a[32:35], v[224:227], v[164:167], a[32:35]
    ds_read_b64_tr_b16 v[132:133], v5 offset:32768
    v_mfma_f32_16x16x32_bf16 a[36:39], v[228:231], v[164:167], a[36:39]
    v_mfma_f32_16x16x32_bf16 a[40:43], v[232:235], v[164:167], a[40:43]
    ds_read_b64_tr_b16 v[134:135], v5 offset:33792
    v_mfma_f32_16x16x32_bf16 a[44:47], v[236:239], v[164:167], a[44:47]
    buffer_load_dwordx4 v14, s[12:15], s23 offen offset:2048 lds
    v_mfma_f32_16x16x32_bf16 a[48:51], v[240:243], v[164:167], a[48:51]
    ds_read_b128 v[200:203], v2 offset:36864
    v_mfma_f32_16x16x32_bf16 a[52:55], v[244:247], v[164:167], a[52:55]
    v_mfma_f32_16x16x32_bf16 a[56:59], v[248:251], v[164:167], a[56:59]
    ds_read_b64_tr_b16 v[136:137], v6 offset:32768
    v_mfma_f32_16x16x32_bf16 a[60:63], v[252:255], v[164:167], a[60:63]
    buffer_load_dwordx4 v15, s[12:15], s23 offen offset:3072 lds
    v_mfma_f32_16x16x32_bf16 a[64:67], v[224:227], v[168:171], a[64:67]
    ds_read_b64_tr_b16 v[138:139], v6 offset:33792
    v_mfma_f32_16x16x32_bf16 a[68:71], v[228:231], v[168:171], a[68:71]
    s_add_u32 m0, s28, 0x1000
    v_mfma_f32_16x16x32_bf16 a[72:75], v[232:235], v[168:171], a[72:75]
    ds_read_b128 v[204:207], v2 offset:38912
    v_mfma_f32_16x16x32_bf16 a[76:79], v[236:239], v[168:171], a[76:79]
    buffer_load_dwordx4 v16, s[12:15], s23 offen offset:0 lds
    v_mfma_f32_16x16x32_bf16 a[80:83], v[240:243], v[168:171], a[80:83]
    ds_read_b64_tr_b16 v[140:141], v7 offset:32768
    v_mfma_f32_16x16x32_bf16 a[84:87], v[244:247], v[168:171], a[84:87]
    v_mfma_f32_16x16x32_bf16 a[88:91], v[248:251], v[168:171], a[88:91]
    ds_read_b64_tr_b16 v[142:143], v7 offset:33792
    v_mfma_f32_16x16x32_bf16 a[92:95], v[252:255], v[168:171], a[92:95]
    buffer_load_dwordx4 v17, s[12:15], s23 offen offset:1024 lds
    v_mfma_f32_16x16x32_bf16 a[96:99], v[224:227], v[172:175], a[96:99]
    ds_read_b128 v[208:211], v2 offset:40960
    v_mfma_f32_16x16x32_bf16 a[100:103], v[228:231], v[172:175], a[100:103]
    v_mfma_f32_16x16x32_bf16 a[104:107], v[232:235], v[172:175], a[104:107]
    ds_read_b64_tr_b16 v[144:145], v8 offset:32768
    v_mfma_f32_16x16x32_bf16 a[108:111], v[236:239], v[172:175], a[108:111]
    buffer_load_dwordx4 v18, s[12:15], s23 offen offset:2048 lds
    v_mfma_f32_16x16x32_bf16 a[112:115], v[240:243], v[172:175], a[112:115]
    ds_read_b64_tr_b16 v[146:147], v8 offset:33792
    v_mfma_f32_16x16x32_bf16 a[116:119], v[244:247], v[172:175], a[116:119]
    v_mfma_f32_16x16x32_bf16 a[120:123], v[248:251], v[172:175], a[120:123]
    ds_read_b128 v[212:215], v2 offset:43008
    v_mfma_f32_16x16x32_bf16 a[124:127], v[252:255], v[172:175], a[124:127]
    buffer_load_dwordx4 v19, s[12:15], s23 offen offset:3072 lds
    v_mfma_f32_16x16x32_bf16 a[128:131], v[224:227], v[176:179], a[128:131]
    ds_read_b64_tr_b16 v[148:149], v9 offset:32768
    v_mfma_f32_16x16x32_bf16 a[132:135], v[228:231], v[176:179], a[132:135]
    s_add_u32 s23, s23, s25
    s_add_u32 m0, s29, 0x4000
    v_mfma_f32_16x16x32_bf16 a[136:139], v[232:235], v[176:179], a[136:139]
    ds_read_b64_tr_b16 v[150:151], v9 offset:33792
    v_mfma_f32_16x16x32_bf16 a[140:143], v[236:239], v[176:179], a[140:143]
    buffer_load_dwordx4 v20, s[16:19], s24 offen offset:0 lds
    v_mfma_f32_16x16x32_bf16 a[144:147], v[240:243], v[176:179], a[144:147]
    ds_read_b128 v[216:219], v2 offset:45056
    v_mfma_f32_16x16x32_bf16 a[148:151], v[244:247], v[176:179], a[148:151]
    v_mfma_f32_16x16x32_bf16 a[152:155], v[248:251], v[176:179], a[152:155]
    ds_read_b64_tr_b16 v[152:153], v10 offset:32768
    v_mfma_f32_16x16x32_bf16 a[156:159], v[252:255], v[176:179], a[156:159]
    buffer_load_dwordx4 v21, s[16:19], s24 offen offset:1024 lds
    v_mfma_f32_16x16x32_bf16 a[160:163], v[224:227], v[180:183], a[160:163]
    ds_read_b64_tr_b16 v[154:155], v10 offset:33792
    v_mfma_f32_16x16x32_bf16 a[164:167], v[228:231], v[180:183], a[164:167]
    v_mfma_f32_16x16x32_bf16 a[168:171], v[232:235], v[180:183], a[168:171]
    ds_read_b128 v[220:223], v2 offset:47104
    v_mfma_f32_16x16x32_bf16 a[172:175], v[236:239], v[180:183], a[172:175]
    buffer_load_dwordx4 v22, s[16:19], s24 offen offset:2048 lds
    v_mfma_f32_16x16x32_bf16 a[176:179], v[240:243], v[180:183], a[176:179]
    ds_read_b64_tr_b16 v[156:157], v11 offset:32768
    v_mfma_f32_16x16x32_bf16 a[180:183], v[244:247], v[180:183], a[180:183]
    v_mfma_f32_16x16x32_bf16 a[184:187], v[248:251], v[180:183], a[184:187]
    ds_read_b64_tr_b16 v[158:159], v11 offset:33792
    v_mfma_f32_16x16x32_bf16 a[188:191], v[252:255], v[180:183], a[188:191]
    buffer_load_dwordx4 v23, s[16:19], s24 offen offset:3072 lds
    v_mfma_f32_16x16x32_bf16 a[192:195], v[224:227], v[184:187], a[192:195]
    v_mfma_f32_16x16x32_bf16 a[196:199], v[228:231], v[184:187], a[196:199]
    s_add_u32 s24, s24, s26
    v_mfma_f32_16x16x32_bf16 a[200:203], v[232:235], v[184:187], a[200:203]
    v_mfma_f32_16x16x32_bf16 a[204:207], v[236:239], v[184:187], a[204:207]
    v_mfma_f32_16x16x32_bf16 a[208:211], v[240:243], v[184:187], a[208:211]
    v_mfma_f32_16x16x32_bf16 a[212:215], v[244:247], v[184:187], a[212:215]
    v_mfma_f32_16x16x32_bf16 a[216:219], v[248:251], v[184:187], a[216:219]
    v_mfma_f32_16x16x32_bf16 a[220:223], v[252:255], v[184:187], a[220:223]
    v_mfma_f32_16x16x32_bf16 a[224:227], v[224:227], v[188:191], a[224:227]
    v_mfma_f32_16x16x32_bf16 a[228:231], v[228:231], v[188:191], a[228:231]
    v_mfma_f32_16x16x32_bf16 a[232:235], v[232:235], v[188:191], a[232:235]
    v_mfma_f32_16x16x32_bf16 a[236:239], v[236:239], v[188:191], a[236:239]
    v_mfma_f32_16x16x32_bf16 a[240:243], v[240:243], v[188:191], a[240:243]
    v_mfma_f32_16x16x32_bf16 a[244:247], v[244:247], v[188:191], a[244:247]
    v_mfma_f32_16x16x32_bf16 a[248:251], v[248:251], v[188:191], a[248:251]
    s_waitcnt vmcnt(16) lgkmcnt(0)
    s_barrier
    v_mfma_f32_16x16x32_bf16 a[252:255], v[252:255], v[188:191], a[252:255]
    v_mfma_f32_16x16x32_bf16 a[0:3], v[192:195], v[128:131], a[0:3]
    ds_read_b128 v[224:227], v3 offset:32768
    v_mfma_f32_16x16x32_bf16 a[4:7], v[196:199], v[128:131], a[4:7]
    s_add_u32 m0, s29, 0x8000
    v_mfma_f32_16x16x32_bf16 a[8:11], v[200:203], v[128:131], a[8:11]
    ds_read_b64_tr_b16 v[160:161], v4 offset:49152
    v_mfma_f32_16x16x32_bf16 a[12:15], v[204:207], v[128:131], a[12:15]
    buffer_load_dwordx4 v20, s[16:19], s24 offen offset:0 lds
    v_mfma_f32_16x16x32_bf16 a[16:19], v[208:211], v[128:131], a[16:19]
    ds_read_b64_tr_b16 v[162:163], v4 offset:50176
    v_mfma_f32_16x16x32_bf16 a[20:23], v[212:215], v[128:131], a[20:23]
    v_mfma_f32_16x16x32_bf16 a[24:27], v[216:219], v[128:131], a[24:27]
    ds_read_b128 v[228:231], v3 offset:34816
    v_mfma_f32_16x16x32_bf16 a[28:31], v[220:223], v[128:131], a[28:31]
    buffer_load_dwordx4 v21, s[16:19], s24 offen offset:1024 lds
    v_mfma_f32_16x16x32_bf16 a[32:35], v[192:195], v[132:135], a[32:35]
    ds_read_b64_tr_b16 v[164:165], v5 offset:49152
    v_mfma_f32_16x16x32_bf16 a[36:39], v[196:199], v[132:135], a[36:39]
    v_mfma_f32_16x16x32_bf16 a[40:43], v[200:203], v[132:135], a[40:43]
    ds_read_b64_tr_b16 v[166:167], v5 offset:50176
    v_mfma_f32_16x16x32_bf16 a[44:47], v[204:207], v[132:135], a[44:47]
    buffer_load_dwordx4 v22, s[16:19], s24 offen offset:2048 lds
    v_mfma_f32_16x16x32_bf16 a[48:51], v[208:211], v[132:135], a[48:51]
    ds_read_b128 v[232:235], v3 offset:36864
    v_mfma_f32_16x16x32_bf16 a[52:55], v[212:215], v[132:135], a[52:55]
    v_mfma_f32_16x16x32_bf16 a[56:59], v[216:219], v[132:135], a[56:59]
    ds_read_b64_tr_b16 v[168:169], v6 offset:49152
    v_mfma_f32_16x16x32_bf16 a[60:63], v[220:223], v[132:135], a[60:63]
    buffer_load_dwordx4 v23, s[16:19], s24 offen offset:3072 lds
    v_mfma_f32_16x16x32_bf16 a[64:67], v[192:195], v[136:139], a[64:67]
    ds_read_b64_tr_b16 v[170:171], v6 offset:50176
    v_mfma_f32_16x16x32_bf16 a[68:71], v[196:199], v[136:139], a[68:71]
    s_add_u32 s24, s24, s26
    v_mfma_f32_16x16x32_bf16 a[72:75], v[200:203], v[136:139], a[72:75]
    ds_read_b128 v[236:239], v3 offset:38912
    v_mfma_f32_16x16x32_bf16 a[76:79], v[204:207], v[136:139], a[76:79]
    v_mfma_f32_16x16x32_bf16 a[80:83], v[208:211], v[136:139], a[80:83]
    ds_read_b64_tr_b16 v[172:173], v7 offset:49152
    v_mfma_f32_16x16x32_bf16 a[84:87], v[212:215], v[136:139], a[84:87]
    v_mfma_f32_16x16x32_bf16 a[88:91], v[216:219], v[136:139], a[88:91]
    ds_read_b64_tr_b16 v[174:175], v7 offset:50176
    v_mfma_f32_16x16x32_bf16 a[92:95], v[220:223], v[136:139], a[92:95]
    v_mfma_f32_16x16x32_bf16 a[96:99], v[192:195], v[140:143], a[96:99]
    ds_read_b128 v[240:243], v3 offset:40960
    v_mfma_f32_16x16x32_bf16 a[100:103], v[196:199], v[140:143], a[100:103]
    v_mfma_f32_16x16x32_bf16 a[104:107], v[200:203], v[140:143], a[104:107]
    ds_read_b64_tr_b16 v[176:177], v8 offset:49152
    v_mfma_f32_16x16x32_bf16 a[108:111], v[204:207], v[140:143], a[108:111]
    v_mfma_f32_16x16x32_bf16 a[112:115], v[208:211], v[140:143], a[112:115]
    ds_read_b64_tr_b16 v[178:179], v8 offset:50176
    v_mfma_f32_16x16x32_bf16 a[116:119], v[212:215], v[140:143], a[116:119]
    v_mfma_f32_16x16x32_bf16 a[120:123], v[216:219], v[140:143], a[120:123]
    ds_read_b128 v[244:247], v3 offset:43008
    v_mfma_f32_16x16x32_bf16 a[124:127], v[220:223], v[140:143], a[124:127]
    v_mfma_f32_16x16x32_bf16 a[128:131], v[192:195], v[144:147], a[128:131]
    ds_read_b64_tr_b16 v[180:181], v9 offset:49152
    v_mfma_f32_16x16x32_bf16 a[132:135], v[196:199], v[144:147], a[132:135]
    v_mfma_f32_16x16x32_bf16 a[136:139], v[200:203], v[144:147], a[136:139]
    ds_read_b64_tr_b16 v[182:183], v9 offset:50176
    v_mfma_f32_16x16x32_bf16 a[140:143], v[204:207], v[144:147], a[140:143]
    v_mfma_f32_16x16x32_bf16 a[144:147], v[208:211], v[144:147], a[144:147]
    ds_read_b128 v[248:251], v3 offset:45056
    v_mfma_f32_16x16x32_bf16 a[148:151], v[212:215], v[144:147], a[148:151]
    v_mfma_f32_16x16x32_bf16 a[152:155], v[216:219], v[144:147], a[152:155]
    ds_read_b64_tr_b16 v[184:185], v10 offset:49152
    v_mfma_f32_16x16x32_bf16 a[156:159], v[220:223], v[144:147], a[156:159]
    v_mfma_f32_16x16x32_bf16 a[160:163], v[192:195], v[148:151], a[160:163]
    ds_read_b64_tr_b16 v[186:187], v10 offset:50176
    v_mfma_f32_16x16x32_bf16 a[164:167], v[196:199], v[148:151], a[164:167]
    v_mfma_f32_16x16x32_bf16 a[168:171], v[200:203], v[148:151], a[168:171]
    ds_read_b128 v[252:255], v3 offset:47104
    v_mfma_f32_16x16x32_bf16 a[172:175], v[204:207], v[148:151], a[172:175]
    v_mfma_f32_16x16x32_bf16 a[176:179], v[208:211], v[148:151], a[176:179]
    ds_read_b64_tr_b16 v[188:189], v11 offset:49152
    v_mfma_f32_16x16x32_bf16 a[180:183], v[212:215], v[148:151], a[180:183]
    v_mfma_f32_16x16x32_bf16 a[184:187], v[216:219], v[148:151], a[184:187]
    ds_read_b64_tr_b16 v[190:191], v11 offset:50176
    v_mfma_f32_16x16x32_bf16 a[188:191], v[220:223], v[148:151], a[188:191]
    v_mfma_f32_16x16x32_bf16 a[192:195], v[192:195], v[152:155], a[192:195]
    v_mfma_f32_16x16x32_bf16 a[196:199], v[196:199], v[152:155], a[196:199]
    v_mfma_f32_16x16x32_bf16 a[200:203], v[200:203], v[152:155], a[200:203]
    v_mfma_f32_16x16x32_bf16 a[204:207], v[204:207], v[152:155], a[204:207]
    v_mfma_f32_16x16x32_bf16 a[208:211], v[208:211], v[152:155], a[208:211]
    v_mfma_f32_16x16x32_bf16 a[212:215], v[212:215], v[152:155], a[212:215]
    v_mfma_f32_16x16x32_bf16 a[216:219], v[216:219], v[152:155], a[216:219]
    v_mfma_f32_16x16x32_bf16 a[220:223], v[220:223], v[152:155], a[220:223]
    v_mfma_f32_16x16x32_bf16 a[224:227], v[192:195], v[156:159], a[224:227]
    v_mfma_f32_16x16x32_bf16 a[228:231], v[196:199], v[156:159], a[228:231]
    v_mfma_f32_16x16x32_bf16 a[232:235], v[200:203], v[156:159], a[232:235]
    v_mfma_f32_16x16x32_bf16 a[236:239], v[204:207], v[156:159], a[236:239]
    v_mfma_f32_16x16x32_bf16 a[240:243], v[208:211], v[156:159], a[240:243]
    v_mfma_f32_16x16x32_bf16 a[244:247], v[212:215], v[156:159], a[244:247]
    v_mfma_f32_16x16x32_bf16 a[248:251], v[216:219], v[156:159], a[248:251]
    s_waitcnt vmcnt(8) lgkmcnt(0)
    s_barrier
    v_mfma_f32_16x16x32_bf16 a[252:255], v[220:223], v[156:159], a[252:255]
    s_sub_u32 s27, s27, 1
    v_mfma_f32_16x16x32_bf16 a[0:3], v[224:227], v[160:163], a[0:3]
    ds_read_b128 v[192:195], v2 offset:0
    v_mfma_f32_16x16x32_bf16 a[4:7], v[228:231], v[160:163], a[4:7]
    s_add_u32 m0, s28, 0x8000
    v_mfma_f32_16x16x32_bf16 a[8:11], v[232:235], v[160:163], a[8:11]
    ds_read_b64_tr_b16 v[128:129], v4 offset:0
    v_mfma_f32_16x16x32_bf16 a[12:15], v[236:239], v[160:163], a[12:15]
    buffer_load_dwordx4 v12, s[12:15], s23 offen offset:0 lds
    v_mfma_f32_16x16x32_bf16 a[16:19], v[240:243], v[160:163], a[16:19]
    ds_read_b64_tr_b16 v[130:131], v4 offset:1024
    v_mfma_f32_16x16x32_bf16 a[20:23], v[244:247], v[160:163], a[20:23]
    v_mfma_f32_16x16x32_bf16 a[24:27], v[248:251], v[160:163], a[24:27]
    ds_read_b128 v[196:199], v2 offset:2048
    v_mfma_f32_16x16x32_bf16 a[28:31], v[252:255], v[160:163], a[28:31]
    buffer_load_dwordx4 v13, s[12:15], s23 offen offset:1024 lds
    v_mfma_f32_16x16x32_bf16 a[32:35], v[224:227], v[164:167], a[32:35]
    ds_read_b64_tr_b16 v[132:133], v5 offset:0
    v_mfma_f32_16x16x32_bf16 a[36:39], v[228:231], v[164:167], a[36:39]
    v_mfma_f32_16x16x32_bf16 a[40:43], v[232:235], v[164:167], a[40:43]
    ds_read_b64_tr_b16 v[134:135], v5 offset:1024
    v_mfma_f32_16x16x32_bf16 a[44:47], v[236:239], v[164:167], a[44:47]
    buffer_load_dwordx4 v14, s[12:15], s23 offen offset:2048 lds
    v_mfma_f32_16x16x32_bf16 a[48:51], v[240:243], v[164:167], a[48:51]
    ds_read_b128 v[200:203], v2 offset:4096
    v_mfma_f32_16x16x32_bf16 a[52:55], v[244:247], v[164:167], a[52:55]
    v_mfma_f32_16x16x32_bf16 a[56:59], v[248:251], v[164:167], a[56:59]
    ds_read_b64_tr_b16 v[136:137], v6 offset:0
    v_mfma_f32_16x16x32_bf16 a[60:63], v[252:255], v[164:167], a[60:63]
    buffer_load_dwordx4 v15, s[12:15], s23 offen offset:3072 lds
    v_mfma_f32_16x16x32_bf16 a[64:67], v[224:227], v[168:171], a[64:67]
    ds_read_b64_tr_b16 v[138:139], v6 offset:1024
    v_mfma_f32_16x16x32_bf16 a[68:71], v[228:231], v[168:171], a[68:71]
    s_add_u32 m0, s28, 0x9000
    v_mfma_f32_16x16x32_bf16 a[72:75], v[232:235], v[168:171], a[72:75]
    ds_read_b128 v[204:207], v2 offset:6144
    v_mfma_f32_16x16x32_bf16 a[76:79], v[236:239], v[168:171], a[76:79]
    buffer_load_dwordx4 v16, s[12:15], s23 offen offset:0 lds
    v_mfma_f32_16x16x32_bf16 a[80:83], v[240:243], v[168:171], a[80:83]
    ds_read_b64_tr_b16 v[140:141], v7 offset:0
    v_mfma_f32_16x16x32_bf16 a[84:87], v[244:247], v[168:171], a[84:87]
    v_mfma_f32_16x16x32_bf16 a[88:91], v[248:251], v[168:171], a[88:91]
    ds_read_b64_tr_b16 v[142:143], v7 offset:1024
    v_mfma_f32_16x16x32_bf16 a[92:95], v[252:255], v[168:171], a[92:95]
    buffer_load_dwordx4 v17, s[12:15], s23 offen offset:1024 lds
    v_mfma_f32_16x16x32_bf16 a[96:99], v[224:227], v[172:175], a[96:99]
    ds_read_b128 v[208:211], v2 offset:8192
    v_mfma_f32_16x16x32_bf16 a[100:103], v[228:231], v[172:175], a[100:103]
    v_mfma_f32_16x16x32_bf16 a[104:107], v[232:235], v[172:175], a[104:107]
    ds_read_b64_tr_b16 v[144:145], v8 offset:0
    v_mfma_f32_16x16x32_bf16 a[108:111], v[236:239], v[172:175], a[108:111]
    buffer_load_dwordx4 v18, s[12:15], s23 offen offset:2048 lds
    v_mfma_f32_16x16x32_bf16 a[112:115], v[240:243], v[172:175], a[112:115]
    ds_read_b64_tr_b16 v[146:147], v8 offset:1024
    v_mfma_f32_16x16x32_bf16 a[116:119], v[244:247], v[172:175], a[116:119]
    v_mfma_f32_16x16x32_bf16 a[120:123], v[248:251], v[172:175], a[120:123]
    ds_read_b128 v[212:215], v2 offset:10240
    v_mfma_f32_16x16x32_bf16 a[124:127], v[252:255], v[172:175], a[124:127]
    buffer_load_dwordx4 v19, s[12:15], s23 offen offset:3072 lds
    v_mfma_f32_16x16x32_bf16 a[128:131], v[224:227], v[176:179], a[128:131]
    ds_read_b64_tr_b16 v[148:149], v9 offset:0
    v_mfma_f32_16x16x32_bf16 a[132:135], v[228:231], v[176:179], a[132:135]
    s_add_u32 s23, s23, s25
    s_add_u32 m0, s29, 0xc000
    v_mfma_f32_16x16x32_bf16 a[136:139], v[232:235], v[176:179], a[136:139]
    ds_read_b64_tr_b16 v[150:151], v9 offset:1024
    v_mfma_f32_16x16x32_bf16 a[140:143], v[236:239], v[176:179], a[140:143]
    buffer_load_dwordx4 v20, s[16:19], s24 offen offset:0 lds
    v_mfma_f32_16x16x32_bf16 a[144:147], v[240:243], v[176:179], a[144:147]
    ds_read_b128 v[216:219], v2 offset:12288
    v_mfma_f32_16x16x32_bf16 a[148:151], v[244:247], v[176:179], a[148:151]
    v_mfma_f32_16x16x32_bf16 a[152:155], v[248:251], v[176:179], a[152:155]
    ds_read_b64_tr_b16 v[152:153], v10 offset:0
    v_mfma_f32_16x16x32_bf16 a[156:159], v[252:255], v[176:179], a[156:159]
    buffer_load_dwordx4 v21, s[16:19], s24 offen offset:1024 lds
    v_mfma_f32_16x16x32_bf16 a[160:163], v[224:227], v[180:183], a[160:163]
    ds_read_b64_tr_b16 v[154:155], v10 offset:1024
    v_mfma_f32_16x16x32_bf16 a[164:167], v[228:231], v[180:183], a[164:167]
    v_mfma_f32_16x16x32_bf16 a[168:171], v[232:235], v[180:183], a[168:171]
    ds_read_b128 v[220:223], v2 offset:14336
    v_mfma_f32_16x16x32_bf16 a[172:175], v[236:239], v[180:183], a[172:175]
    buffer_load_dwordx4 v22, s[16:19], s24 offen offset:2048 lds
    v_mfma_f32_16x16x32_bf16 a[176:179], v[240:243], v[180:183], a[176:179]
    ds_read_b64_tr_b16 v[156:157], v11 offset:0
    v_mfma_f32_16x16x32_bf16 a[180:183], v[244:247], v[180:183], a[180:183]
    v_mfma_f32_16x16x32_bf16 a[184:187], v[248:251], v[180:183], a[184:187]
    ds_read_b64_tr_b16 v[158:159], v11 offset:1024
    v_mfma_f32_16x16x32_bf16 a[188:191], v[252:255], v[180:183], a[188:191]
    buffer_load_dwordx4 v23, s[16:19], s24 offen offset:3072 lds
    v_mfma_f32_16x16x32_bf16 a[192:195], v[224:227], v[184:187], a[192:195]
    v_mfma_f32_16x16x32_bf16 a[196:199], v[228:231], v[184:187], a[196:199]
    s_add_u32 s24, s24, s26
    v_mfma_f32_16x16x32_bf16 a[200:203], v[232:235], v[184:187], a[200:203]
    v_mfma_f32_16x16x32_bf16 a[204:207], v[236:239], v[184:187], a[204:207]
    v_mfma_f32_16x16x32_bf16 a[208:211], v[240:243], v[184:187], a[208:211]
    v_mfma_f32_16x16x32_bf16 a[212:215], v[244:247], v[184:187], a[212:215]
    v_mfma_f32_16x16x32_bf16 a[216:219], v[248:251], v[184:187], a[216:219]
    v_mfma_f32_16x16x32_bf16 a[220:223], v[252:255], v[184:187], a[220:223]
    v_mfma_f32_16x16x32_bf16 a[224:227], v[224:227], v[188:191], a[224:227]
    v_mfma_f32_16x16x32_bf16 a[228:231], v[228:231], v[188:191], a[228:231]
    v_mfma_f32_16x16x32_bf16 a[232:235], v[232:235], v[188:191], a[232:235]
    v_mfma_f32_16x16x32_bf16 a[236:239], v[236:239], v[188:191], a[236:239]
    v_mfma_f32_16x16x32_bf16 a[240:243], v[240:243], v[188:191], a[240:243]
    v_mfma_f32_16x16x32_bf16 a[244:247], v[244:247], v[188:191], a[244:247]
    v_mfma_f32_16x16x32_bf16 a[248:251], v[248:251], v[188:191], a[248:251]
    s_waitcnt vmcnt(16) lgkmcnt(0)
    s_barrier
    v_mfma_f32_16x16x32_bf16 a[252:255], v[252:255], v[188:191], a[252:255]
    s_cmp_lg_u32 s27, 0
    s_cbranch_scc1 g0_272
    s_add_u32 s74, s73, 0x2200000
    s_add_u32 s30, s74, 0x0
    v_accvgpr_read_b32 v28, a0
    v_accvgpr_read_b32 v29, a1
    v_accvgpr_read_b32 v30, a2
    v_accvgpr_read_b32 v31, a3
    v_accvgpr_read_b32 v32, a4
    v_accvgpr_read_b32 v33, a5
    v_accvgpr_read_b32 v34, a6
    v_accvgpr_read_b32 v35, a7
    v_cvt_pk_bf16_f32 v44, v28, v29
    v_cvt_pk_bf16_f32 v45, v30, v31
    v_cvt_pk_bf16_f32 v46, v32, v33
    v_cvt_pk_bf16_f32 v47, v34, v35
    buffer_store_dwordx4 v[44:47], v26, s[8:11], s30 offen offset:0 sc1
    v_accvgpr_read_b32 v36, a32
    v_accvgpr_read_b32 v37, a33
    v_accvgpr_read_b32 v38, a34
    v_accvgpr_read_b32 v39, a35
    v_accvgpr_read_b32 v40, a36
    v_accvgpr_read_b32 v41, a37
    v_accvgpr_read_b32 v42, a38
    v_accvgpr_read_b32 v43, a39
    v_cvt_pk_bf16_f32 v48, v36, v37
    v_cvt_pk_bf16_f32 v49, v38, v39
    v_cvt_pk_bf16_f32 v50, v40, v41
    v_cvt_pk_bf16_f32 v51, v42, v43
    buffer_store_dwordx4 v[48:51], v26, s[8:11], s30 offen offset:1024 sc1
    v_accvgpr_read_b32 v28, a64
    v_accvgpr_read_b32 v29, a65
    v_accvgpr_read_b32 v30, a66
    v_accvgpr_read_b32 v31, a67
    v_accvgpr_read_b32 v32, a68
    v_accvgpr_read_b32 v33, a69
    v_accvgpr_read_b32 v34, a70
    v_accvgpr_read_b32 v35, a71
    v_cvt_pk_bf16_f32 v52, v28, v29
    v_cvt_pk_bf16_f32 v53, v30, v31
    v_cvt_pk_bf16_f32 v54, v32, v33
    v_cvt_pk_bf16_f32 v55, v34, v35
    buffer_store_dwordx4 v[52:55], v26, s[8:11], s30 offen offset:2048 sc1
    v_accvgpr_read_b32 v36, a96
    v_accvgpr_read_b32 v37, a97
    v_accvgpr_read_b32 v38, a98
    v_accvgpr_read_b32 v39, a99
    v_accvgpr_read_b32 v40, a100
    v_accvgpr_read_b32 v41, a101
    v_accvgpr_read_b32 v42, a102
    v_accvgpr_read_b32 v43, a103
    v_cvt_pk_bf16_f32 v56, v36, v37
    v_cvt_pk_bf16_f32 v57, v38, v39
    v_cvt_pk_bf16_f32 v58, v40, v41
    v_cvt_pk_bf16_f32 v59, v42, v43
    buffer_store_dwordx4 v[56:59], v26, s[8:11], s30 offen offset:3072 sc1
    s_add_u32 s30, s74, 0x1000
    v_accvgpr_read_b32 v28, a128
    v_accvgpr_read_b32 v29, a129
    v_accvgpr_read_b32 v30, a130
    v_accvgpr_read_b32 v31, a131
    v_accvgpr_read_b32 v32, a132
    v_accvgpr_read_b32 v33, a133
    v_accvgpr_read_b32 v34, a134
    v_accvgpr_read_b32 v35, a135
    v_cvt_pk_bf16_f32 v60, v28, v29
    v_cvt_pk_bf16_f32 v61, v30, v31
    v_cvt_pk_bf16_f32 v62, v32, v33
    v_cvt_pk_bf16_f32 v63, v34, v35
    buffer_store_dwordx4 v[60:63], v26, s[8:11], s30 offen offset:0 sc1
    v_accvgpr_read_b32 v36, a160
    v_accvgpr_read_b32 v37, a161
    v_accvgpr_read_b32 v38, a162
    v_accvgpr_read_b32 v39, a163
    v_accvgpr_read_b32 v40, a164
    v_accvgpr_read_b32 v41, a165
    v_accvgpr_read_b32 v42, a166
    v_accvgpr_read_b32 v43, a167
    v_cvt_pk_bf16_f32 v64, v36, v37
    v_cvt_pk_bf16_f32 v65, v38, v39
    v_cvt_pk_bf16_f32 v66, v40, v41
    v_cvt_pk_bf16_f32 v67, v42, v43
    buffer_store_dwordx4 v[64:67], v26, s[8:11], s30 offen offset:1024 sc1
    v_accvgpr_read_b32 v28, a192
    v_accvgpr_read_b32 v29, a193
    v_accvgpr_read_b32 v30, a194
    v_accvgpr_read_b32 v31, a195
    v_accvgpr_read_b32 v32, a196
    v_accvgpr_read_b32 v33, a197
    v_accvgpr_read_b32 v34, a198
    v_accvgpr_read_b32 v35, a199
    v_cvt_pk_bf16_f32 v68, v28, v29
    v_cvt_pk_bf16_f32 v69, v30, v31
    v_cvt_pk_bf16_f32 v70, v32, v33
    v_cvt_pk_bf16_f32 v71, v34, v35
    buffer_store_dwordx4 v[68:71], v26, s[8:11], s30 offen offset:2048 sc1
    v_accvgpr_read_b32 v36, a224
    v_accvgpr_read_b32 v37, a225
    v_accvgpr_read_b32 v38, a226
    v_accvgpr_read_b32 v39, a227
    v_accvgpr_read_b32 v40, a228
    v_accvgpr_read_b32 v41, a229
    v_accvgpr_read_b32 v42, a230
    v_accvgpr_read_b32 v43, a231
    v_cvt_pk_bf16_f32 v72, v36, v37
    v_cvt_pk_bf16_f32 v73, v38, v39
    v_cvt_pk_bf16_f32 v74, v40, v41
    v_cvt_pk_bf16_f32 v75, v42, v43
    buffer_store_dwordx4 v[72:75], v26, s[8:11], s30 offen offset:3072 sc1
    s_add_u32 s30, s74, 0x40000
    v_accvgpr_read_b32 v28, a8
    v_accvgpr_read_b32 v29, a9
    v_accvgpr_read_b32 v30, a10
    v_accvgpr_read_b32 v31, a11
    v_accvgpr_read_b32 v32, a12
    v_accvgpr_read_b32 v33, a13
    v_accvgpr_read_b32 v34, a14
    v_accvgpr_read_b32 v35, a15
    v_cvt_pk_bf16_f32 v44, v28, v29
    v_cvt_pk_bf16_f32 v45, v30, v31
    v_cvt_pk_bf16_f32 v46, v32, v33
    v_cvt_pk_bf16_f32 v47, v34, v35
    buffer_store_dwordx4 v[44:47], v26, s[8:11], s30 offen offset:0 sc1
    v_accvgpr_read_b32 v36, a40
    v_accvgpr_read_b32 v37, a41
    v_accvgpr_read_b32 v38, a42
    v_accvgpr_read_b32 v39, a43
    v_accvgpr_read_b32 v40, a44
    v_accvgpr_read_b32 v41, a45
    v_accvgpr_read_b32 v42, a46
    v_accvgpr_read_b32 v43, a47
    v_cvt_pk_bf16_f32 v48, v36, v37
    v_cvt_pk_bf16_f32 v49, v38, v39
    v_cvt_pk_bf16_f32 v50, v40, v41
    v_cvt_pk_bf16_f32 v51, v42, v43
    buffer_store_dwordx4 v[48:51], v26, s[8:11], s30 offen offset:1024 sc1
    v_accvgpr_read_b32 v28, a72
    v_accvgpr_read_b32 v29, a73
    v_accvgpr_read_b32 v30, a74
    v_accvgpr_read_b32 v31, a75
    v_accvgpr_read_b32 v32, a76
    v_accvgpr_read_b32 v33, a77
    v_accvgpr_read_b32 v34, a78
    v_accvgpr_read_b32 v35, a79
    v_cvt_pk_bf16_f32 v52, v28, v29
    v_cvt_pk_bf16_f32 v53, v30, v31
    v_cvt_pk_bf16_f32 v54, v32, v33
    v_cvt_pk_bf16_f32 v55, v34, v35
    buffer_store_dwordx4 v[52:55], v26, s[8:11], s30 offen offset:2048 sc1
    v_accvgpr_read_b32 v36, a104
    v_accvgpr_read_b32 v37, a105
    v_accvgpr_read_b32 v38, a106
    v_accvgpr_read_b32 v39, a107
    v_accvgpr_read_b32 v40, a108
    v_accvgpr_read_b32 v41, a109
    v_accvgpr_read_b32 v42, a110
    v_accvgpr_read_b32 v43, a111
    v_cvt_pk_bf16_f32 v56, v36, v37
    v_cvt_pk_bf16_f32 v57, v38, v39
    v_cvt_pk_bf16_f32 v58, v40, v41
    v_cvt_pk_bf16_f32 v59, v42, v43
    buffer_store_dwordx4 v[56:59], v26, s[8:11], s30 offen offset:3072 sc1
    s_add_u32 s30, s74, 0x41000
    v_accvgpr_read_b32 v28, a136
    v_accvgpr_read_b32 v29, a137
    v_accvgpr_read_b32 v30, a138
    v_accvgpr_read_b32 v31, a139
    v_accvgpr_read_b32 v32, a140
    v_accvgpr_read_b32 v33, a141
    v_accvgpr_read_b32 v34, a142
    v_accvgpr_read_b32 v35, a143
    v_cvt_pk_bf16_f32 v60, v28, v29
    v_cvt_pk_bf16_f32 v61, v30, v31
    v_cvt_pk_bf16_f32 v62, v32, v33
    v_cvt_pk_bf16_f32 v63, v34, v35
    buffer_store_dwordx4 v[60:63], v26, s[8:11], s30 offen offset:0 sc1
    v_accvgpr_read_b32 v36, a168
    v_accvgpr_read_b32 v37, a169
    v_accvgpr_read_b32 v38, a170
    v_accvgpr_read_b32 v39, a171
    v_accvgpr_read_b32 v40, a172
    v_accvgpr_read_b32 v41, a173
    v_accvgpr_read_b32 v42, a174
    v_accvgpr_read_b32 v43, a175
    v_cvt_pk_bf16_f32 v64, v36, v37
    v_cvt_pk_bf16_f32 v65, v38, v39
    v_cvt_pk_bf16_f32 v66, v40, v41
    v_cvt_pk_bf16_f32 v67, v42, v43
    buffer_store_dwordx4 v[64:67], v26, s[8:11], s30 offen offset:1024 sc1
    v_accvgpr_read_b32 v28, a200
    v_accvgpr_read_b32 v29, a201
    v_accvgpr_read_b32 v30, a202
    v_accvgpr_read_b32 v31, a203
    v_accvgpr_read_b32 v32, a204
    v_accvgpr_read_b32 v33, a205
    v_accvgpr_read_b32 v34, a206
    v_accvgpr_read_b32 v35, a207
    v_cvt_pk_bf16_f32 v68, v28, v29
    v_cvt_pk_bf16_f32 v69, v30, v31
    v_cvt_pk_bf16_f32 v70, v32, v33
    v_cvt_pk_bf16_f32 v71, v34, v35
    buffer_store_dwordx4 v[68:71], v26, s[8:11], s30 offen offset:2048 sc1
    v_accvgpr_read_b32 v36, a232
    v_accvgpr_read_b32 v37, a233
    v_accvgpr_read_b32 v38, a234
    v_accvgpr_read_b32 v39, a235
    v_accvgpr_read_b32 v40, a236
    v_accvgpr_read_b32 v41, a237
    v_accvgpr_read_b32 v42, a238
    v_accvgpr_read_b32 v43, a239
    v_cvt_pk_bf16_f32 v72, v36, v37
    v_cvt_pk_bf16_f32 v73, v38, v39
    v_cvt_pk_bf16_f32 v74, v40, v41
    v_cvt_pk_bf16_f32 v75, v42, v43
    buffer_store_dwordx4 v[72:75], v26, s[8:11], s30 offen offset:3072 sc1
    s_add_u32 s30, s74, 0x80000
    v_accvgpr_read_b32 v28, a16
    v_accvgpr_read_b32 v29, a17
    v_accvgpr_read_b32 v30, a18
    v_accvgpr_read_b32 v31, a19
    v_accvgpr_read_b32 v32, a20
    v_accvgpr_read_b32 v33, a21
    v_accvgpr_read_b32 v34, a22
    v_accvgpr_read_b32 v35, a23
    v_cvt_pk_bf16_f32 v44, v28, v29
    v_cvt_pk_bf16_f32 v45, v30, v31
    v_cvt_pk_bf16_f32 v46, v32, v33
    v_cvt_pk_bf16_f32 v47, v34, v35
    buffer_store_dwordx4 v[44:47], v26, s[8:11], s30 offen offset:0 sc1
    v_accvgpr_read_b32 v36, a48
    v_accvgpr_read_b32 v37, a49
    v_accvgpr_read_b32 v38, a50
    v_accvgpr_read_b32 v39, a51
    v_accvgpr_read_b32 v40, a52
    v_accvgpr_read_b32 v41, a53
    v_accvgpr_read_b32 v42, a54
    v_accvgpr_read_b32 v43, a55
    v_cvt_pk_bf16_f32 v48, v36, v37
    v_cvt_pk_bf16_f32 v49, v38, v39
    v_cvt_pk_bf16_f32 v50, v40, v41
    v_cvt_pk_bf16_f32 v51, v42, v43
    buffer_store_dwordx4 v[48:51], v26, s[8:11], s30 offen offset:1024 sc1
    v_accvgpr_read_b32 v28, a80
    v_accvgpr_read_b32 v29, a81
    v_accvgpr_read_b32 v30, a82
    v_accvgpr_read_b32 v31, a83
    v_accvgpr_read_b32 v32, a84
    v_accvgpr_read_b32 v33, a85
    v_accvgpr_read_b32 v34, a86
    v_accvgpr_read_b32 v35, a87
    v_cvt_pk_bf16_f32 v52, v28, v29
    v_cvt_pk_bf16_f32 v53, v30, v31
    v_cvt_pk_bf16_f32 v54, v32, v33
    v_cvt_pk_bf16_f32 v55, v34, v35
    buffer_store_dwordx4 v[52:55], v26, s[8:11], s30 offen offset:2048 sc1
    v_accvgpr_read_b32 v36, a112
    v_accvgpr_read_b32 v37, a113
    v_accvgpr_read_b32 v38, a114
    v_accvgpr_read_b32 v39, a115
    v_accvgpr_read_b32 v40, a116
    v_accvgpr_read_b32 v41, a117
    v_accvgpr_read_b32 v42, a118
    v_accvgpr_read_b32 v43, a119
    v_cvt_pk_bf16_f32 v56, v36, v37
    v_cvt_pk_bf16_f32 v57, v38, v39
    v_cvt_pk_bf16_f32 v58, v40, v41
    v_cvt_pk_bf16_f32 v59, v42, v43
    buffer_store_dwordx4 v[56:59], v26, s[8:11], s30 offen offset:3072 sc1
    s_add_u32 s30, s74, 0x81000
    v_accvgpr_read_b32 v28, a144
    v_accvgpr_read_b32 v29, a145
    v_accvgpr_read_b32 v30, a146
    v_accvgpr_read_b32 v31, a147
    v_accvgpr_read_b32 v32, a148
    v_accvgpr_read_b32 v33, a149
    v_accvgpr_read_b32 v34, a150
    v_accvgpr_read_b32 v35, a151
    v_cvt_pk_bf16_f32 v60, v28, v29
    v_cvt_pk_bf16_f32 v61, v30, v31
    v_cvt_pk_bf16_f32 v62, v32, v33
    v_cvt_pk_bf16_f32 v63, v34, v35
    buffer_store_dwordx4 v[60:63], v26, s[8:11], s30 offen offset:0 sc1
    v_accvgpr_read_b32 v36, a176
    v_accvgpr_read_b32 v37, a177
    v_accvgpr_read_b32 v38, a178
    v_accvgpr_read_b32 v39, a179
    v_accvgpr_read_b32 v40, a180
    v_accvgpr_read_b32 v41, a181
    v_accvgpr_read_b32 v42, a182
    v_accvgpr_read_b32 v43, a183
    v_cvt_pk_bf16_f32 v64, v36, v37
    v_cvt_pk_bf16_f32 v65, v38, v39
    v_cvt_pk_bf16_f32 v66, v40, v41
    v_cvt_pk_bf16_f32 v67, v42, v43
    buffer_store_dwordx4 v[64:67], v26, s[8:11], s30 offen offset:1024 sc1
    v_accvgpr_read_b32 v28, a208
    v_accvgpr_read_b32 v29, a209
    v_accvgpr_read_b32 v30, a210
    v_accvgpr_read_b32 v31, a211
    v_accvgpr_read_b32 v32, a212
    v_accvgpr_read_b32 v33, a213
    v_accvgpr_read_b32 v34, a214
    v_accvgpr_read_b32 v35, a215
    v_cvt_pk_bf16_f32 v68, v28, v29
    v_cvt_pk_bf16_f32 v69, v30, v31
    v_cvt_pk_bf16_f32 v70, v32, v33
    v_cvt_pk_bf16_f32 v71, v34, v35
    buffer_store_dwordx4 v[68:71], v26, s[8:11], s30 offen offset:2048 sc1
    v_accvgpr_read_b32 v36, a240
    v_accvgpr_read_b32 v37, a241
    v_accvgpr_read_b32 v38, a242
    v_accvgpr_read_b32 v39, a243
    v_accvgpr_read_b32 v40, a244
    v_accvgpr_read_b32 v41, a245
    v_accvgpr_read_b32 v42, a246
    v_accvgpr_read_b32 v43, a247
    v_cvt_pk_bf16_f32 v72, v36, v37
    v_cvt_pk_bf16_f32 v73, v38, v39
    v_cvt_pk_bf16_f32 v74, v40, v41
    v_cvt_pk_bf16_f32 v75, v42, v43
    buffer_store_dwordx4 v[72:75], v26, s[8:11], s30 offen offset:3072 sc1
    s_add_u32 s30, s74, 0xc0000
    v_accvgpr_read_b32 v28, a24
    v_accvgpr_read_b32 v29, a25
    v_accvgpr_read_b32 v30, a26
    v_accvgpr_read_b32 v31, a27
    v_accvgpr_read_b32 v32, a28
    v_accvgpr_read_b32 v33, a29
    v_accvgpr_read_b32 v34, a30
    v_accvgpr_read_b32 v35, a31
    v_cvt_pk_bf16_f32 v44, v28, v29
    v_cvt_pk_bf16_f32 v45, v30, v31
    v_cvt_pk_bf16_f32 v46, v32, v33
    v_cvt_pk_bf16_f32 v47, v34, v35
    buffer_store_dwordx4 v[44:47], v26, s[8:11], s30 offen offset:0 sc1
    v_accvgpr_read_b32 v36, a56
    v_accvgpr_read_b32 v37, a57
    v_accvgpr_read_b32 v38, a58
    v_accvgpr_read_b32 v39, a59
    v_accvgpr_read_b32 v40, a60
    v_accvgpr_read_b32 v41, a61
    v_accvgpr_read_b32 v42, a62
    v_accvgpr_read_b32 v43, a63
    v_cvt_pk_bf16_f32 v48, v36, v37
    v_cvt_pk_bf16_f32 v49, v38, v39
    v_cvt_pk_bf16_f32 v50, v40, v41
    v_cvt_pk_bf16_f32 v51, v42, v43
    buffer_store_dwordx4 v[48:51], v26, s[8:11], s30 offen offset:1024 sc1
    v_accvgpr_read_b32 v28, a88
    v_accvgpr_read_b32 v29, a89
    v_accvgpr_read_b32 v30, a90
    v_accvgpr_read_b32 v31, a91
    v_accvgpr_read_b32 v32, a92
    v_accvgpr_read_b32 v33, a93
    v_accvgpr_read_b32 v34, a94
    v_accvgpr_read_b32 v35, a95
    v_cvt_pk_bf16_f32 v52, v28, v29
    v_cvt_pk_bf16_f32 v53, v30, v31
    v_cvt_pk_bf16_f32 v54, v32, v33
    v_cvt_pk_bf16_f32 v55, v34, v35
    buffer_store_dwordx4 v[52:55], v26, s[8:11], s30 offen offset:2048 sc1
    v_accvgpr_read_b32 v36, a120
    v_accvgpr_read_b32 v37, a121
    v_accvgpr_read_b32 v38, a122
    v_accvgpr_read_b32 v39, a123
    v_accvgpr_read_b32 v40, a124
    v_accvgpr_read_b32 v41, a125
    v_accvgpr_read_b32 v42, a126
    v_accvgpr_read_b32 v43, a127
    v_cvt_pk_bf16_f32 v56, v36, v37
    v_cvt_pk_bf16_f32 v57, v38, v39
    v_cvt_pk_bf16_f32 v58, v40, v41
    v_cvt_pk_bf16_f32 v59, v42, v43
    buffer_store_dwordx4 v[56:59], v26, s[8:11], s30 offen offset:3072 sc1
    s_add_u32 s30, s74, 0xc1000
    v_accvgpr_read_b32 v28, a152
    v_accvgpr_read_b32 v29, a153
    v_accvgpr_read_b32 v30, a154
    v_accvgpr_read_b32 v31, a155
    v_accvgpr_read_b32 v32, a156
    v_accvgpr_read_b32 v33, a157
    v_accvgpr_read_b32 v34, a158
    v_accvgpr_read_b32 v35, a159
    v_cvt_pk_bf16_f32 v60, v28, v29
    v_cvt_pk_bf16_f32 v61, v30, v31
    v_cvt_pk_bf16_f32 v62, v32, v33
    v_cvt_pk_bf16_f32 v63, v34, v35
    buffer_store_dwordx4 v[60:63], v26, s[8:11], s30 offen offset:0 sc1
    v_accvgpr_read_b32 v36, a184
    v_accvgpr_read_b32 v37, a185
    v_accvgpr_read_b32 v38, a186
    v_accvgpr_read_b32 v39, a187
    v_accvgpr_read_b32 v40, a188
    v_accvgpr_read_b32 v41, a189
    v_accvgpr_read_b32 v42, a190
    v_accvgpr_read_b32 v43, a191
    v_cvt_pk_bf16_f32 v64, v36, v37
    v_cvt_pk_bf16_f32 v65, v38, v39
    v_cvt_pk_bf16_f32 v66, v40, v41
    v_cvt_pk_bf16_f32 v67, v42, v43
    buffer_store_dwordx4 v[64:67], v26, s[8:11], s30 offen offset:1024 sc1
    v_accvgpr_read_b32 v28, a216
    v_accvgpr_read_b32 v29, a217
    v_accvgpr_read_b32 v30, a218
    v_accvgpr_read_b32 v31, a219
    v_accvgpr_read_b32 v32, a220
    v_accvgpr_read_b32 v33, a221
    v_accvgpr_read_b32 v34, a222
    v_accvgpr_read_b32 v35, a223
    v_cvt_pk_bf16_f32 v68, v28, v29
    v_cvt_pk_bf16_f32 v69, v30, v31
    v_cvt_pk_bf16_f32 v70, v32, v33
    v_cvt_pk_bf16_f32 v71, v34, v35
    buffer_store_dwordx4 v[68:71], v26, s[8:11], s30 offen offset:2048 sc1
    v_accvgpr_read_b32 v36, a248
    v_accvgpr_read_b32 v37, a249
    v_accvgpr_read_b32 v38, a250
    v_accvgpr_read_b32 v39, a251
    v_accvgpr_read_b32 v40, a252
    v_accvgpr_read_b32 v41, a253
    v_accvgpr_read_b32 v42, a254
    v_accvgpr_read_b32 v43, a255
    v_cvt_pk_bf16_f32 v72, v36, v37
    v_cvt_pk_bf16_f32 v73, v38, v39
    v_cvt_pk_bf16_f32 v74, v40, v41
    v_cvt_pk_bf16_f32 v75, v42, v43
    buffer_store_dwordx4 v[72:75], v26, s[8:11], s30 offen offset:3072 sc1
kvg_241:
    s_lshl_b32 s74, s68, 2
    s_add_u32 s74, s74, 32
    s_cmp_ge_u32 s67, 2
    s_cselect_b32 s75, 0x100, 1
    s_branch jsg_240
ehg_238:
    v_sub_f32 v112, 1.0, v112
    v_sub_f32 v113, 1.0, v113
    v_sub_f32 v114, 1.0, v114
    v_sub_f32 v115, 1.0, v115
    v_sub_f32 v116, 1.0, v116
    v_sub_f32 v117, 1.0, v117
    v_sub_f32 v118, 1.0, v118
    v_sub_f32 v119, 1.0, v119
    s_mov_b32 s31, 0xbfb8aa3b
    s_add_u32 s30, s73, 0x0
    v_accvgpr_read_b32 v28, a0
    v_accvgpr_read_b32 v29, a1
    v_accvgpr_read_b32 v30, a2
    v_accvgpr_read_b32 v31, a3
    v_accvgpr_read_b32 v32, a4
    v_accvgpr_read_b32 v33, a5
    v_accvgpr_read_b32 v34, a6
    v_accvgpr_read_b32 v35, a7
    v_mul_f32 v44, s31, v28
    v_mul_f32 v45, s31, v29
    v_mul_f32 v46, s31, v30
    v_mul_f32 v47, s31, v31
    v_mul_f32 v48, s31, v32
    v_mul_f32 v49, s31, v33
    v_mul_f32 v50, s31, v34
    v_mul_f32 v51, s31, v35
    v_exp_f32 v44, v44
    v_accvgpr_read_b32 v36, a128
    v_exp_f32 v45, v45
    v_accvgpr_read_b32 v37, a129
    v_exp_f32 v46, v46
    v_accvgpr_read_b32 v38, a130
    v_exp_f32 v47, v47
    v_accvgpr_read_b32 v39, a131
    v_exp_f32 v48, v48
    v_accvgpr_read_b32 v40, a132
    v_exp_f32 v49, v49
    v_accvgpr_read_b32 v41, a133
    v_exp_f32 v50, v50
    v_accvgpr_read_b32 v42, a134
    v_exp_f32 v51, v51
    v_accvgpr_read_b32 v43, a135
    v_pk_add_f32 v[44:45], v[44:45], 1.0 op_sel_hi:[1,0]
    v_pk_add_f32 v[46:47], v[46:47], 1.0 op_sel_hi:[1,0]
    v_pk_add_f32 v[48:49], v[48:49], 1.0 op_sel_hi:[1,0]
    v_pk_add_f32 v[50:51], v[50:51], 1.0 op_sel_hi:[1,0]
    v_rcp_f32 v44, v44
    v_rcp_f32 v45, v45
    v_pk_mul_f32 v[28:29], v[28:29], v[36:37]
    v_rcp_f32 v46, v46
    v_rcp_f32 v47, v47
    v_pk_mul_f32 v[30:31], v[30:31], v[38:39]
    v_rcp_f32 v48, v48
    v_rcp_f32 v49, v49
    v_pk_mul_f32 v[32:33], v[32:33], v[40:41]
    v_rcp_f32 v50, v50
    v_rcp_f32 v51, v51
    v_pk_mul_f32 v[34:35], v[34:35], v[42:43]
    v_mul_f32 v44, v44, v112
    v_mul_f32 v45, v45, v112
    v_mul_f32 v46, v46, v112
    v_mul_f32 v47, v47, v112
    v_mul_f32 v48, v48, v112
    v_mul_f32 v49, v49, v112
    v_mul_f32 v50, v50, v112
    v_mul_f32 v51, v51, v112
    v_pk_mul_f32 v[28:29], v[28:29], v[44:45]
    v_pk_mul_f32 v[30:31], v[30:31], v[46:47]
    v_pk_mul_f32 v[32:33], v[32:33], v[48:49]
    v_pk_mul_f32 v[34:35], v[34:35], v[50:51]
    v_cvt_pk_bf16_f32 v76, v28, v29
    v_cvt_pk_bf16_f32 v77, v30, v31
    v_cvt_pk_bf16_f32 v78, v32, v33
    v_cvt_pk_bf16_f32 v79, v34, v35
    buffer_store_dwordx4 v[76:79], v26, s[8:11], s30 offen offset:0 sc1
    v_accvgpr_read_b32 v52, a64
    v_accvgpr_read_b32 v53, a65
    v_accvgpr_read_b32 v54, a66
    v_accvgpr_read_b32 v55, a67
    v_accvgpr_read_b32 v56, a68
    v_accvgpr_read_b32 v57, a69
    v_accvgpr_read_b32 v58, a70
    v_accvgpr_read_b32 v59, a71
    v_mul_f32 v68, s31, v52
    v_mul_f32 v69, s31, v53
    v_mul_f32 v70, s31, v54
    v_mul_f32 v71, s31, v55
    v_mul_f32 v72, s31, v56
    v_mul_f32 v73, s31, v57
    v_mul_f32 v74, s31, v58
    v_mul_f32 v75, s31, v59
    v_exp_f32 v68, v68
    v_accvgpr_read_b32 v60, a192
    v_exp_f32 v69, v69
    v_accvgpr_read_b32 v61, a193
    v_exp_f32 v70, v70
    v_accvgpr_read_b32 v62, a194
    v_exp_f32 v71, v71
    v_accvgpr_read_b32 v63, a195
    v_exp_f32 v72, v72
    v_accvgpr_read_b32 v64, a196
    v_exp_f32 v73, v73
    v_accvgpr_read_b32 v65, a197
    v_exp_f32 v74, v74
    v_accvgpr_read_b32 v66, a198
    v_exp_f32 v75, v75
    v_accvgpr_read_b32 v67, a199
    v_pk_add_f32 v[68:69], v[68:69], 1.0 op_sel_hi:[1,0]
    v_pk_add_f32 v[70:71], v[70:71], 1.0 op_sel_hi:[1,0]
    v_pk_add_f32 v[72:73], v[72:73], 1.0 op_sel_hi:[1,0]
    v_pk_add_f32 v[74:75], v[74:75], 1.0 op_sel_hi:[1,0]
    v_rcp_f32 v68, v68
    v_rcp_f32 v69, v69
    v_pk_mul_f32 v[52:53], v[52:53], v[60:61]
    v_rcp_f32 v70, v70
    v_rcp_f32 v71, v71
    v_pk_mul_f32 v[54:55], v[54:55], v[62:63]
    v_rcp_f32 v72, v72
    v_rcp_f32 v73, v73
    v_pk_mul_f32 v[56:57], v[56:57], v[64:65]
    v_rcp_f32 v74, v74
    v_rcp_f32 v75, v75
    v_pk_mul_f32 v[58:59], v[58:59], v[66:67]
    v_mul_f32 v68, v68, v112
    v_mul_f32 v69, v69, v112
    v_mul_f32 v70, v70, v112
    v_mul_f32 v71, v71, v112
    v_mul_f32 v72, v72, v112
    v_mul_f32 v73, v73, v112
    v_mul_f32 v74, v74, v112
    v_mul_f32 v75, v75, v112
    v_pk_mul_f32 v[52:53], v[52:53], v[68:69]
    v_pk_mul_f32 v[54:55], v[54:55], v[70:71]
    v_pk_mul_f32 v[56:57], v[56:57], v[72:73]
    v_pk_mul_f32 v[58:59], v[58:59], v[74:75]
    v_cvt_pk_bf16_f32 v80, v52, v53
    v_cvt_pk_bf16_f32 v81, v54, v55
    v_cvt_pk_bf16_f32 v82, v56, v57
    v_cvt_pk_bf16_f32 v83, v58, v59
    buffer_store_dwordx4 v[80:83], v26, s[8:11], s30 offen offset:1024 sc1
    v_accvgpr_read_b32 v28, a8
    v_accvgpr_read_b32 v29, a9
    v_accvgpr_read_b32 v30, a10
    v_accvgpr_read_b32 v31, a11
    v_accvgpr_read_b32 v32, a12
    v_accvgpr_read_b32 v33, a13
    v_accvgpr_read_b32 v34, a14
    v_accvgpr_read_b32 v35, a15
    v_mul_f32 v44, s31, v28
    v_mul_f32 v45, s31, v29
    v_mul_f32 v46, s31, v30
    v_mul_f32 v47, s31, v31
    v_mul_f32 v48, s31, v32
    v_mul_f32 v49, s31, v33
    v_mul_f32 v50, s31, v34
    v_mul_f32 v51, s31, v35
    v_exp_f32 v44, v44
    v_accvgpr_read_b32 v36, a136
    v_exp_f32 v45, v45
    v_accvgpr_read_b32 v37, a137
    v_exp_f32 v46, v46
    v_accvgpr_read_b32 v38, a138
    v_exp_f32 v47, v47
    v_accvgpr_read_b32 v39, a139
    v_exp_f32 v48, v48
    v_accvgpr_read_b32 v40, a140
    v_exp_f32 v49, v49
    v_accvgpr_read_b32 v41, a141
    v_exp_f32 v50, v50
    v_accvgpr_read_b32 v42, a142
    v_exp_f32 v51, v51
    v_accvgpr_read_b32 v43, a143
    v_pk_add_f32 v[44:45], v[44:45], 1.0 op_sel_hi:[1,0]
    v_pk_add_f32 v[46:47], v[46:47], 1.0 op_sel_hi:[1,0]
    v_pk_add_f32 v[48:49], v[48:49], 1.0 op_sel_hi:[1,0]
    v_pk_add_f32 v[50:51], v[50:51], 1.0 op_sel_hi:[1,0]
    v_rcp_f32 v44, v44
    v_rcp_f32 v45, v45
    v_pk_mul_f32 v[28:29], v[28:29], v[36:37]
    v_rcp_f32 v46, v46
    v_rcp_f32 v47, v47
    v_pk_mul_f32 v[30:31], v[30:31], v[38:39]
    v_rcp_f32 v48, v48
    v_rcp_f32 v49, v49
    v_pk_mul_f32 v[32:33], v[32:33], v[40:41]
    v_rcp_f32 v50, v50
    v_rcp_f32 v51, v51
    v_pk_mul_f32 v[34:35], v[34:35], v[42:43]
    v_mul_f32 v44, v44, v113
    v_mul_f32 v45, v45, v113
    v_mul_f32 v46, v46, v113
    v_mul_f32 v47, v47, v113
    v_mul_f32 v48, v48, v113
    v_mul_f32 v49, v49, v113
    v_mul_f32 v50, v50, v113
    v_mul_f32 v51, v51, v113
    v_pk_mul_f32 v[28:29], v[28:29], v[44:45]
    v_pk_mul_f32 v[30:31], v[30:31], v[46:47]
    v_pk_mul_f32 v[32:33], v[32:33], v[48:49]
    v_pk_mul_f32 v[34:35], v[34:35], v[50:51]
    v_cvt_pk_bf16_f32 v84, v28, v29
    v_cvt_pk_bf16_f32 v85, v30, v31
    v_cvt_pk_bf16_f32 v86, v32, v33
    v_cvt_pk_bf16_f32 v87, v34, v35
    buffer_store_dwordx4 v[84:87], v26, s[8:11], s30 offen offset:2048 sc1
    v_accvgpr_read_b32 v52, a72
    v_accvgpr_read_b32 v53, a73
    v_accvgpr_read_b32 v54, a74
    v_accvgpr_read_b32 v55, a75
    v_accvgpr_read_b32 v56, a76
    v_accvgpr_read_b32 v57, a77
    v_accvgpr_read_b32 v58, a78
    v_accvgpr_read_b32 v59, a79
    v_mul_f32 v68, s31, v52
    v_mul_f32 v69, s31, v53
    v_mul_f32 v70, s31, v54
    v_mul_f32 v71, s31, v55
    v_mul_f32 v72, s31, v56
    v_mul_f32 v73, s31, v57
    v_mul_f32 v74, s31, v58
    v_mul_f32 v75, s31, v59
    v_exp_f32 v68, v68
    v_accvgpr_read_b32 v60, a200
    v_exp_f32 v69, v69
    v_accvgpr_read_b32 v61, a201
    v_exp_f32 v70, v70
    v_accvgpr_read_b32 v62, a202
    v_exp_f32 v71, v71
    v_accvgpr_read_b32 v63, a203
    v_exp_f32 v72, v72
    v_accvgpr_read_b32 v64, a204
    v_exp_f32 v73, v73
    v_accvgpr_read_b32 v65, a205
    v_exp_f32 v74, v74
    v_accvgpr_read_b32 v66, a206
    v_exp_f32 v75, v75
    v_accvgpr_read_b32 v67, a207
    v_pk_add_f32 v[68:69], v[68:69], 1.0 op_sel_hi:[1,0]
    v_pk_add_f32 v[70:71], v[70:71], 1.0 op_sel_hi:[1,0]
    v_pk_add_f32 v[72:73], v[72:73], 1.0 op_sel_hi:[1,0]
    v_pk_add_f32 v[74:75], v[74:75], 1.0 op_sel_hi:[1,0]
    v_rcp_f32 v68, v68
    v_rcp_f32 v69, v69
    v_pk_mul_f32 v[52:53], v[52:53], v[60:61]
    v_rcp_f32 v70, v70
    v_rcp_f32 v71, v71
    v_pk_mul_f32 v[54:55], v[54:55], v[62:63]
    v_rcp_f32 v72, v72
    v_rcp_f32 v73, v73
    v_pk_mul_f32 v[56:57], v[56:57], v[64:65]
    v_rcp_f32 v74, v74
    v_rcp_f32 v75, v75
    v_pk_mul_f32 v[58:59], v[58:59], v[66:67]
    v_mul_f32 v68, v68, v113
    v_mul_f32 v69, v69, v113
    v_mul_f32 v70, v70, v113
    v_mul_f32 v71, v71, v113
    v_mul_f32 v72, v72, v113
    v_mul_f32 v73, v73, v113
    v_mul_f32 v74, v74, v113
    v_mul_f32 v75, v75, v113
    v_pk_mul_f32 v[52:53], v[52:53], v[68:69]
    v_pk_mul_f32 v[54:55], v[54:55], v[70:71]
    v_pk_mul_f32 v[56:57], v[56:57], v[72:73]
    v_pk_mul_f32 v[58:59], v[58:59], v[74:75]
    v_cvt_pk_bf16_f32 v88, v52, v53
    v_cvt_pk_bf16_f32 v89, v54, v55
    v_cvt_pk_bf16_f32 v90, v56, v57
    v_cvt_pk_bf16_f32 v91, v58, v59
    buffer_store_dwordx4 v[88:91], v26, s[8:11], s30 offen offset:3072 sc1
    s_add_u32 s30, s73, 0x1000
    v_accvgpr_read_b32 v28, a16
    v_accvgpr_read_b32 v29, a17
    v_accvgpr_read_b32 v30, a18
    v_accvgpr_read_b32 v31, a19
    v_accvgpr_read_b32 v32, a20
    v_accvgpr_read_b32 v33, a21
    v_accvgpr_read_b32 v34, a22
    v_accvgpr_read_b32 v35, a23
    v_mul_f32 v44, s31, v28
    v_mul_f32 v45, s31, v29
    v_mul_f32 v46, s31, v30
    v_mul_f32 v47, s31, v31
    v_mul_f32 v48, s31, v32
    v_mul_f32 v49, s31, v33
    v_mul_f32 v50, s31, v34
    v_mul_f32 v51, s31, v35
    v_exp_f32 v44, v44
    v_accvgpr_read_b32 v36, a144
    v_exp_f32 v45, v45
    v_accvgpr_read_b32 v37, a145
    v_exp_f32 v46, v46
    v_accvgpr_read_b32 v38, a146
    v_exp_f32 v47, v47
    v_accvgpr_read_b32 v39, a147
    v_exp_f32 v48, v48
    v_accvgpr_read_b32 v40, a148
    v_exp_f32 v49, v49
    v_accvgpr_read_b32 v41, a149
    v_exp_f32 v50, v50
    v_accvgpr_read_b32 v42, a150
    v_exp_f32 v51, v51
    v_accvgpr_read_b32 v43, a151
    v_pk_add_f32 v[44:45], v[44:45], 1.0 op_sel_hi:[1,0]
    v_pk_add_f32 v[46:47], v[46:47], 1.0 op_sel_hi:[1,0]
    v_pk_add_f32 v[48:49], v[48:49], 1.0 op_sel_hi:[1,0]
    v_pk_add_f32 v[50:51], v[50:51], 1.0 op_sel_hi:[1,0]
    v_rcp_f32 v44, v44
    v_rcp_f32 v45, v45
    v_pk_mul_f32 v[28:29], v[28:29], v[36:37]
    v_rcp_f32 v46, v46
    v_rcp_f32 v47, v47
    v_pk_mul_f32 v[30:31], v[30:31], v[38:39]
    v_rcp_f32 v48, v48
    v_rcp_f32 v49, v49
    v_pk_mul_f32 v[32:33], v[32:33], v[40:41]
    v_rcp_f32 v50, v50
    v_rcp_f32 v51, v51
    v_pk_mul_f32 v[34:35], v[34:35], v[42:43]
    v_mul_f32 v44, v44, v114
    v_mul_f32 v45, v45, v114
    v_mul_f32 v46, v46, v114
    v_mul_f32 v47, v47, v114
    v_mul_f32 v48, v48, v114
    v_mul_f32 v49, v49, v114
    v_mul_f32 v50, v50, v114
    v_mul_f32 v51, v51, v114
    v_pk_mul_f32 v[28:29], v[28:29], v[44:45]
    v_pk_mul_f32 v[30:31], v[30:31], v[46:47]
    v_pk_mul_f32 v[32:33], v[32:33], v[48:49]
    v_pk_mul_f32 v[34:35], v[34:35], v[50:51]
    v_cvt_pk_bf16_f32 v76, v28, v29
    v_cvt_pk_bf16_f32 v77, v30, v31
    v_cvt_pk_bf16_f32 v78, v32, v33
    v_cvt_pk_bf16_f32 v79, v34, v35
    buffer_store_dwordx4 v[76:79], v26, s[8:11], s30 offen offset:0 sc1
    v_accvgpr_read_b32 v52, a80
    v_accvgpr_read_b32 v53, a81
    v_accvgpr_read_b32 v54, a82
    v_accvgpr_read_b32 v55, a83
    v_accvgpr_read_b32 v56, a84
    v_accvgpr_read_b32 v57, a85
    v_accvgpr_read_b32 v58, a86
    v_accvgpr_read_b32 v59, a87
    v_mul_f32 v68, s31, v52
    v_mul_f32 v69, s31, v53
    v_mul_f32 v70, s31, v54
    v_mul_f32 v71, s31, v55
    v_mul_f32 v72, s31, v56
    v_mul_f32 v73, s31, v57
    v_mul_f32 v74, s31, v58
    v_mul_f32 v75, s31, v59
    v_exp_f32 v68, v68
    v_accvgpr_read_b32 v60, a208
    v_exp_f32 v69, v69
    v_accvgpr_read_b32 v61, a209
    v_exp_f32 v70, v70
    v_accvgpr_read_b32 v62, a210
    v_exp_f32 v71, v71
    v_accvgpr_read_b32 v63, a211
    v_exp_f32 v72, v72
    v_accvgpr_read_b32 v64, a212
    v_exp_f32 v73, v73
    v_accvgpr_read_b32 v65, a213
    v_exp_f32 v74, v74
    v_accvgpr_read_b32 v66, a214
    v_exp_f32 v75, v75
    v_accvgpr_read_b32 v67, a215
    v_pk_add_f32 v[68:69], v[68:69], 1.0 op_sel_hi:[1,0]
    v_pk_add_f32 v[70:71], v[70:71], 1.0 op_sel_hi:[1,0]
    v_pk_add_f32 v[72:73], v[72:73], 1.0 op_sel_hi:[1,0]
    v_pk_add_f32 v[74:75], v[74:75], 1.0 op_sel_hi:[1,0]
    v_rcp_f32 v68, v68
    v_rcp_f32 v69, v69
    v_pk_mul_f32 v[52:53], v[52:53], v[60:61]
    v_rcp_f32 v70, v70
    v_rcp_f32 v71, v71
    v_pk_mul_f32 v[54:55], v[54:55], v[62:63]
    v_rcp_f32 v72, v72
    v_rcp_f32 v73, v73
    v_pk_mul_f32 v[56:57], v[56:57], v[64:65]
    v_rcp_f32 v74, v74
    v_rcp_f32 v75, v75
    v_pk_mul_f32 v[58:59], v[58:59], v[66:67]
    v_mul_f32 v68, v68, v114
    v_mul_f32 v69, v69, v114
    v_mul_f32 v70, v70, v114
    v_mul_f32 v71, v71, v114
    v_mul_f32 v72, v72, v114
    v_mul_f32 v73, v73, v114
    v_mul_f32 v74, v74, v114
    v_mul_f32 v75, v75, v114
    v_pk_mul_f32 v[52:53], v[52:53], v[68:69]
    v_pk_mul_f32 v[54:55], v[54:55], v[70:71]
    v_pk_mul_f32 v[56:57], v[56:57], v[72:73]
    v_pk_mul_f32 v[58:59], v[58:59], v[74:75]
    v_cvt_pk_bf16_f32 v80, v52, v53
    v_cvt_pk_bf16_f32 v81, v54, v55
    v_cvt_pk_bf16_f32 v82, v56, v57
    v_cvt_pk_bf16_f32 v83, v58, v59
    buffer_store_dwordx4 v[80:83], v26, s[8:11], s30 offen offset:1024 sc1
    v_accvgpr_read_b32 v28, a24
    v_accvgpr_read_b32 v29, a25
    v_accvgpr_read_b32 v30, a26
    v_accvgpr_read_b32 v31, a27
    v_accvgpr_read_b32 v32, a28
    v_accvgpr_read_b32 v33, a29
    v_accvgpr_read_b32 v34, a30
    v_accvgpr_read_b32 v35, a31
    v_mul_f32 v44, s31, v28
    v_mul_f32 v45, s31, v29
    v_mul_f32 v46, s31, v30
    v_mul_f32 v47, s31, v31
    v_mul_f32 v48, s31, v32
    v_mul_f32 v49, s31, v33
    v_mul_f32 v50, s31, v34
    v_mul_f32 v51, s31, v35
    v_exp_f32 v44, v44
    v_accvgpr_read_b32 v36, a152
    v_exp_f32 v45, v45
    v_accvgpr_read_b32 v37, a153
    v_exp_f32 v46, v46
    v_accvgpr_read_b32 v38, a154
    v_exp_f32 v47, v47
    v_accvgpr_read_b32 v39, a155
    v_exp_f32 v48, v48
    v_accvgpr_read_b32 v40, a156
    v_exp_f32 v49, v49
    v_accvgpr_read_b32 v41, a157
    v_exp_f32 v50, v50
    v_accvgpr_read_b32 v42, a158
    v_exp_f32 v51, v51
    v_accvgpr_read_b32 v43, a159
    v_pk_add_f32 v[44:45], v[44:45], 1.0 op_sel_hi:[1,0]
    v_pk_add_f32 v[46:47], v[46:47], 1.0 op_sel_hi:[1,0]
    v_pk_add_f32 v[48:49], v[48:49], 1.0 op_sel_hi:[1,0]
    v_pk_add_f32 v[50:51], v[50:51], 1.0 op_sel_hi:[1,0]
    v_rcp_f32 v44, v44
    v_rcp_f32 v45, v45
    v_pk_mul_f32 v[28:29], v[28:29], v[36:37]
    v_rcp_f32 v46, v46
    v_rcp_f32 v47, v47
    v_pk_mul_f32 v[30:31], v[30:31], v[38:39]
    v_rcp_f32 v48, v48
    v_rcp_f32 v49, v49
    v_pk_mul_f32 v[32:33], v[32:33], v[40:41]
    v_rcp_f32 v50, v50
    v_rcp_f32 v51, v51
    v_pk_mul_f32 v[34:35], v[34:35], v[42:43]
    v_mul_f32 v44, v44, v115
    v_mul_f32 v45, v45, v115
    v_mul_f32 v46, v46, v115
    v_mul_f32 v47, v47, v115
    v_mul_f32 v48, v48, v115
    v_mul_f32 v49, v49, v115
    v_mul_f32 v50, v50, v115
    v_mul_f32 v51, v51, v115
    v_pk_mul_f32 v[28:29], v[28:29], v[44:45]
    v_pk_mul_f32 v[30:31], v[30:31], v[46:47]
    v_pk_mul_f32 v[32:33], v[32:33], v[48:49]
    v_pk_mul_f32 v[34:35], v[34:35], v[50:51]
    v_cvt_pk_bf16_f32 v84, v28, v29
    v_cvt_pk_bf16_f32 v85, v30, v31
    v_cvt_pk_bf16_f32 v86, v32, v33
    v_cvt_pk_bf16_f32 v87, v34, v35
    buffer_store_dwordx4 v[84:87], v26, s[8:11], s30 offen offset:2048 sc1
    v_accvgpr_read_b32 v52, a88
    v_accvgpr_read_b32 v53, a89
    v_accvgpr_read_b32 v54, a90
    v_accvgpr_read_b32 v55, a91
    v_accvgpr_read_b32 v56, a92
    v_accvgpr_read_b32 v57, a93
    v_accvgpr_read_b32 v58, a94
    v_accvgpr_read_b32 v59, a95
    v_mul_f32 v68, s31, v52
    v_mul_f32 v69, s31, v53
    v_mul_f32 v70, s31, v54
    v_mul_f32 v71, s31, v55
    v_mul_f32 v72, s31, v56
    v_mul_f32 v73, s31, v57
    v_mul_f32 v74, s31, v58
    v_mul_f32 v75, s31, v59
    v_exp_f32 v68, v68
    v_accvgpr_read_b32 v60, a216
    v_exp_f32 v69, v69
    v_accvgpr_read_b32 v61, a217
    v_exp_f32 v70, v70
    v_accvgpr_read_b32 v62, a218
    v_exp_f32 v71, v71
    v_accvgpr_read_b32 v63, a219
    v_exp_f32 v72, v72
    v_accvgpr_read_b32 v64, a220
    v_exp_f32 v73, v73
    v_accvgpr_read_b32 v65, a221
    v_exp_f32 v74, v74
    v_accvgpr_read_b32 v66, a222
    v_exp_f32 v75, v75
    v_accvgpr_read_b32 v67, a223
    v_pk_add_f32 v[68:69], v[68:69], 1.0 op_sel_hi:[1,0]
    v_pk_add_f32 v[70:71], v[70:71], 1.0 op_sel_hi:[1,0]
    v_pk_add_f32 v[72:73], v[72:73], 1.0 op_sel_hi:[1,0]
    v_pk_add_f32 v[74:75], v[74:75], 1.0 op_sel_hi:[1,0]
    v_rcp_f32 v68, v68
    v_rcp_f32 v69, v69
    v_pk_mul_f32 v[52:53], v[52:53], v[60:61]
    v_rcp_f32 v70, v70
    v_rcp_f32 v71, v71
    v_pk_mul_f32 v[54:55], v[54:55], v[62:63]
    v_rcp_f32 v72, v72
    v_rcp_f32 v73, v73
    v_pk_mul_f32 v[56:57], v[56:57], v[64:65]
    v_rcp_f32 v74, v74
    v_rcp_f32 v75, v75
    v_pk_mul_f32 v[58:59], v[58:59], v[66:67]
    v_mul_f32 v68, v68, v115
    v_mul_f32 v69, v69, v115
    v_mul_f32 v70, v70, v115
    v_mul_f32 v71, v71, v115
    v_mul_f32 v72, v72, v115
    v_mul_f32 v73, v73, v115
    v_mul_f32 v74, v74, v115
    v_mul_f32 v75, v75, v115
    v_pk_mul_f32 v[52:53], v[52:53], v[68:69]
    v_pk_mul_f32 v[54:55], v[54:55], v[70:71]
    v_pk_mul_f32 v[56:57], v[56:57], v[72:73]
    v_pk_mul_f32 v[58:59], v[58:59], v[74:75]
    v_cvt_pk_bf16_f32 v88, v52, v53
    v_cvt_pk_bf16_f32 v89, v54, v55
    v_cvt_pk_bf16_f32 v90, v56, v57
    v_cvt_pk_bf16_f32 v91, v58, v59
    buffer_store_dwordx4 v[88:91], v26, s[8:11], s30 offen offset:3072 sc1
    s_add_u32 s30, s73, 0x2000
    v_accvgpr_read_b32 v28, a32
    v_accvgpr_read_b32 v29, a33
    v_accvgpr_read_b32 v30, a34
    v_accvgpr_read_b32 v31, a35
    v_accvgpr_read_b32 v32, a36
    v_accvgpr_read_b32 v33, a37
    v_accvgpr_read_b32 v34, a38
    v_accvgpr_read_b32 v35, a39
    v_mul_f32 v44, s31, v28
    v_mul_f32 v45, s31, v29
    v_mul_f32 v46, s31, v30
    v_mul_f32 v47, s31, v31
    v_mul_f32 v48, s31, v32
    v_mul_f32 v49, s31, v33
    v_mul_f32 v50, s31, v34
    v_mul_f32 v51, s31, v35
    v_exp_f32 v44, v44
    v_accvgpr_read_b32 v36, a160
    v_exp_f32 v45, v45
    v_accvgpr_read_b32 v37, a161
    v_exp_f32 v46, v46
    v_accvgpr_read_b32 v38, a162
    v_exp_f32 v47, v47
    v_accvgpr_read_b32 v39, a163
    v_exp_f32 v48, v48
    v_accvgpr_read_b32 v40, a164
    v_exp_f32 v49, v49
    v_accvgpr_read_b32 v41, a165
    v_exp_f32 v50, v50
    v_accvgpr_read_b32 v42, a166
    v_exp_f32 v51, v51
    v_accvgpr_read_b32 v43, a167
    v_pk_add_f32 v[44:45], v[44:45], 1.0 op_sel_hi:[1,0]
    v_pk_add_f32 v[46:47], v[46:47], 1.0 op_sel_hi:[1,0]
    v_pk_add_f32 v[48:49], v[48:49], 1.0 op_sel_hi:[1,0]
    v_pk_add_f32 v[50:51], v[50:51], 1.0 op_sel_hi:[1,0]
    v_rcp_f32 v44, v44
    v_rcp_f32 v45, v45
    v_pk_mul_f32 v[28:29], v[28:29], v[36:37]
    v_rcp_f32 v46, v46
    v_rcp_f32 v47, v47
    v_pk_mul_f32 v[30:31], v[30:31], v[38:39]
    v_rcp_f32 v48, v48
    v_rcp_f32 v49, v49
    v_pk_mul_f32 v[32:33], v[32:33], v[40:41]
    v_rcp_f32 v50, v50
    v_rcp_f32 v51, v51
    v_pk_mul_f32 v[34:35], v[34:35], v[42:43]
    v_mul_f32 v44, v44, v116
    v_mul_f32 v45, v45, v116
    v_mul_f32 v46, v46, v116
    v_mul_f32 v47, v47, v116
    v_mul_f32 v48, v48, v116
    v_mul_f32 v49, v49, v116
    v_mul_f32 v50, v50, v116
    v_mul_f32 v51, v51, v116
    v_pk_mul_f32 v[28:29], v[28:29], v[44:45]
    v_pk_mul_f32 v[30:31], v[30:31], v[46:47]
    v_pk_mul_f32 v[32:33], v[32:33], v[48:49]
    v_pk_mul_f32 v[34:35], v[34:35], v[50:51]
    v_cvt_pk_bf16_f32 v76, v28, v29
    v_cvt_pk_bf16_f32 v77, v30, v31
    v_cvt_pk_bf16_f32 v78, v32, v33
    v_cvt_pk_bf16_f32 v79, v34, v35
    buffer_store_dwordx4 v[76:79], v26, s[8:11], s30 offen offset:0 sc1
    v_accvgpr_read_b32 v52, a96
    v_accvgpr_read_b32 v53, a97
    v_accvgpr_read_b32 v54, a98
    v_accvgpr_read_b32 v55, a99
    v_accvgpr_read_b32 v56, a100
    v_accvgpr_read_b32 v57, a101
    v_accvgpr_read_b32 v58, a102
    v_accvgpr_read_b32 v59, a103
    v_mul_f32 v68, s31, v52
    v_mul_f32 v69, s31, v53
    v_mul_f32 v70, s31, v54
    v_mul_f32 v71, s31, v55
    v_mul_f32 v72, s31, v56
    v_mul_f32 v73, s31, v57
    v_mul_f32 v74, s31, v58
    v_mul_f32 v75, s31, v59
    v_exp_f32 v68, v68
    v_accvgpr_read_b32 v60, a224
    v_exp_f32 v69, v69
    v_accvgpr_read_b32 v61, a225
    v_exp_f32 v70, v70
    v_accvgpr_read_b32 v62, a226
    v_exp_f32 v71, v71
    v_accvgpr_read_b32 v63, a227
    v_exp_f32 v72, v72
    v_accvgpr_read_b32 v64, a228
    v_exp_f32 v73, v73
    v_accvgpr_read_b32 v65, a229
    v_exp_f32 v74, v74
    v_accvgpr_read_b32 v66, a230
    v_exp_f32 v75, v75
    v_accvgpr_read_b32 v67, a231
    v_pk_add_f32 v[68:69], v[68:69], 1.0 op_sel_hi:[1,0]
    v_pk_add_f32 v[70:71], v[70:71], 1.0 op_sel_hi:[1,0]
    v_pk_add_f32 v[72:73], v[72:73], 1.0 op_sel_hi:[1,0]
    v_pk_add_f32 v[74:75], v[74:75], 1.0 op_sel_hi:[1,0]
    v_rcp_f32 v68, v68
    v_rcp_f32 v69, v69
    v_pk_mul_f32 v[52:53], v[52:53], v[60:61]
    v_rcp_f32 v70, v70
    v_rcp_f32 v71, v71
    v_pk_mul_f32 v[54:55], v[54:55], v[62:63]
    v_rcp_f32 v72, v72
    v_rcp_f32 v73, v73
    v_pk_mul_f32 v[56:57], v[56:57], v[64:65]
    v_rcp_f32 v74, v74
    v_rcp_f32 v75, v75
    v_pk_mul_f32 v[58:59], v[58:59], v[66:67]
    v_mul_f32 v68, v68, v116
    v_mul_f32 v69, v69, v116
    v_mul_f32 v70, v70, v116
    v_mul_f32 v71, v71, v116
    v_mul_f32 v72, v72, v116
    v_mul_f32 v73, v73, v116
    v_mul_f32 v74, v74, v116
    v_mul_f32 v75, v75, v116
    v_pk_mul_f32 v[52:53], v[52:53], v[68:69]
    v_pk_mul_f32 v[54:55], v[54:55], v[70:71]
    v_pk_mul_f32 v[56:57], v[56:57], v[72:73]
    v_pk_mul_f32 v[58:59], v[58:59], v[74:75]
    v_cvt_pk_bf16_f32 v80, v52, v53
    v_cvt_pk_bf16_f32 v81, v54, v55
    v_cvt_pk_bf16_f32 v82, v56, v57
    v_cvt_pk_bf16_f32 v83, v58, v59
    buffer_store_dwordx4 v[80:83], v26, s[8:11], s30 offen offset:1024 sc1
    v_accvgpr_read_b32 v28, a40
    v_accvgpr_read_b32 v29, a41
    v_accvgpr_read_b32 v30, a42
    v_accvgpr_read_b32 v31, a43
    v_accvgpr_read_b32 v32, a44
    v_accvgpr_read_b32 v33, a45
    v_accvgpr_read_b32 v34, a46
    v_accvgpr_read_b32 v35, a47
    v_mul_f32 v44, s31, v28
    v_mul_f32 v45, s31, v29
    v_mul_f32 v46, s31, v30
    v_mul_f32 v47, s31, v31
    v_mul_f32 v48, s31, v32
    v_mul_f32 v49, s31, v33
    v_mul_f32 v50, s31, v34
    v_mul_f32 v51, s31, v35
    v_exp_f32 v44, v44
    v_accvgpr_read_b32 v36, a168
    v_exp_f32 v45, v45
    v_accvgpr_read_b32 v37, a169
    v_exp_f32 v46, v46
    v_accvgpr_read_b32 v38, a170
    v_exp_f32 v47, v47
    v_accvgpr_read_b32 v39, a171
    v_exp_f32 v48, v48
    v_accvgpr_read_b32 v40, a172
    v_exp_f32 v49, v49
    v_accvgpr_read_b32 v41, a173
    v_exp_f32 v50, v50
    v_accvgpr_read_b32 v42, a174
    v_exp_f32 v51, v51
    v_accvgpr_read_b32 v43, a175
    v_pk_add_f32 v[44:45], v[44:45], 1.0 op_sel_hi:[1,0]
    v_pk_add_f32 v[46:47], v[46:47], 1.0 op_sel_hi:[1,0]
    v_pk_add_f32 v[48:49], v[48:49], 1.0 op_sel_hi:[1,0]
    v_pk_add_f32 v[50:51], v[50:51], 1.0 op_sel_hi:[1,0]
    v_rcp_f32 v44, v44
    v_rcp_f32 v45, v45
    v_pk_mul_f32 v[28:29], v[28:29], v[36:37]
    v_rcp_f32 v46, v46
    v_rcp_f32 v47, v47
    v_pk_mul_f32 v[30:31], v[30:31], v[38:39]
    v_rcp_f32 v48, v48
    v_rcp_f32 v49, v49
    v_pk_mul_f32 v[32:33], v[32:33], v[40:41]
    v_rcp_f32 v50, v50
    v_rcp_f32 v51, v51
    v_pk_mul_f32 v[34:35], v[34:35], v[42:43]
    v_mul_f32 v44, v44, v117
    v_mul_f32 v45, v45, v117
    v_mul_f32 v46, v46, v117
    v_mul_f32 v47, v47, v117
    v_mul_f32 v48, v48, v117
    v_mul_f32 v49, v49, v117
    v_mul_f32 v50, v50, v117
    v_mul_f32 v51, v51, v117
    v_pk_mul_f32 v[28:29], v[28:29], v[44:45]
    v_pk_mul_f32 v[30:31], v[30:31], v[46:47]
    v_pk_mul_f32 v[32:33], v[32:33], v[48:49]
    v_pk_mul_f32 v[34:35], v[34:35], v[50:51]
    v_cvt_pk_bf16_f32 v84, v28, v29
    v_cvt_pk_bf16_f32 v85, v30, v31
    v_cvt_pk_bf16_f32 v86, v32, v33
    v_cvt_pk_bf16_f32 v87, v34, v35
    buffer_store_dwordx4 v[84:87], v26, s[8:11], s30 offen offset:2048 sc1
    v_accvgpr_read_b32 v52, a104
    v_accvgpr_read_b32 v53, a105
    v_accvgpr_read_b32 v54, a106
    v_accvgpr_read_b32 v55, a107
    v_accvgpr_read_b32 v56, a108
    v_accvgpr_read_b32 v57, a109
    v_accvgpr_read_b32 v58, a110
    v_accvgpr_read_b32 v59, a111
    v_mul_f32 v68, s31, v52
    v_mul_f32 v69, s31, v53
    v_mul_f32 v70, s31, v54
    v_mul_f32 v71, s31, v55
    v_mul_f32 v72, s31, v56
    v_mul_f32 v73, s31, v57
    v_mul_f32 v74, s31, v58
    v_mul_f32 v75, s31, v59
    v_exp_f32 v68, v68
    v_accvgpr_read_b32 v60, a232
    v_exp_f32 v69, v69
    v_accvgpr_read_b32 v61, a233
    v_exp_f32 v70, v70
    v_accvgpr_read_b32 v62, a234
    v_exp_f32 v71, v71
    v_accvgpr_read_b32 v63, a235
    v_exp_f32 v72, v72
    v_accvgpr_read_b32 v64, a236
    v_exp_f32 v73, v73
    v_accvgpr_read_b32 v65, a237
    v_exp_f32 v74, v74
    v_accvgpr_read_b32 v66, a238
    v_exp_f32 v75, v75
    v_accvgpr_read_b32 v67, a239
    v_pk_add_f32 v[68:69], v[68:69], 1.0 op_sel_hi:[1,0]
    v_pk_add_f32 v[70:71], v[70:71], 1.0 op_sel_hi:[1,0]
    v_pk_add_f32 v[72:73], v[72:73], 1.0 op_sel_hi:[1,0]
    v_pk_add_f32 v[74:75], v[74:75], 1.0 op_sel_hi:[1,0]
    v_rcp_f32 v68, v68
    v_rcp_f32 v69, v69
    v_pk_mul_f32 v[52:53], v[52:53], v[60:61]
    v_rcp_f32 v70, v70
    v_rcp_f32 v71, v71
    v_pk_mul_f32 v[54:55], v[54:55], v[62:63]
    v_rcp_f32 v72, v72
    v_rcp_f32 v73, v73
    v_pk_mul_f32 v[56:57], v[56:57], v[64:65]
    v_rcp_f32 v74, v74
    v_rcp_f32 v75, v75
    v_pk_mul_f32 v[58:59], v[58:59], v[66:67]
    v_mul_f32 v68, v68, v117
    v_mul_f32 v69, v69, v117
    v_mul_f32 v70, v70, v117
    v_mul_f32 v71, v71, v117
    v_mul_f32 v72, v72, v117
    v_mul_f32 v73, v73, v117
    v_mul_f32 v74, v74, v117
    v_mul_f32 v75, v75, v117
    v_pk_mul_f32 v[52:53], v[52:53], v[68:69]
    v_pk_mul_f32 v[54:55], v[54:55], v[70:71]
    v_pk_mul_f32 v[56:57], v[56:57], v[72:73]
    v_pk_mul_f32 v[58:59], v[58:59], v[74:75]
    v_cvt_pk_bf16_f32 v88, v52, v53
    v_cvt_pk_bf16_f32 v89, v54, v55
    v_cvt_pk_bf16_f32 v90, v56, v57
    v_cvt_pk_bf16_f32 v91, v58, v59
    buffer_store_dwordx4 v[88:91], v26, s[8:11], s30 offen offset:3072 sc1
    s_add_u32 s30, s73, 0x3000
    v_accvgpr_read_b32 v28, a48
    v_accvgpr_read_b32 v29, a49
    v_accvgpr_read_b32 v30, a50
    v_accvgpr_read_b32 v31, a51
    v_accvgpr_read_b32 v32, a52
    v_accvgpr_read_b32 v33, a53
    v_accvgpr_read_b32 v34, a54
    v_accvgpr_read_b32 v35, a55
    v_mul_f32 v44, s31, v28
    v_mul_f32 v45, s31, v29
    v_mul_f32 v46, s31, v30
    v_mul_f32 v47, s31, v31
    v_mul_f32 v48, s31, v32
    v_mul_f32 v49, s31, v33
    v_mul_f32 v50, s31, v34
    v_mul_f32 v51, s31, v35
    v_exp_f32 v44, v44
    v_accvgpr_read_b32 v36, a176
    v_exp_f32 v45, v45
    v_accvgpr_read_b32 v37, a177
    v_exp_f32 v46, v46
    v_accvgpr_read_b32 v38, a178
    v_exp_f32 v47, v47
    v_accvgpr_read_b32 v39, a179
    v_exp_f32 v48, v48
    v_accvgpr_read_b32 v40, a180
    v_exp_f32 v49, v49
    v_accvgpr_read_b32 v41, a181
    v_exp_f32 v50, v50
    v_accvgpr_read_b32 v42, a182
    v_exp_f32 v51, v51
    v_accvgpr_read_b32 v43, a183
    v_pk_add_f32 v[44:45], v[44:45], 1.0 op_sel_hi:[1,0]
    v_pk_add_f32 v[46:47], v[46:47], 1.0 op_sel_hi:[1,0]
    v_pk_add_f32 v[48:49], v[48:49], 1.0 op_sel_hi:[1,0]
    v_pk_add_f32 v[50:51], v[50:51], 1.0 op_sel_hi:[1,0]
    v_rcp_f32 v44, v44
    v_rcp_f32 v45, v45
    v_pk_mul_f32 v[28:29], v[28:29], v[36:37]
    v_rcp_f32 v46, v46
    v_rcp_f32 v47, v47
    v_pk_mul_f32 v[30:31], v[30:31], v[38:39]
    v_rcp_f32 v48, v48
    v_rcp_f32 v49, v49
    v_pk_mul_f32 v[32:33], v[32:33], v[40:41]
    v_rcp_f32 v50, v50
    v_rcp_f32 v51, v51
    v_pk_mul_f32 v[34:35], v[34:35], v[42:43]
    v_mul_f32 v44, v44, v118
    v_mul_f32 v45, v45, v118
    v_mul_f32 v46, v46, v118
    v_mul_f32 v47, v47, v118
    v_mul_f32 v48, v48, v118
    v_mul_f32 v49, v49, v118
    v_mul_f32 v50, v50, v118
    v_mul_f32 v51, v51, v118
    v_pk_mul_f32 v[28:29], v[28:29], v[44:45]
    v_pk_mul_f32 v[30:31], v[30:31], v[46:47]
    v_pk_mul_f32 v[32:33], v[32:33], v[48:49]
    v_pk_mul_f32 v[34:35], v[34:35], v[50:51]
    v_cvt_pk_bf16_f32 v76, v28, v29
    v_cvt_pk_bf16_f32 v77, v30, v31
    v_cvt_pk_bf16_f32 v78, v32, v33
    v_cvt_pk_bf16_f32 v79, v34, v35
    buffer_store_dwordx4 v[76:79], v26, s[8:11], s30 offen offset:0 sc1
    v_accvgpr_read_b32 v52, a112
    v_accvgpr_read_b32 v53, a113
    v_accvgpr_read_b32 v54, a114
    v_accvgpr_read_b32 v55, a115
    v_accvgpr_read_b32 v56, a116
    v_accvgpr_read_b32 v57, a117
    v_accvgpr_read_b32 v58, a118
    v_accvgpr_read_b32 v59, a119
    v_mul_f32 v68, s31, v52
    v_mul_f32 v69, s31, v53
    v_mul_f32 v70, s31, v54
    v_mul_f32 v71, s31, v55
    v_mul_f32 v72, s31, v56
    v_mul_f32 v73, s31, v57
    v_mul_f32 v74, s31, v58
    v_mul_f32 v75, s31, v59
    v_exp_f32 v68, v68
    v_accvgpr_read_b32 v60, a240
    v_exp_f32 v69, v69
    v_accvgpr_read_b32 v61, a241
    v_exp_f32 v70, v70
    v_accvgpr_read_b32 v62, a242
    v_exp_f32 v71, v71
    v_accvgpr_read_b32 v63, a243
    v_exp_f32 v72, v72
    v_accvgpr_read_b32 v64, a244
    v_exp_f32 v73, v73
    v_accvgpr_read_b32 v65, a245
    v_exp_f32 v74, v74
    v_accvgpr_read_b32 v66, a246
    v_exp_f32 v75, v75
    v_accvgpr_read_b32 v67, a247
    v_pk_add_f32 v[68:69], v[68:69], 1.0 op_sel_hi:[1,0]
    v_pk_add_f32 v[70:71], v[70:71], 1.0 op_sel_hi:[1,0]
    v_pk_add_f32 v[72:73], v[72:73], 1.0 op_sel_hi:[1,0]
    v_pk_add_f32 v[74:75], v[74:75], 1.0 op_sel_hi:[1,0]
    v_rcp_f32 v68, v68
    v_rcp_f32 v69, v69
    v_pk_mul_f32 v[52:53], v[52:53], v[60:61]
    v_rcp_f32 v70, v70
    v_rcp_f32 v71, v71
    v_pk_mul_f32 v[54:55], v[54:55], v[62:63]
    v_rcp_f32 v72, v72
    v_rcp_f32 v73, v73
    v_pk_mul_f32 v[56:57], v[56:57], v[64:65]
    v_rcp_f32 v74, v74
    v_rcp_f32 v75, v75
    v_pk_mul_f32 v[58:59], v[58:59], v[66:67]
    v_mul_f32 v68, v68, v118
    v_mul_f32 v69, v69, v118
    v_mul_f32 v70, v70, v118
    v_mul_f32 v71, v71, v118
    v_mul_f32 v72, v72, v118
    v_mul_f32 v73, v73, v118
    v_mul_f32 v74, v74, v118
    v_mul_f32 v75, v75, v118
    v_pk_mul_f32 v[52:53], v[52:53], v[68:69]
    v_pk_mul_f32 v[54:55], v[54:55], v[70:71]
    v_pk_mul_f32 v[56:57], v[56:57], v[72:73]
    v_pk_mul_f32 v[58:59], v[58:59], v[74:75]
    v_cvt_pk_bf16_f32 v80, v52, v53
    v_cvt_pk_bf16_f32 v81, v54, v55
    v_cvt_pk_bf16_f32 v82, v56, v57
    v_cvt_pk_bf16_f32 v83, v58, v59
    buffer_store_dwordx4 v[80:83], v26, s[8:11], s30 offen offset:1024 sc1
    v_accvgpr_read_b32 v28, a56
    v_accvgpr_read_b32 v29, a57
    v_accvgpr_read_b32 v30, a58
    v_accvgpr_read_b32 v31, a59
    v_accvgpr_read_b32 v32, a60
    v_accvgpr_read_b32 v33, a61
    v_accvgpr_read_b32 v34, a62
    v_accvgpr_read_b32 v35, a63
    v_mul_f32 v44, s31, v28
    v_mul_f32 v45, s31, v29
    v_mul_f32 v46, s31, v30
    v_mul_f32 v47, s31, v31
    v_mul_f32 v48, s31, v32
    v_mul_f32 v49, s31, v33
    v_mul_f32 v50, s31, v34
    v_mul_f32 v51, s31, v35
    v_exp_f32 v44, v44
    v_accvgpr_read_b32 v36, a184
    v_exp_f32 v45, v45
    v_accvgpr_read_b32 v37, a185
    v_exp_f32 v46, v46
    v_accvgpr_read_b32 v38, a186
    v_exp_f32 v47, v47
    v_accvgpr_read_b32 v39, a187
    v_exp_f32 v48, v48
    v_accvgpr_read_b32 v40, a188
    v_exp_f32 v49, v49
    v_accvgpr_read_b32 v41, a189
    v_exp_f32 v50, v50
    v_accvgpr_read_b32 v42, a190
    v_exp_f32 v51, v51
    v_accvgpr_read_b32 v43, a191
    v_pk_add_f32 v[44:45], v[44:45], 1.0 op_sel_hi:[1,0]
    v_pk_add_f32 v[46:47], v[46:47], 1.0 op_sel_hi:[1,0]
    v_pk_add_f32 v[48:49], v[48:49], 1.0 op_sel_hi:[1,0]
    v_pk_add_f32 v[50:51], v[50:51], 1.0 op_sel_hi:[1,0]
    v_rcp_f32 v44, v44
    v_rcp_f32 v45, v45
    v_pk_mul_f32 v[28:29], v[28:29], v[36:37]
    v_rcp_f32 v46, v46
    v_rcp_f32 v47, v47
    v_pk_mul_f32 v[30:31], v[30:31], v[38:39]
    v_rcp_f32 v48, v48
    v_rcp_f32 v49, v49
    v_pk_mul_f32 v[32:33], v[32:33], v[40:41]
    v_rcp_f32 v50, v50
    v_rcp_f32 v51, v51
    v_pk_mul_f32 v[34:35], v[34:35], v[42:43]
    v_mul_f32 v44, v44, v119
    v_mul_f32 v45, v45, v119
    v_mul_f32 v46, v46, v119
    v_mul_f32 v47, v47, v119
    v_mul_f32 v48, v48, v119
    v_mul_f32 v49, v49, v119
    v_mul_f32 v50, v50, v119
    v_mul_f32 v51, v51, v119
    v_pk_mul_f32 v[28:29], v[28:29], v[44:45]
    v_pk_mul_f32 v[30:31], v[30:31], v[46:47]
    v_pk_mul_f32 v[32:33], v[32:33], v[48:49]
    v_pk_mul_f32 v[34:35], v[34:35], v[50:51]
    v_cvt_pk_bf16_f32 v84, v28, v29
    v_cvt_pk_bf16_f32 v85, v30, v31
    v_cvt_pk_bf16_f32 v86, v32, v33
    v_cvt_pk_bf16_f32 v87, v34, v35
    buffer_store_dwordx4 v[84:87], v26, s[8:11], s30 offen offset:2048 sc1
    v_accvgpr_read_b32 v52, a120
    v_accvgpr_read_b32 v53, a121
    v_accvgpr_read_b32 v54, a122
    v_accvgpr_read_b32 v55, a123
    v_accvgpr_read_b32 v56, a124
    v_accvgpr_read_b32 v57, a125
    v_accvgpr_read_b32 v58, a126
    v_accvgpr_read_b32 v59, a127
    v_mul_f32 v68, s31, v52
    v_mul_f32 v69, s31, v53
    v_mul_f32 v70, s31, v54
    v_mul_f32 v71, s31, v55
    v_mul_f32 v72, s31, v56
    v_mul_f32 v73, s31, v57
    v_mul_f32 v74, s31, v58
    v_mul_f32 v75, s31, v59
    v_exp_f32 v68, v68
    v_accvgpr_read_b32 v60, a248
    v_exp_f32 v69, v69
    v_accvgpr_read_b32 v61, a249
    v_exp_f32 v70, v70
    v_accvgpr_read_b32 v62, a250
    v_exp_f32 v71, v71
    v_accvgpr_read_b32 v63, a251
    v_exp_f32 v72, v72
    v_accvgpr_read_b32 v64, a252
    v_exp_f32 v73, v73
    v_accvgpr_read_b32 v65, a253
    v_exp_f32 v74, v74
    v_accvgpr_read_b32 v66, a254
    v_exp_f32 v75, v75
    v_accvgpr_read_b32 v67, a255
    v_pk_add_f32 v[68:69], v[68:69], 1.0 op_sel_hi:[1,0]
    v_pk_add_f32 v[70:71], v[70:71], 1.0 op_sel_hi:[1,0]
    v_pk_add_f32 v[72:73], v[72:73], 1.0 op_sel_hi:[1,0]
    v_pk_add_f32 v[74:75], v[74:75], 1.0 op_sel_hi:[1,0]
    v_rcp_f32 v68, v68
    v_rcp_f32 v69, v69
    v_pk_mul_f32 v[52:53], v[52:53], v[60:61]
    v_rcp_f32 v70, v70
    v_rcp_f32 v71, v71
    v_pk_mul_f32 v[54:55], v[54:55], v[62:63]
    v_rcp_f32 v72, v72
    v_rcp_f32 v73, v73
    v_pk_mul_f32 v[56:57], v[56:57], v[64:65]
    v_rcp_f32 v74, v74
    v_rcp_f32 v75, v75
    v_pk_mul_f32 v[58:59], v[58:59], v[66:67]
    v_mul_f32 v68, v68, v119
    v_mul_f32 v69, v69, v119
    v_mul_f32 v70, v70, v119
    v_mul_f32 v71, v71, v119
    v_mul_f32 v72, v72, v119
    v_mul_f32 v73, v73, v119
    v_mul_f32 v74, v74, v119
    v_mul_f32 v75, v75, v119
    v_pk_mul_f32 v[52:53], v[52:53], v[68:69]
    v_pk_mul_f32 v[54:55], v[54:55], v[70:71]
    v_pk_mul_f32 v[56:57], v[56:57], v[72:73]
    v_pk_mul_f32 v[58:59], v[58:59], v[74:75]
    v_cvt_pk_bf16_f32 v88, v52, v53
    v_cvt_pk_bf16_f32 v89, v54, v55
    v_cvt_pk_bf16_f32 v90, v56, v57
    v_cvt_pk_bf16_f32 v91, v58, v59
    buffer_store_dwordx4 v[88:91], v26, s[8:11], s30 offen offset:3072 sc1
    s_lshl_b32 s74, s68, 2
    s_add_u32 s74, s74, 72
    s_cmp_lt_u32 s69, 20
    s_cselect_b32 s75, 1, 0x100
jsg_240:
    s_waitcnt vmcnt(0)
    s_barrier
    s_cmp_lg_u32 s20, 0
    s_cbranch_scc1 sgg_293
    v_mov_b32 v28, s75
    v_mov_b32 v29, s74
    s_mov_b64 exec, 1
    buffer_atomic_add v28, v29, s[48:51], 0 offen sc1
    s_mov_b64 exec, -1
sgg_293:
    s_cmp_lg_u32 s70, 5
    s_cbranch_scc1 jobg_234
    s_load_dwordx2 s[60:61], s[0:1], 80
    s_load_dwordx2 s[62:63], s[0:1], 40
    s_and_b32 s68, s65, 3
    s_lshr_b32 s74, s65, 4
    s_lshl_b32 s74, s74, 2
    s_add_u32 s68, s68, s74
    s_bfe_u32 s69, s65, 0x20002
    s_cmp_lt_u32 s68, 6
    s_cselect_b32 s67, 0, 1
    s_max_u32 s74, s68, 3
    s_min_u32 s74, s74, 6
    s_lshl_b32 s75, s64, 2
    s_add_u32 s74, s74, s75
    s_mov_b32 s72, 0xb150000
    s_cmp_eq_u32 s74, 4
    s_cselect_b32 s72, 0x51b0000, s72
    s_cmp_eq_u32 s74, 5
    s_cselect_b32 s72, 0x8180000, s72
    s_cmp_eq_u32 s74, 6
    s_cselect_b32 s72, 0x210, s72
    s_cmp_eq_u32 s74, 7
    s_cselect_b32 s72, 0x90c0000, s72
    s_cmp_eq_u32 s74, 8
    s_cselect_b32 s72, 0xb100000, s72
    s_cmp_eq_u32 s74, 9
    s_cselect_b32 s72, 0x8100616, s72
    s_cmp_eq_u32 s74, 10
    s_cselect_b32 s72, 0x20e, s72
    s_cmp_eq_u32 s74, 11
    s_cselect_b32 s72, 0x3001400, s72
    s_cmp_eq_u32 s74, 12
    s_cselect_b32 s72, 0x9001000, s72
    s_cmp_eq_u32 s74, 13
    s_cselect_b32 s72, 0x7001000, s72
    s_cmp_eq_u32 s74, 14
    s_cselect_b32 s72, 0xe00, s72
    s_cmp_eq_u32 s74, 15
    s_cselect_b32 s72, 0x9030814, s72
    s_cmp_eq_u32 s74, 16
    s_cselect_b32 s72, 0x7090c10, s72
    s_cmp_eq_u32 s74, 17
    s_cselect_b32 s72, 0x9070610, s72
    s_cmp_eq_u32 s74, 18
    s_cselect_b32 s72, 0xa12, s72
    s_lshr_b32 s74, s72, 24
    s_cmp_eq_u32 s74, 0
    s_cselect_b32 s47, 1, 0
    s_bfe_u32 s27, s72, 0x80008
    s_and_b32 s74, s72, 0xff
    s_add_u32 s78, s74, s27
    s_cmp_gt_u32 s78, 20
    s_cselect_b32 s78, 0x800, 0
    s_lshl_b32 s24, s74, 18
    s_mul_i32 s75, s68, 28
    s_add_u32 s75, s75, s74
    s_lshl_b32 s75, s75, 16
    s_add_u32 s23, s75, 0x5000000
    s_waitcnt lgkmcnt(0)
    s_mov_b32 s12, s6
    s_mov_b32 s13, s7
    s_mov_b32 s14, 0x10000000
    s_mov_b32 s15, 0x20000
    s_mov_b32 s16, s60
    s_mov_b32 s17, s61
    s_mov_b32 s18, 0x700000
    s_mov_b32 s19, 0x20000
    s_lshl_b32 s30, s22, 14
    v_add_u32 v2, s30, v26
    v_add_u32 v3, 0x400, v2
    v_bfe_u32 v28, v1, 2, 2
    v_lshl_add_u32 v29, v25, 2, v28
    v_lshlrev_b32 v29, 8, v29
    v_and_b32 v30, 3, v1
    v_lshl_add_u32 v29, v30, 3, v29
    v_and_b32 v31, 1, v25
    v_lshl_or_b32 v31, v31, 2, v28
    s_lshl_b32 s30, s21, 13
    s_add_u32 s30, s30, 0x10000
    v_add_u32 v29, s30, v29
    v_xor_b32 v30, 0, v31
    v_lshl_add_u32 v4, v30, 5, v29
    v_xor_b32 v30, 1, v31
    v_lshl_add_u32 v5, v30, 5, v29
    v_xor_b32 v30, 2, v31
    v_lshl_add_u32 v6, v30, 5, v29
    v_xor_b32 v30, 3, v31
    v_lshl_add_u32 v7, v30, 5, v29
    v_xor_b32 v30, 4, v31
    v_lshl_add_u32 v8, v30, 5, v29
    v_xor_b32 v30, 5, v31
    v_lshl_add_u32 v9, v30, 5, v29
    v_xor_b32 v30, 6, v31
    v_lshl_add_u32 v10, v30, 5, v29
    v_xor_b32 v30, 7, v31
    v_lshl_add_u32 v11, v30, 5, v29
    s_add_u32 s30, s28, 0x0
    v_add_u32 v12, s30, v26
    s_add_u32 s30, s28, 0x0
    v_add_u32 v13, s30, v26
    s_add_u32 s30, s28, 0x0
    v_add_u32 v14, s30, v26
    s_add_u32 s30, s28, 0x0
    v_add_u32 v15, s30, v26
    s_add_u32 s30, s28, 0x1000
    v_add_u32 v16, s30, v26
    s_add_u32 s30, s28, 0x1000
    v_add_u32 v17, s30, v26
    s_add_u32 s30, s28, 0x1000
    v_add_u32 v18, s30, v26
    s_add_u32 s30, s28, 0x1000
    v_add_u32 v19, s30, v26
    s_mov_b32 s25, 0x8000
    s_lshl_b32 s74, s69, 9
    s_lshl_b32 s75, s22, 8
    s_add_u32 s74, s74, s75
    v_lshlrev_b32 v30, 1, v25
    v_xor_b32 v29, v24, v30
    s_lshl_b32 s30, s21, 4
    v_add_u32 v28, s30, v25
    s_mov_b32 s30, 2048
    v_mul_lo_u32 v28, v28, s30
    v_add_u32 v28, s74, v28
    v_xor_b32 v30, 0, v29
    v_lshl_add_u32 v20, v30, 4, v28
    v_xor_b32 v30, 8, v29
    v_lshl_add_u32 v21, v30, 4, v28
    v_add_u32 v21, 0x1c00, v21
    v_xor_b32 v30, 0, v29
    v_lshl_add_u32 v22, v30, 4, v28
    v_add_u32 v22, 0x3800, v22
    v_xor_b32 v30, 8, v29
    v_lshl_add_u32 v23, v30, 4, v28
    v_add_u32 v23, 0x5400, v23
    s_mov_b32 s26, 65536
    s_lshl_b32 s74, s68, 2
    s_add_u32 s75, s74, 72
    v_mov_b32 v30, s75
    s_add_u32 s75, s74, 32
    v_mov_b32 v32, s75
    v_mov_b32 v33, 0
    s_cmp_eq_u32 s27, 0
    s_cbranch_scc1 fog_294
    s_mov_b32 s77, 0
plg_296:
    buffer_load_dword v31, v30, s[48:51], 0 offen sc1
    s_add_u32 s77, s77, 1
    s_cmp_ge_u32 s77, 0x20000
    s_cbranch_scc1 L_fb
    s_waitcnt vmcnt(0)
    v_readfirstlane_b32 s76, v31
    s_cmp_ge_u32 s76, s78
    s_cselect_b32 s79, 0xff, 0
    s_and_b32 s76, s76, s79
    s_cmp_ge_u32 s76, 20
    s_cbranch_scc0 plg_296
    s_branch fgg_295
fog_294:
    v_readfirstlane_b32 s76, v33
    s_cmp_ge_u32 s76, 0x1000
    s_cbranch_scc1 fkg_298
    s_mov_b32 s77, 0
plg_299:
    buffer_load_dword v33, v32, s[48:51], 0 offen sc1
    s_add_u32 s77, s77, 1
    s_cmp_ge_u32 s77, 0x20000
    s_cbranch_scc1 L_fb
    s_waitcnt vmcnt(0)
    v_readfirstlane_b32 s76, v33
    s_cmp_ge_u32 s76, 0x1000
    s_cbranch_scc0 plg_299
fkg_298:
    s_mov_b32 s47, 1
    s_lshr_b32 s27, s72, 24
    s_mov_b32 s16, s62
    s_mov_b32 s17, s63
    s_mov_b32 s18, 0x800000
    s_mov_b32 s19, 0x20000
    s_bfe_u32 s75, s72, 0x80010
    s_lshl_b32 s24, s75, 18
    s_lshl_b32 s74, s68, 5
    s_add_u32 s74, s74, s75
    s_lshl_b32 s74, s74, 16
    s_add_u32 s23, s74, 0x9000000
fgg_295:
    s_add_u32 m0, s29, 0x0
    s_nop 0
    buffer_load_dwordx4 v20, s[16:19], s24 offen offset:0 lds
    buffer_load_dwordx4 v21, s[16:19], s24 offen offset:1024 lds
    buffer_load_dwordx4 v22, s[16:19], s24 offen offset:2048 lds
    buffer_load_dwordx4 v23, s[16:19], s24 offen offset:3072 lds
    s_add_u32 s24, s24, s26
    s_add_u32 m0, s28, 0x0
    s_nop 0
    buffer_load_dwordx4 v12, s[12:15], s23 offen offset:0 lds
    buffer_load_dwordx4 v13, s[12:15], s23 offen offset:1024 lds
    buffer_load_dwordx4 v14, s[12:15], s23 offen offset:2048 lds
    buffer_load_dwordx4 v15, s[12:15], s23 offen offset:3072 lds
    s_add_u32 m0, s28, 0x1000
    s_nop 0
    buffer_load_dwordx4 v16, s[12:15], s23 offen offset:0 lds
    buffer_load_dwordx4 v17, s[12:15], s23 offen offset:1024 lds
    buffer_load_dwordx4 v18, s[12:15], s23 offen offset:2048 lds
    buffer_load_dwordx4 v19, s[12:15], s23 offen offset:3072 lds
    s_add_u32 s23, s23, s25
    s_add_u32 m0, s29, 0x4000
    s_nop 0
    buffer_load_dwordx4 v20, s[16:19], s24 offen offset:0 lds
    buffer_load_dwordx4 v21, s[16:19], s24 offen offset:1024 lds
    buffer_load_dwordx4 v22, s[16:19], s24 offen offset:2048 lds
    buffer_load_dwordx4 v23, s[16:19], s24 offen offset:3072 lds
    s_add_u32 s24, s24, s26
    s_add_u32 m0, s29, 0x8000
    s_nop 0
    buffer_load_dwordx4 v20, s[16:19], s24 offen offset:0 lds
    buffer_load_dwordx4 v21, s[16:19], s24 offen offset:1024 lds
    buffer_load_dwordx4 v22, s[16:19], s24 offen offset:2048 lds
    buffer_load_dwordx4 v23, s[16:19], s24 offen offset:3072 lds
    s_add_u32 s24, s24, s26
    s_add_u32 m0, s28, 0x8000
    s_nop 0
    buffer_load_dwordx4 v12, s[12:15], s23 offen offset:0 lds
    buffer_load_dwordx4 v13, s[12:15], s23 offen offset:1024 lds
    buffer_load_dwordx4 v14, s[12:15], s23 offen offset:2048 lds
    buffer_load_dwordx4 v15, s[12:15], s23 offen offset:3072 lds
    s_add_u32 m0, s28, 0x9000
    s_nop 0
    buffer_load_dwordx4 v16, s[12:15], s23 offen offset:0 lds
    buffer_load_dwordx4 v17, s[12:15], s23 offen offset:1024 lds
    buffer_load_dwordx4 v18, s[12:15], s23 offen offset:2048 lds
    buffer_load_dwordx4 v19, s[12:15], s23 offen offset:3072 lds
    s_add_u32 s23, s23, s25
    s_add_u32 m0, s29, 0xc000
    s_nop 0
    buffer_load_dwordx4 v20, s[16:19], s24 offen offset:0 lds
    buffer_load_dwordx4 v21, s[16:19], s24 offen offset:1024 lds
    buffer_load_dwordx4 v22, s[16:19], s24 offen offset:2048 lds
    buffer_load_dwordx4 v23, s[16:19], s24 offen offset:3072 lds
    s_add_u32 s24, s24, s26
    s_waitcnt vmcnt(20)
    s_barrier
    ds_read_b128 v[192:195], v2 offset:0
    ds_read_b64_tr_b16 v[128:129], v4 offset:0
    ds_read_b64_tr_b16 v[130:131], v4 offset:4096
    ds_read_b128 v[196:199], v2 offset:2048
    ds_read_b64_tr_b16 v[132:133], v5 offset:0
    ds_read_b64_tr_b16 v[134:135], v5 offset:4096
    ds_read_b128 v[200:203], v2 offset:4096
    ds_read_b64_tr_b16 v[136:137], v6 offset:0
    ds_read_b64_tr_b16 v[138:139], v6 offset:4096
    ds_read_b128 v[204:207], v2 offset:6144
    ds_read_b64_tr_b16 v[140:141], v7 offset:0
    ds_read_b64_tr_b16 v[142:143], v7 offset:4096
    ds_read_b128 v[208:211], v2 offset:8192
    ds_read_b64_tr_b16 v[144:145], v8 offset:0
    ds_read_b64_tr_b16 v[146:147], v8 offset:4096
    ds_read_b128 v[212:215], v2 offset:10240
    ds_read_b64_tr_b16 v[148:149], v9 offset:0
    ds_read_b64_tr_b16 v[150:151], v9 offset:4096
    ds_read_b128 v[216:219], v2 offset:12288
    ds_read_b64_tr_b16 v[152:153], v10 offset:0
    ds_read_b64_tr_b16 v[154:155], v10 offset:4096
    ds_read_b128 v[220:223], v2 offset:14336
    ds_read_b64_tr_b16 v[156:157], v11 offset:0
    ds_read_b64_tr_b16 v[158:159], v11 offset:4096
    s_waitcnt vmcnt(16) lgkmcnt(0)
    s_barrier
    v_mfma_f32_16x16x32_bf16 a[0:3], v[128:131], v[192:195], 0
    ds_read_b128 v[224:227], v3 offset:0
    v_mfma_f32_16x16x32_bf16 a[8:11], v[128:131], v[196:199], 0
    s_add_u32 m0, s29, 0x0
    v_mfma_f32_16x16x32_bf16 a[16:19], v[128:131], v[200:203], 0
    ds_read_b64_tr_b16 v[160:161], v4 offset:16384
    v_mfma_f32_16x16x32_bf16 a[24:27], v[128:131], v[204:207], 0
    buffer_load_dwordx4 v20, s[16:19], s24 offen offset:0 lds
    v_mfma_f32_16x16x32_bf16 a[32:35], v[128:131], v[208:211], 0
    ds_read_b64_tr_b16 v[162:163], v4 offset:20480
    v_mfma_f32_16x16x32_bf16 a[40:43], v[128:131], v[212:215], 0
    v_mfma_f32_16x16x32_bf16 a[48:51], v[128:131], v[216:219], 0
    ds_read_b128 v[228:231], v3 offset:2048
    v_mfma_f32_16x16x32_bf16 a[56:59], v[128:131], v[220:223], 0
    buffer_load_dwordx4 v21, s[16:19], s24 offen offset:1024 lds
    v_mfma_f32_16x16x32_bf16 a[4:7], v[132:135], v[192:195], 0
    ds_read_b64_tr_b16 v[164:165], v5 offset:16384
    v_mfma_f32_16x16x32_bf16 a[12:15], v[132:135], v[196:199], 0
    v_mfma_f32_16x16x32_bf16 a[20:23], v[132:135], v[200:203], 0
    ds_read_b64_tr_b16 v[166:167], v5 offset:20480
    v_mfma_f32_16x16x32_bf16 a[28:31], v[132:135], v[204:207], 0
    buffer_load_dwordx4 v22, s[16:19], s24 offen offset:2048 lds
    v_mfma_f32_16x16x32_bf16 a[36:39], v[132:135], v[208:211], 0
    ds_read_b128 v[232:235], v3 offset:4096
    v_mfma_f32_16x16x32_bf16 a[44:47], v[132:135], v[212:215], 0
    v_mfma_f32_16x16x32_bf16 a[52:55], v[132:135], v[216:219], 0
    ds_read_b64_tr_b16 v[168:169], v6 offset:16384
    v_mfma_f32_16x16x32_bf16 a[60:63], v[132:135], v[220:223], 0
    buffer_load_dwordx4 v23, s[16:19], s24 offen offset:3072 lds
    v_mfma_f32_16x16x32_bf16 a[64:67], v[136:139], v[192:195], 0
    ds_read_b64_tr_b16 v[170:171], v6 offset:20480
    v_mfma_f32_16x16x32_bf16 a[72:75], v[136:139], v[196:199], 0
    s_add_u32 s24, s24, s26
    v_mfma_f32_16x16x32_bf16 a[80:83], v[136:139], v[200:203], 0
    ds_read_b128 v[236:239], v3 offset:6144
    v_mfma_f32_16x16x32_bf16 a[88:91], v[136:139], v[204:207], 0
    v_mfma_f32_16x16x32_bf16 a[96:99], v[136:139], v[208:211], 0
    ds_read_b64_tr_b16 v[172:173], v7 offset:16384
    v_mfma_f32_16x16x32_bf16 a[104:107], v[136:139], v[212:215], 0
    v_mfma_f32_16x16x32_bf16 a[112:115], v[136:139], v[216:219], 0
    ds_read_b64_tr_b16 v[174:175], v7 offset:20480
    v_mfma_f32_16x16x32_bf16 a[120:123], v[136:139], v[220:223], 0
    v_mfma_f32_16x16x32_bf16 a[68:71], v[140:143], v[192:195], 0
    ds_read_b128 v[240:243], v3 offset:8192
    v_mfma_f32_16x16x32_bf16 a[76:79], v[140:143], v[196:199], 0
    v_mfma_f32_16x16x32_bf16 a[84:87], v[140:143], v[200:203], 0
    ds_read_b64_tr_b16 v[176:177], v8 offset:16384
    v_mfma_f32_16x16x32_bf16 a[92:95], v[140:143], v[204:207], 0
    v_mfma_f32_16x16x32_bf16 a[100:103], v[140:143], v[208:211], 0
    ds_read_b64_tr_b16 v[178:179], v8 offset:20480
    v_mfma_f32_16x16x32_bf16 a[108:111], v[140:143], v[212:215], 0
    v_mfma_f32_16x16x32_bf16 a[116:119], v[140:143], v[216:219], 0
    ds_read_b128 v[244:247], v3 offset:10240
    v_mfma_f32_16x16x32_bf16 a[124:127], v[140:143], v[220:223], 0
    v_mfma_f32_16x16x32_bf16 a[128:131], v[144:147], v[192:195], 0
    ds_read_b64_tr_b16 v[180:181], v9 offset:16384
    v_mfma_f32_16x16x32_bf16 a[136:139], v[144:147], v[196:199], 0
    v_mfma_f32_16x16x32_bf16 a[144:147], v[144:147], v[200:203], 0
    ds_read_b64_tr_b16 v[182:183], v9 offset:20480
    v_mfma_f32_16x16x32_bf16 a[152:155], v[144:147], v[204:207], 0
    v_mfma_f32_16x16x32_bf16 a[160:163], v[144:147], v[208:211], 0
    ds_read_b128 v[248:251], v3 offset:12288
    v_mfma_f32_16x16x32_bf16 a[168:171], v[144:147], v[212:215], 0
    v_mfma_f32_16x16x32_bf16 a[176:179], v[144:147], v[216:219], 0
    ds_read_b64_tr_b16 v[184:185], v10 offset:16384
    v_mfma_f32_16x16x32_bf16 a[184:187], v[144:147], v[220:223], 0
    v_mfma_f32_16x16x32_bf16 a[132:135], v[148:151], v[192:195], 0
    ds_read_b64_tr_b16 v[186:187], v10 offset:20480
    v_mfma_f32_16x16x32_bf16 a[140:143], v[148:151], v[196:199], 0
    v_mfma_f32_16x16x32_bf16 a[148:151], v[148:151], v[200:203], 0
    ds_read_b128 v[252:255], v3 offset:14336
    v_mfma_f32_16x16x32_bf16 a[156:159], v[148:151], v[204:207], 0
    v_mfma_f32_16x16x32_bf16 a[164:167], v[148:151], v[208:211], 0
    ds_read_b64_tr_b16 v[188:189], v11 offset:16384
    v_mfma_f32_16x16x32_bf16 a[172:175], v[148:151], v[212:215], 0
    v_mfma_f32_16x16x32_bf16 a[180:183], v[148:151], v[216:219], 0
    ds_read_b64_tr_b16 v[190:191], v11 offset:20480
    v_mfma_f32_16x16x32_bf16 a[188:191], v[148:151], v[220:223], 0
    v_mfma_f32_16x16x32_bf16 a[192:195], v[152:155], v[192:195], 0
    v_mfma_f32_16x16x32_bf16 a[200:203], v[152:155], v[196:199], 0
    v_mfma_f32_16x16x32_bf16 a[208:211], v[152:155], v[200:203], 0
    v_mfma_f32_16x16x32_bf16 a[216:219], v[152:155], v[204:207], 0
    v_mfma_f32_16x16x32_bf16 a[224:227], v[152:155], v[208:211], 0
    v_mfma_f32_16x16x32_bf16 a[232:235], v[152:155], v[212:215], 0
    v_mfma_f32_16x16x32_bf16 a[240:243], v[152:155], v[216:219], 0
    v_mfma_f32_16x16x32_bf16 a[248:251], v[152:155], v[220:223], 0
    v_mfma_f32_16x16x32_bf16 a[196:199], v[156:159], v[192:195], 0
    v_mfma_f32_16x16x32_bf16 a[204:207], v[156:159], v[196:199], 0
    v_mfma_f32_16x16x32_bf16 a[212:215], v[156:159], v[200:203], 0
    v_mfma_f32_16x16x32_bf16 a[220:223], v[156:159], v[204:207], 0
    v_mfma_f32_16x16x32_bf16 a[228:231], v[156:159], v[208:211], 0
    v_mfma_f32_16x16x32_bf16 a[236:239], v[156:159], v[212:215], 0
    v_mfma_f32_16x16x32_bf16 a[244:247], v[156:159], v[216:219], 0
    s_waitcnt vmcnt(8) lgkmcnt(0)
    s_barrier
    v_mfma_f32_16x16x32_bf16 a[252:255], v[156:159], v[220:223], 0
    s_branch g1_301
g0_302:
    s_cmp_lg_u32 s27, 2
    s_cbranch_scc1 ge_304
    buffer_load_dword v33, v32, s[48:51], 0 offen sc1
ge_304:
    s_cmp_lg_u32 s27, 1
    s_cbranch_scc1 gns_303
    s_cmp_lg_u32 s47, 0
    s_cbranch_scc1 fng_305
    v_readfirstlane_b32 s76, v33
    s_cmp_ge_u32 s76, 0x1000
    s_cbranch_scc1 fkg_307
    s_mov_b32 s77, 0
plg_308:
    buffer_load_dword v33, v32, s[48:51], 0 offen sc1
    s_add_u32 s77, s77, 1
    s_cmp_ge_u32 s77, 0x20000
    s_cbranch_scc1 L_fb
    s_waitcnt vmcnt(0)
    v_readfirstlane_b32 s76, v33
    s_cmp_ge_u32 s76, 0x1000
    s_cbranch_scc0 plg_308
fkg_307:
    s_mov_b32 s47, 1
    s_lshr_b32 s27, s72, 24
    s_add_u32 s27, s27, 1
    s_mov_b32 s16, s62
    s_mov_b32 s17, s63
    s_mov_b32 s18, 0x800000
    s_mov_b32 s19, 0x20000
    s_bfe_u32 s75, s72, 0x80010
    s_lshl_b32 s24, s75, 18
    s_lshl_b32 s74, s68, 5
    s_add_u32 s74, s74, s75
    s_lshl_b32 s74, s74, 16
    s_add_u32 s23, s74, 0x9000000
    s_branch fsg_306
fng_305:
    s_mov_b32 s14, 0
    s_mov_b32 s18, 0
fsg_306:
gns_303:
    v_mfma_f32_16x16x32_bf16 a[0:3], v[128:131], v[192:195], a[0:3]
    ds_read_b128 v[224:227], v3 offset:0
    v_mfma_f32_16x16x32_bf16 a[8:11], v[128:131], v[196:199], a[8:11]
    s_add_u32 m0, s29, 0x0
    v_mfma_f32_16x16x32_bf16 a[16:19], v[128:131], v[200:203], a[16:19]
    ds_read_b64_tr_b16 v[160:161], v4 offset:16384
    v_mfma_f32_16x16x32_bf16 a[24:27], v[128:131], v[204:207], a[24:27]
    buffer_load_dwordx4 v20, s[16:19], s24 offen offset:0 lds
    v_mfma_f32_16x16x32_bf16 a[32:35], v[128:131], v[208:211], a[32:35]
    ds_read_b64_tr_b16 v[162:163], v4 offset:20480
    v_mfma_f32_16x16x32_bf16 a[40:43], v[128:131], v[212:215], a[40:43]
    v_mfma_f32_16x16x32_bf16 a[48:51], v[128:131], v[216:219], a[48:51]
    ds_read_b128 v[228:231], v3 offset:2048
    v_mfma_f32_16x16x32_bf16 a[56:59], v[128:131], v[220:223], a[56:59]
    buffer_load_dwordx4 v21, s[16:19], s24 offen offset:1024 lds
    v_mfma_f32_16x16x32_bf16 a[4:7], v[132:135], v[192:195], a[4:7]
    ds_read_b64_tr_b16 v[164:165], v5 offset:16384
    v_mfma_f32_16x16x32_bf16 a[12:15], v[132:135], v[196:199], a[12:15]
    v_mfma_f32_16x16x32_bf16 a[20:23], v[132:135], v[200:203], a[20:23]
    ds_read_b64_tr_b16 v[166:167], v5 offset:20480
    v_mfma_f32_16x16x32_bf16 a[28:31], v[132:135], v[204:207], a[28:31]
    buffer_load_dwordx4 v22, s[16:19], s24 offen offset:2048 lds
    v_mfma_f32_16x16x32_bf16 a[36:39], v[132:135], v[208:211], a[36:39]
    ds_read_b128 v[232:235], v3 offset:4096
    v_mfma_f32_16x16x32_bf16 a[44:47], v[132:135], v[212:215], a[44:47]
    v_mfma_f32_16x16x32_bf16 a[52:55], v[132:135], v[216:219], a[52:55]
    ds_read_b64_tr_b16 v[168:169], v6 offset:16384
    v_mfma_f32_16x16x32_bf16 a[60:63], v[132:135], v[220:223], a[60:63]
    buffer_load_dwordx4 v23, s[16:19], s24 offen offset:3072 lds
    v_mfma_f32_16x16x32_bf16 a[64:67], v[136:139], v[192:195], a[64:67]
    ds_read_b64_tr_b16 v[170:171], v6 offset:20480
    v_mfma_f32_16x16x32_bf16 a[72:75], v[136:139], v[196:199], a[72:75]
    s_add_u32 s24, s24, s26
    v_mfma_f32_16x16x32_bf16 a[80:83], v[136:139], v[200:203], a[80:83]
    ds_read_b128 v[236:239], v3 offset:6144
    v_mfma_f32_16x16x32_bf16 a[88:91], v[136:139], v[204:207], a[88:91]
    v_mfma_f32_16x16x32_bf16 a[96:99], v[136:139], v[208:211], a[96:99]
    ds_read_b64_tr_b16 v[172:173], v7 offset:16384
    v_mfma_f32_16x16x32_bf16 a[104:107], v[136:139], v[212:215], a[104:107]
    v_mfma_f32_16x16x32_bf16 a[112:115], v[136:139], v[216:219], a[112:115]
    ds_read_b64_tr_b16 v[174:175], v7 offset:20480
    v_mfma_f32_16x16x32_bf16 a[120:123], v[136:139], v[220:223], a[120:123]
    v_mfma_f32_16x16x32_bf16 a[68:71], v[140:143], v[192:195], a[68:71]
    ds_read_b128 v[240:243], v3 offset:8192
    v_mfma_f32_16x16x32_bf16 a[76:79], v[140:143], v[196:199], a[76:79]
    v_mfma_f32_16x16x32_bf16 a[84:87], v[140:143], v[200:203], a[84:87]
    ds_read_b64_tr_b16 v[176:177], v8 offset:16384
    v_mfma_f32_16x16x32_bf16 a[92:95], v[140:143], v[204:207], a[92:95]
    v_mfma_f32_16x16x32_bf16 a[100:103], v[140:143], v[208:211], a[100:103]
    ds_read_b64_tr_b16 v[178:179], v8 offset:20480
    v_mfma_f32_16x16x32_bf16 a[108:111], v[140:143], v[212:215], a[108:111]
    v_mfma_f32_16x16x32_bf16 a[116:119], v[140:143], v[216:219], a[116:119]
    ds_read_b128 v[244:247], v3 offset:10240
    v_mfma_f32_16x16x32_bf16 a[124:127], v[140:143], v[220:223], a[124:127]
    v_mfma_f32_16x16x32_bf16 a[128:131], v[144:147], v[192:195], a[128:131]
    ds_read_b64_tr_b16 v[180:181], v9 offset:16384
    v_mfma_f32_16x16x32_bf16 a[136:139], v[144:147], v[196:199], a[136:139]
    v_mfma_f32_16x16x32_bf16 a[144:147], v[144:147], v[200:203], a[144:147]
    ds_read_b64_tr_b16 v[182:183], v9 offset:20480
    v_mfma_f32_16x16x32_bf16 a[152:155], v[144:147], v[204:207], a[152:155]
    v_mfma_f32_16x16x32_bf16 a[160:163], v[144:147], v[208:211], a[160:163]
    ds_read_b128 v[248:251], v3 offset:12288
    v_mfma_f32_16x16x32_bf16 a[168:171], v[144:147], v[212:215], a[168:171]
    v_mfma_f32_16x16x32_bf16 a[176:179], v[144:147], v[216:219], a[176:179]
    ds_read_b64_tr_b16 v[184:185], v10 offset:16384
    v_mfma_f32_16x16x32_bf16 a[184:187], v[144:147], v[220:223], a[184:187]
    v_mfma_f32_16x16x32_bf16 a[132:135], v[148:151], v[192:195], a[132:135]
    ds_read_b64_tr_b16 v[186:187], v10 offset:20480
    v_mfma_f32_16x16x32_bf16 a[140:143], v[148:151], v[196:199], a[140:143]
    v_mfma_f32_16x16x32_bf16 a[148:151], v[148:151], v[200:203], a[148:151]
    ds_read_b128 v[252:255], v3 offset:14336
    v_mfma_f32_16x16x32_bf16 a[156:159], v[148:151], v[204:207], a[156:159]
    v_mfma_f32_16x16x32_bf16 a[164:167], v[148:151], v[208:211], a[164:167]
    ds_read_b64_tr_b16 v[188:189], v11 offset:16384
    v_mfma_f32_16x16x32_bf16 a[172:175], v[148:151], v[212:215], a[172:175]
    v_mfma_f32_16x16x32_bf16 a[180:183], v[148:151], v[216:219], a[180:183]
    ds_read_b64_tr_b16 v[190:191], v11 offset:20480
    v_mfma_f32_16x16x32_bf16 a[188:191], v[148:151], v[220:223], a[188:191]
    v_mfma_f32_16x16x32_bf16 a[192:195], v[152:155], v[192:195], a[192:195]
    v_mfma_f32_16x16x32_bf16 a[200:203], v[152:155], v[196:199], a[200:203]
    v_mfma_f32_16x16x32_bf16 a[208:211], v[152:155], v[200:203], a[208:211]
    v_mfma_f32_16x16x32_bf16 a[216:219], v[152:155], v[204:207], a[216:219]
    v_mfma_f32_16x16x32_bf16 a[224:227], v[152:155], v[208:211], a[224:227]
    v_mfma_f32_16x16x32_bf16 a[232:235], v[152:155], v[212:215], a[232:235]
    v_mfma_f32_16x16x32_bf16 a[240:243], v[152:155], v[216:219], a[240:243]
    v_mfma_f32_16x16x32_bf16 a[248:251], v[152:155], v[220:223], a[248:251]
    v_mfma_f32_16x16x32_bf16 a[196:199], v[156:159], v[192:195], a[196:199]
    v_mfma_f32_16x16x32_bf16 a[204:207], v[156:159], v[196:199], a[204:207]
    v_mfma_f32_16x16x32_bf16 a[212:215], v[156:159], v[200:203], a[212:215]
    v_mfma_f32_16x16x32_bf16 a[220:223], v[156:159], v[204:207], a[220:223]
    v_mfma_f32_16x16x32_bf16 a[228:231], v[156:159], v[208:211], a[228:231]
    v_mfma_f32_16x16x32_bf16 a[236:239], v[156:159], v[212:215], a[236:239]
    v_mfma_f32_16x16x32_bf16 a[244:247], v[156:159], v[216:219], a[244:247]
    s_waitcnt vmcnt(8) lgkmcnt(0)
    s_barrier
    v_mfma_f32_16x16x32_bf16 a[252:255], v[156:159], v[220:223], a[252:255]
g1_301:
    v_mfma_f32_16x16x32_bf16 a[0:3], v[160:163], v[224:227], a[0:3]
    ds_read_b128 v[192:195], v2 offset:32768
    v_mfma_f32_16x16x32_bf16 a[8:11], v[160:163], v[228:231], a[8:11]
    s_add_u32 m0, s28, 0x0
    v_mfma_f32_16x16x32_bf16 a[16:19], v[160:163], v[232:235], a[16:19]
    ds_read_b64_tr_b16 v[128:129], v4 offset:32768
    v_mfma_f32_16x16x32_bf16 a[24:27], v[160:163], v[236:239], a[24:27]
    buffer_load_dwordx4 v12, s[12:15], s23 offen offset:0 lds
    v_mfma_f32_16x16x32_bf16 a[32:35], v[160:163], v[240:243], a[32:35]
    ds_read_b64_tr_b16 v[130:131], v4 offset:36864
    v_mfma_f32_16x16x32_bf16 a[40:43], v[160:163], v[244:247], a[40:43]
    v_mfma_f32_16x16x32_bf16 a[48:51], v[160:163], v[248:251], a[48:51]
    ds_read_b128 v[196:199], v2 offset:34816
    v_mfma_f32_16x16x32_bf16 a[56:59], v[160:163], v[252:255], a[56:59]
    buffer_load_dwordx4 v13, s[12:15], s23 offen offset:1024 lds
    v_mfma_f32_16x16x32_bf16 a[4:7], v[164:167], v[224:227], a[4:7]
    ds_read_b64_tr_b16 v[132:133], v5 offset:32768
    v_mfma_f32_16x16x32_bf16 a[12:15], v[164:167], v[228:231], a[12:15]
    v_mfma_f32_16x16x32_bf16 a[20:23], v[164:167], v[232:235], a[20:23]
    ds_read_b64_tr_b16 v[134:135], v5 offset:36864
    v_mfma_f32_16x16x32_bf16 a[28:31], v[164:167], v[236:239], a[28:31]
    buffer_load_dwordx4 v14, s[12:15], s23 offen offset:2048 lds
    v_mfma_f32_16x16x32_bf16 a[36:39], v[164:167], v[240:243], a[36:39]
    ds_read_b128 v[200:203], v2 offset:36864
    v_mfma_f32_16x16x32_bf16 a[44:47], v[164:167], v[244:247], a[44:47]
    v_mfma_f32_16x16x32_bf16 a[52:55], v[164:167], v[248:251], a[52:55]
    ds_read_b64_tr_b16 v[136:137], v6 offset:32768
    v_mfma_f32_16x16x32_bf16 a[60:63], v[164:167], v[252:255], a[60:63]
    buffer_load_dwordx4 v15, s[12:15], s23 offen offset:3072 lds
    v_mfma_f32_16x16x32_bf16 a[64:67], v[168:171], v[224:227], a[64:67]
    ds_read_b64_tr_b16 v[138:139], v6 offset:36864
    v_mfma_f32_16x16x32_bf16 a[72:75], v[168:171], v[228:231], a[72:75]
    s_add_u32 m0, s28, 0x1000
    v_mfma_f32_16x16x32_bf16 a[80:83], v[168:171], v[232:235], a[80:83]
    ds_read_b128 v[204:207], v2 offset:38912
    v_mfma_f32_16x16x32_bf16 a[88:91], v[168:171], v[236:239], a[88:91]
    buffer_load_dwordx4 v16, s[12:15], s23 offen offset:0 lds
    v_mfma_f32_16x16x32_bf16 a[96:99], v[168:171], v[240:243], a[96:99]
    ds_read_b64_tr_b16 v[140:141], v7 offset:32768
    v_mfma_f32_16x16x32_bf16 a[104:107], v[168:171], v[244:247], a[104:107]
    v_mfma_f32_16x16x32_bf16 a[112:115], v[168:171], v[248:251], a[112:115]
    ds_read_b64_tr_b16 v[142:143], v7 offset:36864
    v_mfma_f32_16x16x32_bf16 a[120:123], v[168:171], v[252:255], a[120:123]
    buffer_load_dwordx4 v17, s[12:15], s23 offen offset:1024 lds
    v_mfma_f32_16x16x32_bf16 a[68:71], v[172:175], v[224:227], a[68:71]
    ds_read_b128 v[208:211], v2 offset:40960
    v_mfma_f32_16x16x32_bf16 a[76:79], v[172:175], v[228:231], a[76:79]
    v_mfma_f32_16x16x32_bf16 a[84:87], v[172:175], v[232:235], a[84:87]
    ds_read_b64_tr_b16 v[144:145], v8 offset:32768
    v_mfma_f32_16x16x32_bf16 a[92:95], v[172:175], v[236:239], a[92:95]
    buffer_load_dwordx4 v18, s[12:15], s23 offen offset:2048 lds
    v_mfma_f32_16x16x32_bf16 a[100:103], v[172:175], v[240:243], a[100:103]
    ds_read_b64_tr_b16 v[146:147], v8 offset:36864
    v_mfma_f32_16x16x32_bf16 a[108:111], v[172:175], v[244:247], a[108:111]
    v_mfma_f32_16x16x32_bf16 a[116:119], v[172:175], v[248:251], a[116:119]
    ds_read_b128 v[212:215], v2 offset:43008
    v_mfma_f32_16x16x32_bf16 a[124:127], v[172:175], v[252:255], a[124:127]
    buffer_load_dwordx4 v19, s[12:15], s23 offen offset:3072 lds
    v_mfma_f32_16x16x32_bf16 a[128:131], v[176:179], v[224:227], a[128:131]
    ds_read_b64_tr_b16 v[148:149], v9 offset:32768
    v_mfma_f32_16x16x32_bf16 a[136:139], v[176:179], v[228:231], a[136:139]
    s_add_u32 s23, s23, s25
    s_add_u32 m0, s29, 0x4000
    v_mfma_f32_16x16x32_bf16 a[144:147], v[176:179], v[232:235], a[144:147]
    ds_read_b64_tr_b16 v[150:151], v9 offset:36864
    v_mfma_f32_16x16x32_bf16 a[152:155], v[176:179], v[236:239], a[152:155]
    buffer_load_dwordx4 v20, s[16:19], s24 offen offset:0 lds
    v_mfma_f32_16x16x32_bf16 a[160:163], v[176:179], v[240:243], a[160:163]
    ds_read_b128 v[216:219], v2 offset:45056
    v_mfma_f32_16x16x32_bf16 a[168:171], v[176:179], v[244:247], a[168:171]
    v_mfma_f32_16x16x32_bf16 a[176:179], v[176:179], v[248:251], a[176:179]
    ds_read_b64_tr_b16 v[152:153], v10 offset:32768
    v_mfma_f32_16x16x32_bf16 a[184:187], v[176:179], v[252:255], a[184:187]
    buffer_load_dwordx4 v21, s[16:19], s24 offen offset:1024 lds
    v_mfma_f32_16x16x32_bf16 a[132:135], v[180:183], v[224:227], a[132:135]
    ds_read_b64_tr_b16 v[154:155], v10 offset:36864
    v_mfma_f32_16x16x32_bf16 a[140:143], v[180:183], v[228:231], a[140:143]
    v_mfma_f32_16x16x32_bf16 a[148:151], v[180:183], v[232:235], a[148:151]
    ds_read_b128 v[220:223], v2 offset:47104
    v_mfma_f32_16x16x32_bf16 a[156:159], v[180:183], v[236:239], a[156:159]
    buffer_load_dwordx4 v22, s[16:19], s24 offen offset:2048 lds
    v_mfma_f32_16x16x32_bf16 a[164:167], v[180:183], v[240:243], a[164:167]
    ds_read_b64_tr_b16 v[156:157], v11 offset:32768
    v_mfma_f32_16x16x32_bf16 a[172:175], v[180:183], v[244:247], a[172:175]
    v_mfma_f32_16x16x32_bf16 a[180:183], v[180:183], v[248:251], a[180:183]
    ds_read_b64_tr_b16 v[158:159], v11 offset:36864
    v_mfma_f32_16x16x32_bf16 a[188:191], v[180:183], v[252:255], a[188:191]
    buffer_load_dwordx4 v23, s[16:19], s24 offen offset:3072 lds
    v_mfma_f32_16x16x32_bf16 a[192:195], v[184:187], v[224:227], a[192:195]
    v_mfma_f32_16x16x32_bf16 a[200:203], v[184:187], v[228:231], a[200:203]
    s_add_u32 s24, s24, s26
    v_mfma_f32_16x16x32_bf16 a[208:211], v[184:187], v[232:235], a[208:211]
    v_mfma_f32_16x16x32_bf16 a[216:219], v[184:187], v[236:239], a[216:219]
    v_mfma_f32_16x16x32_bf16 a[224:227], v[184:187], v[240:243], a[224:227]
    v_mfma_f32_16x16x32_bf16 a[232:235], v[184:187], v[244:247], a[232:235]
    v_mfma_f32_16x16x32_bf16 a[240:243], v[184:187], v[248:251], a[240:243]
    v_mfma_f32_16x16x32_bf16 a[248:251], v[184:187], v[252:255], a[248:251]
    v_mfma_f32_16x16x32_bf16 a[196:199], v[188:191], v[224:227], a[196:199]
    v_mfma_f32_16x16x32_bf16 a[204:207], v[188:191], v[228:231], a[204:207]
    v_mfma_f32_16x16x32_bf16 a[212:215], v[188:191], v[232:235], a[212:215]
    v_mfma_f32_16x16x32_bf16 a[220:223], v[188:191], v[236:239], a[220:223]
    v_mfma_f32_16x16x32_bf16 a[228:231], v[188:191], v[240:243], a[228:231]
    v_mfma_f32_16x16x32_bf16 a[236:239], v[188:191], v[244:247], a[236:239]
    v_mfma_f32_16x16x32_bf16 a[244:247], v[188:191], v[248:251], a[244:247]
    s_waitcnt vmcnt(16) lgkmcnt(0)
    s_barrier
    v_mfma_f32_16x16x32_bf16 a[252:255], v[188:191], v[252:255], a[252:255]
    v_mfma_f32_16x16x32_bf16 a[0:3], v[128:131], v[192:195], a[0:3]
    ds_read_b128 v[224:227], v3 offset:32768
    v_mfma_f32_16x16x32_bf16 a[8:11], v[128:131], v[196:199], a[8:11]
    s_add_u32 m0, s29, 0x8000
    v_mfma_f32_16x16x32_bf16 a[16:19], v[128:131], v[200:203], a[16:19]
    ds_read_b64_tr_b16 v[160:161], v4 offset:49152
    v_mfma_f32_16x16x32_bf16 a[24:27], v[128:131], v[204:207], a[24:27]
    buffer_load_dwordx4 v20, s[16:19], s24 offen offset:0 lds
    v_mfma_f32_16x16x32_bf16 a[32:35], v[128:131], v[208:211], a[32:35]
    ds_read_b64_tr_b16 v[162:163], v4 offset:53248
    v_mfma_f32_16x16x32_bf16 a[40:43], v[128:131], v[212:215], a[40:43]
    v_mfma_f32_16x16x32_bf16 a[48:51], v[128:131], v[216:219], a[48:51]
    ds_read_b128 v[228:231], v3 offset:34816
    v_mfma_f32_16x16x32_bf16 a[56:59], v[128:131], v[220:223], a[56:59]
    buffer_load_dwordx4 v21, s[16:19], s24 offen offset:1024 lds
    v_mfma_f32_16x16x32_bf16 a[4:7], v[132:135], v[192:195], a[4:7]
    ds_read_b64_tr_b16 v[164:165], v5 offset:49152
    v_mfma_f32_16x16x32_bf16 a[12:15], v[132:135], v[196:199], a[12:15]
    v_mfma_f32_16x16x32_bf16 a[20:23], v[132:135], v[200:203], a[20:23]
    ds_read_b64_tr_b16 v[166:167], v5 offset:53248
    v_mfma_f32_16x16x32_bf16 a[28:31], v[132:135], v[204:207], a[28:31]
    buffer_load_dwordx4 v22, s[16:19], s24 offen offset:2048 lds
    v_mfma_f32_16x16x32_bf16 a[36:39], v[132:135], v[208:211], a[36:39]
    ds_read_b128 v[232:235], v3 offset:36864
    v_mfma_f32_16x16x32_bf16 a[44:47], v[132:135], v[212:215], a[44:47]
    v_mfma_f32_16x16x32_bf16 a[52:55], v[132:135], v[216:219], a[52:55]
    ds_read_b64_tr_b16 v[168:169], v6 offset:49152
    v_mfma_f32_16x16x32_bf16 a[60:63], v[132:135], v[220:223], a[60:63]
    buffer_load_dwordx4 v23, s[16:19], s24 offen offset:3072 lds
    v_mfma_f32_16x16x32_bf16 a[64:67], v[136:139], v[192:195], a[64:67]
    ds_read_b64_tr_b16 v[170:171], v6 offset:53248
    v_mfma_f32_16x16x32_bf16 a[72:75], v[136:139], v[196:199], a[72:75]
    s_add_u32 s24, s24, s26
    v_mfma_f32_16x16x32_bf16 a[80:83], v[136:139], v[200:203], a[80:83]
    ds_read_b128 v[236:239], v3 offset:38912
    v_mfma_f32_16x16x32_bf16 a[88:91], v[136:139], v[204:207], a[88:91]
    v_mfma_f32_16x16x32_bf16 a[96:99], v[136:139], v[208:211], a[96:99]
    ds_read_b64_tr_b16 v[172:173], v7 offset:49152
    v_mfma_f32_16x16x32_bf16 a[104:107], v[136:139], v[212:215], a[104:107]
    v_mfma_f32_16x16x32_bf16 a[112:115], v[136:139], v[216:219], a[112:115]
    ds_read_b64_tr_b16 v[174:175], v7 offset:53248
    v_mfma_f32_16x16x32_bf16 a[120:123], v[136:139], v[220:223], a[120:123]
    v_mfma_f32_16x16x32_bf16 a[68:71], v[140:143], v[192:195], a[68:71]
    ds_read_b128 v[240:243], v3 offset:40960
    v_mfma_f32_16x16x32_bf16 a[76:79], v[140:143], v[196:199], a[76:79]
    v_mfma_f32_16x16x32_bf16 a[84:87], v[140:143], v[200:203], a[84:87]
    ds_read_b64_tr_b16 v[176:177], v8 offset:49152
    v_mfma_f32_16x16x32_bf16 a[92:95], v[140:143], v[204:207], a[92:95]
    v_mfma_f32_16x16x32_bf16 a[100:103], v[140:143], v[208:211], a[100:103]
    ds_read_b64_tr_b16 v[178:179], v8 offset:53248
    v_mfma_f32_16x16x32_bf16 a[108:111], v[140:143], v[212:215], a[108:111]
    v_mfma_f32_16x16x32_bf16 a[116:119], v[140:143], v[216:219], a[116:119]
    ds_read_b128 v[244:247], v3 offset:43008
    v_mfma_f32_16x16x32_bf16 a[124:127], v[140:143], v[220:223], a[124:127]
    v_mfma_f32_16x16x32_bf16 a[128:131], v[144:147], v[192:195], a[128:131]
    ds_read_b64_tr_b16 v[180:181], v9 offset:49152
    v_mfma_f32_16x16x32_bf16 a[136:139], v[144:147], v[196:199], a[136:139]
    v_mfma_f32_16x16x32_bf16 a[144:147], v[144:147], v[200:203], a[144:147]
    ds_read_b64_tr_b16 v[182:183], v9 offset:53248
    v_mfma_f32_16x16x32_bf16 a[152:155], v[144:147], v[204:207], a[152:155]
    v_mfma_f32_16x16x32_bf16 a[160:163], v[144:147], v[208:211], a[160:163]
    ds_read_b128 v[248:251], v3 offset:45056
    v_mfma_f32_16x16x32_bf16 a[168:171], v[144:147], v[212:215], a[168:171]
    v_mfma_f32_16x16x32_bf16 a[176:179], v[144:147], v[216:219], a[176:179]
    ds_read_b64_tr_b16 v[184:185], v10 offset:49152
    v_mfma_f32_16x16x32_bf16 a[184:187], v[144:147], v[220:223], a[184:187]
    v_mfma_f32_16x16x32_bf16 a[132:135], v[148:151], v[192:195], a[132:135]
    ds_read_b64_tr_b16 v[186:187], v10 offset:53248
    v_mfma_f32_16x16x32_bf16 a[140:143], v[148:151], v[196:199], a[140:143]
    v_mfma_f32_16x16x32_bf16 a[148:151], v[148:151], v[200:203], a[148:151]
    ds_read_b128 v[252:255], v3 offset:47104
    v_mfma_f32_16x16x32_bf16 a[156:159], v[148:151], v[204:207], a[156:159]
    v_mfma_f32_16x16x32_bf16 a[164:167], v[148:151], v[208:211], a[164:167]
    ds_read_b64_tr_b16 v[188:189], v11 offset:49152
    v_mfma_f32_16x16x32_bf16 a[172:175], v[148:151], v[212:215], a[172:175]
    v_mfma_f32_16x16x32_bf16 a[180:183], v[148:151], v[216:219], a[180:183]
    ds_read_b64_tr_b16 v[190:191], v11 offset:53248
    v_mfma_f32_16x16x32_bf16 a[188:191], v[148:151], v[220:223], a[188:191]
    v_mfma_f32_16x16x32_bf16 a[192:195], v[152:155], v[192:195], a[192:195]
    v_mfma_f32_16x16x32_bf16 a[200:203], v[152:155], v[196:199], a[200:203]
    v_mfma_f32_16x16x32_bf16 a[208:211], v[152:155], v[200:203], a[208:211]
    v_mfma_f32_16x16x32_bf16 a[216:219], v[152:155], v[204:207], a[216:219]
    v_mfma_f32_16x16x32_bf16 a[224:227], v[152:155], v[208:211], a[224:227]
    v_mfma_f32_16x16x32_bf16 a[232:235], v[152:155], v[212:215], a[232:235]
    v_mfma_f32_16x16x32_bf16 a[240:243], v[152:155], v[216:219], a[240:243]
    v_mfma_f32_16x16x32_bf16 a[248:251], v[152:155], v[220:223], a[248:251]
    v_mfma_f32_16x16x32_bf16 a[196:199], v[156:159], v[192:195], a[196:199]
    v_mfma_f32_16x16x32_bf16 a[204:207], v[156:159], v[196:199], a[204:207]
    v_mfma_f32_16x16x32_bf16 a[212:215], v[156:159], v[200:203], a[212:215]
    v_mfma_f32_16x16x32_bf16 a[220:223], v[156:159], v[204:207], a[220:223]
    v_mfma_f32_16x16x32_bf16 a[228:231], v[156:159], v[208:211], a[228:231]
    v_mfma_f32_16x16x32_bf16 a[236:239], v[156:159], v[212:215], a[236:239]
    v_mfma_f32_16x16x32_bf16 a[244:247], v[156:159], v[216:219], a[244:247]
    s_waitcnt vmcnt(8) lgkmcnt(0)
    s_barrier
    v_mfma_f32_16x16x32_bf16 a[252:255], v[156:159], v[220:223], a[252:255]
    s_sub_u32 s27, s27, 1
    v_mfma_f32_16x16x32_bf16 a[0:3], v[160:163], v[224:227], a[0:3]
    ds_read_b128 v[192:195], v2 offset:0
    v_mfma_f32_16x16x32_bf16 a[8:11], v[160:163], v[228:231], a[8:11]
    s_add_u32 m0, s28, 0x8000
    v_mfma_f32_16x16x32_bf16 a[16:19], v[160:163], v[232:235], a[16:19]
    ds_read_b64_tr_b16 v[128:129], v4 offset:0
    v_mfma_f32_16x16x32_bf16 a[24:27], v[160:163], v[236:239], a[24:27]
    buffer_load_dwordx4 v12, s[12:15], s23 offen offset:0 lds
    v_mfma_f32_16x16x32_bf16 a[32:35], v[160:163], v[240:243], a[32:35]
    ds_read_b64_tr_b16 v[130:131], v4 offset:4096
    v_mfma_f32_16x16x32_bf16 a[40:43], v[160:163], v[244:247], a[40:43]
    v_mfma_f32_16x16x32_bf16 a[48:51], v[160:163], v[248:251], a[48:51]
    ds_read_b128 v[196:199], v2 offset:2048
    v_mfma_f32_16x16x32_bf16 a[56:59], v[160:163], v[252:255], a[56:59]
    buffer_load_dwordx4 v13, s[12:15], s23 offen offset:1024 lds
    v_mfma_f32_16x16x32_bf16 a[4:7], v[164:167], v[224:227], a[4:7]
    ds_read_b64_tr_b16 v[132:133], v5 offset:0
    v_mfma_f32_16x16x32_bf16 a[12:15], v[164:167], v[228:231], a[12:15]
    v_mfma_f32_16x16x32_bf16 a[20:23], v[164:167], v[232:235], a[20:23]
    ds_read_b64_tr_b16 v[134:135], v5 offset:4096
    v_mfma_f32_16x16x32_bf16 a[28:31], v[164:167], v[236:239], a[28:31]
    buffer_load_dwordx4 v14, s[12:15], s23 offen offset:2048 lds
    v_mfma_f32_16x16x32_bf16 a[36:39], v[164:167], v[240:243], a[36:39]
    ds_read_b128 v[200:203], v2 offset:4096
    v_mfma_f32_16x16x32_bf16 a[44:47], v[164:167], v[244:247], a[44:47]
    v_mfma_f32_16x16x32_bf16 a[52:55], v[164:167], v[248:251], a[52:55]
    ds_read_b64_tr_b16 v[136:137], v6 offset:0
    v_mfma_f32_16x16x32_bf16 a[60:63], v[164:167], v[252:255], a[60:63]
    buffer_load_dwordx4 v15, s[12:15], s23 offen offset:3072 lds
    v_mfma_f32_16x16x32_bf16 a[64:67], v[168:171], v[224:227], a[64:67]
    ds_read_b64_tr_b16 v[138:139], v6 offset:4096
    v_mfma_f32_16x16x32_bf16 a[72:75], v[168:171], v[228:231], a[72:75]
    s_add_u32 m0, s28, 0x9000
    v_mfma_f32_16x16x32_bf16 a[80:83], v[168:171], v[232:235], a[80:83]
    ds_read_b128 v[204:207], v2 offset:6144
    v_mfma_f32_16x16x32_bf16 a[88:91], v[168:171], v[236:239], a[88:91]
    buffer_load_dwordx4 v16, s[12:15], s23 offen offset:0 lds
    v_mfma_f32_16x16x32_bf16 a[96:99], v[168:171], v[240:243], a[96:99]
    ds_read_b64_tr_b16 v[140:141], v7 offset:0
    v_mfma_f32_16x16x32_bf16 a[104:107], v[168:171], v[244:247], a[104:107]
    v_mfma_f32_16x16x32_bf16 a[112:115], v[168:171], v[248:251], a[112:115]
    ds_read_b64_tr_b16 v[142:143], v7 offset:4096
    v_mfma_f32_16x16x32_bf16 a[120:123], v[168:171], v[252:255], a[120:123]
    buffer_load_dwordx4 v17, s[12:15], s23 offen offset:1024 lds
    v_mfma_f32_16x16x32_bf16 a[68:71], v[172:175], v[224:227], a[68:71]
    ds_read_b128 v[208:211], v2 offset:8192
    v_mfma_f32_16x16x32_bf16 a[76:79], v[172:175], v[228:231], a[76:79]
    v_mfma_f32_16x16x32_bf16 a[84:87], v[172:175], v[232:235], a[84:87]
    ds_read_b64_tr_b16 v[144:145], v8 offset:0
    v_mfma_f32_16x16x32_bf16 a[92:95], v[172:175], v[236:239], a[92:95]
    buffer_load_dwordx4 v18, s[12:15], s23 offen offset:2048 lds
    v_mfma_f32_16x16x32_bf16 a[100:103], v[172:175], v[240:243], a[100:103]
    ds_read_b64_tr_b16 v[146:147], v8 offset:4096
    v_mfma_f32_16x16x32_bf16 a[108:111], v[172:175], v[244:247], a[108:111]
    v_mfma_f32_16x16x32_bf16 a[116:119], v[172:175], v[248:251], a[116:119]
    ds_read_b128 v[212:215], v2 offset:10240
    v_mfma_f32_16x16x32_bf16 a[124:127], v[172:175], v[252:255], a[124:127]
    buffer_load_dwordx4 v19, s[12:15], s23 offen offset:3072 lds
    v_mfma_f32_16x16x32_bf16 a[128:131], v[176:179], v[224:227], a[128:131]
    ds_read_b64_tr_b16 v[148:149], v9 offset:0
    v_mfma_f32_16x16x32_bf16 a[136:139], v[176:179], v[228:231], a[136:139]
    s_add_u32 s23, s23, s25
    s_add_u32 m0, s29, 0xc000
    v_mfma_f32_16x16x32_bf16 a[144:147], v[176:179], v[232:235], a[144:147]
    ds_read_b64_tr_b16 v[150:151], v9 offset:4096
    v_mfma_f32_16x16x32_bf16 a[152:155], v[176:179], v[236:239], a[152:155]
    buffer_load_dwordx4 v20, s[16:19], s24 offen offset:0 lds
    v_mfma_f32_16x16x32_bf16 a[160:163], v[176:179], v[240:243], a[160:163]
    ds_read_b128 v[216:219], v2 offset:12288
    v_mfma_f32_16x16x32_bf16 a[168:171], v[176:179], v[244:247], a[168:171]
    v_mfma_f32_16x16x32_bf16 a[176:179], v[176:179], v[248:251], a[176:179]
    ds_read_b64_tr_b16 v[152:153], v10 offset:0
    v_mfma_f32_16x16x32_bf16 a[184:187], v[176:179], v[252:255], a[184:187]
    buffer_load_dwordx4 v21, s[16:19], s24 offen offset:1024 lds
    v_mfma_f32_16x16x32_bf16 a[132:135], v[180:183], v[224:227], a[132:135]
    ds_read_b64_tr_b16 v[154:155], v10 offset:4096
    v_mfma_f32_16x16x32_bf16 a[140:143], v[180:183], v[228:231], a[140:143]
    v_mfma_f32_16x16x32_bf16 a[148:151], v[180:183], v[232:235], a[148:151]
    ds_read_b128 v[220:223], v2 offset:14336
    v_mfma_f32_16x16x32_bf16 a[156:159], v[180:183], v[236:239], a[156:159]
    buffer_load_dwordx4 v22, s[16:19], s24 offen offset:2048 lds
    v_mfma_f32_16x16x32_bf16 a[164:167], v[180:183], v[240:243], a[164:167]
    ds_read_b64_tr_b16 v[156:157], v11 offset:0
    v_mfma_f32_16x16x32_bf16 a[172:175], v[180:183], v[244:247], a[172:175]
    v_mfma_f32_16x16x32_bf16 a[180:183], v[180:183], v[248:251], a[180:183]
    ds_read_b64_tr_b16 v[158:159], v11 offset:4096
    v_mfma_f32_16x16x32_bf16 a[188:191], v[180:183], v[252:255], a[188:191]
    buffer_load_dwordx4 v23, s[16:19], s24 offen offset:3072 lds
    v_mfma_f32_16x16x32_bf16 a[192:195], v[184:187], v[224:227], a[192:195]
    v_mfma_f32_16x16x32_bf16 a[200:203], v[184:187], v[228:231], a[200:203]
    s_add_u32 s24, s24, s26
    v_mfma_f32_16x16x32_bf16 a[208:211], v[184:187], v[232:235], a[208:211]
    v_mfma_f32_16x16x32_bf16 a[216:219], v[184:187], v[236:239], a[216:219]
    v_mfma_f32_16x16x32_bf16 a[224:227], v[184:187], v[240:243], a[224:227]
    v_mfma_f32_16x16x32_bf16 a[232:235], v[184:187], v[244:247], a[232:235]
    v_mfma_f32_16x16x32_bf16 a[240:243], v[184:187], v[248:251], a[240:243]
    v_mfma_f32_16x16x32_bf16 a[248:251], v[184:187], v[252:255], a[248:251]
    v_mfma_f32_16x16x32_bf16 a[196:199], v[188:191], v[224:227], a[196:199]
    v_mfma_f32_16x16x32_bf16 a[204:207], v[188:191], v[228:231], a[204:207]
    v_mfma_f32_16x16x32_bf16 a[212:215], v[188:191], v[232:235], a[212:215]
    v_mfma_f32_16x16x32_bf16 a[220:223], v[188:191], v[236:239], a[220:223]
    v_mfma_f32_16x16x32_bf16 a[228:231], v[188:191], v[240:243], a[228:231]
    v_mfma_f32_16x16x32_bf16 a[236:239], v[188:191], v[244:247], a[236:239]
    v_mfma_f32_16x16x32_bf16 a[244:247], v[188:191], v[248:251], a[244:247]
    s_waitcnt vmcnt(16) lgkmcnt(0)
    s_barrier
    v_mfma_f32_16x16x32_bf16 a[252:255], v[188:191], v[252:255], a[252:255]
    s_cmp_lg_u32 s27, 0
    s_cbranch_scc1 g0_302
    s_lshl_b32 s74, s68, 1
    s_add_u32 s74, s74, s22
    s_lshl_b32 s80, s74, 18
    s_lshl_b32 s74, s74, 5
    s_add_u32 s74, s74, s69
    s_lshl_b32 s74, s74, 1
    s_add_u32 s74, s74, s21
    s_lshl_b32 s73, s74, 12
    s_and_b32 s74, s74, 7
    s_lshl_b32 s74, s74, 8
    s_add_u32 s80, s80, s74
    s_lshl_b32 s74, s64, 22
    s_add_u32 s74, s74, s73
    s_add_u32 s74, s74, 0xa000000
    s_cmp_eq_u32 s64, 0
    s_cbranch_scc1 kpg_310
    s_add_u32 s30, s74, 0x0
    v_accvgpr_read_b32 v28, a0
    v_accvgpr_read_b32 v29, a1
    v_accvgpr_read_b32 v30, a2
    v_accvgpr_read_b32 v31, a3
    v_accvgpr_read_b32 v32, a4
    v_accvgpr_read_b32 v33, a5
    v_accvgpr_read_b32 v34, a6
    v_accvgpr_read_b32 v35, a7
    v_cvt_pk_bf16_f32 v44, v28, v29
    v_cvt_pk_bf16_f32 v45, v30, v31
    v_cvt_pk_bf16_f32 v46, v32, v33
    v_cvt_pk_bf16_f32 v47, v34, v35
    buffer_store_dwordx4 v[44:47], v26, s[8:11], s30 offen offset:0 sc1
    v_accvgpr_read_b32 v36, a64
    v_accvgpr_read_b32 v37, a65
    v_accvgpr_read_b32 v38, a66
    v_accvgpr_read_b32 v39, a67
    v_accvgpr_read_b32 v40, a68
    v_accvgpr_read_b32 v41, a69
    v_accvgpr_read_b32 v42, a70
    v_accvgpr_read_b32 v43, a71
    v_cvt_pk_bf16_f32 v48, v36, v37
    v_cvt_pk_bf16_f32 v49, v38, v39
    v_cvt_pk_bf16_f32 v50, v40, v41
    v_cvt_pk_bf16_f32 v51, v42, v43
    buffer_store_dwordx4 v[48:51], v26, s[8:11], s30 offen offset:1024 sc1
    v_accvgpr_read_b32 v28, a128
    v_accvgpr_read_b32 v29, a129
    v_accvgpr_read_b32 v30, a130
    v_accvgpr_read_b32 v31, a131
    v_accvgpr_read_b32 v32, a132
    v_accvgpr_read_b32 v33, a133
    v_accvgpr_read_b32 v34, a134
    v_accvgpr_read_b32 v35, a135
    v_cvt_pk_bf16_f32 v52, v28, v29
    v_cvt_pk_bf16_f32 v53, v30, v31
    v_cvt_pk_bf16_f32 v54, v32, v33
    v_cvt_pk_bf16_f32 v55, v34, v35
    buffer_store_dwordx4 v[52:55], v26, s[8:11], s30 offen offset:2048 sc1
    v_accvgpr_read_b32 v36, a192
    v_accvgpr_read_b32 v37, a193
    v_accvgpr_read_b32 v38, a194
    v_accvgpr_read_b32 v39, a195
    v_accvgpr_read_b32 v40, a196
    v_accvgpr_read_b32 v41, a197
    v_accvgpr_read_b32 v42, a198
    v_accvgpr_read_b32 v43, a199
    v_cvt_pk_bf16_f32 v56, v36, v37
    v_cvt_pk_bf16_f32 v57, v38, v39
    v_cvt_pk_bf16_f32 v58, v40, v41
    v_cvt_pk_bf16_f32 v59, v42, v43
    buffer_store_dwordx4 v[56:59], v26, s[8:11], s30 offen offset:3072 sc1
    s_add_u32 s30, s74, 0x8000
    v_accvgpr_read_b32 v28, a8
    v_accvgpr_read_b32 v29, a9
    v_accvgpr_read_b32 v30, a10
    v_accvgpr_read_b32 v31, a11
    v_accvgpr_read_b32 v32, a12
    v_accvgpr_read_b32 v33, a13
    v_accvgpr_read_b32 v34, a14
    v_accvgpr_read_b32 v35, a15
    v_cvt_pk_bf16_f32 v60, v28, v29
    v_cvt_pk_bf16_f32 v61, v30, v31
    v_cvt_pk_bf16_f32 v62, v32, v33
    v_cvt_pk_bf16_f32 v63, v34, v35
    buffer_store_dwordx4 v[60:63], v26, s[8:11], s30 offen offset:0 sc1
    v_accvgpr_read_b32 v36, a72
    v_accvgpr_read_b32 v37, a73
    v_accvgpr_read_b32 v38, a74
    v_accvgpr_read_b32 v39, a75
    v_accvgpr_read_b32 v40, a76
    v_accvgpr_read_b32 v41, a77
    v_accvgpr_read_b32 v42, a78
    v_accvgpr_read_b32 v43, a79
    v_cvt_pk_bf16_f32 v64, v36, v37
    v_cvt_pk_bf16_f32 v65, v38, v39
    v_cvt_pk_bf16_f32 v66, v40, v41
    v_cvt_pk_bf16_f32 v67, v42, v43
    buffer_store_dwordx4 v[64:67], v26, s[8:11], s30 offen offset:1024 sc1
    v_accvgpr_read_b32 v28, a136
    v_accvgpr_read_b32 v29, a137
    v_accvgpr_read_b32 v30, a138
    v_accvgpr_read_b32 v31, a139
    v_accvgpr_read_b32 v32, a140
    v_accvgpr_read_b32 v33, a141
    v_accvgpr_read_b32 v34, a142
    v_accvgpr_read_b32 v35, a143
    v_cvt_pk_bf16_f32 v68, v28, v29
    v_cvt_pk_bf16_f32 v69, v30, v31
    v_cvt_pk_bf16_f32 v70, v32, v33
    v_cvt_pk_bf16_f32 v71, v34, v35
    buffer_store_dwordx4 v[68:71], v26, s[8:11], s30 offen offset:2048 sc1
    v_accvgpr_read_b32 v36, a200
    v_accvgpr_read_b32 v37, a201
    v_accvgpr_read_b32 v38, a202
    v_accvgpr_read_b32 v39, a203
    v_accvgpr_read_b32 v40, a204
    v_accvgpr_read_b32 v41, a205
    v_accvgpr_read_b32 v42, a206
    v_accvgpr_read_b32 v43, a207
    v_cvt_pk_bf16_f32 v72, v36, v37
    v_cvt_pk_bf16_f32 v73, v38, v39
    v_cvt_pk_bf16_f32 v74, v40, v41
    v_cvt_pk_bf16_f32 v75, v42, v43
    buffer_store_dwordx4 v[72:75], v26, s[8:11], s30 offen offset:3072 sc1
    s_branch keg_311
kpg_310:
    v_accvgpr_read_b32 v128, a0
    v_accvgpr_read_b32 v129, a1
    v_accvgpr_read_b32 v130, a2
    v_accvgpr_read_b32 v131, a3
    v_accvgpr_read_b32 v132, a4
    v_accvgpr_read_b32 v133, a5
    v_accvgpr_read_b32 v134, a6
    v_accvgpr_read_b32 v135, a7
    v_accvgpr_read_b32 v136, a64
    v_accvgpr_read_b32 v137, a65
    v_accvgpr_read_b32 v138, a66
    v_accvgpr_read_b32 v139, a67
    v_accvgpr_read_b32 v140, a68
    v_accvgpr_read_b32 v141, a69
    v_accvgpr_read_b32 v142, a70
    v_accvgpr_read_b32 v143, a71
    v_accvgpr_read_b32 v144, a128
    v_accvgpr_read_b32 v145, a129
    v_accvgpr_read_b32 v146, a130
    v_accvgpr_read_b32 v147, a131
    v_accvgpr_read_b32 v148, a132
    v_accvgpr_read_b32 v149, a133
    v_accvgpr_read_b32 v150, a134
    v_accvgpr_read_b32 v151, a135
    v_accvgpr_read_b32 v152, a192
    v_accvgpr_read_b32 v153, a193
    v_accvgpr_read_b32 v154, a194
    v_accvgpr_read_b32 v155, a195
    v_accvgpr_read_b32 v156, a196
    v_accvgpr_read_b32 v157, a197
    v_accvgpr_read_b32 v158, a198
    v_accvgpr_read_b32 v159, a199
    v_accvgpr_read_b32 v160, a8
    v_accvgpr_read_b32 v161, a9
    v_accvgpr_read_b32 v162, a10
    v_accvgpr_read_b32 v163, a11
    v_accvgpr_read_b32 v164, a12
    v_accvgpr_read_b32 v165, a13
    v_accvgpr_read_b32 v166, a14
    v_accvgpr_read_b32 v167, a15
    v_accvgpr_read_b32 v168, a72
    v_accvgpr_read_b32 v169, a73
    v_accvgpr_read_b32 v170, a74
    v_accvgpr_read_b32 v171, a75
    v_accvgpr_read_b32 v172, a76
    v_accvgpr_read_b32 v173, a77
    v_accvgpr_read_b32 v174, a78
    v_accvgpr_read_b32 v175, a79
    v_accvgpr_read_b32 v176, a136
    v_accvgpr_read_b32 v177, a137
    v_accvgpr_read_b32 v178, a138
    v_accvgpr_read_b32 v179, a139
    v_accvgpr_read_b32 v180, a140
    v_accvgpr_read_b32 v181, a141
    v_accvgpr_read_b32 v182, a142
    v_accvgpr_read_b32 v183, a143
    v_accvgpr_read_b32 v184, a200
    v_accvgpr_read_b32 v185, a201
    v_accvgpr_read_b32 v186, a202
    v_accvgpr_read_b32 v187, a203
    v_accvgpr_read_b32 v188, a204
    v_accvgpr_read_b32 v189, a205
    v_accvgpr_read_b32 v190, a206
    v_accvgpr_read_b32 v191, a207
keg_311:
    s_cmp_eq_u32 s64, 1
    s_cbranch_scc1 kpg_312
    s_add_u32 s30, s74, 0x10000
    v_accvgpr_read_b32 v28, a16
    v_accvgpr_read_b32 v29, a17
    v_accvgpr_read_b32 v30, a18
    v_accvgpr_read_b32 v31, a19
    v_accvgpr_read_b32 v32, a20
    v_accvgpr_read_b32 v33, a21
    v_accvgpr_read_b32 v34, a22
    v_accvgpr_read_b32 v35, a23
    v_cvt_pk_bf16_f32 v44, v28, v29
    v_cvt_pk_bf16_f32 v45, v30, v31
    v_cvt_pk_bf16_f32 v46, v32, v33
    v_cvt_pk_bf16_f32 v47, v34, v35
    buffer_store_dwordx4 v[44:47], v26, s[8:11], s30 offen offset:0 sc1
    v_accvgpr_read_b32 v36, a80
    v_accvgpr_read_b32 v37, a81
    v_accvgpr_read_b32 v38, a82
    v_accvgpr_read_b32 v39, a83
    v_accvgpr_read_b32 v40, a84
    v_accvgpr_read_b32 v41, a85
    v_accvgpr_read_b32 v42, a86
    v_accvgpr_read_b32 v43, a87
    v_cvt_pk_bf16_f32 v48, v36, v37
    v_cvt_pk_bf16_f32 v49, v38, v39
    v_cvt_pk_bf16_f32 v50, v40, v41
    v_cvt_pk_bf16_f32 v51, v42, v43
    buffer_store_dwordx4 v[48:51], v26, s[8:11], s30 offen offset:1024 sc1
    v_accvgpr_read_b32 v28, a144
    v_accvgpr_read_b32 v29, a145
    v_accvgpr_read_b32 v30, a146
    v_accvgpr_read_b32 v31, a147
    v_accvgpr_read_b32 v32, a148
    v_accvgpr_read_b32 v33, a149
    v_accvgpr_read_b32 v34, a150
    v_accvgpr_read_b32 v35, a151
    v_cvt_pk_bf16_f32 v52, v28, v29
    v_cvt_pk_bf16_f32 v53, v30, v31
    v_cvt_pk_bf16_f32 v54, v32, v33
    v_cvt_pk_bf16_f32 v55, v34, v35
    buffer_store_dwordx4 v[52:55], v26, s[8:11], s30 offen offset:2048 sc1
    v_accvgpr_read_b32 v36, a208
    v_accvgpr_read_b32 v37, a209
    v_accvgpr_read_b32 v38, a210
    v_accvgpr_read_b32 v39, a211
    v_accvgpr_read_b32 v40, a212
    v_accvgpr_read_b32 v41, a213
    v_accvgpr_read_b32 v42, a214
    v_accvgpr_read_b32 v43, a215
    v_cvt_pk_bf16_f32 v56, v36, v37
    v_cvt_pk_bf16_f32 v57, v38, v39
    v_cvt_pk_bf16_f32 v58, v40, v41
    v_cvt_pk_bf16_f32 v59, v42, v43
    buffer_store_dwordx4 v[56:59], v26, s[8:11], s30 offen offset:3072 sc1
    s_add_u32 s30, s74, 0x18000
    v_accvgpr_read_b32 v28, a24
    v_accvgpr_read_b32 v29, a25
    v_accvgpr_read_b32 v30, a26
    v_accvgpr_read_b32 v31, a27
    v_accvgpr_read_b32 v32, a28
    v_accvgpr_read_b32 v33, a29
    v_accvgpr_read_b32 v34, a30
    v_accvgpr_read_b32 v35, a31
    v_cvt_pk_bf16_f32 v60, v28, v29
    v_cvt_pk_bf16_f32 v61, v30, v31
    v_cvt_pk_bf16_f32 v62, v32, v33
    v_cvt_pk_bf16_f32 v63, v34, v35
    buffer_store_dwordx4 v[60:63], v26, s[8:11], s30 offen offset:0 sc1
    v_accvgpr_read_b32 v36, a88
    v_accvgpr_read_b32 v37, a89
    v_accvgpr_read_b32 v38, a90
    v_accvgpr_read_b32 v39, a91
    v_accvgpr_read_b32 v40, a92
    v_accvgpr_read_b32 v41, a93
    v_accvgpr_read_b32 v42, a94
    v_accvgpr_read_b32 v43, a95
    v_cvt_pk_bf16_f32 v64, v36, v37
    v_cvt_pk_bf16_f32 v65, v38, v39
    v_cvt_pk_bf16_f32 v66, v40, v41
    v_cvt_pk_bf16_f32 v67, v42, v43
    buffer_store_dwordx4 v[64:67], v26, s[8:11], s30 offen offset:1024 sc1
    v_accvgpr_read_b32 v28, a152
    v_accvgpr_read_b32 v29, a153
    v_accvgpr_read_b32 v30, a154
    v_accvgpr_read_b32 v31, a155
    v_accvgpr_read_b32 v32, a156
    v_accvgpr_read_b32 v33, a157
    v_accvgpr_read_b32 v34, a158
    v_accvgpr_read_b32 v35, a159
    v_cvt_pk_bf16_f32 v68, v28, v29
    v_cvt_pk_bf16_f32 v69, v30, v31
    v_cvt_pk_bf16_f32 v70, v32, v33
    v_cvt_pk_bf16_f32 v71, v34, v35
    buffer_store_dwordx4 v[68:71], v26, s[8:11], s30 offen offset:2048 sc1
    v_accvgpr_read_b32 v36, a216
    v_accvgpr_read_b32 v37, a217
    v_accvgpr_read_b32 v38, a218
    v_accvgpr_read_b32 v39, a219
    v_accvgpr_read_b32 v40, a220
    v_accvgpr_read_b32 v41, a221
    v_accvgpr_read_b32 v42, a222
    v_accvgpr_read_b32 v43, a223
    v_cvt_pk_bf16_f32 v72, v36, v37
    v_cvt_pk_bf16_f32 v73, v38, v39
    v_cvt_pk_bf16_f32 v74, v40, v41
    v_cvt_pk_bf16_f32 v75, v42, v43
    buffer_store_dwordx4 v[72:75], v26, s[8:11], s30 offen offset:3072 sc1
    s_branch keg_313
kpg_312:
    v_accvgpr_read_b32 v128, a16
    v_accvgpr_read_b32 v129, a17
    v_accvgpr_read_b32 v130, a18
    v_accvgpr_read_b32 v131, a19
    v_accvgpr_read_b32 v132, a20
    v_accvgpr_read_b32 v133, a21
    v_accvgpr_read_b32 v134, a22
    v_accvgpr_read_b32 v135, a23
    v_accvgpr_read_b32 v136, a80
    v_accvgpr_read_b32 v137, a81
    v_accvgpr_read_b32 v138, a82
    v_accvgpr_read_b32 v139, a83
    v_accvgpr_read_b32 v140, a84
    v_accvgpr_read_b32 v141, a85
    v_accvgpr_read_b32 v142, a86
    v_accvgpr_read_b32 v143, a87
    v_accvgpr_read_b32 v144, a144
    v_accvgpr_read_b32 v145, a145
    v_accvgpr_read_b32 v146, a146
    v_accvgpr_read_b32 v147, a147
    v_accvgpr_read_b32 v148, a148
    v_accvgpr_read_b32 v149, a149
    v_accvgpr_read_b32 v150, a150
    v_accvgpr_read_b32 v151, a151
    v_accvgpr_read_b32 v152, a208
    v_accvgpr_read_b32 v153, a209
    v_accvgpr_read_b32 v154, a210
    v_accvgpr_read_b32 v155, a211
    v_accvgpr_read_b32 v156, a212
    v_accvgpr_read_b32 v157, a213
    v_accvgpr_read_b32 v158, a214
    v_accvgpr_read_b32 v159, a215
    v_accvgpr_read_b32 v160, a24
    v_accvgpr_read_b32 v161, a25
    v_accvgpr_read_b32 v162, a26
    v_accvgpr_read_b32 v163, a27
    v_accvgpr_read_b32 v164, a28
    v_accvgpr_read_b32 v165, a29
    v_accvgpr_read_b32 v166, a30
    v_accvgpr_read_b32 v167, a31
    v_accvgpr_read_b32 v168, a88
    v_accvgpr_read_b32 v169, a89
    v_accvgpr_read_b32 v170, a90
    v_accvgpr_read_b32 v171, a91
    v_accvgpr_read_b32 v172, a92
    v_accvgpr_read_b32 v173, a93
    v_accvgpr_read_b32 v174, a94
    v_accvgpr_read_b32 v175, a95
    v_accvgpr_read_b32 v176, a152
    v_accvgpr_read_b32 v177, a153
    v_accvgpr_read_b32 v178, a154
    v_accvgpr_read_b32 v179, a155
    v_accvgpr_read_b32 v180, a156
    v_accvgpr_read_b32 v181, a157
    v_accvgpr_read_b32 v182, a158
    v_accvgpr_read_b32 v183, a159
    v_accvgpr_read_b32 v184, a216
    v_accvgpr_read_b32 v185, a217
    v_accvgpr_read_b32 v186, a218
    v_accvgpr_read_b32 v187, a219
    v_accvgpr_read_b32 v188, a220
    v_accvgpr_read_b32 v189, a221
    v_accvgpr_read_b32 v190, a222
    v_accvgpr_read_b32 v191, a223
keg_313:
    s_cmp_eq_u32 s64, 2
    s_cbranch_scc1 kpg_314
    s_add_u32 s30, s74, 0x20000
    v_accvgpr_read_b32 v28, a32
    v_accvgpr_read_b32 v29, a33
    v_accvgpr_read_b32 v30, a34
    v_accvgpr_read_b32 v31, a35
    v_accvgpr_read_b32 v32, a36
    v_accvgpr_read_b32 v33, a37
    v_accvgpr_read_b32 v34, a38
    v_accvgpr_read_b32 v35, a39
    v_cvt_pk_bf16_f32 v44, v28, v29
    v_cvt_pk_bf16_f32 v45, v30, v31
    v_cvt_pk_bf16_f32 v46, v32, v33
    v_cvt_pk_bf16_f32 v47, v34, v35
    buffer_store_dwordx4 v[44:47], v26, s[8:11], s30 offen offset:0 sc1
    v_accvgpr_read_b32 v36, a96
    v_accvgpr_read_b32 v37, a97
    v_accvgpr_read_b32 v38, a98
    v_accvgpr_read_b32 v39, a99
    v_accvgpr_read_b32 v40, a100
    v_accvgpr_read_b32 v41, a101
    v_accvgpr_read_b32 v42, a102
    v_accvgpr_read_b32 v43, a103
    v_cvt_pk_bf16_f32 v48, v36, v37
    v_cvt_pk_bf16_f32 v49, v38, v39
    v_cvt_pk_bf16_f32 v50, v40, v41
    v_cvt_pk_bf16_f32 v51, v42, v43
    buffer_store_dwordx4 v[48:51], v26, s[8:11], s30 offen offset:1024 sc1
    v_accvgpr_read_b32 v28, a160
    v_accvgpr_read_b32 v29, a161
    v_accvgpr_read_b32 v30, a162
    v_accvgpr_read_b32 v31, a163
    v_accvgpr_read_b32 v32, a164
    v_accvgpr_read_b32 v33, a165
    v_accvgpr_read_b32 v34, a166
    v_accvgpr_read_b32 v35, a167
    v_cvt_pk_bf16_f32 v52, v28, v29
    v_cvt_pk_bf16_f32 v53, v30, v31
    v_cvt_pk_bf16_f32 v54, v32, v33
    v_cvt_pk_bf16_f32 v55, v34, v35
    buffer_store_dwordx4 v[52:55], v26, s[8:11], s30 offen offset:2048 sc1
    v_accvgpr_read_b32 v36, a224
    v_accvgpr_read_b32 v37, a225
    v_accvgpr_read_b32 v38, a226
    v_accvgpr_read_b32 v39, a227
    v_accvgpr_read_b32 v40, a228
    v_accvgpr_read_b32 v41, a229
    v_accvgpr_read_b32 v42, a230
    v_accvgpr_read_b32 v43, a231
    v_cvt_pk_bf16_f32 v56, v36, v37
    v_cvt_pk_bf16_f32 v57, v38, v39
    v_cvt_pk_bf16_f32 v58, v40, v41
    v_cvt_pk_bf16_f32 v59, v42, v43
    buffer_store_dwordx4 v[56:59], v26, s[8:11], s30 offen offset:3072 sc1
    s_add_u32 s30, s74, 0x28000
    v_accvgpr_read_b32 v28, a40
    v_accvgpr_read_b32 v29, a41
    v_accvgpr_read_b32 v30, a42
    v_accvgpr_read_b32 v31, a43
    v_accvgpr_read_b32 v32, a44
    v_accvgpr_read_b32 v33, a45
    v_accvgpr_read_b32 v34, a46
    v_accvgpr_read_b32 v35, a47
    v_cvt_pk_bf16_f32 v60, v28, v29
    v_cvt_pk_bf16_f32 v61, v30, v31
    v_cvt_pk_bf16_f32 v62, v32, v33
    v_cvt_pk_bf16_f32 v63, v34, v35
    buffer_store_dwordx4 v[60:63], v26, s[8:11], s30 offen offset:0 sc1
    v_accvgpr_read_b32 v36, a104
    v_accvgpr_read_b32 v37, a105
    v_accvgpr_read_b32 v38, a106
    v_accvgpr_read_b32 v39, a107
    v_accvgpr_read_b32 v40, a108
    v_accvgpr_read_b32 v41, a109
    v_accvgpr_read_b32 v42, a110
    v_accvgpr_read_b32 v43, a111
    v_cvt_pk_bf16_f32 v64, v36, v37
    v_cvt_pk_bf16_f32 v65, v38, v39
    v_cvt_pk_bf16_f32 v66, v40, v41
    v_cvt_pk_bf16_f32 v67, v42, v43
    buffer_store_dwordx4 v[64:67], v26, s[8:11], s30 offen offset:1024 sc1
    v_accvgpr_read_b32 v28, a168
    v_accvgpr_read_b32 v29, a169
    v_accvgpr_read_b32 v30, a170
    v_accvgpr_read_b32 v31, a171
    v_accvgpr_read_b32 v32, a172
    v_accvgpr_read_b32 v33, a173
    v_accvgpr_read_b32 v34, a174
    v_accvgpr_read_b32 v35, a175
    v_cvt_pk_bf16_f32 v68, v28, v29
    v_cvt_pk_bf16_f32 v69, v30, v31
    v_cvt_pk_bf16_f32 v70, v32, v33
    v_cvt_pk_bf16_f32 v71, v34, v35
    buffer_store_dwordx4 v[68:71], v26, s[8:11], s30 offen offset:2048 sc1
    v_accvgpr_read_b32 v36, a232
    v_accvgpr_read_b32 v37, a233
    v_accvgpr_read_b32 v38, a234
    v_accvgpr_read_b32 v39, a235
    v_accvgpr_read_b32 v40, a236
    v_accvgpr_read_b32 v41, a237
    v_accvgpr_read_b32 v42, a238
    v_accvgpr_read_b32 v43, a239
    v_cvt_pk_bf16_f32 v72, v36, v37
    v_cvt_pk_bf16_f32 v73, v38, v39
    v_cvt_pk_bf16_f32 v74, v40, v41
    v_cvt_pk_bf16_f32 v75, v42, v43
    buffer_store_dwordx4 v[72:75], v26, s[8:11], s30 offen offset:3072 sc1
    s_branch keg_315
kpg_314:
    v_accvgpr_read_b32 v128, a32
    v_accvgpr_read_b32 v129, a33
    v_accvgpr_read_b32 v130, a34
    v_accvgpr_read_b32 v131, a35
    v_accvgpr_read_b32 v132, a36
    v_accvgpr_read_b32 v133, a37
    v_accvgpr_read_b32 v134, a38
    v_accvgpr_read_b32 v135, a39
    v_accvgpr_read_b32 v136, a96
    v_accvgpr_read_b32 v137, a97
    v_accvgpr_read_b32 v138, a98
    v_accvgpr_read_b32 v139, a99
    v_accvgpr_read_b32 v140, a100
    v_accvgpr_read_b32 v141, a101
    v_accvgpr_read_b32 v142, a102
    v_accvgpr_read_b32 v143, a103
    v_accvgpr_read_b32 v144, a160
    v_accvgpr_read_b32 v145, a161
    v_accvgpr_read_b32 v146, a162
    v_accvgpr_read_b32 v147, a163
    v_accvgpr_read_b32 v148, a164
    v_accvgpr_read_b32 v149, a165
    v_accvgpr_read_b32 v150, a166
    v_accvgpr_read_b32 v151, a167
    v_accvgpr_read_b32 v152, a224
    v_accvgpr_read_b32 v153, a225
    v_accvgpr_read_b32 v154, a226
    v_accvgpr_read_b32 v155, a227
    v_accvgpr_read_b32 v156, a228
    v_accvgpr_read_b32 v157, a229
    v_accvgpr_read_b32 v158, a230
    v_accvgpr_read_b32 v159, a231
    v_accvgpr_read_b32 v160, a40
    v_accvgpr_read_b32 v161, a41
    v_accvgpr_read_b32 v162, a42
    v_accvgpr_read_b32 v163, a43
    v_accvgpr_read_b32 v164, a44
    v_accvgpr_read_b32 v165, a45
    v_accvgpr_read_b32 v166, a46
    v_accvgpr_read_b32 v167, a47
    v_accvgpr_read_b32 v168, a104
    v_accvgpr_read_b32 v169, a105
    v_accvgpr_read_b32 v170, a106
    v_accvgpr_read_b32 v171, a107
    v_accvgpr_read_b32 v172, a108
    v_accvgpr_read_b32 v173, a109
    v_accvgpr_read_b32 v174, a110
    v_accvgpr_read_b32 v175, a111
    v_accvgpr_read_b32 v176, a168
    v_accvgpr_read_b32 v177, a169
    v_accvgpr_read_b32 v178, a170
    v_accvgpr_read_b32 v179, a171
    v_accvgpr_read_b32 v180, a172
    v_accvgpr_read_b32 v181, a173
    v_accvgpr_read_b32 v182, a174
    v_accvgpr_read_b32 v183, a175
    v_accvgpr_read_b32 v184, a232
    v_accvgpr_read_b32 v185, a233
    v_accvgpr_read_b32 v186, a234
    v_accvgpr_read_b32 v187, a235
    v_accvgpr_read_b32 v188, a236
    v_accvgpr_read_b32 v189, a237
    v_accvgpr_read_b32 v190, a238
    v_accvgpr_read_b32 v191, a239
keg_315:
    s_cmp_eq_u32 s64, 3
    s_cbranch_scc1 kpg_316
    s_add_u32 s30, s74, 0x30000
    v_accvgpr_read_b32 v28, a48
    v_accvgpr_read_b32 v29, a49
    v_accvgpr_read_b32 v30, a50
    v_accvgpr_read_b32 v31, a51
    v_accvgpr_read_b32 v32, a52
    v_accvgpr_read_b32 v33, a53
    v_accvgpr_read_b32 v34, a54
    v_accvgpr_read_b32 v35, a55
    v_cvt_pk_bf16_f32 v44, v28, v29
    v_cvt_pk_bf16_f32 v45, v30, v31
    v_cvt_pk_bf16_f32 v46, v32, v33
    v_cvt_pk_bf16_f32 v47, v34, v35
    buffer_store_dwordx4 v[44:47], v26, s[8:11], s30 offen offset:0 sc1
    v_accvgpr_read_b32 v36, a112
    v_accvgpr_read_b32 v37, a113
    v_accvgpr_read_b32 v38, a114
    v_accvgpr_read_b32 v39, a115
    v_accvgpr_read_b32 v40, a116
    v_accvgpr_read_b32 v41, a117
    v_accvgpr_read_b32 v42, a118
    v_accvgpr_read_b32 v43, a119
    v_cvt_pk_bf16_f32 v48, v36, v37
    v_cvt_pk_bf16_f32 v49, v38, v39
    v_cvt_pk_bf16_f32 v50, v40, v41
    v_cvt_pk_bf16_f32 v51, v42, v43
    buffer_store_dwordx4 v[48:51], v26, s[8:11], s30 offen offset:1024 sc1
    v_accvgpr_read_b32 v28, a176
    v_accvgpr_read_b32 v29, a177
    v_accvgpr_read_b32 v30, a178
    v_accvgpr_read_b32 v31, a179
    v_accvgpr_read_b32 v32, a180
    v_accvgpr_read_b32 v33, a181
    v_accvgpr_read_b32 v34, a182
    v_accvgpr_read_b32 v35, a183
    v_cvt_pk_bf16_f32 v52, v28, v29
    v_cvt_pk_bf16_f32 v53, v30, v31
    v_cvt_pk_bf16_f32 v54, v32, v33
    v_cvt_pk_bf16_f32 v55, v34, v35
    buffer_store_dwordx4 v[52:55], v26, s[8:11], s30 offen offset:2048 sc1
    v_accvgpr_read_b32 v36, a240
    v_accvgpr_read_b32 v37, a241
    v_accvgpr_read_b32 v38, a242
    v_accvgpr_read_b32 v39, a243
    v_accvgpr_read_b32 v40, a244
    v_accvgpr_read_b32 v41, a245
    v_accvgpr_read_b32 v42, a246
    v_accvgpr_read_b32 v43, a247
    v_cvt_pk_bf16_f32 v56, v36, v37
    v_cvt_pk_bf16_f32 v57, v38, v39
    v_cvt_pk_bf16_f32 v58, v40, v41
    v_cvt_pk_bf16_f32 v59, v42, v43
    buffer_store_dwordx4 v[56:59], v26, s[8:11], s30 offen offset:3072 sc1
    s_add_u32 s30, s74, 0x38000
    v_accvgpr_read_b32 v28, a56
    v_accvgpr_read_b32 v29, a57
    v_accvgpr_read_b32 v30, a58
    v_accvgpr_read_b32 v31, a59
    v_accvgpr_read_b32 v32, a60
    v_accvgpr_read_b32 v33, a61
    v_accvgpr_read_b32 v34, a62
    v_accvgpr_read_b32 v35, a63
    v_cvt_pk_bf16_f32 v60, v28, v29
    v_cvt_pk_bf16_f32 v61, v30, v31
    v_cvt_pk_bf16_f32 v62, v32, v33
    v_cvt_pk_bf16_f32 v63, v34, v35
    buffer_store_dwordx4 v[60:63], v26, s[8:11], s30 offen offset:0 sc1
    v_accvgpr_read_b32 v36, a120
    v_accvgpr_read_b32 v37, a121
    v_accvgpr_read_b32 v38, a122
    v_accvgpr_read_b32 v39, a123
    v_accvgpr_read_b32 v40, a124
    v_accvgpr_read_b32 v41, a125
    v_accvgpr_read_b32 v42, a126
    v_accvgpr_read_b32 v43, a127
    v_cvt_pk_bf16_f32 v64, v36, v37
    v_cvt_pk_bf16_f32 v65, v38, v39
    v_cvt_pk_bf16_f32 v66, v40, v41
    v_cvt_pk_bf16_f32 v67, v42, v43
    buffer_store_dwordx4 v[64:67], v26, s[8:11], s30 offen offset:1024 sc1
    v_accvgpr_read_b32 v28, a184
    v_accvgpr_read_b32 v29, a185
    v_accvgpr_read_b32 v30, a186
    v_accvgpr_read_b32 v31, a187
    v_accvgpr_read_b32 v32, a188
    v_accvgpr_read_b32 v33, a189
    v_accvgpr_read_b32 v34, a190
    v_accvgpr_read_b32 v35, a191
    v_cvt_pk_bf16_f32 v68, v28, v29
    v_cvt_pk_bf16_f32 v69, v30, v31
    v_cvt_pk_bf16_f32 v70, v32, v33
    v_cvt_pk_bf16_f32 v71, v34, v35
    buffer_store_dwordx4 v[68:71], v26, s[8:11], s30 offen offset:2048 sc1
    v_accvgpr_read_b32 v36, a248
    v_accvgpr_read_b32 v37, a249
    v_accvgpr_read_b32 v38, a250
    v_accvgpr_read_b32 v39, a251
    v_accvgpr_read_b32 v40, a252
    v_accvgpr_read_b32 v41, a253
    v_accvgpr_read_b32 v42, a254
    v_accvgpr_read_b32 v43, a255
    v_cvt_pk_bf16_f32 v72, v36, v37
    v_cvt_pk_bf16_f32 v73, v38, v39
    v_cvt_pk_bf16_f32 v74, v40, v41
    v_cvt_pk_bf16_f32 v75, v42, v43
    buffer_store_dwordx4 v[72:75], v26, s[8:11], s30 offen offset:3072 sc1
    s_branch keg_317
kpg_316:
    v_accvgpr_read_b32 v128, a48
    v_accvgpr_read_b32 v129, a49
    v_accvgpr_read_b32 v130, a50
    v_accvgpr_read_b32 v131, a51
    v_accvgpr_read_b32 v132, a52
    v_accvgpr_read_b32 v133, a53
    v_accvgpr_read_b32 v134, a54
    v_accvgpr_read_b32 v135, a55
    v_accvgpr_read_b32 v136, a112
    v_accvgpr_read_b32 v137, a113
    v_accvgpr_read_b32 v138, a114
    v_accvgpr_read_b32 v139, a115
    v_accvgpr_read_b32 v140, a116
    v_accvgpr_read_b32 v141, a117
    v_accvgpr_read_b32 v142, a118
    v_accvgpr_read_b32 v143, a119
    v_accvgpr_read_b32 v144, a176
    v_accvgpr_read_b32 v145, a177
    v_accvgpr_read_b32 v146, a178
    v_accvgpr_read_b32 v147, a179
    v_accvgpr_read_b32 v148, a180
    v_accvgpr_read_b32 v149, a181
    v_accvgpr_read_b32 v150, a182
    v_accvgpr_read_b32 v151, a183
    v_accvgpr_read_b32 v152, a240
    v_accvgpr_read_b32 v153, a241
    v_accvgpr_read_b32 v154, a242
    v_accvgpr_read_b32 v155, a243
    v_accvgpr_read_b32 v156, a244
    v_accvgpr_read_b32 v157, a245
    v_accvgpr_read_b32 v158, a246
    v_accvgpr_read_b32 v159, a247
    v_accvgpr_read_b32 v160, a56
    v_accvgpr_read_b32 v161, a57
    v_accvgpr_read_b32 v162, a58
    v_accvgpr_read_b32 v163, a59
    v_accvgpr_read_b32 v164, a60
    v_accvgpr_read_b32 v165, a61
    v_accvgpr_read_b32 v166, a62
    v_accvgpr_read_b32 v167, a63
    v_accvgpr_read_b32 v168, a120
    v_accvgpr_read_b32 v169, a121
    v_accvgpr_read_b32 v170, a122
    v_accvgpr_read_b32 v171, a123
    v_accvgpr_read_b32 v172, a124
    v_accvgpr_read_b32 v173, a125
    v_accvgpr_read_b32 v174, a126
    v_accvgpr_read_b32 v175, a127
    v_accvgpr_read_b32 v176, a184
    v_accvgpr_read_b32 v177, a185
    v_accvgpr_read_b32 v178, a186
    v_accvgpr_read_b32 v179, a187
    v_accvgpr_read_b32 v180, a188
    v_accvgpr_read_b32 v181, a189
    v_accvgpr_read_b32 v182, a190
    v_accvgpr_read_b32 v183, a191
    v_accvgpr_read_b32 v184, a248
    v_accvgpr_read_b32 v185, a249
    v_accvgpr_read_b32 v186, a250
    v_accvgpr_read_b32 v187, a251
    v_accvgpr_read_b32 v188, a252
    v_accvgpr_read_b32 v189, a253
    v_accvgpr_read_b32 v190, a254
    v_accvgpr_read_b32 v191, a255
keg_317:
    s_lshl_b32 s79, s65, 2
    s_add_u32 s79, s79, 128
    s_mov_b32 s75, 1
    s_waitcnt vmcnt(0)
    s_barrier
    s_cmp_lg_u32 s20, 0
    s_cbranch_scc1 sgg_318
    v_mov_b32 v28, s75
    v_mov_b32 v29, s79
    s_mov_b64 exec, 1
    buffer_atomic_add v28, v29, s[48:51], 0 offen sc1
    s_mov_b64 exec, -1
sgg_318:
    s_cmp_eq_u32 s67, 0
    s_cbranch_scc1 eog_319
    s_mov_b32 s71, s73
    s_mov_b32 s72, s80
    s_lshl_b32 s74, s64, 2
    s_add_u32 s74, s74, s69
    s_lshl_b32 s74, s74, 1
    s_and_b32 s75, s65, 1
    s_add_u32 s69, s74, s75
    s_mov_b32 s68, 6
    s_lshl_b32 s74, s20, 6
    s_add_u32 s74, s74, s69
    s_add_u32 s74, s74, 1536
    s_lshl_b32 s73, s74, 13
    s_lshl_b32 s74, s20, 8
    s_add_u32 s74, s74, 0x7001800
    v_lshlrev_b32 v28, 2, v24
    buffer_load_dword v112, v28, s[8:11], s74 offen offset:0 sc1
    buffer_load_dword v113, v28, s[8:11], s74 offen offset:64 sc1
    buffer_load_dword v114, v28, s[8:11], s74 offen offset:128 sc1
    buffer_load_dword v115, v28, s[8:11], s74 offen offset:192 sc1
    v_mov_b32 v30, 56
    s_mov_b32 s77, 0
plg_320:
    buffer_load_dword v31, v30, s[48:51], 0 offen sc1
    s_add_u32 s77, s77, 1
    s_cmp_ge_u32 s77, 0x20000
    s_cbranch_scc1 L_fb
    s_waitcnt vmcnt(0)
    v_readfirstlane_b32 s76, v31
    s_cmp_ge_u32 s76, 0x1000
    s_cbranch_scc0 plg_320
    s_mov_b32 s74, s69
    s_lshl_b32 s80, s20, 1
    s_lshr_b32 s75, s74, 3
    s_and_b32 s76, s74, 7
    s_lshl_b32 s76, s76, 2
    v_and_b32 v28, 3, v1
    v_add_u32 v28, s76, v28
    v_lshrrev_b32 v29, v28, s46
    v_and_b32 v29, 1, v29
    v_lshlrev_b32 v28, 20, v28
    v_lshl_add_u32 v28, v29, 13, v28
    s_lshl_b32 s77, s75, 2
    s_add_u32 s77, s77, 0xc008000
    s_lshl_b32 s78, s68, 3
    s_add_u32 s78, s78, 8
    s_mov_b32 s79, 0
pgg_322:
    buffer_load_dword v29, v28, s[8:11], s77 offen sc1
    s_add_u32 s79, s79, 1
    s_cmp_ge_u32 s79, 0x20000
    s_cbranch_scc1 L_fb
    s_waitcnt vmcnt(0)
    v_cmp_gt_u32 vcc, s78, v29
    s_cbranch_vccnz pgg_322
    s_lshl_b32 s77, s75, 3
    s_add_u32 s77, s77, s68
    s_lshl_b32 s77, s77, 4
    s_add_u32 s77, s77, s80
    s_lshl_b32 s77, s77, 10
    s_add_u32 s77, s77, 0xc010000
    v_readlane_b32 s98, v28, 0
    v_readlane_b32 s99, v28, 1
    v_readlane_b32 s100, v28, 2
    v_readlane_b32 s101, v28, 3
    s_add_u32 s98, s98, s77
    s_add_u32 s99, s99, s77
    s_add_u32 s100, s100, s77
    s_add_u32 s101, s101, s77
    s_lshl_b32 s78, s68, 5
    s_add_u32 s78, s78, s74
    s_lshl_b32 s78, s78, 4
    s_add_u32 s78, s78, s80
    s_lshl_b32 s78, s78, 12
    s_add_u32 s78, s78, 0x9000000
    s_add_u32 s30, s73, 0x3400000
    s_add_u32 s31, s30, 0x1000
    buffer_load_dwordx4 v[128:131], v26, s[8:11], s30 offen offset:0
    buffer_load_dwordx4 v[132:135], v26, s[8:11], s30 offen offset:1024
    buffer_load_dwordx4 v[136:139], v26, s[8:11], s30 offen offset:2048
    buffer_load_dwordx4 v[140:143], v26, s[8:11], s30 offen offset:3072
    buffer_load_dwordx4 v[144:147], v26, s[8:11], s31 offen offset:0
    buffer_load_dwordx4 v[148:151], v26, s[8:11], s31 offen offset:1024
    buffer_load_dwordx4 v[152:155], v26, s[8:11], s31 offen offset:2048
    buffer_load_dwordx4 v[156:159], v26, s[8:11], s31 offen offset:3072
    s_add_u32 s30, s73, 0x1000000
    s_add_u32 s31, s30, 0x1000
    buffer_load_dwordx4 v[192:195], v124, s[8:11], s98 offen offset:0
    buffer_load_dwordx4 v[196:199], v124, s[8:11], s99 offen offset:0
    buffer_load_dwordx4 v[200:203], v124, s[8:11], s100 offen offset:0
    buffer_load_dwordx4 v[204:207], v124, s[8:11], s101 offen offset:0
    buffer_load_dwordx4 v[160:163], v26, s[8:11], s30 offen offset:0
    buffer_load_dwordx4 v[164:167], v26, s[8:11], s30 offen offset:1024
    buffer_load_dwordx4 v[168:171], v26, s[8:11], s30 offen offset:2048
    buffer_load_dwordx4 v[172:175], v26, s[8:11], s30 offen offset:3072
    buffer_load_dwordx4 v[176:179], v26, s[8:11], s31 offen offset:0
    buffer_load_dwordx4 v[180:183], v26, s[8:11], s31 offen offset:1024
    buffer_load_dwordx4 v[184:187], v26, s[8:11], s31 offen offset:2048
    buffer_load_dwordx4 v[188:191], v26, s[8:11], s31 offen offset:3072
    s_add_u32 s30, s73, 0x2200000
    s_add_u32 s31, s30, 0x1000
    buffer_load_dwordx4 v[208:211], v26, s[8:11], s30 offen offset:0
    buffer_load_dwordx4 v[212:215], v26, s[8:11], s30 offen offset:1024
    buffer_load_dwordx4 v[216:219], v26, s[8:11], s30 offen offset:2048
    buffer_load_dwordx4 v[220:223], v26, s[8:11], s30 offen offset:3072
    buffer_load_dwordx4 v[224:227], v26, s[8:11], s31 offen offset:0
    buffer_load_dwordx4 v[228:231], v26, s[8:11], s31 offen offset:1024
    buffer_load_dwordx4 v[232:235], v26, s[8:11], s31 offen offset:2048
    buffer_load_dwordx4 v[236:239], v26, s[8:11], s31 offen offset:3072
    buffer_load_dwordx2 v[240:241], v125, s[8:11], s98 offen offset:0
    buffer_load_dwordx2 v[242:243], v125, s[8:11], s99 offen offset:0
    buffer_load_dwordx2 v[244:245], v125, s[8:11], s100 offen offset:0
    buffer_load_dwordx2 v[246:247], v125, s[8:11], s101 offen offset:0
    s_waitcnt vmcnt(12)
    v_mfma_f32_16x16x32_bf16 v[32:35], v[192:195], v[128:131], 0
    v_mfma_f32_16x16x32_bf16 v[36:39], v[160:163], v[128:131], 0
    v_mfma_f32_16x16x32_bf16 v[40:43], v[192:195], v[144:147], 0
    v_mfma_f32_16x16x32_bf16 v[44:47], v[160:163], v[144:147], 0
    v_mfma_f32_16x16x32_bf16 v[48:51], v[176:179], v[144:147], 0
    v_mfma_f32_16x16x32_bf16 v[32:35], v[196:199], v[132:135], v[32:35]
    v_mfma_f32_16x16x32_bf16 v[36:39], v[164:167], v[132:135], v[36:39]
    v_mfma_f32_16x16x32_bf16 v[40:43], v[196:199], v[148:151], v[40:43]
    v_mfma_f32_16x16x32_bf16 v[44:47], v[164:167], v[148:151], v[44:47]
    v_mfma_f32_16x16x32_bf16 v[48:51], v[180:183], v[148:151], v[48:51]
    v_mfma_f32_16x16x32_bf16 v[32:35], v[200:203], v[136:139], v[32:35]
    v_mfma_f32_16x16x32_bf16 v[36:39], v[168:171], v[136:139], v[36:39]
    v_mfma_f32_16x16x32_bf16 v[40:43], v[200:203], v[152:155], v[40:43]
    v_mfma_f32_16x16x32_bf16 v[44:47], v[168:171], v[152:155], v[44:47]
    v_mfma_f32_16x16x32_bf16 v[48:51], v[184:187], v[152:155], v[48:51]
    v_mfma_f32_16x16x32_bf16 v[32:35], v[204:207], v[140:143], v[32:35]
    v_mfma_f32_16x16x32_bf16 v[36:39], v[172:175], v[140:143], v[36:39]
    v_mfma_f32_16x16x32_bf16 v[40:43], v[204:207], v[156:159], v[40:43]
    v_mfma_f32_16x16x32_bf16 v[44:47], v[172:175], v[156:159], v[44:47]
    v_mfma_f32_16x16x32_bf16 v[48:51], v[188:191], v[156:159], v[48:51]
    s_add_u32 s30, s73, 0x3440000
    s_add_u32 s31, s30, 0x1000
    buffer_load_dwordx4 v[128:131], v26, s[8:11], s30 offen offset:0
    buffer_load_dwordx4 v[132:135], v26, s[8:11], s30 offen offset:1024
    buffer_load_dwordx4 v[136:139], v26, s[8:11], s30 offen offset:2048
    buffer_load_dwordx4 v[140:143], v26, s[8:11], s30 offen offset:3072
    buffer_load_dwordx4 v[144:147], v26, s[8:11], s31 offen offset:0
    buffer_load_dwordx4 v[148:151], v26, s[8:11], s31 offen offset:1024
    buffer_load_dwordx4 v[152:155], v26, s[8:11], s31 offen offset:2048
    buffer_load_dwordx4 v[156:159], v26, s[8:11], s31 offen offset:3072
    s_add_u32 s30, s73, 0x1040000
    s_add_u32 s31, s30, 0x1000
    buffer_load_dwordx4 v[192:195], v124, s[8:11], s98 offen offset:1024
    buffer_load_dwordx4 v[196:199], v124, s[8:11], s99 offen offset:1024
    buffer_load_dwordx4 v[200:203], v124, s[8:11], s100 offen offset:1024
    buffer_load_dwordx4 v[204:207], v124, s[8:11], s101 offen offset:1024
    buffer_load_dwordx4 v[160:163], v26, s[8:11], s30 offen offset:0
    buffer_load_dwordx4 v[164:167], v26, s[8:11], s30 offen offset:1024
    buffer_load_dwordx4 v[168:171], v26, s[8:11], s30 offen offset:2048
    buffer_load_dwordx4 v[172:175], v26, s[8:11], s30 offen offset:3072
    buffer_load_dwordx4 v[176:179], v26, s[8:11], s31 offen offset:0
    buffer_load_dwordx4 v[180:183], v26, s[8:11], s31 offen offset:1024
    buffer_load_dwordx4 v[184:187], v26, s[8:11], s31 offen offset:2048
    buffer_load_dwordx4 v[188:191], v26, s[8:11], s31 offen offset:3072
    v_cndmask_b32 v36, v126, v36, s[88:89]
    v_cndmask_b32 v48, v126, v48, s[88:89]
    v_cndmask_b32 v37, v126, v37, s[90:91]
    v_cndmask_b32 v49, v126, v49, s[90:91]
    v_cndmask_b32 v38, v126, v38, s[92:93]
    v_cndmask_b32 v50, v126, v50, s[92:93]
    v_cndmask_b32 v39, v126, v39, s[94:95]
    v_cndmask_b32 v51, v126, v51, s[94:95]
    v_max3_f32 v28, v32, v33, v36
    v_max3_f32 v30, v40, v41, v44
    v_max3_f32 v28, v28, v37, v38
    v_max3_f32 v30, v30, v45, v46
    v_max_f32 v28, v28, v39
    v_max3_f32 v30, v30, v47, v48
    v_mov_b32 v29, v28
    v_max3_f32 v30, v30, v49, v50
    s_nop 0
    v_permlane16_swap_b32 v28, v29
    v_max_f32 v30, v30, v51
    v_max_f32 v28, v28, v29
    v_mov_b32 v31, v30
    v_mov_b32 v29, v28
    s_nop 0
    v_permlane16_swap_b32 v30, v31
    v_permlane32_swap_b32 v28, v29
    v_max_f32 v30, v30, v31
    v_max_f32 v28, v28, v29
    v_mov_b32 v31, v30
    v_mul_f32 v28, s96, v28
    s_nop 0
    v_permlane32_swap_b32 v30, v31
    v_fma_f32 v32, v32, s96, -v28
    v_max_f32 v30, v30, v31
    v_fma_f32 v33, v33, s96, -v28
    v_mul_f32 v30, s96, v30
    v_fma_f32 v36, v36, s96, -v28
    v_fma_f32 v40, v40, s96, -v30
    v_fma_f32 v37, v37, s96, -v28
    v_fma_f32 v41, v41, s96, -v30
    v_fma_f32 v38, v38, s96, -v28
    v_fma_f32 v44, v44, s96, -v30
    v_fma_f32 v39, v39, s96, -v28
    v_fma_f32 v45, v45, s96, -v30
    v_exp_f32 v32, v32
    v_fma_f32 v46, v46, s96, -v30
    v_exp_f32 v33, v33
    v_fma_f32 v47, v47, s96, -v30
    v_exp_f32 v36, v36
    v_fma_f32 v48, v48, s96, -v30
    v_exp_f32 v37, v37
    v_fma_f32 v49, v49, s96, -v30
    v_exp_f32 v38, v38
    v_fma_f32 v50, v50, s96, -v30
    v_exp_f32 v39, v39
    v_fma_f32 v51, v51, s96, -v30
    v_mov_b32 v61, 0
    v_exp_f32 v40, v40
    v_mov_b32 v62, 0
    v_exp_f32 v41, v41
    v_cvt_pk_bf16_f32 v60, v32, v33
    v_exp_f32 v44, v44
    v_cvt_pk_bf16_f32 v63, v32, v33
    v_exp_f32 v45, v45
    v_cvt_pk_bf16_f32 v52, v36, v37
    v_exp_f32 v46, v46
    v_cvt_pk_bf16_f32 v53, v38, v39
    v_exp_f32 v47, v47
    v_exp_f32 v48, v48
    v_exp_f32 v49, v49
    v_exp_f32 v50, v50
    v_exp_f32 v51, v51
    v_mov_b32 v249, 0
    v_mov_b32 v250, 0
    v_cvt_pk_bf16_f32 v248, v40, v41
    v_cvt_pk_bf16_f32 v251, v40, v41
    v_cvt_pk_bf16_f32 v56, v44, v45
    v_cvt_pk_bf16_f32 v57, v46, v47
    v_cvt_pk_bf16_f32 v58, v48, v49
    v_cvt_pk_bf16_f32 v59, v50, v51
    s_add_u32 s32, s78, 0x0
    s_add_u32 s33, s78, 0x8000
    s_waitcnt vmcnt(20)
    v_mfma_f32_16x16x16_bf16 v[252:255], v[120:121], v[52:53], 0
    v_mfma_f32_16x16x16_bf16 v[64:67], v[208:209], v[52:53], 0
    v_mfma_f32_16x16x16_bf16 v[68:71], v[212:213], v[52:53], 0
    v_mfma_f32_16x16x16_bf16 v[72:75], v[216:217], v[52:53], 0
    v_mfma_f32_16x16x16_bf16 v[76:79], v[220:221], v[52:53], 0
    v_mfma_f32_16x16x16_bf16 v[80:83], v[224:225], v[52:53], 0
    v_mfma_f32_16x16x16_bf16 v[84:87], v[228:229], v[52:53], 0
    v_mfma_f32_16x16x16_bf16 v[88:91], v[232:233], v[52:53], 0
    v_mfma_f32_16x16x16_bf16 v[92:95], v[236:237], v[52:53], 0
    v_mfma_f32_16x16x16_bf16 v[252:255], v[120:121], v[60:61], v[252:255]
    v_mfma_f32_16x16x16_bf16 v[64:67], v[240:241], v[60:61], v[64:67]
    v_mfma_f32_16x16x16_bf16 v[68:71], v[240:241], v[62:63], v[68:71]
    v_mfma_f32_16x16x16_bf16 v[72:75], v[242:243], v[60:61], v[72:75]
    v_mfma_f32_16x16x16_bf16 v[76:79], v[242:243], v[62:63], v[76:79]
    v_mfma_f32_16x16x16_bf16 v[80:83], v[244:245], v[60:61], v[80:83]
    v_mfma_f32_16x16x16_bf16 v[84:87], v[244:245], v[62:63], v[84:87]
    v_mfma_f32_16x16x16_bf16 v[88:91], v[246:247], v[60:61], v[88:91]
    v_mfma_f32_16x16x16_bf16 v[92:95], v[246:247], v[62:63], v[92:95]
    v_rcp_f32 v28, v252
    s_nop 0
    v_mul_f32 v28, v28, v112
    v_pk_mul_f32 v[64:65], v[64:65], v[28:29] op_sel_hi:[1,0]
    v_pk_mul_f32 v[66:67], v[66:67], v[28:29] op_sel_hi:[1,0]
    v_cvt_pk_bf16_f32 v96, v64, v65
    v_cvt_pk_bf16_f32 v97, v66, v67
    v_pk_mul_f32 v[68:69], v[68:69], v[28:29] op_sel_hi:[1,0]
    v_pk_mul_f32 v[70:71], v[70:71], v[28:29] op_sel_hi:[1,0]
    v_cvt_pk_bf16_f32 v98, v68, v69
    v_cvt_pk_bf16_f32 v99, v70, v71
    v_pk_mul_f32 v[72:73], v[72:73], v[28:29] op_sel_hi:[1,0]
    v_pk_mul_f32 v[74:75], v[74:75], v[28:29] op_sel_hi:[1,0]
    v_cvt_pk_bf16_f32 v100, v72, v73
    v_cvt_pk_bf16_f32 v101, v74, v75
    v_pk_mul_f32 v[76:77], v[76:77], v[28:29] op_sel_hi:[1,0]
    v_pk_mul_f32 v[78:79], v[78:79], v[28:29] op_sel_hi:[1,0]
    v_cvt_pk_bf16_f32 v102, v76, v77
    v_cvt_pk_bf16_f32 v103, v78, v79
    v_pk_mul_f32 v[80:81], v[80:81], v[28:29] op_sel_hi:[1,0]
    v_pk_mul_f32 v[82:83], v[82:83], v[28:29] op_sel_hi:[1,0]
    v_cvt_pk_bf16_f32 v104, v80, v81
    v_cvt_pk_bf16_f32 v105, v82, v83
    v_pk_mul_f32 v[84:85], v[84:85], v[28:29] op_sel_hi:[1,0]
    v_pk_mul_f32 v[86:87], v[86:87], v[28:29] op_sel_hi:[1,0]
    v_cvt_pk_bf16_f32 v106, v84, v85
    v_cvt_pk_bf16_f32 v107, v86, v87
    v_pk_mul_f32 v[88:89], v[88:89], v[28:29] op_sel_hi:[1,0]
    v_pk_mul_f32 v[90:91], v[90:91], v[28:29] op_sel_hi:[1,0]
    v_cvt_pk_bf16_f32 v108, v88, v89
    v_cvt_pk_bf16_f32 v109, v90, v91
    v_pk_mul_f32 v[92:93], v[92:93], v[28:29] op_sel_hi:[1,0]
    v_pk_mul_f32 v[94:95], v[94:95], v[28:29] op_sel_hi:[1,0]
    v_cvt_pk_bf16_f32 v110, v92, v93
    v_cvt_pk_bf16_f32 v111, v94, v95
    buffer_store_dwordx4 v[96:99], v26, s[8:11], s32 offen offset:0 sc1
    buffer_store_dwordx4 v[100:103], v26, s[8:11], s32 offen offset:1024 sc1
    buffer_store_dwordx4 v[104:107], v26, s[8:11], s33 offen offset:0 sc1
    buffer_store_dwordx4 v[108:111], v26, s[8:11], s33 offen offset:1024 sc1
    v_mfma_f32_16x16x32_bf16 v[252:255], v[120:123], v[56:59], 0
    v_mfma_f32_16x16x32_bf16 v[64:67], v[208:211], v[56:59], 0
    v_mfma_f32_16x16x32_bf16 v[68:71], v[212:215], v[56:59], 0
    v_mfma_f32_16x16x32_bf16 v[72:75], v[216:219], v[56:59], 0
    v_mfma_f32_16x16x32_bf16 v[76:79], v[220:223], v[56:59], 0
    v_mfma_f32_16x16x32_bf16 v[80:83], v[224:227], v[56:59], 0
    v_mfma_f32_16x16x32_bf16 v[84:87], v[228:231], v[56:59], 0
    v_mfma_f32_16x16x32_bf16 v[88:91], v[232:235], v[56:59], 0
    v_mfma_f32_16x16x32_bf16 v[92:95], v[236:239], v[56:59], 0
    v_mfma_f32_16x16x16_bf16 v[252:255], v[120:121], v[248:249], v[252:255]
    v_mfma_f32_16x16x16_bf16 v[64:67], v[240:241], v[248:249], v[64:67]
    v_mfma_f32_16x16x16_bf16 v[68:71], v[240:241], v[250:251], v[68:71]
    v_mfma_f32_16x16x16_bf16 v[72:75], v[242:243], v[248:249], v[72:75]
    v_mfma_f32_16x16x16_bf16 v[76:79], v[242:243], v[250:251], v[76:79]
    v_mfma_f32_16x16x16_bf16 v[80:83], v[244:245], v[248:249], v[80:83]
    v_mfma_f32_16x16x16_bf16 v[84:87], v[244:245], v[250:251], v[84:87]
    v_mfma_f32_16x16x16_bf16 v[88:91], v[246:247], v[248:249], v[88:91]
    v_mfma_f32_16x16x16_bf16 v[92:95], v[246:247], v[250:251], v[92:95]
    s_add_u32 s30, s73, 0x2240000
    s_add_u32 s31, s30, 0x1000
    buffer_load_dwordx4 v[208:211], v26, s[8:11], s30 offen offset:0
    buffer_load_dwordx4 v[212:215], v26, s[8:11], s30 offen offset:1024
    buffer_load_dwordx4 v[216:219], v26, s[8:11], s30 offen offset:2048
    buffer_load_dwordx4 v[220:223], v26, s[8:11], s30 offen offset:3072
    buffer_load_dwordx4 v[224:227], v26, s[8:11], s31 offen offset:0
    buffer_load_dwordx4 v[228:231], v26, s[8:11], s31 offen offset:1024
    buffer_load_dwordx4 v[232:235], v26, s[8:11], s31 offen offset:2048
    buffer_load_dwordx4 v[236:239], v26, s[8:11], s31 offen offset:3072
    buffer_load_dwordx2 v[240:241], v125, s[8:11], s98 offen offset:1024
    buffer_load_dwordx2 v[242:243], v125, s[8:11], s99 offen offset:1024
    buffer_load_dwordx2 v[244:245], v125, s[8:11], s100 offen offset:1024
    buffer_load_dwordx2 v[246:247], v125, s[8:11], s101 offen offset:1024
    v_rcp_f32 v28, v252
    s_nop 0
    v_mul_f32 v28, v28, v113
    v_pk_mul_f32 v[64:65], v[64:65], v[28:29] op_sel_hi:[1,0]
    v_pk_mul_f32 v[66:67], v[66:67], v[28:29] op_sel_hi:[1,0]
    v_cvt_pk_bf16_f32 v96, v64, v65
    v_cvt_pk_bf16_f32 v97, v66, v67
    v_pk_mul_f32 v[68:69], v[68:69], v[28:29] op_sel_hi:[1,0]
    v_pk_mul_f32 v[70:71], v[70:71], v[28:29] op_sel_hi:[1,0]
    v_cvt_pk_bf16_f32 v98, v68, v69
    v_cvt_pk_bf16_f32 v99, v70, v71
    v_pk_mul_f32 v[72:73], v[72:73], v[28:29] op_sel_hi:[1,0]
    v_pk_mul_f32 v[74:75], v[74:75], v[28:29] op_sel_hi:[1,0]
    v_cvt_pk_bf16_f32 v100, v72, v73
    v_cvt_pk_bf16_f32 v101, v74, v75
    v_pk_mul_f32 v[76:77], v[76:77], v[28:29] op_sel_hi:[1,0]
    v_pk_mul_f32 v[78:79], v[78:79], v[28:29] op_sel_hi:[1,0]
    v_cvt_pk_bf16_f32 v102, v76, v77
    v_cvt_pk_bf16_f32 v103, v78, v79
    v_pk_mul_f32 v[80:81], v[80:81], v[28:29] op_sel_hi:[1,0]
    v_pk_mul_f32 v[82:83], v[82:83], v[28:29] op_sel_hi:[1,0]
    v_cvt_pk_bf16_f32 v104, v80, v81
    v_cvt_pk_bf16_f32 v105, v82, v83
    v_pk_mul_f32 v[84:85], v[84:85], v[28:29] op_sel_hi:[1,0]
    v_pk_mul_f32 v[86:87], v[86:87], v[28:29] op_sel_hi:[1,0]
    v_cvt_pk_bf16_f32 v106, v84, v85
    v_cvt_pk_bf16_f32 v107, v86, v87
    v_pk_mul_f32 v[88:89], v[88:89], v[28:29] op_sel_hi:[1,0]
    v_pk_mul_f32 v[90:91], v[90:91], v[28:29] op_sel_hi:[1,0]
    v_cvt_pk_bf16_f32 v108, v88, v89
    v_cvt_pk_bf16_f32 v109, v90, v91
    v_pk_mul_f32 v[92:93], v[92:93], v[28:29] op_sel_hi:[1,0]
    v_pk_mul_f32 v[94:95], v[94:95], v[28:29] op_sel_hi:[1,0]
    v_cvt_pk_bf16_f32 v110, v92, v93
    v_cvt_pk_bf16_f32 v111, v94, v95
    buffer_store_dwordx4 v[96:99], v26, s[8:11], s32 offen offset:2048 sc1
    buffer_store_dwordx4 v[100:103], v26, s[8:11], s32 offen offset:3072 sc1
    buffer_store_dwordx4 v[104:107], v26, s[8:11], s33 offen offset:2048 sc1
    buffer_store_dwordx4 v[108:111], v26, s[8:11], s33 offen offset:3072 sc1
    s_waitcnt vmcnt(20)
    v_mfma_f32_16x16x32_bf16 v[32:35], v[192:195], v[128:131], 0
    v_mfma_f32_16x16x32_bf16 v[36:39], v[160:163], v[128:131], 0
    v_mfma_f32_16x16x32_bf16 v[40:43], v[192:195], v[144:147], 0
    v_mfma_f32_16x16x32_bf16 v[44:47], v[160:163], v[144:147], 0
    v_mfma_f32_16x16x32_bf16 v[48:51], v[176:179], v[144:147], 0
    v_mfma_f32_16x16x32_bf16 v[32:35], v[196:199], v[132:135], v[32:35]
    v_mfma_f32_16x16x32_bf16 v[36:39], v[164:167], v[132:135], v[36:39]
    v_mfma_f32_16x16x32_bf16 v[40:43], v[196:199], v[148:151], v[40:43]
    v_mfma_f32_16x16x32_bf16 v[44:47], v[164:167], v[148:151], v[44:47]
    v_mfma_f32_16x16x32_bf16 v[48:51], v[180:183], v[148:151], v[48:51]
    v_mfma_f32_16x16x32_bf16 v[32:35], v[200:203], v[136:139], v[32:35]
    v_mfma_f32_16x16x32_bf16 v[36:39], v[168:171], v[136:139], v[36:39]
    v_mfma_f32_16x16x32_bf16 v[40:43], v[200:203], v[152:155], v[40:43]
    v_mfma_f32_16x16x32_bf16 v[44:47], v[168:171], v[152:155], v[44:47]
    v_mfma_f32_16x16x32_bf16 v[48:51], v[184:187], v[152:155], v[48:51]
    v_mfma_f32_16x16x32_bf16 v[32:35], v[204:207], v[140:143], v[32:35]
    v_mfma_f32_16x16x32_bf16 v[36:39], v[172:175], v[140:143], v[36:39]
    v_mfma_f32_16x16x32_bf16 v[40:43], v[204:207], v[156:159], v[40:43]
    v_mfma_f32_16x16x32_bf16 v[44:47], v[172:175], v[156:159], v[44:47]
    v_mfma_f32_16x16x32_bf16 v[48:51], v[188:191], v[156:159], v[48:51]
    s_nop 4
    v_cndmask_b32 v36, v126, v36, s[88:89]
    s_nop 1
    v_cndmask_b32 v48, v126, v48, s[88:89]
    v_cndmask_b32 v37, v126, v37, s[90:91]
    v_cndmask_b32 v49, v126, v49, s[90:91]
    v_cndmask_b32 v38, v126, v38, s[92:93]
    v_cndmask_b32 v50, v126, v50, s[92:93]
    v_cndmask_b32 v39, v126, v39, s[94:95]
    v_cndmask_b32 v51, v126, v51, s[94:95]
    v_max3_f32 v28, v32, v33, v36
    v_max3_f32 v30, v40, v41, v44
    v_max3_f32 v28, v28, v37, v38
    v_max3_f32 v30, v30, v45, v46
    v_max_f32 v28, v28, v39
    v_max3_f32 v30, v30, v47, v48
    v_mov_b32 v29, v28
    v_max3_f32 v30, v30, v49, v50
    s_nop 0
    v_permlane16_swap_b32 v28, v29
    v_max_f32 v30, v30, v51
    v_max_f32 v28, v28, v29
    v_mov_b32 v31, v30
    v_mov_b32 v29, v28
    s_nop 0
    v_permlane16_swap_b32 v30, v31
    v_permlane32_swap_b32 v28, v29
    v_max_f32 v30, v30, v31
    v_max_f32 v28, v28, v29
    v_mov_b32 v31, v30
    v_mul_f32 v28, s96, v28
    s_nop 0
    v_permlane32_swap_b32 v30, v31
    v_fma_f32 v32, v32, s96, -v28
    v_max_f32 v30, v30, v31
    v_fma_f32 v33, v33, s96, -v28
    v_mul_f32 v30, s96, v30
    v_fma_f32 v36, v36, s96, -v28
    v_fma_f32 v40, v40, s96, -v30
    v_fma_f32 v37, v37, s96, -v28
    v_fma_f32 v41, v41, s96, -v30
    v_fma_f32 v38, v38, s96, -v28
    v_fma_f32 v44, v44, s96, -v30
    v_fma_f32 v39, v39, s96, -v28
    v_fma_f32 v45, v45, s96, -v30
    v_exp_f32 v32, v32
    v_fma_f32 v46, v46, s96, -v30
    v_exp_f32 v33, v33
    v_fma_f32 v47, v47, s96, -v30
    v_exp_f32 v36, v36
    v_fma_f32 v48, v48, s96, -v30
    v_exp_f32 v37, v37
    v_fma_f32 v49, v49, s96, -v30
    v_exp_f32 v38, v38
    v_fma_f32 v50, v50, s96, -v30
    v_exp_f32 v39, v39
    v_fma_f32 v51, v51, s96, -v30
    v_mov_b32 v61, 0
    v_exp_f32 v40, v40
    v_mov_b32 v62, 0
    v_exp_f32 v41, v41
    v_cvt_pk_bf16_f32 v60, v32, v33
    v_exp_f32 v44, v44
    v_cvt_pk_bf16_f32 v63, v32, v33
    v_exp_f32 v45, v45
    v_cvt_pk_bf16_f32 v52, v36, v37
    v_exp_f32 v46, v46
    v_cvt_pk_bf16_f32 v53, v38, v39
    v_exp_f32 v47, v47
    v_exp_f32 v48, v48
    v_exp_f32 v49, v49
    v_exp_f32 v50, v50
    v_exp_f32 v51, v51
    v_mov_b32 v249, 0
    v_mov_b32 v250, 0
    v_cvt_pk_bf16_f32 v248, v40, v41
    v_cvt_pk_bf16_f32 v251, v40, v41
    v_cvt_pk_bf16_f32 v56, v44, v45
    v_cvt_pk_bf16_f32 v57, v46, v47
    v_cvt_pk_bf16_f32 v58, v48, v49
    v_cvt_pk_bf16_f32 v59, v50, v51
    s_add_u32 s32, s78, 0x1000
    s_add_u32 s33, s78, 0x9000
    s_waitcnt vmcnt(4)
    v_mfma_f32_16x16x16_bf16 v[252:255], v[120:121], v[52:53], 0
    v_mfma_f32_16x16x16_bf16 v[64:67], v[208:209], v[52:53], 0
    v_mfma_f32_16x16x16_bf16 v[68:71], v[212:213], v[52:53], 0
    v_mfma_f32_16x16x16_bf16 v[72:75], v[216:217], v[52:53], 0
    v_mfma_f32_16x16x16_bf16 v[76:79], v[220:221], v[52:53], 0
    v_mfma_f32_16x16x16_bf16 v[80:83], v[224:225], v[52:53], 0
    v_mfma_f32_16x16x16_bf16 v[84:87], v[228:229], v[52:53], 0
    v_mfma_f32_16x16x16_bf16 v[88:91], v[232:233], v[52:53], 0
    v_mfma_f32_16x16x16_bf16 v[92:95], v[236:237], v[52:53], 0
    v_mfma_f32_16x16x16_bf16 v[252:255], v[120:121], v[60:61], v[252:255]
    v_mfma_f32_16x16x16_bf16 v[64:67], v[240:241], v[60:61], v[64:67]
    v_mfma_f32_16x16x16_bf16 v[68:71], v[240:241], v[62:63], v[68:71]
    v_mfma_f32_16x16x16_bf16 v[72:75], v[242:243], v[60:61], v[72:75]
    v_mfma_f32_16x16x16_bf16 v[76:79], v[242:243], v[62:63], v[76:79]
    v_mfma_f32_16x16x16_bf16 v[80:83], v[244:245], v[60:61], v[80:83]
    v_mfma_f32_16x16x16_bf16 v[84:87], v[244:245], v[62:63], v[84:87]
    v_mfma_f32_16x16x16_bf16 v[88:91], v[246:247], v[60:61], v[88:91]
    v_mfma_f32_16x16x16_bf16 v[92:95], v[246:247], v[62:63], v[92:95]
    v_rcp_f32 v28, v252
    s_nop 0
    v_mul_f32 v28, v28, v114
    v_pk_mul_f32 v[64:65], v[64:65], v[28:29] op_sel_hi:[1,0]
    v_pk_mul_f32 v[66:67], v[66:67], v[28:29] op_sel_hi:[1,0]
    v_cvt_pk_bf16_f32 v96, v64, v65
    v_cvt_pk_bf16_f32 v97, v66, v67
    v_pk_mul_f32 v[68:69], v[68:69], v[28:29] op_sel_hi:[1,0]
    v_pk_mul_f32 v[70:71], v[70:71], v[28:29] op_sel_hi:[1,0]
    v_cvt_pk_bf16_f32 v98, v68, v69
    v_cvt_pk_bf16_f32 v99, v70, v71
    v_pk_mul_f32 v[72:73], v[72:73], v[28:29] op_sel_hi:[1,0]
    v_pk_mul_f32 v[74:75], v[74:75], v[28:29] op_sel_hi:[1,0]
    v_cvt_pk_bf16_f32 v100, v72, v73
    v_cvt_pk_bf16_f32 v101, v74, v75
    v_pk_mul_f32 v[76:77], v[76:77], v[28:29] op_sel_hi:[1,0]
    v_pk_mul_f32 v[78:79], v[78:79], v[28:29] op_sel_hi:[1,0]
    v_cvt_pk_bf16_f32 v102, v76, v77
    v_cvt_pk_bf16_f32 v103, v78, v79
    v_pk_mul_f32 v[80:81], v[80:81], v[28:29] op_sel_hi:[1,0]
    v_pk_mul_f32 v[82:83], v[82:83], v[28:29] op_sel_hi:[1,0]
    v_cvt_pk_bf16_f32 v104, v80, v81
    v_cvt_pk_bf16_f32 v105, v82, v83
    v_pk_mul_f32 v[84:85], v[84:85], v[28:29] op_sel_hi:[1,0]
    v_pk_mul_f32 v[86:87], v[86:87], v[28:29] op_sel_hi:[1,0]
    v_cvt_pk_bf16_f32 v106, v84, v85
    v_cvt_pk_bf16_f32 v107, v86, v87
    v_pk_mul_f32 v[88:89], v[88:89], v[28:29] op_sel_hi:[1,0]
    v_pk_mul_f32 v[90:91], v[90:91], v[28:29] op_sel_hi:[1,0]
    v_cvt_pk_bf16_f32 v108, v88, v89
    v_cvt_pk_bf16_f32 v109, v90, v91
    v_pk_mul_f32 v[92:93], v[92:93], v[28:29] op_sel_hi:[1,0]
    v_pk_mul_f32 v[94:95], v[94:95], v[28:29] op_sel_hi:[1,0]
    v_cvt_pk_bf16_f32 v110, v92, v93
    v_cvt_pk_bf16_f32 v111, v94, v95
    buffer_store_dwordx4 v[96:99], v26, s[8:11], s32 offen offset:0 sc1
    buffer_store_dwordx4 v[100:103], v26, s[8:11], s32 offen offset:1024 sc1
    buffer_store_dwordx4 v[104:107], v26, s[8:11], s33 offen offset:0 sc1
    buffer_store_dwordx4 v[108:111], v26, s[8:11], s33 offen offset:1024 sc1
    v_mfma_f32_16x16x32_bf16 v[252:255], v[120:123], v[56:59], 0
    v_mfma_f32_16x16x32_bf16 v[64:67], v[208:211], v[56:59], 0
    v_mfma_f32_16x16x32_bf16 v[68:71], v[212:215], v[56:59], 0
    v_mfma_f32_16x16x32_bf16 v[72:75], v[216:219], v[56:59], 0
    v_mfma_f32_16x16x32_bf16 v[76:79], v[220:223], v[56:59], 0
    v_mfma_f32_16x16x32_bf16 v[80:83], v[224:227], v[56:59], 0
    v_mfma_f32_16x16x32_bf16 v[84:87], v[228:231], v[56:59], 0
    v_mfma_f32_16x16x32_bf16 v[88:91], v[232:235], v[56:59], 0
    v_mfma_f32_16x16x32_bf16 v[92:95], v[236:239], v[56:59], 0
    v_mfma_f32_16x16x16_bf16 v[252:255], v[120:121], v[248:249], v[252:255]
    v_mfma_f32_16x16x16_bf16 v[64:67], v[240:241], v[248:249], v[64:67]
    v_mfma_f32_16x16x16_bf16 v[68:71], v[240:241], v[250:251], v[68:71]
    v_mfma_f32_16x16x16_bf16 v[72:75], v[242:243], v[248:249], v[72:75]
    v_mfma_f32_16x16x16_bf16 v[76:79], v[242:243], v[250:251], v[76:79]
    v_mfma_f32_16x16x16_bf16 v[80:83], v[244:245], v[248:249], v[80:83]
    v_mfma_f32_16x16x16_bf16 v[84:87], v[244:245], v[250:251], v[84:87]
    v_mfma_f32_16x16x16_bf16 v[88:91], v[246:247], v[248:249], v[88:91]
    v_mfma_f32_16x16x16_bf16 v[92:95], v[246:247], v[250:251], v[92:95]
    v_rcp_f32 v28, v252
    s_nop 0
    v_mul_f32 v28, v28, v115
    v_pk_mul_f32 v[64:65], v[64:65], v[28:29] op_sel_hi:[1,0]
    v_pk_mul_f32 v[66:67], v[66:67], v[28:29] op_sel_hi:[1,0]
    v_cvt_pk_bf16_f32 v96, v64, v65
    v_cvt_pk_bf16_f32 v97, v66, v67
    v_pk_mul_f32 v[68:69], v[68:69], v[28:29] op_sel_hi:[1,0]
    v_pk_mul_f32 v[70:71], v[70:71], v[28:29] op_sel_hi:[1,0]
    v_cvt_pk_bf16_f32 v98, v68, v69
    v_cvt_pk_bf16_f32 v99, v70, v71
    v_pk_mul_f32 v[72:73], v[72:73], v[28:29] op_sel_hi:[1,0]
    v_pk_mul_f32 v[74:75], v[74:75], v[28:29] op_sel_hi:[1,0]
    v_cvt_pk_bf16_f32 v100, v72, v73
    v_cvt_pk_bf16_f32 v101, v74, v75
    v_pk_mul_f32 v[76:77], v[76:77], v[28:29] op_sel_hi:[1,0]
    v_pk_mul_f32 v[78:79], v[78:79], v[28:29] op_sel_hi:[1,0]
    v_cvt_pk_bf16_f32 v102, v76, v77
    v_cvt_pk_bf16_f32 v103, v78, v79
    v_pk_mul_f32 v[80:81], v[80:81], v[28:29] op_sel_hi:[1,0]
    v_pk_mul_f32 v[82:83], v[82:83], v[28:29] op_sel_hi:[1,0]
    v_cvt_pk_bf16_f32 v104, v80, v81
    v_cvt_pk_bf16_f32 v105, v82, v83
    v_pk_mul_f32 v[84:85], v[84:85], v[28:29] op_sel_hi:[1,0]
    v_pk_mul_f32 v[86:87], v[86:87], v[28:29] op_sel_hi:[1,0]
    v_cvt_pk_bf16_f32 v106, v84, v85
    v_cvt_pk_bf16_f32 v107, v86, v87
    v_pk_mul_f32 v[88:89], v[88:89], v[28:29] op_sel_hi:[1,0]
    v_pk_mul_f32 v[90:91], v[90:91], v[28:29] op_sel_hi:[1,0]
    v_cvt_pk_bf16_f32 v108, v88, v89
    v_cvt_pk_bf16_f32 v109, v90, v91
    v_pk_mul_f32 v[92:93], v[92:93], v[28:29] op_sel_hi:[1,0]
    v_pk_mul_f32 v[94:95], v[94:95], v[28:29] op_sel_hi:[1,0]
    v_cvt_pk_bf16_f32 v110, v92, v93
    v_cvt_pk_bf16_f32 v111, v94, v95
    buffer_store_dwordx4 v[96:99], v26, s[8:11], s32 offen offset:2048 sc1
    buffer_store_dwordx4 v[100:103], v26, s[8:11], s32 offen offset:3072 sc1
    buffer_store_dwordx4 v[104:107], v26, s[8:11], s33 offen offset:2048 sc1
    buffer_store_dwordx4 v[108:111], v26, s[8:11], s33 offen offset:3072 sc1
    s_mov_b32 s74, 56
    s_mov_b32 s75, 0x10000
    s_waitcnt vmcnt(0)
    s_barrier
    s_cmp_lg_u32 s20, 0
    s_cbranch_scc1 sgg_323
    v_mov_b32 v28, s75
    v_mov_b32 v29, s74
    s_mov_b64 exec, 1
    buffer_atomic_add v28, v29, s[48:51], 0 offen sc1
    s_mov_b64 exec, -1
sgg_323:
    s_mov_b32 s73, s71
    s_mov_b32 s80, s72
    s_lshl_b32 s79, s65, 2
    s_add_u32 s79, s79, 128
    s_cmp_lg_u32 s64, 0
    s_cbranch_scc1 kfg_324
    v_accvgpr_read_b32 v128, a0
    v_accvgpr_read_b32 v129, a1
    v_accvgpr_read_b32 v130, a2
    v_accvgpr_read_b32 v131, a3
    v_accvgpr_read_b32 v132, a4
    v_accvgpr_read_b32 v133, a5
    v_accvgpr_read_b32 v134, a6
    v_accvgpr_read_b32 v135, a7
    v_accvgpr_read_b32 v136, a64
    v_accvgpr_read_b32 v137, a65
    v_accvgpr_read_b32 v138, a66
    v_accvgpr_read_b32 v139, a67
    v_accvgpr_read_b32 v140, a68
    v_accvgpr_read_b32 v141, a69
    v_accvgpr_read_b32 v142, a70
    v_accvgpr_read_b32 v143, a71
    v_accvgpr_read_b32 v144, a128
    v_accvgpr_read_b32 v145, a129
    v_accvgpr_read_b32 v146, a130
    v_accvgpr_read_b32 v147, a131
    v_accvgpr_read_b32 v148, a132
    v_accvgpr_read_b32 v149, a133
    v_accvgpr_read_b32 v150, a134
    v_accvgpr_read_b32 v151, a135
    v_accvgpr_read_b32 v152, a192
    v_accvgpr_read_b32 v153, a193
    v_accvgpr_read_b32 v154, a194
    v_accvgpr_read_b32 v155, a195
    v_accvgpr_read_b32 v156, a196
    v_accvgpr_read_b32 v157, a197
    v_accvgpr_read_b32 v158, a198
    v_accvgpr_read_b32 v159, a199
    v_accvgpr_read_b32 v160, a8
    v_accvgpr_read_b32 v161, a9
    v_accvgpr_read_b32 v162, a10
    v_accvgpr_read_b32 v163, a11
    v_accvgpr_read_b32 v164, a12
    v_accvgpr_read_b32 v165, a13
    v_accvgpr_read_b32 v166, a14
    v_accvgpr_read_b32 v167, a15
    v_accvgpr_read_b32 v168, a72
    v_accvgpr_read_b32 v169, a73
    v_accvgpr_read_b32 v170, a74
    v_accvgpr_read_b32 v171, a75
    v_accvgpr_read_b32 v172, a76
    v_accvgpr_read_b32 v173, a77
    v_accvgpr_read_b32 v174, a78
    v_accvgpr_read_b32 v175, a79
    v_accvgpr_read_b32 v176, a136
    v_accvgpr_read_b32 v177, a137
    v_accvgpr_read_b32 v178, a138
    v_accvgpr_read_b32 v179, a139
    v_accvgpr_read_b32 v180, a140
    v_accvgpr_read_b32 v181, a141
    v_accvgpr_read_b32 v182, a142
    v_accvgpr_read_b32 v183, a143
    v_accvgpr_read_b32 v184, a200
    v_accvgpr_read_b32 v185, a201
    v_accvgpr_read_b32 v186, a202
    v_accvgpr_read_b32 v187, a203
    v_accvgpr_read_b32 v188, a204
    v_accvgpr_read_b32 v189, a205
    v_accvgpr_read_b32 v190, a206
    v_accvgpr_read_b32 v191, a207
kfg_324:
    s_cmp_lg_u32 s64, 1
    s_cbranch_scc1 kfg_325
    v_accvgpr_read_b32 v128, a16
    v_accvgpr_read_b32 v129, a17
    v_accvgpr_read_b32 v130, a18
    v_accvgpr_read_b32 v131, a19
    v_accvgpr_read_b32 v132, a20
    v_accvgpr_read_b32 v133, a21
    v_accvgpr_read_b32 v134, a22
    v_accvgpr_read_b32 v135, a23
    v_accvgpr_read_b32 v136, a80
    v_accvgpr_read_b32 v137, a81
    v_accvgpr_read_b32 v138, a82
    v_accvgpr_read_b32 v139, a83
    v_accvgpr_read_b32 v140, a84
    v_accvgpr_read_b32 v141, a85
    v_accvgpr_read_b32 v142, a86
    v_accvgpr_read_b32 v143, a87
    v_accvgpr_read_b32 v144, a144
    v_accvgpr_read_b32 v145, a145
    v_accvgpr_read_b32 v146, a146
    v_accvgpr_read_b32 v147, a147
    v_accvgpr_read_b32 v148, a148
    v_accvgpr_read_b32 v149, a149
    v_accvgpr_read_b32 v150, a150
    v_accvgpr_read_b32 v151, a151
    v_accvgpr_read_b32 v152, a208
    v_accvgpr_read_b32 v153, a209
    v_accvgpr_read_b32 v154, a210
    v_accvgpr_read_b32 v155, a211
    v_accvgpr_read_b32 v156, a212
    v_accvgpr_read_b32 v157, a213
    v_accvgpr_read_b32 v158, a214
    v_accvgpr_read_b32 v159, a215
    v_accvgpr_read_b32 v160, a24
    v_accvgpr_read_b32 v161, a25
    v_accvgpr_read_b32 v162, a26
    v_accvgpr_read_b32 v163, a27
    v_accvgpr_read_b32 v164, a28
    v_accvgpr_read_b32 v165, a29
    v_accvgpr_read_b32 v166, a30
    v_accvgpr_read_b32 v167, a31
    v_accvgpr_read_b32 v168, a88
    v_accvgpr_read_b32 v169, a89
    v_accvgpr_read_b32 v170, a90
    v_accvgpr_read_b32 v171, a91
    v_accvgpr_read_b32 v172, a92
    v_accvgpr_read_b32 v173, a93
    v_accvgpr_read_b32 v174, a94
    v_accvgpr_read_b32 v175, a95
    v_accvgpr_read_b32 v176, a152
    v_accvgpr_read_b32 v177, a153
    v_accvgpr_read_b32 v178, a154
    v_accvgpr_read_b32 v179, a155
    v_accvgpr_read_b32 v180, a156
    v_accvgpr_read_b32 v181, a157
    v_accvgpr_read_b32 v182, a158
    v_accvgpr_read_b32 v183, a159
    v_accvgpr_read_b32 v184, a216
    v_accvgpr_read_b32 v185, a217
    v_accvgpr_read_b32 v186, a218
    v_accvgpr_read_b32 v187, a219
    v_accvgpr_read_b32 v188, a220
    v_accvgpr_read_b32 v189, a221
    v_accvgpr_read_b32 v190, a222
    v_accvgpr_read_b32 v191, a223
kfg_325:
    s_cmp_lg_u32 s64, 2
    s_cbranch_scc1 kfg_326
    v_accvgpr_read_b32 v128, a32
    v_accvgpr_read_b32 v129, a33
    v_accvgpr_read_b32 v130, a34
    v_accvgpr_read_b32 v131, a35
    v_accvgpr_read_b32 v132, a36
    v_accvgpr_read_b32 v133, a37
    v_accvgpr_read_b32 v134, a38
    v_accvgpr_read_b32 v135, a39
    v_accvgpr_read_b32 v136, a96
    v_accvgpr_read_b32 v137, a97
    v_accvgpr_read_b32 v138, a98
    v_accvgpr_read_b32 v139, a99
    v_accvgpr_read_b32 v140, a100
    v_accvgpr_read_b32 v141, a101
    v_accvgpr_read_b32 v142, a102
    v_accvgpr_read_b32 v143, a103
    v_accvgpr_read_b32 v144, a160
    v_accvgpr_read_b32 v145, a161
    v_accvgpr_read_b32 v146, a162
    v_accvgpr_read_b32 v147, a163
    v_accvgpr_read_b32 v148, a164
    v_accvgpr_read_b32 v149, a165
    v_accvgpr_read_b32 v150, a166
    v_accvgpr_read_b32 v151, a167
    v_accvgpr_read_b32 v152, a224
    v_accvgpr_read_b32 v153, a225
    v_accvgpr_read_b32 v154, a226
    v_accvgpr_read_b32 v155, a227
    v_accvgpr_read_b32 v156, a228
    v_accvgpr_read_b32 v157, a229
    v_accvgpr_read_b32 v158, a230
    v_accvgpr_read_b32 v159, a231
    v_accvgpr_read_b32 v160, a40
    v_accvgpr_read_b32 v161, a41
    v_accvgpr_read_b32 v162, a42
    v_accvgpr_read_b32 v163, a43
    v_accvgpr_read_b32 v164, a44
    v_accvgpr_read_b32 v165, a45
    v_accvgpr_read_b32 v166, a46
    v_accvgpr_read_b32 v167, a47
    v_accvgpr_read_b32 v168, a104
    v_accvgpr_read_b32 v169, a105
    v_accvgpr_read_b32 v170, a106
    v_accvgpr_read_b32 v171, a107
    v_accvgpr_read_b32 v172, a108
    v_accvgpr_read_b32 v173, a109
    v_accvgpr_read_b32 v174, a110
    v_accvgpr_read_b32 v175, a111
    v_accvgpr_read_b32 v176, a168
    v_accvgpr_read_b32 v177, a169
    v_accvgpr_read_b32 v178, a170
    v_accvgpr_read_b32 v179, a171
    v_accvgpr_read_b32 v180, a172
    v_accvgpr_read_b32 v181, a173
    v_accvgpr_read_b32 v182, a174
    v_accvgpr_read_b32 v183, a175
    v_accvgpr_read_b32 v184, a232
    v_accvgpr_read_b32 v185, a233
    v_accvgpr_read_b32 v186, a234
    v_accvgpr_read_b32 v187, a235
    v_accvgpr_read_b32 v188, a236
    v_accvgpr_read_b32 v189, a237
    v_accvgpr_read_b32 v190, a238
    v_accvgpr_read_b32 v191, a239
kfg_326:
    s_cmp_lg_u32 s64, 3
    s_cbranch_scc1 kfg_327
    v_accvgpr_read_b32 v128, a48
    v_accvgpr_read_b32 v129, a49
    v_accvgpr_read_b32 v130, a50
    v_accvgpr_read_b32 v131, a51
    v_accvgpr_read_b32 v132, a52
    v_accvgpr_read_b32 v133, a53
    v_accvgpr_read_b32 v134, a54
    v_accvgpr_read_b32 v135, a55
    v_accvgpr_read_b32 v136, a112
    v_accvgpr_read_b32 v137, a113
    v_accvgpr_read_b32 v138, a114
    v_accvgpr_read_b32 v139, a115
    v_accvgpr_read_b32 v140, a116
    v_accvgpr_read_b32 v141, a117
    v_accvgpr_read_b32 v142, a118
    v_accvgpr_read_b32 v143, a119
    v_accvgpr_read_b32 v144, a176
    v_accvgpr_read_b32 v145, a177
    v_accvgpr_read_b32 v146, a178
    v_accvgpr_read_b32 v147, a179
    v_accvgpr_read_b32 v148, a180
    v_accvgpr_read_b32 v149, a181
    v_accvgpr_read_b32 v150, a182
    v_accvgpr_read_b32 v151, a183
    v_accvgpr_read_b32 v152, a240
    v_accvgpr_read_b32 v153, a241
    v_accvgpr_read_b32 v154, a242
    v_accvgpr_read_b32 v155, a243
    v_accvgpr_read_b32 v156, a244
    v_accvgpr_read_b32 v157, a245
    v_accvgpr_read_b32 v158, a246
    v_accvgpr_read_b32 v159, a247
    v_accvgpr_read_b32 v160, a56
    v_accvgpr_read_b32 v161, a57
    v_accvgpr_read_b32 v162, a58
    v_accvgpr_read_b32 v163, a59
    v_accvgpr_read_b32 v164, a60
    v_accvgpr_read_b32 v165, a61
    v_accvgpr_read_b32 v166, a62
    v_accvgpr_read_b32 v167, a63
    v_accvgpr_read_b32 v168, a120
    v_accvgpr_read_b32 v169, a121
    v_accvgpr_read_b32 v170, a122
    v_accvgpr_read_b32 v171, a123
    v_accvgpr_read_b32 v172, a124
    v_accvgpr_read_b32 v173, a125
    v_accvgpr_read_b32 v174, a126
    v_accvgpr_read_b32 v175, a127
    v_accvgpr_read_b32 v176, a184
    v_accvgpr_read_b32 v177, a185
    v_accvgpr_read_b32 v178, a186
    v_accvgpr_read_b32 v179, a187
    v_accvgpr_read_b32 v180, a188
    v_accvgpr_read_b32 v181, a189
    v_accvgpr_read_b32 v182, a190
    v_accvgpr_read_b32 v183, a191
    v_accvgpr_read_b32 v184, a248
    v_accvgpr_read_b32 v185, a249
    v_accvgpr_read_b32 v186, a250
    v_accvgpr_read_b32 v187, a251
    v_accvgpr_read_b32 v188, a252
    v_accvgpr_read_b32 v189, a253
    v_accvgpr_read_b32 v190, a254
    v_accvgpr_read_b32 v191, a255
kfg_327:
eog_319:
    v_mov_b32 v30, s79
    s_lshl_b32 s81, s64, 16
    s_add_u32 s73, s73, s81
    s_add_u32 s80, s80, s81
    v_and_b32 v88, 1, v25
    v_lshlrev_b32 v88, 5, v88
    v_lshrrev_b32 v89, 1, v25
    v_lshl_add_u32 v88, v89, 4, v88
    v_lshl_add_u32 v88, v24, 11, v88
    s_mov_b32 s77, 0
plg_328:
    buffer_load_dword v31, v30, s[48:51], 0 offen sc1
    s_add_u32 s77, s77, 1
    s_cmp_ge_u32 s77, 0x20000
    s_cbranch_scc1 L_fb
    s_waitcnt vmcnt(0)
    v_readfirstlane_b32 s76, v31
    s_and_b32 s76, s76, 0xff
    s_cmp_ge_u32 s76, 4
    s_cbranch_scc0 plg_328
    buffer_load_dword v31, off, s[48:51], 0 offset:108 sc1
    v_lshrrev_b32 v30, 2, v26
    v_and_b32 v30, 28, v30
    buffer_load_dword v89, v30, s[48:51], 0 offen sc1
    s_add_u32 s30, s64, 1
    s_and_b32 s30, s30, 3
    s_lshl_b32 s30, s30, 22
    s_add_u32 s30, s30, s73
    s_add_u32 s30, s30, 0xa000000
    buffer_load_dwordx4 v[32:35], v26, s[8:11], s30 offen offset:0
    buffer_load_dwordx4 v[36:39], v26, s[8:11], s30 offen offset:1024
    buffer_load_dwordx4 v[40:43], v26, s[8:11], s30 offen offset:2048
    buffer_load_dwordx4 v[44:47], v26, s[8:11], s30 offen offset:3072
    s_add_u32 s30, s64, 2
    s_and_b32 s30, s30, 3
    s_lshl_b32 s30, s30, 22
    s_add_u32 s30, s30, s73
    s_add_u32 s30, s30, 0xa000000
    buffer_load_dwordx4 v[48:51], v26, s[8:11], s30 offen offset:0
    buffer_load_dwordx4 v[52:55], v26, s[8:11], s30 offen offset:1024
    buffer_load_dwordx4 v[56:59], v26, s[8:11], s30 offen offset:2048
    buffer_load_dwordx4 v[60:63], v26, s[8:11], s30 offen offset:3072
    s_add_u32 s30, s64, 3
    s_and_b32 s30, s30, 3
    s_lshl_b32 s30, s30, 22
    s_add_u32 s30, s30, s73
    s_add_u32 s30, s30, 0xa000000
    buffer_load_dwordx4 v[64:67], v26, s[8:11], s30 offen offset:0
    buffer_load_dwordx4 v[68:71], v26, s[8:11], s30 offen offset:1024
    buffer_load_dwordx4 v[72:75], v26, s[8:11], s30 offen offset:2048
    buffer_load_dwordx4 v[76:79], v26, s[8:11], s30 offen offset:3072
    s_add_u32 s30, s64, 1
    s_and_b32 s30, s30, 3
    s_lshl_b32 s30, s30, 22
    s_add_u32 s30, s30, s73
    s_add_u32 s30, s30, 0xa008000
    buffer_load_dwordx4 v[192:195], v26, s[8:11], s30 offen offset:0
    buffer_load_dwordx4 v[196:199], v26, s[8:11], s30 offen offset:1024
    buffer_load_dwordx4 v[200:203], v26, s[8:11], s30 offen offset:2048
    buffer_load_dwordx4 v[204:207], v26, s[8:11], s30 offen offset:3072
    s_add_u32 s30, s64, 2
    s_and_b32 s30, s30, 3
    s_lshl_b32 s30, s30, 22
    s_add_u32 s30, s30, s73
    s_add_u32 s30, s30, 0xa008000
    buffer_load_dwordx4 v[208:211], v26, s[8:11], s30 offen offset:0
    buffer_load_dwordx4 v[212:215], v26, s[8:11], s30 offen offset:1024
    buffer_load_dwordx4 v[216:219], v26, s[8:11], s30 offen offset:2048
    buffer_load_dwordx4 v[220:223], v26, s[8:11], s30 offen offset:3072
    s_add_u32 s30, s64, 3
    s_and_b32 s30, s30, 3
    s_lshl_b32 s30, s30, 22
    s_add_u32 s30, s30, s73
    s_add_u32 s30, s30, 0xa008000
    buffer_load_dwordx4 v[224:227], v26, s[8:11], s30 offen offset:0
    buffer_load_dwordx4 v[228:231], v26, s[8:11], s30 offen offset:1024
    buffer_load_dwordx4 v[232:235], v26, s[8:11], s30 offen offset:2048
    buffer_load_dwordx4 v[236:239], v26, s[8:11], s30 offen offset:3072
    s_mov_b32 s33, 0xffff0000
    s_waitcnt vmcnt(12)
    v_lshlrev_b32 v96, 16, v32
    v_and_b32 v97, s33, v32
    v_lshlrev_b32 v98, 16, v33
    v_and_b32 v99, s33, v33
    v_lshlrev_b32 v100, 16, v34
    v_and_b32 v101, s33, v34
    v_lshlrev_b32 v102, 16, v35
    v_and_b32 v103, s33, v35
    v_pk_add_f32 v[128:129], v[128:129], v[96:97]
    v_pk_add_f32 v[130:131], v[130:131], v[98:99]
    v_pk_add_f32 v[132:133], v[132:133], v[100:101]
    v_pk_add_f32 v[134:135], v[134:135], v[102:103]
    v_lshlrev_b32 v96, 16, v48
    v_and_b32 v97, s33, v48
    v_lshlrev_b32 v98, 16, v49
    v_and_b32 v99, s33, v49
    v_lshlrev_b32 v100, 16, v50
    v_and_b32 v101, s33, v50
    v_lshlrev_b32 v102, 16, v51
    v_and_b32 v103, s33, v51
    v_pk_add_f32 v[128:129], v[128:129], v[96:97]
    v_pk_add_f32 v[130:131], v[130:131], v[98:99]
    v_pk_add_f32 v[132:133], v[132:133], v[100:101]
    v_pk_add_f32 v[134:135], v[134:135], v[102:103]
    v_lshlrev_b32 v96, 16, v64
    v_and_b32 v97, s33, v64
    v_lshlrev_b32 v98, 16, v65
    v_and_b32 v99, s33, v65
    v_lshlrev_b32 v100, 16, v66
    v_and_b32 v101, s33, v66
    v_lshlrev_b32 v102, 16, v67
    v_and_b32 v103, s33, v67
    v_pk_add_f32 v[128:129], v[128:129], v[96:97]
    v_pk_add_f32 v[130:131], v[130:131], v[98:99]
    v_pk_add_f32 v[132:133], v[132:133], v[100:101]
    v_pk_add_f32 v[134:135], v[134:135], v[102:103]
    v_cvt_pk_bf16_f32 v128, v128, v129
    v_cvt_pk_bf16_f32 v129, v130, v131
    v_cvt_pk_bf16_f32 v130, v132, v133
    v_cvt_pk_bf16_f32 v131, v134, v135
    v_lshlrev_b32 v104, 16, v36
    v_and_b32 v105, s33, v36
    v_lshlrev_b32 v106, 16, v37
    v_and_b32 v107, s33, v37
    v_lshlrev_b32 v108, 16, v38
    v_and_b32 v109, s33, v38
    v_lshlrev_b32 v110, 16, v39
    v_and_b32 v111, s33, v39
    v_pk_add_f32 v[136:137], v[136:137], v[104:105]
    v_pk_add_f32 v[138:139], v[138:139], v[106:107]
    v_pk_add_f32 v[140:141], v[140:141], v[108:109]
    v_pk_add_f32 v[142:143], v[142:143], v[110:111]
    v_lshlrev_b32 v104, 16, v52
    v_and_b32 v105, s33, v52
    v_lshlrev_b32 v106, 16, v53
    v_and_b32 v107, s33, v53
    v_lshlrev_b32 v108, 16, v54
    v_and_b32 v109, s33, v54
    v_lshlrev_b32 v110, 16, v55
    v_and_b32 v111, s33, v55
    v_pk_add_f32 v[136:137], v[136:137], v[104:105]
    v_pk_add_f32 v[138:139], v[138:139], v[106:107]
    v_pk_add_f32 v[140:141], v[140:141], v[108:109]
    v_pk_add_f32 v[142:143], v[142:143], v[110:111]
    v_lshlrev_b32 v104, 16, v68
    v_and_b32 v105, s33, v68
    v_lshlrev_b32 v106, 16, v69
    v_and_b32 v107, s33, v69
    v_lshlrev_b32 v108, 16, v70
    v_and_b32 v109, s33, v70
    v_lshlrev_b32 v110, 16, v71
    v_and_b32 v111, s33, v71
    v_pk_add_f32 v[136:137], v[136:137], v[104:105]
    v_pk_add_f32 v[138:139], v[138:139], v[106:107]
    v_pk_add_f32 v[140:141], v[140:141], v[108:109]
    v_pk_add_f32 v[142:143], v[142:143], v[110:111]
    v_cvt_pk_bf16_f32 v136, v136, v137
    v_cvt_pk_bf16_f32 v137, v138, v139
    v_cvt_pk_bf16_f32 v138, v140, v141
    v_cvt_pk_bf16_f32 v139, v142, v143
    v_lshlrev_b32 v96, 16, v40
    v_and_b32 v97, s33, v40
    v_lshlrev_b32 v98, 16, v41
    v_and_b32 v99, s33, v41
    v_lshlrev_b32 v100, 16, v42
    v_and_b32 v101, s33, v42
    v_lshlrev_b32 v102, 16, v43
    v_and_b32 v103, s33, v43
    v_pk_add_f32 v[144:145], v[144:145], v[96:97]
    v_pk_add_f32 v[146:147], v[146:147], v[98:99]
    v_pk_add_f32 v[148:149], v[148:149], v[100:101]
    v_pk_add_f32 v[150:151], v[150:151], v[102:103]
    v_lshlrev_b32 v96, 16, v56
    v_and_b32 v97, s33, v56
    v_lshlrev_b32 v98, 16, v57
    v_and_b32 v99, s33, v57
    v_lshlrev_b32 v100, 16, v58
    v_and_b32 v101, s33, v58
    v_lshlrev_b32 v102, 16, v59
    v_and_b32 v103, s33, v59
    v_pk_add_f32 v[144:145], v[144:145], v[96:97]
    v_pk_add_f32 v[146:147], v[146:147], v[98:99]
    v_pk_add_f32 v[148:149], v[148:149], v[100:101]
    v_pk_add_f32 v[150:151], v[150:151], v[102:103]
    v_lshlrev_b32 v96, 16, v72
    v_and_b32 v97, s33, v72
    v_lshlrev_b32 v98, 16, v73
    v_and_b32 v99, s33, v73
    v_lshlrev_b32 v100, 16, v74
    v_and_b32 v101, s33, v74
    v_lshlrev_b32 v102, 16, v75
    v_and_b32 v103, s33, v75
    v_pk_add_f32 v[144:145], v[144:145], v[96:97]
    v_pk_add_f32 v[146:147], v[146:147], v[98:99]
    v_pk_add_f32 v[148:149], v[148:149], v[100:101]
    v_pk_add_f32 v[150:151], v[150:151], v[102:103]
    v_cvt_pk_bf16_f32 v144, v144, v145
    v_cvt_pk_bf16_f32 v145, v146, v147
    v_cvt_pk_bf16_f32 v146, v148, v149
    v_cvt_pk_bf16_f32 v147, v150, v151
    v_lshlrev_b32 v104, 16, v44
    v_and_b32 v105, s33, v44
    v_lshlrev_b32 v106, 16, v45
    v_and_b32 v107, s33, v45
    v_lshlrev_b32 v108, 16, v46
    v_and_b32 v109, s33, v46
    v_lshlrev_b32 v110, 16, v47
    v_and_b32 v111, s33, v47
    v_pk_add_f32 v[152:153], v[152:153], v[104:105]
    v_pk_add_f32 v[154:155], v[154:155], v[106:107]
    v_pk_add_f32 v[156:157], v[156:157], v[108:109]
    v_pk_add_f32 v[158:159], v[158:159], v[110:111]
    v_lshlrev_b32 v104, 16, v60
    v_and_b32 v105, s33, v60
    v_lshlrev_b32 v106, 16, v61
    v_and_b32 v107, s33, v61
    v_lshlrev_b32 v108, 16, v62
    v_and_b32 v109, s33, v62
    v_lshlrev_b32 v110, 16, v63
    v_and_b32 v111, s33, v63
    v_pk_add_f32 v[152:153], v[152:153], v[104:105]
    v_pk_add_f32 v[154:155], v[154:155], v[106:107]
    v_pk_add_f32 v[156:157], v[156:157], v[108:109]
    v_pk_add_f32 v[158:159], v[158:159], v[110:111]
    v_lshlrev_b32 v104, 16, v76
    v_and_b32 v105, s33, v76
    v_lshlrev_b32 v106, 16, v77
    v_and_b32 v107, s33, v77
    v_lshlrev_b32 v108, 16, v78
    v_and_b32 v109, s33, v78
    v_lshlrev_b32 v110, 16, v79
    v_and_b32 v111, s33, v79
    v_pk_add_f32 v[152:153], v[152:153], v[104:105]
    v_pk_add_f32 v[154:155], v[154:155], v[106:107]
    v_pk_add_f32 v[156:157], v[156:157], v[108:109]
    v_pk_add_f32 v[158:159], v[158:159], v[110:111]
    v_cvt_pk_bf16_f32 v152, v152, v153
    v_cvt_pk_bf16_f32 v153, v154, v155
    v_cvt_pk_bf16_f32 v154, v156, v157
    v_cvt_pk_bf16_f32 v155, v158, v159
    s_waitcnt vmcnt(0)
    v_lshlrev_b32 v96, 16, v192
    v_and_b32 v97, s33, v192
    v_lshlrev_b32 v98, 16, v193
    v_and_b32 v99, s33, v193
    v_lshlrev_b32 v100, 16, v194
    v_and_b32 v101, s33, v194
    v_lshlrev_b32 v102, 16, v195
    v_and_b32 v103, s33, v195
    v_pk_add_f32 v[160:161], v[160:161], v[96:97]
    v_pk_add_f32 v[162:163], v[162:163], v[98:99]
    v_pk_add_f32 v[164:165], v[164:165], v[100:101]
    v_pk_add_f32 v[166:167], v[166:167], v[102:103]
    v_lshlrev_b32 v96, 16, v208
    v_and_b32 v97, s33, v208
    v_lshlrev_b32 v98, 16, v209
    v_and_b32 v99, s33, v209
    v_lshlrev_b32 v100, 16, v210
    v_and_b32 v101, s33, v210
    v_lshlrev_b32 v102, 16, v211
    v_and_b32 v103, s33, v211
    v_pk_add_f32 v[160:161], v[160:161], v[96:97]
    v_pk_add_f32 v[162:163], v[162:163], v[98:99]
    v_pk_add_f32 v[164:165], v[164:165], v[100:101]
    v_pk_add_f32 v[166:167], v[166:167], v[102:103]
    v_lshlrev_b32 v96, 16, v224
    v_and_b32 v97, s33, v224
    v_lshlrev_b32 v98, 16, v225
    v_and_b32 v99, s33, v225
    v_lshlrev_b32 v100, 16, v226
    v_and_b32 v101, s33, v226
    v_lshlrev_b32 v102, 16, v227
    v_and_b32 v103, s33, v227
    v_pk_add_f32 v[160:161], v[160:161], v[96:97]
    v_pk_add_f32 v[162:163], v[162:163], v[98:99]
    v_pk_add_f32 v[164:165], v[164:165], v[100:101]
    v_pk_add_f32 v[166:167], v[166:167], v[102:103]
    v_cvt_pk_bf16_f32 v160, v160, v161
    v_cvt_pk_bf16_f32 v161, v162, v163
    v_cvt_pk_bf16_f32 v162, v164, v165
    v_cvt_pk_bf16_f32 v163, v166, v167
    v_lshlrev_b32 v104, 16, v196
    v_and_b32 v105, s33, v196
    v_lshlrev_b32 v106, 16, v197
    v_and_b32 v107, s33, v197
    v_lshlrev_b32 v108, 16, v198
    v_and_b32 v109, s33, v198
    v_lshlrev_b32 v110, 16, v199
    v_and_b32 v111, s33, v199
    v_pk_add_f32 v[168:169], v[168:169], v[104:105]
    v_pk_add_f32 v[170:171], v[170:171], v[106:107]
    v_pk_add_f32 v[172:173], v[172:173], v[108:109]
    v_pk_add_f32 v[174:175], v[174:175], v[110:111]
    v_lshlrev_b32 v104, 16, v212
    v_and_b32 v105, s33, v212
    v_lshlrev_b32 v106, 16, v213
    v_and_b32 v107, s33, v213
    v_lshlrev_b32 v108, 16, v214
    v_and_b32 v109, s33, v214
    v_lshlrev_b32 v110, 16, v215
    v_and_b32 v111, s33, v215
    v_pk_add_f32 v[168:169], v[168:169], v[104:105]
    v_pk_add_f32 v[170:171], v[170:171], v[106:107]
    v_pk_add_f32 v[172:173], v[172:173], v[108:109]
    v_pk_add_f32 v[174:175], v[174:175], v[110:111]
    v_lshlrev_b32 v104, 16, v228
    v_and_b32 v105, s33, v228
    v_lshlrev_b32 v106, 16, v229
    v_and_b32 v107, s33, v229
    v_lshlrev_b32 v108, 16, v230
    v_and_b32 v109, s33, v230
    v_lshlrev_b32 v110, 16, v231
    v_and_b32 v111, s33, v231
    v_pk_add_f32 v[168:169], v[168:169], v[104:105]
    v_pk_add_f32 v[170:171], v[170:171], v[106:107]
    v_pk_add_f32 v[172:173], v[172:173], v[108:109]
    v_pk_add_f32 v[174:175], v[174:175], v[110:111]
    v_cvt_pk_bf16_f32 v168, v168, v169
    v_cvt_pk_bf16_f32 v169, v170, v171
    v_cvt_pk_bf16_f32 v170, v172, v173
    v_cvt_pk_bf16_f32 v171, v174, v175
    v_lshlrev_b32 v96, 16, v200
    v_and_b32 v97, s33, v200
    v_lshlrev_b32 v98, 16, v201
    v_and_b32 v99, s33, v201
    v_lshlrev_b32 v100, 16, v202
    v_and_b32 v101, s33, v202
    v_lshlrev_b32 v102, 16, v203
    v_and_b32 v103, s33, v203
    v_pk_add_f32 v[176:177], v[176:177], v[96:97]
    v_pk_add_f32 v[178:179], v[178:179], v[98:99]
    v_pk_add_f32 v[180:181], v[180:181], v[100:101]
    v_pk_add_f32 v[182:183], v[182:183], v[102:103]
    v_lshlrev_b32 v96, 16, v216
    v_and_b32 v97, s33, v216
    v_lshlrev_b32 v98, 16, v217
    v_and_b32 v99, s33, v217
    v_lshlrev_b32 v100, 16, v218
    v_and_b32 v101, s33, v218
    v_lshlrev_b32 v102, 16, v219
    v_and_b32 v103, s33, v219
    v_pk_add_f32 v[176:177], v[176:177], v[96:97]
    v_pk_add_f32 v[178:179], v[178:179], v[98:99]
    v_pk_add_f32 v[180:181], v[180:181], v[100:101]
    v_pk_add_f32 v[182:183], v[182:183], v[102:103]
    v_lshlrev_b32 v96, 16, v232
    v_and_b32 v97, s33, v232
    v_lshlrev_b32 v98, 16, v233
    v_and_b32 v99, s33, v233
    v_lshlrev_b32 v100, 16, v234
    v_and_b32 v101, s33, v234
    v_lshlrev_b32 v102, 16, v235
    v_and_b32 v103, s33, v235
    v_pk_add_f32 v[176:177], v[176:177], v[96:97]
    v_pk_add_f32 v[178:179], v[178:179], v[98:99]
    v_pk_add_f32 v[180:181], v[180:181], v[100:101]
    v_pk_add_f32 v[182:183], v[182:183], v[102:103]
    v_cvt_pk_bf16_f32 v176, v176, v177
    v_cvt_pk_bf16_f32 v177, v178, v179
    v_cvt_pk_bf16_f32 v178, v180, v181
    v_cvt_pk_bf16_f32 v179, v182, v183
    v_lshlrev_b32 v104, 16, v204
    v_and_b32 v105, s33, v204
    v_lshlrev_b32 v106, 16, v205
    v_and_b32 v107, s33, v205
    v_lshlrev_b32 v108, 16, v206
    v_and_b32 v109, s33, v206
    v_lshlrev_b32 v110, 16, v207
    v_and_b32 v111, s33, v207
    v_pk_add_f32 v[184:185], v[184:185], v[104:105]
    v_pk_add_f32 v[186:187], v[186:187], v[106:107]
    v_pk_add_f32 v[188:189], v[188:189], v[108:109]
    v_pk_add_f32 v[190:191], v[190:191], v[110:111]
    v_lshlrev_b32 v104, 16, v220
    v_and_b32 v105, s33, v220
    v_lshlrev_b32 v106, 16, v221
    v_and_b32 v107, s33, v221
    v_lshlrev_b32 v108, 16, v222
    v_and_b32 v109, s33, v222
    v_lshlrev_b32 v110, 16, v223
    v_and_b32 v111, s33, v223
    v_pk_add_f32 v[184:185], v[184:185], v[104:105]
    v_pk_add_f32 v[186:187], v[186:187], v[106:107]
    v_pk_add_f32 v[188:189], v[188:189], v[108:109]
    v_pk_add_f32 v[190:191], v[190:191], v[110:111]
    v_lshlrev_b32 v104, 16, v236
    v_and_b32 v105, s33, v236
    v_lshlrev_b32 v106, 16, v237
    v_and_b32 v107, s33, v237
    v_lshlrev_b32 v108, 16, v238
    v_and_b32 v109, s33, v238
    v_lshlrev_b32 v110, 16, v239
    v_and_b32 v111, s33, v239
    v_pk_add_f32 v[184:185], v[184:185], v[104:105]
    v_pk_add_f32 v[186:187], v[186:187], v[106:107]
    v_pk_add_f32 v[188:189], v[188:189], v[108:109]
    v_pk_add_f32 v[190:191], v[190:191], v[110:111]
    v_cvt_pk_bf16_f32 v184, v184, v185
    v_cvt_pk_bf16_f32 v185, v186, v187
    v_cvt_pk_bf16_f32 v186, v188, v189
    v_cvt_pk_bf16_f32 v187, v190, v191
    v_cmp_ne_u32 vcc, 0, v31
    s_cbranch_vccnz L_end
    v_cmp_ne_u32 vcc, -1, v89
    s_cbranch_vccnz L_fb
    s_cmp_lg_u32 s67, 0
    s_cbranch_scc1 tbg_330
    s_add_u32 s30, s80, 0x0
    v_permlane16_swap_b32 v128, v130
    v_permlane16_swap_b32 v129, v131
    buffer_store_dwordx4 v[128:131], v88, s[84:87], s30 offen offset:0
    v_permlane16_swap_b32 v136, v138
    v_permlane16_swap_b32 v137, v139
    buffer_store_dwordx4 v[136:139], v88, s[84:87], s30 offen offset:64
    v_permlane16_swap_b32 v144, v146
    v_permlane16_swap_b32 v145, v147
    buffer_store_dwordx4 v[144:147], v88, s[84:87], s30 offen offset:128
    v_permlane16_swap_b32 v152, v154
    v_permlane16_swap_b32 v153, v155
    buffer_store_dwordx4 v[152:155], v88, s[84:87], s30 offen offset:192
    s_add_u32 s30, s80, 0x8000
    v_permlane16_swap_b32 v160, v162
    v_permlane16_swap_b32 v161, v163
    buffer_store_dwordx4 v[160:163], v88, s[84:87], s30 offen offset:0
    v_permlane16_swap_b32 v168, v170
    v_permlane16_swap_b32 v169, v171
    buffer_store_dwordx4 v[168:171], v88, s[84:87], s30 offen offset:64
    v_permlane16_swap_b32 v176, v178
    v_permlane16_swap_b32 v177, v179
    buffer_store_dwordx4 v[176:179], v88, s[84:87], s30 offen offset:128
    v_permlane16_swap_b32 v184, v186
    v_permlane16_swap_b32 v185, v187
    buffer_store_dwordx4 v[184:187], v88, s[84:87], s30 offen offset:192
    s_branch L_end
tbg_330:
    s_add_u32 s30, s73, 0x6000000
    buffer_store_dwordx4 v[128:131], v26, s[8:11], s30 offen offset:0 sc1
    buffer_store_dwordx4 v[136:139], v26, s[8:11], s30 offen offset:1024 sc1
    buffer_store_dwordx4 v[144:147], v26, s[8:11], s30 offen offset:2048 sc1
    buffer_store_dwordx4 v[152:155], v26, s[8:11], s30 offen offset:3072 sc1
    s_add_u32 s30, s73, 0x6008000
    buffer_store_dwordx4 v[160:163], v26, s[8:11], s30 offen offset:0 sc1
    buffer_store_dwordx4 v[168:171], v26, s[8:11], s30 offen offset:1024 sc1
    buffer_store_dwordx4 v[176:179], v26, s[8:11], s30 offen offset:2048 sc1
    buffer_store_dwordx4 v[184:187], v26, s[8:11], s30 offen offset:3072 sc1
    s_mov_b32 s75, 0x100
    s_waitcnt vmcnt(0)
    s_barrier
    s_cmp_lg_u32 s20, 0
    s_cbranch_scc1 sgg_331
    v_mov_b32 v28, s75
    v_mov_b32 v29, s79
    s_mov_b64 exec, 1
    buffer_atomic_add v28, v29, s[48:51], 0 offen sc1
    s_mov_b64 exec, -1
sgg_331:
    s_branch L_end
L_fb:
    s_mov_b64 exec, -1
    s_waitcnt vmcnt(0) lgkmcnt(0)
    s_load_dwordx2 s[32:33], s[0:1], 104
    s_load_dwordx2 s[34:35], s[0:1], 112
    s_load_dwordx2 s[36:37], s[0:1], 0
    s_load_dwordx2 s[38:39], s[0:1], 96
    s_waitcnt lgkmcnt(0)
    s_mov_b32 s12, s32
    s_mov_b32 s13, s33
    s_mov_b32 s14, 0x100
    s_mov_b32 s15, 0x20000
    s_mov_b32 s8, s34
    s_mov_b32 s9, s35
    s_mov_b32 s10, 0x10000000
    s_mov_b32 s11, 0x20000
    s_mov_b32 s20, s36
    s_mov_b32 s21, s37
    s_mov_b32 s22, 0x400000
    s_mov_b32 s23, 0x20000
    s_mov_b32 s24, s38
    s_mov_b32 s25, s39
    s_mov_b32 s26, 0x400000
    s_mov_b32 s27, 0x20000
    v_mov_b32 v1, 1
    v_mov_b32 v2, 108
    s_mov_b64 exec, 1
    buffer_atomic_add v1, v2, s[12:15], 0 offen sc0 sc1
    s_waitcnt vmcnt(0)
    v_readfirstlane_b32 s56, v1
    s_mov_b64 exec, -1
    s_cmp_eq_u32 s56, 0
    s_cbranch_scc1 fbrun_332
    s_mov_b32 s56, 0
fbw_333:
    buffer_load_dword v1, v2, s[12:15], 0 offen sc1
    s_add_u32 s56, s56, 1
    s_waitcnt vmcnt(0)
    s_cmp_lt_u32 s56, 1024
    s_cbranch_scc1 fbw_333
    s_branch L_end
fbrun_332:
    v_mbcnt_lo_u32_b32 v0, -1, 0
    v_mbcnt_hi_u32_b32 v0, -1, v0
    v_and_b32 v1, 15, v0
    v_lshrrev_b32 v2, 4, v0
    v_lshlrev_b32 v20, 4, v0
    s_mov_b32 s64, 0x05040100
    s_mov_b32 s65, 0x07060302
    s_mov_b32 s66, 0x3e0293ee
    s_mov_b32 s67, 0xffff0000
    v_add_u32 v17, 0, v1
    v_cmp_gt_u32 vcc, 8, v17
    v_min_u32 v17, 39, v17
    s_nop 0
    v_cndmask_b32 v17, v17, 39, vcc
    v_lshlrev_b32 v32, 2, v2
    v_sub_u32 v17, v17, v32
    v_add_u32 v18, 16, v1
    v_cmp_gt_u32 vcc, 8, v18
    v_min_u32 v18, 39, v18
    s_nop 0
    v_cndmask_b32 v18, v18, 39, vcc
    v_lshlrev_b32 v32, 2, v2
    v_sub_u32 v18, v18, v32
    v_add_u32 v19, 32, v1
    v_cmp_gt_u32 vcc, 8, v19
    v_min_u32 v19, 39, v19
    s_nop 0
    v_cndmask_b32 v19, v19, 39, vcc
    v_lshlrev_b32 v32, 2, v2
    v_sub_u32 v19, v19, v32
    v_lshlrev_b32 v21, 15, v2
    v_lshl_add_u32 v21, v1, 4, v21
    v_mov_b32 v32, 0
    v_mov_b32 v33, 0
    v_mov_b32 v34, 0
    v_mov_b32 v35, 0
    s_mov_b32 s56, 0xe014000
    buffer_store_dwordx4 v[32:35], v20, s[8:11], s56 offen
    s_add_u32 s56, s56, 1024
    buffer_store_dwordx4 v[32:35], v20, s[8:11], s56 offen
    s_add_u32 s56, s56, 1024
    buffer_store_dwordx4 v[32:35], v20, s[8:11], s56 offen
    s_add_u32 s56, s56, 1024
    buffer_store_dwordx4 v[32:35], v20, s[8:11], s56 offen
    s_add_u32 s56, s56, 1024
    buffer_store_dwordx4 v[32:35], v20, s[8:11], s56 offen
    s_add_u32 s56, s56, 1024
    buffer_store_dwordx4 v[32:35], v20, s[8:11], s56 offen
    s_add_u32 s56, s56, 1024
    buffer_store_dwordx4 v[32:35], v20, s[8:11], s56 offen
    s_add_u32 s56, s56, 1024
    buffer_store_dwordx4 v[32:35], v20, s[8:11], s56 offen
    s_add_u32 s56, s56, 1024
    buffer_store_dwordx4 v[32:35], v20, s[8:11], s56 offen
    s_add_u32 s56, s56, 1024
    buffer_store_dwordx4 v[32:35], v20, s[8:11], s56 offen
    s_add_u32 s56, s56, 1024
    buffer_store_dwordx4 v[32:35], v20, s[8:11], s56 offen
    s_add_u32 s56, s56, 1024
    buffer_store_dwordx4 v[32:35], v20, s[8:11], s56 offen
    s_add_u32 s56, s56, 1024
    buffer_store_dwordx4 v[32:35], v20, s[8:11], s56 offen
    s_add_u32 s56, s56, 1024
    buffer_store_dwordx4 v[32:35], v20, s[8:11], s56 offen
    s_add_u32 s56, s56, 1024
    buffer_store_dwordx4 v[32:35], v20, s[8:11], s56 offen
    s_add_u32 s56, s56, 1024
    buffer_store_dwordx4 v[32:35], v20, s[8:11], s56 offen
    s_add_u32 s56, s56, 1024
    s_mov_b32 s40, 0
fbseg_334:
    s_mov_b32 s57, 0xe000000
    s_cmp_lg_u32 s40, 0
    s_cbranch_scc1 fbm_335
    s_load_dwordx2 s[32:33], s[0:1], 8
    s_waitcnt lgkmcnt(0)
    s_mov_b32 s28, s32
    s_mov_b32 s29, s33
    s_mov_b32 s30, 0x4000
    s_mov_b32 s31, 0x20000
    s_mov_b32 s56, 0
    buffer_load_dwordx4 v[32:35], v20, s[28:31], s56 offen
    s_add_u32 s56, s56, 1024
    buffer_load_dwordx4 v[36:39], v20, s[28:31], s56 offen
    s_add_u32 s56, s56, 1024
    buffer_load_dwordx4 v[40:43], v20, s[28:31], s56 offen
    s_add_u32 s56, s56, 1024
    buffer_load_dwordx4 v[44:47], v20, s[28:31], s56 offen
    s_add_u32 s56, s56, 1024
    buffer_load_dwordx4 v[48:51], v20, s[28:31], s56 offen
    s_add_u32 s56, s56, 1024
    buffer_load_dwordx4 v[52:55], v20, s[28:31], s56 offen
    s_add_u32 s56, s56, 1024
    buffer_load_dwordx4 v[56:59], v20, s[28:31], s56 offen
    s_add_u32 s56, s56, 1024
    buffer_load_dwordx4 v[60:63], v20, s[28:31], s56 offen
    s_add_u32 s56, s56, 1024
    buffer_load_dwordx4 v[64:67], v20, s[28:31], s56 offen
    s_add_u32 s56, s56, 1024
    buffer_load_dwordx4 v[68:71], v20, s[28:31], s56 offen
    s_add_u32 s56, s56, 1024
    buffer_load_dwordx4 v[72:75], v20, s[28:31], s56 offen
    s_add_u32 s56, s56, 1024
    buffer_load_dwordx4 v[76:79], v20, s[28:31], s56 offen
    s_add_u32 s56, s56, 1024
    buffer_load_dwordx4 v[80:83], v20, s[28:31], s56 offen
    s_add_u32 s56, s56, 1024
    buffer_load_dwordx4 v[84:87], v20, s[28:31], s56 offen
    s_add_u32 s56, s56, 1024
    buffer_load_dwordx4 v[88:91], v20, s[28:31], s56 offen
    s_add_u32 s56, s56, 1024
    buffer_load_dwordx4 v[92:95], v20, s[28:31], s56 offen
    s_add_u32 s56, s56, 1024
    s_waitcnt vmcnt(0)
    buffer_store_dwordx4 v[32:35], v20, s[8:11], s57 offen
    s_add_u32 s57, s57, 1024
    buffer_store_dwordx4 v[36:39], v20, s[8:11], s57 offen
    s_add_u32 s57, s57, 1024
    buffer_store_dwordx4 v[40:43], v20, s[8:11], s57 offen
    s_add_u32 s57, s57, 1024
    buffer_store_dwordx4 v[44:47], v20, s[8:11], s57 offen
    s_add_u32 s57, s57, 1024
    buffer_store_dwordx4 v[48:51], v20, s[8:11], s57 offen
    s_add_u32 s57, s57, 1024
    buffer_store_dwordx4 v[52:55], v20, s[8:11], s57 offen
    s_add_u32 s57, s57, 1024
    buffer_store_dwordx4 v[56:59], v20, s[8:11], s57 offen
    s_add_u32 s57, s57, 1024
    buffer_store_dwordx4 v[60:63], v20, s[8:11], s57 offen
    s_add_u32 s57, s57, 1024
    buffer_store_dwordx4 v[64:67], v20, s[8:11], s57 offen
    s_add_u32 s57, s57, 1024
    buffer_store_dwordx4 v[68:71], v20, s[8:11], s57 offen
    s_add_u32 s57, s57, 1024
    buffer_store_dwordx4 v[72:75], v20, s[8:11], s57 offen
    s_add_u32 s57, s57, 1024
    buffer_store_dwordx4 v[76:79], v20, s[8:11], s57 offen
    s_add_u32 s57, s57, 1024
    buffer_store_dwordx4 v[80:83], v20, s[8:11], s57 offen
    s_add_u32 s57, s57, 1024
    buffer_store_dwordx4 v[84:87], v20, s[8:11], s57 offen
    s_add_u32 s57, s57, 1024
    buffer_store_dwordx4 v[88:91], v20, s[8:11], s57 offen
    s_add_u32 s57, s57, 1024
    buffer_store_dwordx4 v[92:95], v20, s[8:11], s57 offen
    s_add_u32 s57, s57, 1024
    s_waitcnt vmcnt(0)
    s_branch fbx_336
fbm_335:
    s_mov_b32 s56, 0xe380000
    buffer_load_dwordx4 v[32:35], v20, s[8:11], s56 offen
    s_add_u32 s56, s56, 1024
    buffer_load_dwordx4 v[36:39], v20, s[8:11], s56 offen
    s_add_u32 s56, s56, 1024
    buffer_load_dwordx4 v[40:43], v20, s[8:11], s56 offen
    s_add_u32 s56, s56, 1024
    buffer_load_dwordx4 v[44:47], v20, s[8:11], s56 offen
    s_add_u32 s56, s56, 1024
    buffer_load_dwordx4 v[48:51], v20, s[8:11], s56 offen
    s_add_u32 s56, s56, 1024
    buffer_load_dwordx4 v[52:55], v20, s[8:11], s56 offen
    s_add_u32 s56, s56, 1024
    buffer_load_dwordx4 v[56:59], v20, s[8:11], s56 offen
    s_add_u32 s56, s56, 1024
    buffer_load_dwordx4 v[60:63], v20, s[8:11], s56 offen
    s_add_u32 s56, s56, 1024
    buffer_load_dwordx4 v[64:67], v20, s[8:11], s56 offen
    s_add_u32 s56, s56, 1024
    buffer_load_dwordx4 v[68:71], v20, s[8:11], s56 offen
    s_add_u32 s56, s56, 1024
    buffer_load_dwordx4 v[72:75], v20, s[8:11], s56 offen
    s_add_u32 s56, s56, 1024
    buffer_load_dwordx4 v[76:79], v20, s[8:11], s56 offen
    s_add_u32 s56, s56, 1024
    buffer_load_dwordx4 v[80:83], v20, s[8:11], s56 offen
    s_add_u32 s56, s56, 1024
    buffer_load_dwordx4 v[84:87], v20, s[8:11], s56 offen
    s_add_u32 s56, s56, 1024
    buffer_load_dwordx4 v[88:91], v20, s[8:11], s56 offen
    s_add_u32 s56, s56, 1024
    buffer_load_dwordx4 v[92:95], v20, s[8:11], s56 offen
    s_add_u32 s56, s56, 1024
    s_waitcnt vmcnt(0)
    buffer_store_dwordx4 v[32:35], v20, s[8:11], s57 offen
    s_add_u32 s57, s57, 1024
    buffer_store_dwordx4 v[36:39], v20, s[8:11], s57 offen
    s_add_u32 s57, s57, 1024
    buffer_store_dwordx4 v[40:43], v20, s[8:11], s57 offen
    s_add_u32 s57, s57, 1024
    buffer_store_dwordx4 v[44:47], v20, s[8:11], s57 offen
    s_add_u32 s57, s57, 1024
    buffer_store_dwordx4 v[48:51], v20, s[8:11], s57 offen
    s_add_u32 s57, s57, 1024
    buffer_store_dwordx4 v[52:55], v20, s[8:11], s57 offen
    s_add_u32 s57, s57, 1024
    buffer_store_dwordx4 v[56:59], v20, s[8:11], s57 offen
    s_add_u32 s57, s57, 1024
    buffer_store_dwordx4 v[60:63], v20, s[8:11], s57 offen
    s_add_u32 s57, s57, 1024
    buffer_store_dwordx4 v[64:67], v20, s[8:11], s57 offen
    s_add_u32 s57, s57, 1024
    buffer_store_dwordx4 v[68:71], v20, s[8:11], s57 offen
    s_add_u32 s57, s57, 1024
    buffer_store_dwordx4 v[72:75], v20, s[8:11], s57 offen
    s_add_u32 s57, s57, 1024
    buffer_store_dwordx4 v[76:79], v20, s[8:11], s57 offen
    s_add_u32 s57, s57, 1024
    buffer_store_dwordx4 v[80:83], v20, s[8:11], s57 offen
    s_add_u32 s57, s57, 1024
    buffer_store_dwordx4 v[84:87], v20, s[8:11], s57 offen
    s_add_u32 s57, s57, 1024
    buffer_store_dwordx4 v[88:91], v20, s[8:11], s57 offen
    s_add_u32 s57, s57, 1024
    buffer_store_dwordx4 v[92:95], v20, s[8:11], s57 offen
    s_add_u32 s57, s57, 1024
    s_waitcnt vmcnt(0)
fbx_336:
    s_lshl_b32 s56, s40, 16
    s_mov_b32 s45, 0
fbc_337:
    buffer_load_dwordx4 v[32:35], v20, s[20:23], s56 offen
    s_add_u32 s56, s56, 1024
    buffer_load_dwordx4 v[36:39], v20, s[20:23], s56 offen
    s_add_u32 s56, s56, 1024
    buffer_load_dwordx4 v[40:43], v20, s[20:23], s56 offen
    s_add_u32 s56, s56, 1024
    buffer_load_dwordx4 v[44:47], v20, s[20:23], s56 offen
    s_add_u32 s56, s56, 1024
    buffer_load_dwordx4 v[48:51], v20, s[20:23], s56 offen
    s_add_u32 s56, s56, 1024
    buffer_load_dwordx4 v[52:55], v20, s[20:23], s56 offen
    s_add_u32 s56, s56, 1024
    buffer_load_dwordx4 v[56:59], v20, s[20:23], s56 offen
    s_add_u32 s56, s56, 1024
    buffer_load_dwordx4 v[60:63], v20, s[20:23], s56 offen
    s_add_u32 s56, s56, 1024
    buffer_load_dwordx4 v[64:67], v20, s[20:23], s56 offen
    s_add_u32 s56, s56, 1024
    buffer_load_dwordx4 v[68:71], v20, s[20:23], s56 offen
    s_add_u32 s56, s56, 1024
    buffer_load_dwordx4 v[72:75], v20, s[20:23], s56 offen
    s_add_u32 s56, s56, 1024
    buffer_load_dwordx4 v[76:79], v20, s[20:23], s56 offen
    s_add_u32 s56, s56, 1024
    buffer_load_dwordx4 v[80:83], v20, s[20:23], s56 offen
    s_add_u32 s56, s56, 1024
    buffer_load_dwordx4 v[84:87], v20, s[20:23], s56 offen
    s_add_u32 s56, s56, 1024
    buffer_load_dwordx4 v[88:91], v20, s[20:23], s56 offen
    s_add_u32 s56, s56, 1024
    buffer_load_dwordx4 v[92:95], v20, s[20:23], s56 offen
    s_add_u32 s56, s56, 1024
    s_waitcnt vmcnt(0)
    buffer_store_dwordx4 v[32:35], v20, s[8:11], s57 offen
    s_add_u32 s57, s57, 1024
    buffer_store_dwordx4 v[36:39], v20, s[8:11], s57 offen
    s_add_u32 s57, s57, 1024
    buffer_store_dwordx4 v[40:43], v20, s[8:11], s57 offen
    s_add_u32 s57, s57, 1024
    buffer_store_dwordx4 v[44:47], v20, s[8:11], s57 offen
    s_add_u32 s57, s57, 1024
    buffer_store_dwordx4 v[48:51], v20, s[8:11], s57 offen
    s_add_u32 s57, s57, 1024
    buffer_store_dwordx4 v[52:55], v20, s[8:11], s57 offen
    s_add_u32 s57, s57, 1024
    buffer_store_dwordx4 v[56:59], v20, s[8:11], s57 offen
    s_add_u32 s57, s57, 1024
    buffer_store_dwordx4 v[60:63], v20, s[8:11], s57 offen
    s_add_u32 s57, s57, 1024
    buffer_store_dwordx4 v[64:67], v20, s[8:11], s57 offen
    s_add_u32 s57, s57, 1024
    buffer_store_dwordx4 v[68:71], v20, s[8:11], s57 offen
    s_add_u32 s57, s57, 1024
    buffer_store_dwordx4 v[72:75], v20, s[8:11], s57 offen
    s_add_u32 s57, s57, 1024
    buffer_store_dwordx4 v[76:79], v20, s[8:11], s57 offen
    s_add_u32 s57, s57, 1024
    buffer_store_dwordx4 v[80:83], v20, s[8:11], s57 offen
    s_add_u32 s57, s57, 1024
    buffer_store_dwordx4 v[84:87], v20, s[8:11], s57 offen
    s_add_u32 s57, s57, 1024
    buffer_store_dwordx4 v[88:91], v20, s[8:11], s57 offen
    s_add_u32 s57, s57, 1024
    buffer_store_dwordx4 v[92:95], v20, s[8:11], s57 offen
    s_add_u32 s57, s57, 1024
    s_waitcnt vmcnt(0)
    s_add_u32 s45, s45, 1
    s_cmp_lt_u32 s45, 4
    s_cbranch_scc1 fbc_337
    s_mov_b32 s41, 0
fbjob_338:
    s_cmp_lg_u32 s41, 0
    s_cbranch_scc1 fbn_346
    s_load_dwordx2 s[32:33], s[0:1], 16
    s_waitcnt lgkmcnt(0)
    s_mov_b32 s16, s32
    s_mov_b32 s17, s33
    s_mov_b32 s18, 0x800000
    s_mov_b32 s19, 0x20000
    s_mov_b32 s46, 0xe000000
    s_mov_b32 s51, 0x800
    s_mov_b32 s52, 0x2000
    s_mov_b32 s53, 0x2000
    s_mov_b32 s49, 0x40000
    s_mov_b32 s44, 0x7
    s_mov_b32 s43, 0x20
    s_mov_b32 s50, 0xe080000
    s_branch fbgo_339
fbn_346:
    s_cmp_lg_u32 s41, 1
    s_cbranch_scc1 fbn_347
    s_load_dwordx2 s[32:33], s[0:1], 24
    s_waitcnt lgkmcnt(0)
    s_mov_b32 s16, s32
    s_mov_b32 s17, s33
    s_mov_b32 s18, 0x800000
    s_mov_b32 s19, 0x20000
    s_mov_b32 s46, 0xe000000
    s_mov_b32 s51, 0x800
    s_mov_b32 s52, 0x2000
    s_mov_b32 s53, 0x2000
    s_mov_b32 s49, 0x40000
    s_mov_b32 s44, 0x7
    s_mov_b32 s43, 0x20
    s_mov_b32 s50, 0xe100000
    s_branch fbgo_339
fbn_347:
    s_cmp_lg_u32 s41, 2
    s_cbranch_scc1 fbn_348
    s_load_dwordx2 s[32:33], s[0:1], 32
    s_waitcnt lgkmcnt(0)
    s_mov_b32 s16, s32
    s_mov_b32 s17, s33
    s_mov_b32 s18, 0x800000
    s_mov_b32 s19, 0x20000
    s_mov_b32 s46, 0xe000000
    s_mov_b32 s51, 0x800
    s_mov_b32 s52, 0x2000
    s_mov_b32 s53, 0x2000
    s_mov_b32 s49, 0x40000
    s_mov_b32 s44, 0x7
    s_mov_b32 s43, 0x20
    s_mov_b32 s50, 0xe180000
    s_branch fbgo_339
fbn_348:
    s_cmp_lg_u32 s41, 3
    s_cbranch_scc1 fbn_349
    s_load_dwordx2 s[32:33], s[0:1], 64
    s_waitcnt lgkmcnt(0)
    s_mov_b32 s16, s32
    s_mov_b32 s17, s33
    s_mov_b32 s18, 0x700000
    s_mov_b32 s19, 0x20000
    s_mov_b32 s46, 0xe000000
    s_mov_b32 s51, 0x800
    s_mov_b32 s52, 0x1c00
    s_mov_b32 s53, 0x1c00
    s_mov_b32 s49, 0x38000
    s_mov_b32 s44, 0x7
    s_mov_b32 s43, 0x1c
    s_mov_b32 s50, 0xe280000
    s_branch fbgo_339
fbn_349:
    s_cmp_lg_u32 s41, 4
    s_cbranch_scc1 fbn_350
    s_load_dwordx2 s[32:33], s[0:1], 72
    s_waitcnt lgkmcnt(0)
    s_mov_b32 s16, s32
    s_mov_b32 s17, s33
    s_mov_b32 s18, 0x700000
    s_mov_b32 s19, 0x20000
    s_mov_b32 s46, 0xe000000
    s_mov_b32 s51, 0x800
    s_mov_b32 s52, 0x1c00
    s_mov_b32 s53, 0x1c00
    s_mov_b32 s49, 0x38000
    s_mov_b32 s44, 0x7
    s_mov_b32 s43, 0x1c
    s_mov_b32 s50, 0xe300000
    s_branch fbgo_339
fbn_350:
    s_cmp_lg_u32 s41, 5
    s_cbranch_scc1 fbn_351
    s_load_dwordx2 s[32:33], s[0:1], 40
    s_waitcnt lgkmcnt(0)
    s_mov_b32 s16, s32
    s_mov_b32 s17, s33
    s_mov_b32 s18, 0x800000
    s_mov_b32 s19, 0x20000
    s_mov_b32 s46, 0xe200000
    s_mov_b32 s51, 0x2000
    s_mov_b32 s52, 0x800
    s_mov_b32 s53, 0x800
    s_mov_b32 s49, 0x10000
    s_mov_b32 s44, 0x1f
    s_mov_b32 s43, 0x8
    s_mov_b32 s50, 0xe380000
    s_branch fbgo_339
fbn_351:
    s_load_dwordx2 s[32:33], s[0:1], 80
    s_waitcnt lgkmcnt(0)
    s_mov_b32 s16, s32
    s_mov_b32 s17, s33
    s_mov_b32 s18, 0x700000
    s_mov_b32 s19, 0x20000
    s_mov_b32 s46, 0xe280000
    s_mov_b32 s51, 0x1c00
    s_mov_b32 s52, 0x800
    s_mov_b32 s53, 0x800
    s_mov_b32 s49, 0x10000
    s_mov_b32 s44, 0x1b
    s_mov_b32 s43, 0x8
    s_mov_b32 s50, 0xe400000
fbgo_339:
    v_mul_u32_u24 v4, 1, v1
    v_add_u32 v4, 0, v4
    v_mul_lo_u32 v4, v4, s51
    v_lshl_add_u32 v4, v2, 4, v4
    v_mul_u32_u24 v5, 1, v1
    v_add_u32 v5, 16, v5
    v_mul_lo_u32 v5, v5, s51
    v_lshl_add_u32 v5, v2, 4, v5
    v_mul_u32_u24 v6, 1, v1
    v_add_u32 v6, 32, v6
    v_mul_lo_u32 v6, v6, s51
    v_lshl_add_u32 v6, v2, 4, v6
    v_mul_u32_u24 v8, 8, v2
    v_add_u32 v8, 0, v8
    v_mul_lo_u32 v8, v8, s52
    v_lshl_add_u32 v8, v1, 4, v8
    v_mul_u32_u24 v9, 8, v2
    v_add_u32 v9, 1, v9
    v_mul_lo_u32 v9, v9, s52
    v_lshl_add_u32 v9, v1, 4, v9
    v_mul_u32_u24 v10, 8, v2
    v_add_u32 v10, 2, v10
    v_mul_lo_u32 v10, v10, s52
    v_lshl_add_u32 v10, v1, 4, v10
    v_mul_u32_u24 v11, 8, v2
    v_add_u32 v11, 3, v11
    v_mul_lo_u32 v11, v11, s52
    v_lshl_add_u32 v11, v1, 4, v11
    v_mul_u32_u24 v12, 8, v2
    v_add_u32 v12, 4, v12
    v_mul_lo_u32 v12, v12, s52
    v_lshl_add_u32 v12, v1, 4, v12
    v_mul_u32_u24 v13, 8, v2
    v_add_u32 v13, 5, v13
    v_mul_lo_u32 v13, v13, s52
    v_lshl_add_u32 v13, v1, 4, v13
    v_mul_u32_u24 v14, 8, v2
    v_add_u32 v14, 6, v14
    v_mul_lo_u32 v14, v14, s52
    v_lshl_add_u32 v14, v1, 4, v14
    v_mul_u32_u24 v15, 8, v2
    v_add_u32 v15, 7, v15
    v_mul_lo_u32 v15, v15, s52
    v_lshl_add_u32 v15, v1, 4, v15
    v_mul_u32_u24 v16, 4, v2
    v_add_u32 v16, 0, v16
    v_mul_lo_u32 v16, v16, s53
    v_lshl_add_u32 v16, v1, 4, v16
    s_mov_b32 s42, 0
fbblk_340:
    v_accvgpr_write_b32 a0, 0
    v_accvgpr_write_b32 a1, 0
    v_accvgpr_write_b32 a2, 0
    v_accvgpr_write_b32 a3, 0
    v_accvgpr_write_b32 a4, 0
    v_accvgpr_write_b32 a5, 0
    v_accvgpr_write_b32 a6, 0
    v_accvgpr_write_b32 a7, 0
    v_accvgpr_write_b32 a8, 0
    v_accvgpr_write_b32 a9, 0
    v_accvgpr_write_b32 a10, 0
    v_accvgpr_write_b32 a11, 0
    v_accvgpr_write_b32 a12, 0
    v_accvgpr_write_b32 a13, 0
    v_accvgpr_write_b32 a14, 0
    v_accvgpr_write_b32 a15, 0
    v_accvgpr_write_b32 a16, 0
    v_accvgpr_write_b32 a17, 0
    v_accvgpr_write_b32 a18, 0
    v_accvgpr_write_b32 a19, 0
    v_accvgpr_write_b32 a20, 0
    v_accvgpr_write_b32 a21, 0
    v_accvgpr_write_b32 a22, 0
    v_accvgpr_write_b32 a23, 0
    v_accvgpr_write_b32 a24, 0
    v_accvgpr_write_b32 a25, 0
    v_accvgpr_write_b32 a26, 0
    v_accvgpr_write_b32 a27, 0
    v_accvgpr_write_b32 a28, 0
    v_accvgpr_write_b32 a29, 0
    v_accvgpr_write_b32 a30, 0
    v_accvgpr_write_b32 a31, 0
    v_accvgpr_write_b32 a32, 0
    v_accvgpr_write_b32 a33, 0
    v_accvgpr_write_b32 a34, 0
    v_accvgpr_write_b32 a35, 0
    v_accvgpr_write_b32 a36, 0
    v_accvgpr_write_b32 a37, 0
    v_accvgpr_write_b32 a38, 0
    v_accvgpr_write_b32 a39, 0
    v_accvgpr_write_b32 a40, 0
    v_accvgpr_write_b32 a41, 0
    v_accvgpr_write_b32 a42, 0
    v_accvgpr_write_b32 a43, 0
    v_accvgpr_write_b32 a44, 0
    v_accvgpr_write_b32 a45, 0
    v_accvgpr_write_b32 a46, 0
    v_accvgpr_write_b32 a47, 0
    v_accvgpr_write_b32 a48, 0
    v_accvgpr_write_b32 a49, 0
    v_accvgpr_write_b32 a50, 0
    v_accvgpr_write_b32 a51, 0
    v_accvgpr_write_b32 a52, 0
    v_accvgpr_write_b32 a53, 0
    v_accvgpr_write_b32 a54, 0
    v_accvgpr_write_b32 a55, 0
    v_accvgpr_write_b32 a56, 0
    v_accvgpr_write_b32 a57, 0
    v_accvgpr_write_b32 a58, 0
    v_accvgpr_write_b32 a59, 0
    v_accvgpr_write_b32 a60, 0
    v_accvgpr_write_b32 a61, 0
    v_accvgpr_write_b32 a62, 0
    v_accvgpr_write_b32 a63, 0
    v_accvgpr_write_b32 a64, 0
    v_accvgpr_write_b32 a65, 0
    v_accvgpr_write_b32 a66, 0
    v_accvgpr_write_b32 a67, 0
    v_accvgpr_write_b32 a68, 0
    v_accvgpr_write_b32 a69, 0
    v_accvgpr_write_b32 a70, 0
    v_accvgpr_write_b32 a71, 0
    v_accvgpr_write_b32 a72, 0
    v_accvgpr_write_b32 a73, 0
    v_accvgpr_write_b32 a74, 0
    v_accvgpr_write_b32 a75, 0
    v_accvgpr_write_b32 a76, 0
    v_accvgpr_write_b32 a77, 0
    v_accvgpr_write_b32 a78, 0
    v_accvgpr_write_b32 a79, 0
    v_accvgpr_write_b32 a80, 0
    v_accvgpr_write_b32 a81, 0
    v_accvgpr_write_b32 a82, 0
    v_accvgpr_write_b32 a83, 0
    v_accvgpr_write_b32 a84, 0
    v_accvgpr_write_b32 a85, 0
    v_accvgpr_write_b32 a86, 0
    v_accvgpr_write_b32 a87, 0
    v_accvgpr_write_b32 a88, 0
    v_accvgpr_write_b32 a89, 0
    v_accvgpr_write_b32 a90, 0
    v_accvgpr_write_b32 a91, 0
    v_accvgpr_write_b32 a92, 0
    v_accvgpr_write_b32 a93, 0
    v_accvgpr_write_b32 a94, 0
    v_accvgpr_write_b32 a95, 0
    s_mov_b32 s47, s46
    s_lshl_b32 s48, s42, 8
    buffer_load_dwordx4 v[32:35], v8, s[16:19], s48 offen
    buffer_load_dwordx4 v[36:39], v9, s[16:19], s48 offen
    buffer_load_dwordx4 v[40:43], v10, s[16:19], s48 offen
    buffer_load_dwordx4 v[44:47], v11, s[16:19], s48 offen
    buffer_load_dwordx4 v[48:51], v12, s[16:19], s48 offen
    buffer_load_dwordx4 v[52:55], v13, s[16:19], s48 offen
    buffer_load_dwordx4 v[56:59], v14, s[16:19], s48 offen
    buffer_load_dwordx4 v[60:63], v15, s[16:19], s48 offen
    buffer_load_dwordx4 v[64:67], v4, s[8:11], s47 offen
    buffer_load_dwordx4 v[68:71], v5, s[8:11], s47 offen
    buffer_load_dwordx4 v[72:75], v6, s[8:11], s47 offen
    s_add_u32 s48, s48, s49
    s_add_u32 s47, s47, 64
    buffer_load_dwordx4 v[76:79], v8, s[16:19], s48 offen
    buffer_load_dwordx4 v[80:83], v9, s[16:19], s48 offen
    buffer_load_dwordx4 v[84:87], v10, s[16:19], s48 offen
    buffer_load_dwordx4 v[88:91], v11, s[16:19], s48 offen
    buffer_load_dwordx4 v[92:95], v12, s[16:19], s48 offen
    buffer_load_dwordx4 v[96:99], v13, s[16:19], s48 offen
    buffer_load_dwordx4 v[100:103], v14, s[16:19], s48 offen
    buffer_load_dwordx4 v[104:107], v15, s[16:19], s48 offen
    buffer_load_dwordx4 v[108:111], v4, s[8:11], s47 offen
    buffer_load_dwordx4 v[112:115], v5, s[8:11], s47 offen
    buffer_load_dwordx4 v[116:119], v6, s[8:11], s47 offen
    s_add_u32 s48, s48, s49
    s_add_u32 s47, s47, 64
    buffer_load_dwordx4 v[120:123], v8, s[16:19], s48 offen
    buffer_load_dwordx4 v[124:127], v9, s[16:19], s48 offen
    buffer_load_dwordx4 v[128:131], v10, s[16:19], s48 offen
    buffer_load_dwordx4 v[132:135], v11, s[16:19], s48 offen
    buffer_load_dwordx4 v[136:139], v12, s[16:19], s48 offen
    buffer_load_dwordx4 v[140:143], v13, s[16:19], s48 offen
    buffer_load_dwordx4 v[144:147], v14, s[16:19], s48 offen
    buffer_load_dwordx4 v[148:151], v15, s[16:19], s48 offen
    buffer_load_dwordx4 v[152:155], v4, s[8:11], s47 offen
    buffer_load_dwordx4 v[156:159], v5, s[8:11], s47 offen
    buffer_load_dwordx4 v[160:163], v6, s[8:11], s47 offen
    s_add_u32 s48, s48, s49
    s_add_u32 s47, s47, 64
    buffer_load_dwordx4 v[164:167], v8, s[16:19], s48 offen
    buffer_load_dwordx4 v[168:171], v9, s[16:19], s48 offen
    buffer_load_dwordx4 v[172:175], v10, s[16:19], s48 offen
    buffer_load_dwordx4 v[176:179], v11, s[16:19], s48 offen
    buffer_load_dwordx4 v[180:183], v12, s[16:19], s48 offen
    buffer_load_dwordx4 v[184:187], v13, s[16:19], s48 offen
    buffer_load_dwordx4 v[188:191], v14, s[16:19], s48 offen
    buffer_load_dwordx4 v[192:195], v15, s[16:19], s48 offen
    buffer_load_dwordx4 v[196:199], v4, s[8:11], s47 offen
    buffer_load_dwordx4 v[200:203], v5, s[8:11], s47 offen
    buffer_load_dwordx4 v[204:207], v6, s[8:11], s47 offen
    s_add_u32 s48, s48, s49
    s_add_u32 s47, s47, 64
    s_mov_b32 s45, 0
fbk_341:
    s_waitcnt vmcnt(33)
    v_perm_b32 v240, v36, v32, s64
    v_perm_b32 v241, v44, v40, s64
    v_perm_b32 v242, v52, v48, s64
    v_perm_b32 v243, v60, v56, s64
    s_nop 1
    v_mfma_f32_16x16x32_bf16 a[0:3], v[64:67], v[240:243], a[0:3]
    v_mfma_f32_16x16x32_bf16 a[4:7], v[68:71], v[240:243], a[4:7]
    v_mfma_f32_16x16x32_bf16 a[8:11], v[72:75], v[240:243], a[8:11]
    v_perm_b32 v244, v36, v32, s65
    v_perm_b32 v245, v44, v40, s65
    v_perm_b32 v246, v52, v48, s65
    v_perm_b32 v247, v60, v56, s65
    s_nop 1
    v_mfma_f32_16x16x32_bf16 a[12:15], v[64:67], v[244:247], a[12:15]
    v_mfma_f32_16x16x32_bf16 a[16:19], v[68:71], v[244:247], a[16:19]
    v_mfma_f32_16x16x32_bf16 a[20:23], v[72:75], v[244:247], a[20:23]
    v_perm_b32 v240, v37, v33, s64
    v_perm_b32 v241, v45, v41, s64
    v_perm_b32 v242, v53, v49, s64
    v_perm_b32 v243, v61, v57, s64
    s_nop 1
    v_mfma_f32_16x16x32_bf16 a[24:27], v[64:67], v[240:243], a[24:27]
    v_mfma_f32_16x16x32_bf16 a[28:31], v[68:71], v[240:243], a[28:31]
    v_mfma_f32_16x16x32_bf16 a[32:35], v[72:75], v[240:243], a[32:35]
    v_perm_b32 v244, v37, v33, s65
    v_perm_b32 v245, v45, v41, s65
    v_perm_b32 v246, v53, v49, s65
    v_perm_b32 v247, v61, v57, s65
    s_nop 1
    v_mfma_f32_16x16x32_bf16 a[36:39], v[64:67], v[244:247], a[36:39]
    v_mfma_f32_16x16x32_bf16 a[40:43], v[68:71], v[244:247], a[40:43]
    v_mfma_f32_16x16x32_bf16 a[44:47], v[72:75], v[244:247], a[44:47]
    v_perm_b32 v240, v38, v34, s64
    v_perm_b32 v241, v46, v42, s64
    v_perm_b32 v242, v54, v50, s64
    v_perm_b32 v243, v62, v58, s64
    s_nop 1
    v_mfma_f32_16x16x32_bf16 a[48:51], v[64:67], v[240:243], a[48:51]
    v_mfma_f32_16x16x32_bf16 a[52:55], v[68:71], v[240:243], a[52:55]
    v_mfma_f32_16x16x32_bf16 a[56:59], v[72:75], v[240:243], a[56:59]
    v_perm_b32 v244, v38, v34, s65
    v_perm_b32 v245, v46, v42, s65
    v_perm_b32 v246, v54, v50, s65
    v_perm_b32 v247, v62, v58, s65
    s_nop 1
    v_mfma_f32_16x16x32_bf16 a[60:63], v[64:67], v[244:247], a[60:63]
    v_mfma_f32_16x16x32_bf16 a[64:67], v[68:71], v[244:247], a[64:67]
    v_mfma_f32_16x16x32_bf16 a[68:71], v[72:75], v[244:247], a[68:71]
    v_perm_b32 v240, v39, v35, s64
    v_perm_b32 v241, v47, v43, s64
    v_perm_b32 v242, v55, v51, s64
    v_perm_b32 v243, v63, v59, s64
    s_nop 1
    v_mfma_f32_16x16x32_bf16 a[72:75], v[64:67], v[240:243], a[72:75]
    v_mfma_f32_16x16x32_bf16 a[76:79], v[68:71], v[240:243], a[76:79]
    v_mfma_f32_16x16x32_bf16 a[80:83], v[72:75], v[240:243], a[80:83]
    v_perm_b32 v244, v39, v35, s65
    v_perm_b32 v245, v47, v43, s65
    v_perm_b32 v246, v55, v51, s65
    v_perm_b32 v247, v63, v59, s65
    s_nop 1
    v_mfma_f32_16x16x32_bf16 a[84:87], v[64:67], v[244:247], a[84:87]
    v_mfma_f32_16x16x32_bf16 a[88:91], v[68:71], v[244:247], a[88:91]
    v_mfma_f32_16x16x32_bf16 a[92:95], v[72:75], v[244:247], a[92:95]
    buffer_load_dwordx4 v[32:35], v8, s[16:19], s48 offen
    buffer_load_dwordx4 v[36:39], v9, s[16:19], s48 offen
    buffer_load_dwordx4 v[40:43], v10, s[16:19], s48 offen
    buffer_load_dwordx4 v[44:47], v11, s[16:19], s48 offen
    buffer_load_dwordx4 v[48:51], v12, s[16:19], s48 offen
    buffer_load_dwordx4 v[52:55], v13, s[16:19], s48 offen
    buffer_load_dwordx4 v[56:59], v14, s[16:19], s48 offen
    buffer_load_dwordx4 v[60:63], v15, s[16:19], s48 offen
    buffer_load_dwordx4 v[64:67], v4, s[8:11], s47 offen
    buffer_load_dwordx4 v[68:71], v5, s[8:11], s47 offen
    buffer_load_dwordx4 v[72:75], v6, s[8:11], s47 offen
    s_add_u32 s48, s48, s49
    s_add_u32 s47, s47, 64
    s_waitcnt vmcnt(33)
    v_perm_b32 v240, v80, v76, s64
    v_perm_b32 v241, v88, v84, s64
    v_perm_b32 v242, v96, v92, s64
    v_perm_b32 v243, v104, v100, s64
    s_nop 1
    v_mfma_f32_16x16x32_bf16 a[0:3], v[108:111], v[240:243], a[0:3]
    v_mfma_f32_16x16x32_bf16 a[4:7], v[112:115], v[240:243], a[4:7]
    v_mfma_f32_16x16x32_bf16 a[8:11], v[116:119], v[240:243], a[8:11]
    v_perm_b32 v244, v80, v76, s65
    v_perm_b32 v245, v88, v84, s65
    v_perm_b32 v246, v96, v92, s65
    v_perm_b32 v247, v104, v100, s65
    s_nop 1
    v_mfma_f32_16x16x32_bf16 a[12:15], v[108:111], v[244:247], a[12:15]
    v_mfma_f32_16x16x32_bf16 a[16:19], v[112:115], v[244:247], a[16:19]
    v_mfma_f32_16x16x32_bf16 a[20:23], v[116:119], v[244:247], a[20:23]
    v_perm_b32 v240, v81, v77, s64
    v_perm_b32 v241, v89, v85, s64
    v_perm_b32 v242, v97, v93, s64
    v_perm_b32 v243, v105, v101, s64
    s_nop 1
    v_mfma_f32_16x16x32_bf16 a[24:27], v[108:111], v[240:243], a[24:27]
    v_mfma_f32_16x16x32_bf16 a[28:31], v[112:115], v[240:243], a[28:31]
    v_mfma_f32_16x16x32_bf16 a[32:35], v[116:119], v[240:243], a[32:35]
    v_perm_b32 v244, v81, v77, s65
    v_perm_b32 v245, v89, v85, s65
    v_perm_b32 v246, v97, v93, s65
    v_perm_b32 v247, v105, v101, s65
    s_nop 1
    v_mfma_f32_16x16x32_bf16 a[36:39], v[108:111], v[244:247], a[36:39]
    v_mfma_f32_16x16x32_bf16 a[40:43], v[112:115], v[244:247], a[40:43]
    v_mfma_f32_16x16x32_bf16 a[44:47], v[116:119], v[244:247], a[44:47]
    v_perm_b32 v240, v82, v78, s64
    v_perm_b32 v241, v90, v86, s64
    v_perm_b32 v242, v98, v94, s64
    v_perm_b32 v243, v106, v102, s64
    s_nop 1
    v_mfma_f32_16x16x32_bf16 a[48:51], v[108:111], v[240:243], a[48:51]
    v_mfma_f32_16x16x32_bf16 a[52:55], v[112:115], v[240:243], a[52:55]
    v_mfma_f32_16x16x32_bf16 a[56:59], v[116:119], v[240:243], a[56:59]
    v_perm_b32 v244, v82, v78, s65
    v_perm_b32 v245, v90, v86, s65
    v_perm_b32 v246, v98, v94, s65
    v_perm_b32 v247, v106, v102, s65
    s_nop 1
    v_mfma_f32_16x16x32_bf16 a[60:63], v[108:111], v[244:247], a[60:63]
    v_mfma_f32_16x16x32_bf16 a[64:67], v[112:115], v[244:247], a[64:67]
    v_mfma_f32_16x16x32_bf16 a[68:71], v[116:119], v[244:247], a[68:71]
    v_perm_b32 v240, v83, v79, s64
    v_perm_b32 v241, v91, v87, s64
    v_perm_b32 v242, v99, v95, s64
    v_perm_b32 v243, v107, v103, s64
    s_nop 1
    v_mfma_f32_16x16x32_bf16 a[72:75], v[108:111], v[240:243], a[72:75]
    v_mfma_f32_16x16x32_bf16 a[76:79], v[112:115], v[240:243], a[76:79]
    v_mfma_f32_16x16x32_bf16 a[80:83], v[116:119], v[240:243], a[80:83]
    v_perm_b32 v244, v83, v79, s65
    v_perm_b32 v245, v91, v87, s65
    v_perm_b32 v246, v99, v95, s65
    v_perm_b32 v247, v107, v103, s65
    s_nop 1
    v_mfma_f32_16x16x32_bf16 a[84:87], v[108:111], v[244:247], a[84:87]
    v_mfma_f32_16x16x32_bf16 a[88:91], v[112:115], v[244:247], a[88:91]
    v_mfma_f32_16x16x32_bf16 a[92:95], v[116:119], v[244:247], a[92:95]
    buffer_load_dwordx4 v[76:79], v8, s[16:19], s48 offen
    buffer_load_dwordx4 v[80:83], v9, s[16:19], s48 offen
    buffer_load_dwordx4 v[84:87], v10, s[16:19], s48 offen
    buffer_load_dwordx4 v[88:91], v11, s[16:19], s48 offen
    buffer_load_dwordx4 v[92:95], v12, s[16:19], s48 offen
    buffer_load_dwordx4 v[96:99], v13, s[16:19], s48 offen
    buffer_load_dwordx4 v[100:103], v14, s[16:19], s48 offen
    buffer_load_dwordx4 v[104:107], v15, s[16:19], s48 offen
    buffer_load_dwordx4 v[108:111], v4, s[8:11], s47 offen
    buffer_load_dwordx4 v[112:115], v5, s[8:11], s47 offen
    buffer_load_dwordx4 v[116:119], v6, s[8:11], s47 offen
    s_add_u32 s48, s48, s49
    s_add_u32 s47, s47, 64
    s_waitcnt vmcnt(33)
    v_perm_b32 v240, v124, v120, s64
    v_perm_b32 v241, v132, v128, s64
    v_perm_b32 v242, v140, v136, s64
    v_perm_b32 v243, v148, v144, s64
    s_nop 1
    v_mfma_f32_16x16x32_bf16 a[0:3], v[152:155], v[240:243], a[0:3]
    v_mfma_f32_16x16x32_bf16 a[4:7], v[156:159], v[240:243], a[4:7]
    v_mfma_f32_16x16x32_bf16 a[8:11], v[160:163], v[240:243], a[8:11]
    v_perm_b32 v244, v124, v120, s65
    v_perm_b32 v245, v132, v128, s65
    v_perm_b32 v246, v140, v136, s65
    v_perm_b32 v247, v148, v144, s65
    s_nop 1
    v_mfma_f32_16x16x32_bf16 a[12:15], v[152:155], v[244:247], a[12:15]
    v_mfma_f32_16x16x32_bf16 a[16:19], v[156:159], v[244:247], a[16:19]
    v_mfma_f32_16x16x32_bf16 a[20:23], v[160:163], v[244:247], a[20:23]
    v_perm_b32 v240, v125, v121, s64
    v_perm_b32 v241, v133, v129, s64
    v_perm_b32 v242, v141, v137, s64
    v_perm_b32 v243, v149, v145, s64
    s_nop 1
    v_mfma_f32_16x16x32_bf16 a[24:27], v[152:155], v[240:243], a[24:27]
    v_mfma_f32_16x16x32_bf16 a[28:31], v[156:159], v[240:243], a[28:31]
    v_mfma_f32_16x16x32_bf16 a[32:35], v[160:163], v[240:243], a[32:35]
    v_perm_b32 v244, v125, v121, s65
    v_perm_b32 v245, v133, v129, s65
    v_perm_b32 v246, v141, v137, s65
    v_perm_b32 v247, v149, v145, s65
    s_nop 1
    v_mfma_f32_16x16x32_bf16 a[36:39], v[152:155], v[244:247], a[36:39]
    v_mfma_f32_16x16x32_bf16 a[40:43], v[156:159], v[244:247], a[40:43]
    v_mfma_f32_16x16x32_bf16 a[44:47], v[160:163], v[244:247], a[44:47]
    v_perm_b32 v240, v126, v122, s64
    v_perm_b32 v241, v134, v130, s64
    v_perm_b32 v242, v142, v138, s64
    v_perm_b32 v243, v150, v146, s64
    s_nop 1
    v_mfma_f32_16x16x32_bf16 a[48:51], v[152:155], v[240:243], a[48:51]
    v_mfma_f32_16x16x32_bf16 a[52:55], v[156:159], v[240:243], a[52:55]
    v_mfma_f32_16x16x32_bf16 a[56:59], v[160:163], v[240:243], a[56:59]
    v_perm_b32 v244, v126, v122, s65
    v_perm_b32 v245, v134, v130, s65
    v_perm_b32 v246, v142, v138, s65
    v_perm_b32 v247, v150, v146, s65
    s_nop 1
    v_mfma_f32_16x16x32_bf16 a[60:63], v[152:155], v[244:247], a[60:63]
    v_mfma_f32_16x16x32_bf16 a[64:67], v[156:159], v[244:247], a[64:67]
    v_mfma_f32_16x16x32_bf16 a[68:71], v[160:163], v[244:247], a[68:71]
    v_perm_b32 v240, v127, v123, s64
    v_perm_b32 v241, v135, v131, s64
    v_perm_b32 v242, v143, v139, s64
    v_perm_b32 v243, v151, v147, s64
    s_nop 1
    v_mfma_f32_16x16x32_bf16 a[72:75], v[152:155], v[240:243], a[72:75]
    v_mfma_f32_16x16x32_bf16 a[76:79], v[156:159], v[240:243], a[76:79]
    v_mfma_f32_16x16x32_bf16 a[80:83], v[160:163], v[240:243], a[80:83]
    v_perm_b32 v244, v127, v123, s65
    v_perm_b32 v245, v135, v131, s65
    v_perm_b32 v246, v143, v139, s65
    v_perm_b32 v247, v151, v147, s65
    s_nop 1
    v_mfma_f32_16x16x32_bf16 a[84:87], v[152:155], v[244:247], a[84:87]
    v_mfma_f32_16x16x32_bf16 a[88:91], v[156:159], v[244:247], a[88:91]
    v_mfma_f32_16x16x32_bf16 a[92:95], v[160:163], v[244:247], a[92:95]
    buffer_load_dwordx4 v[120:123], v8, s[16:19], s48 offen
    buffer_load_dwordx4 v[124:127], v9, s[16:19], s48 offen
    buffer_load_dwordx4 v[128:131], v10, s[16:19], s48 offen
    buffer_load_dwordx4 v[132:135], v11, s[16:19], s48 offen
    buffer_load_dwordx4 v[136:139], v12, s[16:19], s48 offen
    buffer_load_dwordx4 v[140:143], v13, s[16:19], s48 offen
    buffer_load_dwordx4 v[144:147], v14, s[16:19], s48 offen
    buffer_load_dwordx4 v[148:151], v15, s[16:19], s48 offen
    buffer_load_dwordx4 v[152:155], v4, s[8:11], s47 offen
    buffer_load_dwordx4 v[156:159], v5, s[8:11], s47 offen
    buffer_load_dwordx4 v[160:163], v6, s[8:11], s47 offen
    s_add_u32 s48, s48, s49
    s_add_u32 s47, s47, 64
    s_waitcnt vmcnt(33)
    v_perm_b32 v240, v168, v164, s64
    v_perm_b32 v241, v176, v172, s64
    v_perm_b32 v242, v184, v180, s64
    v_perm_b32 v243, v192, v188, s64
    s_nop 1
    v_mfma_f32_16x16x32_bf16 a[0:3], v[196:199], v[240:243], a[0:3]
    v_mfma_f32_16x16x32_bf16 a[4:7], v[200:203], v[240:243], a[4:7]
    v_mfma_f32_16x16x32_bf16 a[8:11], v[204:207], v[240:243], a[8:11]
    v_perm_b32 v244, v168, v164, s65
    v_perm_b32 v245, v176, v172, s65
    v_perm_b32 v246, v184, v180, s65
    v_perm_b32 v247, v192, v188, s65
    s_nop 1
    v_mfma_f32_16x16x32_bf16 a[12:15], v[196:199], v[244:247], a[12:15]
    v_mfma_f32_16x16x32_bf16 a[16:19], v[200:203], v[244:247], a[16:19]
    v_mfma_f32_16x16x32_bf16 a[20:23], v[204:207], v[244:247], a[20:23]
    v_perm_b32 v240, v169, v165, s64
    v_perm_b32 v241, v177, v173, s64
    v_perm_b32 v242, v185, v181, s64
    v_perm_b32 v243, v193, v189, s64
    s_nop 1
    v_mfma_f32_16x16x32_bf16 a[24:27], v[196:199], v[240:243], a[24:27]
    v_mfma_f32_16x16x32_bf16 a[28:31], v[200:203], v[240:243], a[28:31]
    v_mfma_f32_16x16x32_bf16 a[32:35], v[204:207], v[240:243], a[32:35]
    v_perm_b32 v244, v169, v165, s65
    v_perm_b32 v245, v177, v173, s65
    v_perm_b32 v246, v185, v181, s65
    v_perm_b32 v247, v193, v189, s65
    s_nop 1
    v_mfma_f32_16x16x32_bf16 a[36:39], v[196:199], v[244:247], a[36:39]
    v_mfma_f32_16x16x32_bf16 a[40:43], v[200:203], v[244:247], a[40:43]
    v_mfma_f32_16x16x32_bf16 a[44:47], v[204:207], v[244:247], a[44:47]
    v_perm_b32 v240, v170, v166, s64
    v_perm_b32 v241, v178, v174, s64
    v_perm_b32 v242, v186, v182, s64
    v_perm_b32 v243, v194, v190, s64
    s_nop 1
    v_mfma_f32_16x16x32_bf16 a[48:51], v[196:199], v[240:243], a[48:51]
    v_mfma_f32_16x16x32_bf16 a[52:55], v[200:203], v[240:243], a[52:55]
    v_mfma_f32_16x16x32_bf16 a[56:59], v[204:207], v[240:243], a[56:59]
    v_perm_b32 v244, v170, v166, s65
    v_perm_b32 v245, v178, v174, s65
    v_perm_b32 v246, v186, v182, s65
    v_perm_b32 v247, v194, v190, s65
    s_nop 1
    v_mfma_f32_16x16x32_bf16 a[60:63], v[196:199], v[244:247], a[60:63]
    v_mfma_f32_16x16x32_bf16 a[64:67], v[200:203], v[244:247], a[64:67]
    v_mfma_f32_16x16x32_bf16 a[68:71], v[204:207], v[244:247], a[68:71]
    v_perm_b32 v240, v171, v167, s64
    v_perm_b32 v241, v179, v175, s64
    v_perm_b32 v242, v187, v183, s64
    v_perm_b32 v243, v195, v191, s64
    s_nop 1
    v_mfma_f32_16x16x32_bf16 a[72:75], v[196:199], v[240:243], a[72:75]
    v_mfma_f32_16x16x32_bf16 a[76:79], v[200:203], v[240:243], a[76:79]
    v_mfma_f32_16x16x32_bf16 a[80:83], v[204:207], v[240:243], a[80:83]
    v_perm_b32 v244, v171, v167, s65
    v_perm_b32 v245, v179, v175, s65
    v_perm_b32 v246, v187, v183, s65
    v_perm_b32 v247, v195, v191, s65
    s_nop 1
    v_mfma_f32_16x16x32_bf16 a[84:87], v[196:199], v[244:247], a[84:87]
    v_mfma_f32_16x16x32_bf16 a[88:91], v[200:203], v[244:247], a[88:91]
    v_mfma_f32_16x16x32_bf16 a[92:95], v[204:207], v[244:247], a[92:95]
    buffer_load_dwordx4 v[164:167], v8, s[16:19], s48 offen
    buffer_load_dwordx4 v[168:171], v9, s[16:19], s48 offen
    buffer_load_dwordx4 v[172:175], v10, s[16:19], s48 offen
    buffer_load_dwordx4 v[176:179], v11, s[16:19], s48 offen
    buffer_load_dwordx4 v[180:183], v12, s[16:19], s48 offen
    buffer_load_dwordx4 v[184:187], v13, s[16:19], s48 offen
    buffer_load_dwordx4 v[188:191], v14, s[16:19], s48 offen
    buffer_load_dwordx4 v[192:195], v15, s[16:19], s48 offen
    buffer_load_dwordx4 v[196:199], v4, s[8:11], s47 offen
    buffer_load_dwordx4 v[200:203], v5, s[8:11], s47 offen
    buffer_load_dwordx4 v[204:207], v6, s[8:11], s47 offen
    s_add_u32 s48, s48, s49
    s_add_u32 s47, s47, 64
    s_add_u32 s45, s45, 1
    s_cmp_lt_u32 s45, s44
    s_cbranch_scc1 fbk_341
    s_waitcnt vmcnt(33)
    v_perm_b32 v240, v36, v32, s64
    v_perm_b32 v241, v44, v40, s64
    v_perm_b32 v242, v52, v48, s64
    v_perm_b32 v243, v60, v56, s64
    s_nop 1
    v_mfma_f32_16x16x32_bf16 a[0:3], v[64:67], v[240:243], a[0:3]
    v_mfma_f32_16x16x32_bf16 a[4:7], v[68:71], v[240:243], a[4:7]
    v_mfma_f32_16x16x32_bf16 a[8:11], v[72:75], v[240:243], a[8:11]
    v_perm_b32 v244, v36, v32, s65
    v_perm_b32 v245, v44, v40, s65
    v_perm_b32 v246, v52, v48, s65
    v_perm_b32 v247, v60, v56, s65
    s_nop 1
    v_mfma_f32_16x16x32_bf16 a[12:15], v[64:67], v[244:247], a[12:15]
    v_mfma_f32_16x16x32_bf16 a[16:19], v[68:71], v[244:247], a[16:19]
    v_mfma_f32_16x16x32_bf16 a[20:23], v[72:75], v[244:247], a[20:23]
    v_perm_b32 v240, v37, v33, s64
    v_perm_b32 v241, v45, v41, s64
    v_perm_b32 v242, v53, v49, s64
    v_perm_b32 v243, v61, v57, s64
    s_nop 1
    v_mfma_f32_16x16x32_bf16 a[24:27], v[64:67], v[240:243], a[24:27]
    v_mfma_f32_16x16x32_bf16 a[28:31], v[68:71], v[240:243], a[28:31]
    v_mfma_f32_16x16x32_bf16 a[32:35], v[72:75], v[240:243], a[32:35]
    v_perm_b32 v244, v37, v33, s65
    v_perm_b32 v245, v45, v41, s65
    v_perm_b32 v246, v53, v49, s65
    v_perm_b32 v247, v61, v57, s65
    s_nop 1
    v_mfma_f32_16x16x32_bf16 a[36:39], v[64:67], v[244:247], a[36:39]
    v_mfma_f32_16x16x32_bf16 a[40:43], v[68:71], v[244:247], a[40:43]
    v_mfma_f32_16x16x32_bf16 a[44:47], v[72:75], v[244:247], a[44:47]
    v_perm_b32 v240, v38, v34, s64
    v_perm_b32 v241, v46, v42, s64
    v_perm_b32 v242, v54, v50, s64
    v_perm_b32 v243, v62, v58, s64
    s_nop 1
    v_mfma_f32_16x16x32_bf16 a[48:51], v[64:67], v[240:243], a[48:51]
    v_mfma_f32_16x16x32_bf16 a[52:55], v[68:71], v[240:243], a[52:55]
    v_mfma_f32_16x16x32_bf16 a[56:59], v[72:75], v[240:243], a[56:59]
    v_perm_b32 v244, v38, v34, s65
    v_perm_b32 v245, v46, v42, s65
    v_perm_b32 v246, v54, v50, s65
    v_perm_b32 v247, v62, v58, s65
    s_nop 1
    v_mfma_f32_16x16x32_bf16 a[60:63], v[64:67], v[244:247], a[60:63]
    v_mfma_f32_16x16x32_bf16 a[64:67], v[68:71], v[244:247], a[64:67]
    v_mfma_f32_16x16x32_bf16 a[68:71], v[72:75], v[244:247], a[68:71]
    v_perm_b32 v240, v39, v35, s64
    v_perm_b32 v241, v47, v43, s64
    v_perm_b32 v242, v55, v51, s64
    v_perm_b32 v243, v63, v59, s64
    s_nop 1
    v_mfma_f32_16x16x32_bf16 a[72:75], v[64:67], v[240:243], a[72:75]
    v_mfma_f32_16x16x32_bf16 a[76:79], v[68:71], v[240:243], a[76:79]
    v_mfma_f32_16x16x32_bf16 a[80:83], v[72:75], v[240:243], a[80:83]
    v_perm_b32 v244, v39, v35, s65
    v_perm_b32 v245, v47, v43, s65
    v_perm_b32 v246, v55, v51, s65
    v_perm_b32 v247, v63, v59, s65
    s_nop 1
    v_mfma_f32_16x16x32_bf16 a[84:87], v[64:67], v[244:247], a[84:87]
    v_mfma_f32_16x16x32_bf16 a[88:91], v[68:71], v[244:247], a[88:91]
    v_mfma_f32_16x16x32_bf16 a[92:95], v[72:75], v[244:247], a[92:95]
    s_waitcnt vmcnt(22)
    v_perm_b32 v240, v80, v76, s64
    v_perm_b32 v241, v88, v84, s64
    v_perm_b32 v242, v96, v92, s64
    v_perm_b32 v243, v104, v100, s64
    s_nop 1
    v_mfma_f32_16x16x32_bf16 a[0:3], v[108:111], v[240:243], a[0:3]
    v_mfma_f32_16x16x32_bf16 a[4:7], v[112:115], v[240:243], a[4:7]
    v_mfma_f32_16x16x32_bf16 a[8:11], v[116:119], v[240:243], a[8:11]
    v_perm_b32 v244, v80, v76, s65
    v_perm_b32 v245, v88, v84, s65
    v_perm_b32 v246, v96, v92, s65
    v_perm_b32 v247, v104, v100, s65
    s_nop 1
    v_mfma_f32_16x16x32_bf16 a[12:15], v[108:111], v[244:247], a[12:15]
    v_mfma_f32_16x16x32_bf16 a[16:19], v[112:115], v[244:247], a[16:19]
    v_mfma_f32_16x16x32_bf16 a[20:23], v[116:119], v[244:247], a[20:23]
    v_perm_b32 v240, v81, v77, s64
    v_perm_b32 v241, v89, v85, s64
    v_perm_b32 v242, v97, v93, s64
    v_perm_b32 v243, v105, v101, s64
    s_nop 1
    v_mfma_f32_16x16x32_bf16 a[24:27], v[108:111], v[240:243], a[24:27]
    v_mfma_f32_16x16x32_bf16 a[28:31], v[112:115], v[240:243], a[28:31]
    v_mfma_f32_16x16x32_bf16 a[32:35], v[116:119], v[240:243], a[32:35]
    v_perm_b32 v244, v81, v77, s65
    v_perm_b32 v245, v89, v85, s65
    v_perm_b32 v246, v97, v93, s65
    v_perm_b32 v247, v105, v101, s65
    s_nop 1
    v_mfma_f32_16x16x32_bf16 a[36:39], v[108:111], v[244:247], a[36:39]
    v_mfma_f32_16x16x32_bf16 a[40:43], v[112:115], v[244:247], a[40:43]
    v_mfma_f32_16x16x32_bf16 a[44:47], v[116:119], v[244:247], a[44:47]
    v_perm_b32 v240, v82, v78, s64
    v_perm_b32 v241, v90, v86, s64
    v_perm_b32 v242, v98, v94, s64
    v_perm_b32 v243, v106, v102, s64
    s_nop 1
    v_mfma_f32_16x16x32_bf16 a[48:51], v[108:111], v[240:243], a[48:51]
    v_mfma_f32_16x16x32_bf16 a[52:55], v[112:115], v[240:243], a[52:55]
    v_mfma_f32_16x16x32_bf16 a[56:59], v[116:119], v[240:243], a[56:59]
    v_perm_b32 v244, v82, v78, s65
    v_perm_b32 v245, v90, v86, s65
    v_perm_b32 v246, v98, v94, s65
    v_perm_b32 v247, v106, v102, s65
    s_nop 1
    v_mfma_f32_16x16x32_bf16 a[60:63], v[108:111], v[244:247], a[60:63]
    v_mfma_f32_16x16x32_bf16 a[64:67], v[112:115], v[244:247], a[64:67]
    v_mfma_f32_16x16x32_bf16 a[68:71], v[116:119], v[244:247], a[68:71]
    v_perm_b32 v240, v83, v79, s64
    v_perm_b32 v241, v91, v87, s64
    v_perm_b32 v242, v99, v95, s64
    v_perm_b32 v243, v107, v103, s64
    s_nop 1
    v_mfma_f32_16x16x32_bf16 a[72:75], v[108:111], v[240:243], a[72:75]
    v_mfma_f32_16x16x32_bf16 a[76:79], v[112:115], v[240:243], a[76:79]
    v_mfma_f32_16x16x32_bf16 a[80:83], v[116:119], v[240:243], a[80:83]
    v_perm_b32 v244, v83, v79, s65
    v_perm_b32 v245, v91, v87, s65
    v_perm_b32 v246, v99, v95, s65
    v_perm_b32 v247, v107, v103, s65
    s_nop 1
    v_mfma_f32_16x16x32_bf16 a[84:87], v[108:111], v[244:247], a[84:87]
    v_mfma_f32_16x16x32_bf16 a[88:91], v[112:115], v[244:247], a[88:91]
    v_mfma_f32_16x16x32_bf16 a[92:95], v[116:119], v[244:247], a[92:95]
    s_waitcnt vmcnt(11)
    v_perm_b32 v240, v124, v120, s64
    v_perm_b32 v241, v132, v128, s64
    v_perm_b32 v242, v140, v136, s64
    v_perm_b32 v243, v148, v144, s64
    s_nop 1
    v_mfma_f32_16x16x32_bf16 a[0:3], v[152:155], v[240:243], a[0:3]
    v_mfma_f32_16x16x32_bf16 a[4:7], v[156:159], v[240:243], a[4:7]
    v_mfma_f32_16x16x32_bf16 a[8:11], v[160:163], v[240:243], a[8:11]
    v_perm_b32 v244, v124, v120, s65
    v_perm_b32 v245, v132, v128, s65
    v_perm_b32 v246, v140, v136, s65
    v_perm_b32 v247, v148, v144, s65
    s_nop 1
    v_mfma_f32_16x16x32_bf16 a[12:15], v[152:155], v[244:247], a[12:15]
    v_mfma_f32_16x16x32_bf16 a[16:19], v[156:159], v[244:247], a[16:19]
    v_mfma_f32_16x16x32_bf16 a[20:23], v[160:163], v[244:247], a[20:23]
    v_perm_b32 v240, v125, v121, s64
    v_perm_b32 v241, v133, v129, s64
    v_perm_b32 v242, v141, v137, s64
    v_perm_b32 v243, v149, v145, s64
    s_nop 1
    v_mfma_f32_16x16x32_bf16 a[24:27], v[152:155], v[240:243], a[24:27]
    v_mfma_f32_16x16x32_bf16 a[28:31], v[156:159], v[240:243], a[28:31]
    v_mfma_f32_16x16x32_bf16 a[32:35], v[160:163], v[240:243], a[32:35]
    v_perm_b32 v244, v125, v121, s65
    v_perm_b32 v245, v133, v129, s65
    v_perm_b32 v246, v141, v137, s65
    v_perm_b32 v247, v149, v145, s65
    s_nop 1
    v_mfma_f32_16x16x32_bf16 a[36:39], v[152:155], v[244:247], a[36:39]
    v_mfma_f32_16x16x32_bf16 a[40:43], v[156:159], v[244:247], a[40:43]
    v_mfma_f32_16x16x32_bf16 a[44:47], v[160:163], v[244:247], a[44:47]
    v_perm_b32 v240, v126, v122, s64
    v_perm_b32 v241, v134, v130, s64
    v_perm_b32 v242, v142, v138, s64
    v_perm_b32 v243, v150, v146, s64
    s_nop 1
    v_mfma_f32_16x16x32_bf16 a[48:51], v[152:155], v[240:243], a[48:51]
    v_mfma_f32_16x16x32_bf16 a[52:55], v[156:159], v[240:243], a[52:55]
    v_mfma_f32_16x16x32_bf16 a[56:59], v[160:163], v[240:243], a[56:59]
    v_perm_b32 v244, v126, v122, s65
    v_perm_b32 v245, v134, v130, s65
    v_perm_b32 v246, v142, v138, s65
    v_perm_b32 v247, v150, v146, s65
    s_nop 1
    v_mfma_f32_16x16x32_bf16 a[60:63], v[152:155], v[244:247], a[60:63]
    v_mfma_f32_16x16x32_bf16 a[64:67], v[156:159], v[244:247], a[64:67]
    v_mfma_f32_16x16x32_bf16 a[68:71], v[160:163], v[244:247], a[68:71]
    v_perm_b32 v240, v127, v123, s64
    v_perm_b32 v241, v135, v131, s64
    v_perm_b32 v242, v143, v139, s64
    v_perm_b32 v243, v151, v147, s64
    s_nop 1
    v_mfma_f32_16x16x32_bf16 a[72:75], v[152:155], v[240:243], a[72:75]
    v_mfma_f32_16x16x32_bf16 a[76:79], v[156:159], v[240:243], a[76:79]
    v_mfma_f32_16x16x32_bf16 a[80:83], v[160:163], v[240:243], a[80:83]
    v_perm_b32 v244, v127, v123, s65
    v_perm_b32 v245, v135, v131, s65
    v_perm_b32 v246, v143, v139, s65
    v_perm_b32 v247, v151, v147, s65
    s_nop 1
    v_mfma_f32_16x16x32_bf16 a[84:87], v[152:155], v[244:247], a[84:87]
    v_mfma_f32_16x16x32_bf16 a[88:91], v[156:159], v[244:247], a[88:91]
    v_mfma_f32_16x16x32_bf16 a[92:95], v[160:163], v[244:247], a[92:95]
    s_waitcnt vmcnt(0)
    v_perm_b32 v240, v168, v164, s64
    v_perm_b32 v241, v176, v172, s64
    v_perm_b32 v242, v184, v180, s64
    v_perm_b32 v243, v192, v188, s64
    s_nop 1
    v_mfma_f32_16x16x32_bf16 a[0:3], v[196:199], v[240:243], a[0:3]
    v_mfma_f32_16x16x32_bf16 a[4:7], v[200:203], v[240:243], a[4:7]
    v_mfma_f32_16x16x32_bf16 a[8:11], v[204:207], v[240:243], a[8:11]
    v_perm_b32 v244, v168, v164, s65
    v_perm_b32 v245, v176, v172, s65
    v_perm_b32 v246, v184, v180, s65
    v_perm_b32 v247, v192, v188, s65
    s_nop 1
    v_mfma_f32_16x16x32_bf16 a[12:15], v[196:199], v[244:247], a[12:15]
    v_mfma_f32_16x16x32_bf16 a[16:19], v[200:203], v[244:247], a[16:19]
    v_mfma_f32_16x16x32_bf16 a[20:23], v[204:207], v[244:247], a[20:23]
    v_perm_b32 v240, v169, v165, s64
    v_perm_b32 v241, v177, v173, s64
    v_perm_b32 v242, v185, v181, s64
    v_perm_b32 v243, v193, v189, s64
    s_nop 1
    v_mfma_f32_16x16x32_bf16 a[24:27], v[196:199], v[240:243], a[24:27]
    v_mfma_f32_16x16x32_bf16 a[28:31], v[200:203], v[240:243], a[28:31]
    v_mfma_f32_16x16x32_bf16 a[32:35], v[204:207], v[240:243], a[32:35]
    v_perm_b32 v244, v169, v165, s65
    v_perm_b32 v245, v177, v173, s65
    v_perm_b32 v246, v185, v181, s65
    v_perm_b32 v247, v193, v189, s65
    s_nop 1
    v_mfma_f32_16x16x32_bf16 a[36:39], v[196:199], v[244:247], a[36:39]
    v_mfma_f32_16x16x32_bf16 a[40:43], v[200:203], v[244:247], a[40:43]
    v_mfma_f32_16x16x32_bf16 a[44:47], v[204:207], v[244:247], a[44:47]
    v_perm_b32 v240, v170, v166, s64
    v_perm_b32 v241, v178, v174, s64
    v_perm_b32 v242, v186, v182, s64
    v_perm_b32 v243, v194, v190, s64
    s_nop 1
    v_mfma_f32_16x16x32_bf16 a[48:51], v[196:199], v[240:243], a[48:51]
    v_mfma_f32_16x16x32_bf16 a[52:55], v[200:203], v[240:243], a[52:55]
    v_mfma_f32_16x16x32_bf16 a[56:59], v[204:207], v[240:243], a[56:59]
    v_perm_b32 v244, v170, v166, s65
    v_perm_b32 v245, v178, v174, s65
    v_perm_b32 v246, v186, v182, s65
    v_perm_b32 v247, v194, v190, s65
    s_nop 1
    v_mfma_f32_16x16x32_bf16 a[60:63], v[196:199], v[244:247], a[60:63]
    v_mfma_f32_16x16x32_bf16 a[64:67], v[200:203], v[244:247], a[64:67]
    v_mfma_f32_16x16x32_bf16 a[68:71], v[204:207], v[244:247], a[68:71]
    v_perm_b32 v240, v171, v167, s64
    v_perm_b32 v241, v179, v175, s64
    v_perm_b32 v242, v187, v183, s64
    v_perm_b32 v243, v195, v191, s64
    s_nop 1
    v_mfma_f32_16x16x32_bf16 a[72:75], v[196:199], v[240:243], a[72:75]
    v_mfma_f32_16x16x32_bf16 a[76:79], v[200:203], v[240:243], a[76:79]
    v_mfma_f32_16x16x32_bf16 a[80:83], v[204:207], v[240:243], a[80:83]
    v_perm_b32 v244, v171, v167, s65
    v_perm_b32 v245, v179, v175, s65
    v_perm_b32 v246, v187, v183, s65
    v_perm_b32 v247, v195, v191, s65
    s_nop 1
    v_mfma_f32_16x16x32_bf16 a[84:87], v[196:199], v[244:247], a[84:87]
    v_mfma_f32_16x16x32_bf16 a[88:91], v[200:203], v[244:247], a[88:91]
    v_mfma_f32_16x16x32_bf16 a[92:95], v[204:207], v[244:247], a[92:95]
    s_mov_b32 s56, s50
    s_mul_i32 s57, s53, 12
    v_accvgpr_read_b32 v216, a0
    v_accvgpr_read_b32 v217, a12
    v_accvgpr_read_b32 v218, a24
    v_accvgpr_read_b32 v219, a36
    v_accvgpr_read_b32 v220, a48
    v_accvgpr_read_b32 v221, a60
    v_accvgpr_read_b32 v222, a72
    v_accvgpr_read_b32 v223, a84
    v_cvt_pk_bf16_f32 v224, v216, v217
    v_cvt_pk_bf16_f32 v225, v218, v219
    v_cvt_pk_bf16_f32 v226, v220, v221
    v_cvt_pk_bf16_f32 v227, v222, v223
    buffer_store_dwordx4 v[224:227], v16, s[8:11], s56 offen
    s_waitcnt vmcnt(1)
    s_add_u32 s56, s56, s53
    v_accvgpr_read_b32 v228, a1
    v_accvgpr_read_b32 v229, a13
    v_accvgpr_read_b32 v230, a25
    v_accvgpr_read_b32 v231, a37
    v_accvgpr_read_b32 v232, a49
    v_accvgpr_read_b32 v233, a61
    v_accvgpr_read_b32 v234, a73
    v_accvgpr_read_b32 v235, a85
    v_cvt_pk_bf16_f32 v236, v228, v229
    v_cvt_pk_bf16_f32 v237, v230, v231
    v_cvt_pk_bf16_f32 v238, v232, v233
    v_cvt_pk_bf16_f32 v239, v234, v235
    buffer_store_dwordx4 v[236:239], v16, s[8:11], s56 offen
    s_waitcnt vmcnt(1)
    s_add_u32 s56, s56, s53
    v_accvgpr_read_b32 v216, a2
    v_accvgpr_read_b32 v217, a14
    v_accvgpr_read_b32 v218, a26
    v_accvgpr_read_b32 v219, a38
    v_accvgpr_read_b32 v220, a50
    v_accvgpr_read_b32 v221, a62
    v_accvgpr_read_b32 v222, a74
    v_accvgpr_read_b32 v223, a86
    v_cvt_pk_bf16_f32 v224, v216, v217
    v_cvt_pk_bf16_f32 v225, v218, v219
    v_cvt_pk_bf16_f32 v226, v220, v221
    v_cvt_pk_bf16_f32 v227, v222, v223
    buffer_store_dwordx4 v[224:227], v16, s[8:11], s56 offen
    s_waitcnt vmcnt(1)
    s_add_u32 s56, s56, s53
    v_accvgpr_read_b32 v228, a3
    v_accvgpr_read_b32 v229, a15
    v_accvgpr_read_b32 v230, a27
    v_accvgpr_read_b32 v231, a39
    v_accvgpr_read_b32 v232, a51
    v_accvgpr_read_b32 v233, a63
    v_accvgpr_read_b32 v234, a75
    v_accvgpr_read_b32 v235, a87
    v_cvt_pk_bf16_f32 v236, v228, v229
    v_cvt_pk_bf16_f32 v237, v230, v231
    v_cvt_pk_bf16_f32 v238, v232, v233
    v_cvt_pk_bf16_f32 v239, v234, v235
    buffer_store_dwordx4 v[236:239], v16, s[8:11], s56 offen
    s_waitcnt vmcnt(1)
    s_add_u32 s56, s56, s53
    s_add_u32 s56, s56, s57
    v_accvgpr_read_b32 v216, a4
    v_accvgpr_read_b32 v217, a16
    v_accvgpr_read_b32 v218, a28
    v_accvgpr_read_b32 v219, a40
    v_accvgpr_read_b32 v220, a52
    v_accvgpr_read_b32 v221, a64
    v_accvgpr_read_b32 v222, a76
    v_accvgpr_read_b32 v223, a88
    v_cvt_pk_bf16_f32 v224, v216, v217
    v_cvt_pk_bf16_f32 v225, v218, v219
    v_cvt_pk_bf16_f32 v226, v220, v221
    v_cvt_pk_bf16_f32 v227, v222, v223
    buffer_store_dwordx4 v[224:227], v16, s[8:11], s56 offen
    s_waitcnt vmcnt(1)
    s_add_u32 s56, s56, s53
    v_accvgpr_read_b32 v228, a5
    v_accvgpr_read_b32 v229, a17
    v_accvgpr_read_b32 v230, a29
    v_accvgpr_read_b32 v231, a41
    v_accvgpr_read_b32 v232, a53
    v_accvgpr_read_b32 v233, a65
    v_accvgpr_read_b32 v234, a77
    v_accvgpr_read_b32 v235, a89
    v_cvt_pk_bf16_f32 v236, v228, v229
    v_cvt_pk_bf16_f32 v237, v230, v231
    v_cvt_pk_bf16_f32 v238, v232, v233
    v_cvt_pk_bf16_f32 v239, v234, v235
    buffer_store_dwordx4 v[236:239], v16, s[8:11], s56 offen
    s_waitcnt vmcnt(1)
    s_add_u32 s56, s56, s53
    v_accvgpr_read_b32 v216, a6
    v_accvgpr_read_b32 v217, a18
    v_accvgpr_read_b32 v218, a30
    v_accvgpr_read_b32 v219, a42
    v_accvgpr_read_b32 v220, a54
    v_accvgpr_read_b32 v221, a66
    v_accvgpr_read_b32 v222, a78
    v_accvgpr_read_b32 v223, a90
    v_cvt_pk_bf16_f32 v224, v216, v217
    v_cvt_pk_bf16_f32 v225, v218, v219
    v_cvt_pk_bf16_f32 v226, v220, v221
    v_cvt_pk_bf16_f32 v227, v222, v223
    buffer_store_dwordx4 v[224:227], v16, s[8:11], s56 offen
    s_waitcnt vmcnt(1)
    s_add_u32 s56, s56, s53
    v_accvgpr_read_b32 v228, a7
    v_accvgpr_read_b32 v229, a19
    v_accvgpr_read_b32 v230, a31
    v_accvgpr_read_b32 v231, a43
    v_accvgpr_read_b32 v232, a55
    v_accvgpr_read_b32 v233, a67
    v_accvgpr_read_b32 v234, a79
    v_accvgpr_read_b32 v235, a91
    v_cvt_pk_bf16_f32 v236, v228, v229
    v_cvt_pk_bf16_f32 v237, v230, v231
    v_cvt_pk_bf16_f32 v238, v232, v233
    v_cvt_pk_bf16_f32 v239, v234, v235
    buffer_store_dwordx4 v[236:239], v16, s[8:11], s56 offen
    s_waitcnt vmcnt(1)
    s_add_u32 s56, s56, s53
    s_add_u32 s56, s56, s57
    v_accvgpr_read_b32 v216, a8
    v_accvgpr_read_b32 v217, a20
    v_accvgpr_read_b32 v218, a32
    v_accvgpr_read_b32 v219, a44
    v_accvgpr_read_b32 v220, a56
    v_accvgpr_read_b32 v221, a68
    v_accvgpr_read_b32 v222, a80
    v_accvgpr_read_b32 v223, a92
    v_cvt_pk_bf16_f32 v224, v216, v217
    v_cvt_pk_bf16_f32 v225, v218, v219
    v_cvt_pk_bf16_f32 v226, v220, v221
    v_cvt_pk_bf16_f32 v227, v222, v223
    buffer_store_dwordx4 v[224:227], v16, s[8:11], s56 offen
    s_waitcnt vmcnt(1)
    s_add_u32 s56, s56, s53
    v_accvgpr_read_b32 v228, a9
    v_accvgpr_read_b32 v229, a21
    v_accvgpr_read_b32 v230, a33
    v_accvgpr_read_b32 v231, a45
    v_accvgpr_read_b32 v232, a57
    v_accvgpr_read_b32 v233, a69
    v_accvgpr_read_b32 v234, a81
    v_accvgpr_read_b32 v235, a93
    v_cvt_pk_bf16_f32 v236, v228, v229
    v_cvt_pk_bf16_f32 v237, v230, v231
    v_cvt_pk_bf16_f32 v238, v232, v233
    v_cvt_pk_bf16_f32 v239, v234, v235
    buffer_store_dwordx4 v[236:239], v16, s[8:11], s56 offen
    s_waitcnt vmcnt(1)
    s_add_u32 s56, s56, s53
    v_accvgpr_read_b32 v216, a10
    v_accvgpr_read_b32 v217, a22
    v_accvgpr_read_b32 v218, a34
    v_accvgpr_read_b32 v219, a46
    v_accvgpr_read_b32 v220, a58
    v_accvgpr_read_b32 v221, a70
    v_accvgpr_read_b32 v222, a82
    v_accvgpr_read_b32 v223, a94
    v_cvt_pk_bf16_f32 v224, v216, v217
    v_cvt_pk_bf16_f32 v225, v218, v219
    v_cvt_pk_bf16_f32 v226, v220, v221
    v_cvt_pk_bf16_f32 v227, v222, v223
    buffer_store_dwordx4 v[224:227], v16, s[8:11], s56 offen
    s_waitcnt vmcnt(1)
    s_add_u32 s56, s56, s53
    v_accvgpr_read_b32 v228, a11
    v_accvgpr_read_b32 v229, a23
    v_accvgpr_read_b32 v230, a35
    v_accvgpr_read_b32 v231, a47
    v_accvgpr_read_b32 v232, a59
    v_accvgpr_read_b32 v233, a71
    v_accvgpr_read_b32 v234, a83
    v_accvgpr_read_b32 v235, a95
    v_cvt_pk_bf16_f32 v236, v228, v229
    v_cvt_pk_bf16_f32 v237, v230, v231
    v_cvt_pk_bf16_f32 v238, v232, v233
    v_cvt_pk_bf16_f32 v239, v234, v235
    buffer_store_dwordx4 v[236:239], v16, s[8:11], s56 offen
    s_waitcnt vmcnt(1)
    s_add_u32 s56, s56, s53
    s_add_u32 s56, s56, s57
    s_waitcnt vmcnt(0)
    s_add_u32 s50, s50, 256
    s_add_u32 s42, s42, 1
    s_cmp_lt_u32 s42, s43
    s_cbranch_scc1 fbblk_340
    s_add_u32 s41, s41, 1
    s_cmp_lg_u32 s41, 5
    s_cbranch_scc1 fbna_342
    s_mov_b32 s53, 8192
    v_mul_u32_u24 v4, 1, v1
    v_add_u32 v4, 0, v4
    v_mul_lo_u32 v4, v4, s53
    v_lshl_add_u32 v4, v2, 4, v4
    v_mul_u32_u24 v5, 1, v1
    v_add_u32 v5, 16, v5
    v_mul_lo_u32 v5, v5, s53
    v_lshl_add_u32 v5, v2, 4, v5
    v_mul_u32_u24 v6, 1, v1
    v_add_u32 v6, 32, v6
    v_mul_lo_u32 v6, v6, s53
    v_lshl_add_u32 v6, v2, 4, v6
    v_mul_u32_u24 v16, 4, v2
    v_add_u32 v16, 0, v16
    v_mul_lo_u32 v16, v16, s53
    v_lshl_add_u32 v16, v1, 4, v16
    s_mov_b32 s54, 0
fbh_343:
    s_add_u32 s56, s54, 0xe080000
    buffer_load_dwordx4 v[32:35], v4, s[8:11], s56 offen offset:0
    buffer_load_dwordx4 v[36:39], v4, s[8:11], s56 offen offset:64
    buffer_load_dwordx4 v[40:43], v4, s[8:11], s56 offen offset:128
    buffer_load_dwordx4 v[44:47], v4, s[8:11], s56 offen offset:192
    buffer_load_dwordx4 v[48:51], v5, s[8:11], s56 offen offset:0
    buffer_load_dwordx4 v[52:55], v5, s[8:11], s56 offen offset:64
    buffer_load_dwordx4 v[56:59], v5, s[8:11], s56 offen offset:128
    buffer_load_dwordx4 v[60:63], v5, s[8:11], s56 offen offset:192
    buffer_load_dwordx4 v[64:67], v6, s[8:11], s56 offen offset:0
    buffer_load_dwordx4 v[68:71], v6, s[8:11], s56 offen offset:64
    buffer_load_dwordx4 v[72:75], v6, s[8:11], s56 offen offset:128
    buffer_load_dwordx4 v[76:79], v6, s[8:11], s56 offen offset:192
    s_add_u32 s56, s54, 0xe100000
    buffer_load_dwordx4 v[80:83], v4, s[8:11], s56 offen offset:0
    buffer_load_dwordx4 v[84:87], v4, s[8:11], s56 offen offset:64
    buffer_load_dwordx4 v[88:91], v4, s[8:11], s56 offen offset:128
    buffer_load_dwordx4 v[92:95], v4, s[8:11], s56 offen offset:192
    buffer_load_dwordx4 v[96:99], v5, s[8:11], s56 offen offset:0
    buffer_load_dwordx4 v[100:103], v5, s[8:11], s56 offen offset:64
    buffer_load_dwordx4 v[104:107], v5, s[8:11], s56 offen offset:128
    buffer_load_dwordx4 v[108:111], v5, s[8:11], s56 offen offset:192
    buffer_load_dwordx4 v[112:115], v6, s[8:11], s56 offen offset:0
    buffer_load_dwordx4 v[116:119], v6, s[8:11], s56 offen offset:64
    buffer_load_dwordx4 v[120:123], v6, s[8:11], s56 offen offset:128
    buffer_load_dwordx4 v[124:127], v6, s[8:11], s56 offen offset:192
    s_add_u32 s56, s54, 0xe180000
    buffer_load_dwordx4 v[128:131], v21, s[8:11], s56 offen
    s_add_u32 s56, s54, 0xe182000
    buffer_load_dwordx4 v[132:135], v21, s[8:11], s56 offen
    s_add_u32 s56, s54, 0xe184000
    buffer_load_dwordx4 v[136:139], v21, s[8:11], s56 offen
    s_add_u32 s56, s54, 0xe186000
    buffer_load_dwordx4 v[140:143], v21, s[8:11], s56 offen
    s_add_u32 s56, s54, 0xe1a0000
    buffer_load_dwordx4 v[144:147], v21, s[8:11], s56 offen
    s_add_u32 s56, s54, 0xe1a2000
    buffer_load_dwordx4 v[148:151], v21, s[8:11], s56 offen
    s_add_u32 s56, s54, 0xe1a4000
    buffer_load_dwordx4 v[152:155], v21, s[8:11], s56 offen
    s_add_u32 s56, s54, 0xe1a6000
    buffer_load_dwordx4 v[156:159], v21, s[8:11], s56 offen
    s_add_u32 s56, s54, 0xe1c0000
    buffer_load_dwordx4 v[160:163], v21, s[8:11], s56 offen
    s_add_u32 s56, s54, 0xe1c2000
    buffer_load_dwordx4 v[164:167], v21, s[8:11], s56 offen
    s_add_u32 s56, s54, 0xe1c4000
    buffer_load_dwordx4 v[168:171], v21, s[8:11], s56 offen
    s_add_u32 s56, s54, 0xe1c6000
    buffer_load_dwordx4 v[172:175], v21, s[8:11], s56 offen
    v_accvgpr_write_b32 a0, 0
    v_accvgpr_write_b32 a1, 0
    v_accvgpr_write_b32 a2, 0
    v_accvgpr_write_b32 a3, 0
    v_accvgpr_write_b32 a4, 0
    v_accvgpr_write_b32 a5, 0
    v_accvgpr_write_b32 a6, 0
    v_accvgpr_write_b32 a7, 0
    v_accvgpr_write_b32 a8, 0
    v_accvgpr_write_b32 a9, 0
    v_accvgpr_write_b32 a10, 0
    v_accvgpr_write_b32 a11, 0
    v_accvgpr_write_b32 a12, 0
    v_accvgpr_write_b32 a13, 0
    v_accvgpr_write_b32 a14, 0
    v_accvgpr_write_b32 a15, 0
    v_accvgpr_write_b32 a16, 0
    v_accvgpr_write_b32 a17, 0
    v_accvgpr_write_b32 a18, 0
    v_accvgpr_write_b32 a19, 0
    v_accvgpr_write_b32 a20, 0
    v_accvgpr_write_b32 a21, 0
    v_accvgpr_write_b32 a22, 0
    v_accvgpr_write_b32 a23, 0
    v_accvgpr_write_b32 a24, 0
    v_accvgpr_write_b32 a25, 0
    v_accvgpr_write_b32 a26, 0
    v_accvgpr_write_b32 a27, 0
    v_accvgpr_write_b32 a28, 0
    v_accvgpr_write_b32 a29, 0
    v_accvgpr_write_b32 a30, 0
    v_accvgpr_write_b32 a31, 0
    v_accvgpr_write_b32 a32, 0
    v_accvgpr_write_b32 a33, 0
    v_accvgpr_write_b32 a34, 0
    v_accvgpr_write_b32 a35, 0
    v_accvgpr_write_b32 a36, 0
    v_accvgpr_write_b32 a37, 0
    v_accvgpr_write_b32 a38, 0
    v_accvgpr_write_b32 a39, 0
    v_accvgpr_write_b32 a40, 0
    v_accvgpr_write_b32 a41, 0
    v_accvgpr_write_b32 a42, 0
    v_accvgpr_write_b32 a43, 0
    v_accvgpr_write_b32 a44, 0
    v_accvgpr_write_b32 a45, 0
    v_accvgpr_write_b32 a46, 0
    v_accvgpr_write_b32 a47, 0
    v_accvgpr_write_b32 a48, 0
    v_accvgpr_write_b32 a49, 0
    v_accvgpr_write_b32 a50, 0
    v_accvgpr_write_b32 a51, 0
    v_accvgpr_write_b32 a52, 0
    v_accvgpr_write_b32 a53, 0
    v_accvgpr_write_b32 a54, 0
    v_accvgpr_write_b32 a55, 0
    v_accvgpr_write_b32 a56, 0
    v_accvgpr_write_b32 a57, 0
    v_accvgpr_write_b32 a58, 0
    v_accvgpr_write_b32 a59, 0
    v_accvgpr_write_b32 a60, 0
    v_accvgpr_write_b32 a61, 0
    v_accvgpr_write_b32 a62, 0
    v_accvgpr_write_b32 a63, 0
    v_accvgpr_write_b32 a64, 0
    v_accvgpr_write_b32 a65, 0
    v_accvgpr_write_b32 a66, 0
    v_accvgpr_write_b32 a67, 0
    v_accvgpr_write_b32 a68, 0
    v_accvgpr_write_b32 a69, 0
    v_accvgpr_write_b32 a70, 0
    v_accvgpr_write_b32 a71, 0
    v_accvgpr_write_b32 a72, 0
    v_accvgpr_write_b32 a73, 0
    v_accvgpr_write_b32 a74, 0
    v_accvgpr_write_b32 a75, 0
    v_accvgpr_write_b32 a76, 0
    v_accvgpr_write_b32 a77, 0
    v_accvgpr_write_b32 a78, 0
    v_accvgpr_write_b32 a79, 0
    v_accvgpr_write_b32 a80, 0
    v_accvgpr_write_b32 a81, 0
    v_accvgpr_write_b32 a82, 0
    v_accvgpr_write_b32 a83, 0
    v_accvgpr_write_b32 a84, 0
    v_accvgpr_write_b32 a85, 0
    v_accvgpr_write_b32 a86, 0
    v_accvgpr_write_b32 a87, 0
    v_accvgpr_write_b32 a88, 0
    v_accvgpr_write_b32 a89, 0
    v_accvgpr_write_b32 a90, 0
    v_accvgpr_write_b32 a91, 0
    v_accvgpr_write_b32 a92, 0
    v_accvgpr_write_b32 a93, 0
    v_accvgpr_write_b32 a94, 0
    v_accvgpr_write_b32 a95, 0
    s_waitcnt vmcnt(0)
    v_mfma_f32_16x16x32_bf16 v[176:179], v[80:83], v[32:35], 0
    v_mfma_f32_16x16x32_bf16 v[180:183], v[96:99], v[32:35], 0
    v_mfma_f32_16x16x32_bf16 v[184:187], v[112:115], v[32:35], 0
    v_mfma_f32_16x16x32_bf16 v[188:191], v[80:83], v[48:51], 0
    v_mfma_f32_16x16x32_bf16 v[192:195], v[96:99], v[48:51], 0
    v_mfma_f32_16x16x32_bf16 v[196:199], v[112:115], v[48:51], 0
    v_mfma_f32_16x16x32_bf16 v[200:203], v[80:83], v[64:67], 0
    v_mfma_f32_16x16x32_bf16 v[204:207], v[96:99], v[64:67], 0
    v_mfma_f32_16x16x32_bf16 v[208:211], v[112:115], v[64:67], 0
    v_mfma_f32_16x16x32_bf16 v[176:179], v[84:87], v[36:39], v[176:179]
    v_mfma_f32_16x16x32_bf16 v[180:183], v[100:103], v[36:39], v[180:183]
    v_mfma_f32_16x16x32_bf16 v[184:187], v[116:119], v[36:39], v[184:187]
    v_mfma_f32_16x16x32_bf16 v[188:191], v[84:87], v[52:55], v[188:191]
    v_mfma_f32_16x16x32_bf16 v[192:195], v[100:103], v[52:55], v[192:195]
    v_mfma_f32_16x16x32_bf16 v[196:199], v[116:119], v[52:55], v[196:199]
    v_mfma_f32_16x16x32_bf16 v[200:203], v[84:87], v[68:71], v[200:203]
    v_mfma_f32_16x16x32_bf16 v[204:207], v[100:103], v[68:71], v[204:207]
    v_mfma_f32_16x16x32_bf16 v[208:211], v[116:119], v[68:71], v[208:211]
    v_mfma_f32_16x16x32_bf16 v[176:179], v[88:91], v[40:43], v[176:179]
    v_mfma_f32_16x16x32_bf16 v[180:183], v[104:107], v[40:43], v[180:183]
    v_mfma_f32_16x16x32_bf16 v[184:187], v[120:123], v[40:43], v[184:187]
    v_mfma_f32_16x16x32_bf16 v[188:191], v[88:91], v[56:59], v[188:191]
    v_mfma_f32_16x16x32_bf16 v[192:195], v[104:107], v[56:59], v[192:195]
    v_mfma_f32_16x16x32_bf16 v[196:199], v[120:123], v[56:59], v[196:199]
    v_mfma_f32_16x16x32_bf16 v[200:203], v[88:91], v[72:75], v[200:203]
    v_mfma_f32_16x16x32_bf16 v[204:207], v[104:107], v[72:75], v[204:207]
    v_mfma_f32_16x16x32_bf16 v[208:211], v[120:123], v[72:75], v[208:211]
    v_mfma_f32_16x16x32_bf16 v[176:179], v[92:95], v[44:47], v[176:179]
    v_mfma_f32_16x16x32_bf16 v[180:183], v[108:111], v[44:47], v[180:183]
    v_mfma_f32_16x16x32_bf16 v[184:187], v[124:127], v[44:47], v[184:187]
    v_mfma_f32_16x16x32_bf16 v[188:191], v[92:95], v[60:63], v[188:191]
    v_mfma_f32_16x16x32_bf16 v[192:195], v[108:111], v[60:63], v[192:195]
    v_mfma_f32_16x16x32_bf16 v[196:199], v[124:127], v[60:63], v[196:199]
    v_mfma_f32_16x16x32_bf16 v[200:203], v[92:95], v[76:79], v[200:203]
    v_mfma_f32_16x16x32_bf16 v[204:207], v[108:111], v[76:79], v[204:207]
    v_mfma_f32_16x16x32_bf16 v[208:211], v[124:127], v[76:79], v[208:211]
    v_mov_b32 v34, 0xf149f2ca
    v_cmp_le_i32 vcc, 0, v17
    s_nop 1
    v_cndmask_b32 v176, v34, v176, vcc
    v_cmp_le_i32 vcc, 1, v17
    s_nop 1
    v_cndmask_b32 v177, v34, v177, vcc
    v_cmp_le_i32 vcc, 2, v17
    s_nop 1
    v_cndmask_b32 v178, v34, v178, vcc
    v_cmp_le_i32 vcc, 3, v17
    s_nop 1
    v_cndmask_b32 v179, v34, v179, vcc
    v_cmp_le_i32 vcc, 16, v17
    s_nop 1
    v_cndmask_b32 v180, v34, v180, vcc
    v_cmp_le_i32 vcc, 17, v17
    s_nop 1
    v_cndmask_b32 v181, v34, v181, vcc
    v_cmp_le_i32 vcc, 18, v17
    s_nop 1
    v_cndmask_b32 v182, v34, v182, vcc
    v_cmp_le_i32 vcc, 19, v17
    s_nop 1
    v_cndmask_b32 v183, v34, v183, vcc
    v_cmp_le_i32 vcc, 32, v17
    s_nop 1
    v_cndmask_b32 v184, v34, v184, vcc
    v_cmp_le_i32 vcc, 33, v17
    s_nop 1
    v_cndmask_b32 v185, v34, v185, vcc
    v_cmp_le_i32 vcc, 34, v17
    s_nop 1
    v_cndmask_b32 v186, v34, v186, vcc
    v_cmp_le_i32 vcc, 35, v17
    s_nop 1
    v_cndmask_b32 v187, v34, v187, vcc
    v_max_f32 v32, v176, v177
    v_max3_f32 v32, v32, v178, v179
    v_max3_f32 v32, v32, v180, v181
    v_max3_f32 v32, v32, v182, v183
    v_max3_f32 v32, v32, v184, v185
    v_max3_f32 v32, v32, v186, v187
    v_mov_b32 v33, v32
    s_nop 1
    v_permlane16_swap_b32 v32, v33
    v_max_f32 v32, v32, v33
    v_mov_b32 v33, v32
    s_nop 1
    v_permlane32_swap_b32 v32, v33
    v_max_f32 v32, v32, v33
    v_sub_f32 v176, v176, v32
    v_mul_f32 v176, s66, v176
    v_exp_f32 v176, v176
    v_sub_f32 v177, v177, v32
    v_mul_f32 v177, s66, v177
    v_exp_f32 v177, v177
    v_sub_f32 v178, v178, v32
    v_mul_f32 v178, s66, v178
    v_exp_f32 v178, v178
    v_sub_f32 v179, v179, v32
    v_mul_f32 v179, s66, v179
    v_exp_f32 v179, v179
    v_sub_f32 v180, v180, v32
    v_mul_f32 v180, s66, v180
    v_exp_f32 v180, v180
    v_sub_f32 v181, v181, v32
    v_mul_f32 v181, s66, v181
    v_exp_f32 v181, v181
    v_sub_f32 v182, v182, v32
    v_mul_f32 v182, s66, v182
    v_exp_f32 v182, v182
    v_sub_f32 v183, v183, v32
    v_mul_f32 v183, s66, v183
    v_exp_f32 v183, v183
    v_sub_f32 v184, v184, v32
    v_mul_f32 v184, s66, v184
    v_exp_f32 v184, v184
    v_sub_f32 v185, v185, v32
    v_mul_f32 v185, s66, v185
    v_exp_f32 v185, v185
    v_sub_f32 v186, v186, v32
    v_mul_f32 v186, s66, v186
    v_exp_f32 v186, v186
    v_sub_f32 v187, v187, v32
    v_mul_f32 v187, s66, v187
    v_exp_f32 v187, v187
    v_add_f32 v32, v176, v177
    v_add_f32 v32, v32, v178
    v_add_f32 v32, v32, v179
    v_add_f32 v32, v32, v180
    v_add_f32 v32, v32, v181
    v_add_f32 v32, v32, v182
    v_add_f32 v32, v32, v183
    v_add_f32 v32, v32, v184
    v_add_f32 v32, v32, v185
    v_add_f32 v32, v32, v186
    v_add_f32 v32, v32, v187
    v_mov_b32 v33, v32
    s_nop 1
    v_permlane16_swap_b32 v32, v33
    v_add_f32 v32, v32, v33
    v_mov_b32 v33, v32
    s_nop 1
    v_permlane32_swap_b32 v32, v33
    v_add_f32 v32, v32, v33
    v_rcp_f32 v32, v32
    s_nop 0
    v_mul_f32 v176, v176, v32
    v_mul_f32 v177, v177, v32
    v_mul_f32 v178, v178, v32
    v_mul_f32 v179, v179, v32
    v_mul_f32 v180, v180, v32
    v_mul_f32 v181, v181, v32
    v_mul_f32 v182, v182, v32
    v_mul_f32 v183, v183, v32
    v_mul_f32 v184, v184, v32
    v_mul_f32 v185, v185, v32
    v_mul_f32 v186, v186, v32
    v_mul_f32 v187, v187, v32
    v_cvt_pk_bf16_f32 v212, v176, v177
    v_cvt_pk_bf16_f32 v213, v178, v179
    v_cvt_pk_bf16_f32 v214, v180, v181
    v_cvt_pk_bf16_f32 v215, v182, v183
    v_cvt_pk_bf16_f32 v216, v184, v185
    v_cvt_pk_bf16_f32 v217, v186, v187
    v_mov_b32 v218, 0
    v_mov_b32 v219, 0
    v_cmp_le_i32 vcc, 0, v18
    s_nop 1
    v_cndmask_b32 v188, v34, v188, vcc
    v_cmp_le_i32 vcc, 1, v18
    s_nop 1
    v_cndmask_b32 v189, v34, v189, vcc
    v_cmp_le_i32 vcc, 2, v18
    s_nop 1
    v_cndmask_b32 v190, v34, v190, vcc
    v_cmp_le_i32 vcc, 3, v18
    s_nop 1
    v_cndmask_b32 v191, v34, v191, vcc
    v_cmp_le_i32 vcc, 16, v18
    s_nop 1
    v_cndmask_b32 v192, v34, v192, vcc
    v_cmp_le_i32 vcc, 17, v18
    s_nop 1
    v_cndmask_b32 v193, v34, v193, vcc
    v_cmp_le_i32 vcc, 18, v18
    s_nop 1
    v_cndmask_b32 v194, v34, v194, vcc
    v_cmp_le_i32 vcc, 19, v18
    s_nop 1
    v_cndmask_b32 v195, v34, v195, vcc
    v_cmp_le_i32 vcc, 32, v18
    s_nop 1
    v_cndmask_b32 v196, v34, v196, vcc
    v_cmp_le_i32 vcc, 33, v18
    s_nop 1
    v_cndmask_b32 v197, v34, v197, vcc
    v_cmp_le_i32 vcc, 34, v18
    s_nop 1
    v_cndmask_b32 v198, v34, v198, vcc
    v_cmp_le_i32 vcc, 35, v18
    s_nop 1
    v_cndmask_b32 v199, v34, v199, vcc
    v_max_f32 v32, v188, v189
    v_max3_f32 v32, v32, v190, v191
    v_max3_f32 v32, v32, v192, v193
    v_max3_f32 v32, v32, v194, v195
    v_max3_f32 v32, v32, v196, v197
    v_max3_f32 v32, v32, v198, v199
    v_mov_b32 v33, v32
    s_nop 1
    v_permlane16_swap_b32 v32, v33
    v_max_f32 v32, v32, v33
    v_mov_b32 v33, v32
    s_nop 1
    v_permlane32_swap_b32 v32, v33
    v_max_f32 v32, v32, v33
    v_sub_f32 v188, v188, v32
    v_mul_f32 v188, s66, v188
    v_exp_f32 v188, v188
    v_sub_f32 v189, v189, v32
    v_mul_f32 v189, s66, v189
    v_exp_f32 v189, v189
    v_sub_f32 v190, v190, v32
    v_mul_f32 v190, s66, v190
    v_exp_f32 v190, v190
    v_sub_f32 v191, v191, v32
    v_mul_f32 v191, s66, v191
    v_exp_f32 v191, v191
    v_sub_f32 v192, v192, v32
    v_mul_f32 v192, s66, v192
    v_exp_f32 v192, v192
    v_sub_f32 v193, v193, v32
    v_mul_f32 v193, s66, v193
    v_exp_f32 v193, v193
    v_sub_f32 v194, v194, v32
    v_mul_f32 v194, s66, v194
    v_exp_f32 v194, v194
    v_sub_f32 v195, v195, v32
    v_mul_f32 v195, s66, v195
    v_exp_f32 v195, v195
    v_sub_f32 v196, v196, v32
    v_mul_f32 v196, s66, v196
    v_exp_f32 v196, v196
    v_sub_f32 v197, v197, v32
    v_mul_f32 v197, s66, v197
    v_exp_f32 v197, v197
    v_sub_f32 v198, v198, v32
    v_mul_f32 v198, s66, v198
    v_exp_f32 v198, v198
    v_sub_f32 v199, v199, v32
    v_mul_f32 v199, s66, v199
    v_exp_f32 v199, v199
    v_add_f32 v32, v188, v189
    v_add_f32 v32, v32, v190
    v_add_f32 v32, v32, v191
    v_add_f32 v32, v32, v192
    v_add_f32 v32, v32, v193
    v_add_f32 v32, v32, v194
    v_add_f32 v32, v32, v195
    v_add_f32 v32, v32, v196
    v_add_f32 v32, v32, v197
    v_add_f32 v32, v32, v198
    v_add_f32 v32, v32, v199
    v_mov_b32 v33, v32
    s_nop 1
    v_permlane16_swap_b32 v32, v33
    v_add_f32 v32, v32, v33
    v_mov_b32 v33, v32
    s_nop 1
    v_permlane32_swap_b32 v32, v33
    v_add_f32 v32, v32, v33
    v_rcp_f32 v32, v32
    s_nop 0
    v_mul_f32 v188, v188, v32
    v_mul_f32 v189, v189, v32
    v_mul_f32 v190, v190, v32
    v_mul_f32 v191, v191, v32
    v_mul_f32 v192, v192, v32
    v_mul_f32 v193, v193, v32
    v_mul_f32 v194, v194, v32
    v_mul_f32 v195, v195, v32
    v_mul_f32 v196, v196, v32
    v_mul_f32 v197, v197, v32
    v_mul_f32 v198, v198, v32
    v_mul_f32 v199, v199, v32
    v_cvt_pk_bf16_f32 v220, v188, v189
    v_cvt_pk_bf16_f32 v221, v190, v191
    v_cvt_pk_bf16_f32 v222, v192, v193
    v_cvt_pk_bf16_f32 v223, v194, v195
    v_cvt_pk_bf16_f32 v224, v196, v197
    v_cvt_pk_bf16_f32 v225, v198, v199
    v_mov_b32 v226, 0
    v_mov_b32 v227, 0
    v_cmp_le_i32 vcc, 0, v19
    s_nop 1
    v_cndmask_b32 v200, v34, v200, vcc
    v_cmp_le_i32 vcc, 1, v19
    s_nop 1
    v_cndmask_b32 v201, v34, v201, vcc
    v_cmp_le_i32 vcc, 2, v19
    s_nop 1
    v_cndmask_b32 v202, v34, v202, vcc
    v_cmp_le_i32 vcc, 3, v19
    s_nop 1
    v_cndmask_b32 v203, v34, v203, vcc
    v_cmp_le_i32 vcc, 16, v19
    s_nop 1
    v_cndmask_b32 v204, v34, v204, vcc
    v_cmp_le_i32 vcc, 17, v19
    s_nop 1
    v_cndmask_b32 v205, v34, v205, vcc
    v_cmp_le_i32 vcc, 18, v19
    s_nop 1
    v_cndmask_b32 v206, v34, v206, vcc
    v_cmp_le_i32 vcc, 19, v19
    s_nop 1
    v_cndmask_b32 v207, v34, v207, vcc
    v_cmp_le_i32 vcc, 32, v19
    s_nop 1
    v_cndmask_b32 v208, v34, v208, vcc
    v_cmp_le_i32 vcc, 33, v19
    s_nop 1
    v_cndmask_b32 v209, v34, v209, vcc
    v_cmp_le_i32 vcc, 34, v19
    s_nop 1
    v_cndmask_b32 v210, v34, v210, vcc
    v_cmp_le_i32 vcc, 35, v19
    s_nop 1
    v_cndmask_b32 v211, v34, v211, vcc
    v_max_f32 v32, v200, v201
    v_max3_f32 v32, v32, v202, v203
    v_max3_f32 v32, v32, v204, v205
    v_max3_f32 v32, v32, v206, v207
    v_max3_f32 v32, v32, v208, v209
    v_max3_f32 v32, v32, v210, v211
    v_mov_b32 v33, v32
    s_nop 1
    v_permlane16_swap_b32 v32, v33
    v_max_f32 v32, v32, v33
    v_mov_b32 v33, v32
    s_nop 1
    v_permlane32_swap_b32 v32, v33
    v_max_f32 v32, v32, v33
    v_sub_f32 v200, v200, v32
    v_mul_f32 v200, s66, v200
    v_exp_f32 v200, v200
    v_sub_f32 v201, v201, v32
    v_mul_f32 v201, s66, v201
    v_exp_f32 v201, v201
    v_sub_f32 v202, v202, v32
    v_mul_f32 v202, s66, v202
    v_exp_f32 v202, v202
    v_sub_f32 v203, v203, v32
    v_mul_f32 v203, s66, v203
    v_exp_f32 v203, v203
    v_sub_f32 v204, v204, v32
    v_mul_f32 v204, s66, v204
    v_exp_f32 v204, v204
    v_sub_f32 v205, v205, v32
    v_mul_f32 v205, s66, v205
    v_exp_f32 v205, v205
    v_sub_f32 v206, v206, v32
    v_mul_f32 v206, s66, v206
    v_exp_f32 v206, v206
    v_sub_f32 v207, v207, v32
    v_mul_f32 v207, s66, v207
    v_exp_f32 v207, v207
    v_sub_f32 v208, v208, v32
    v_mul_f32 v208, s66, v208
    v_exp_f32 v208, v208
    v_sub_f32 v209, v209, v32
    v_mul_f32 v209, s66, v209
    v_exp_f32 v209, v209
    v_sub_f32 v210, v210, v32
    v_mul_f32 v210, s66, v210
    v_exp_f32 v210, v210
    v_sub_f32 v211, v211, v32
    v_mul_f32 v211, s66, v211
    v_exp_f32 v211, v211
    v_add_f32 v32, v200, v201
    v_add_f32 v32, v32, v202
    v_add_f32 v32, v32, v203
    v_add_f32 v32, v32, v204
    v_add_f32 v32, v32, v205
    v_add_f32 v32, v32, v206
    v_add_f32 v32, v32, v207
    v_add_f32 v32, v32, v208
    v_add_f32 v32, v32, v209
    v_add_f32 v32, v32, v210
    v_add_f32 v32, v32, v211
    v_mov_b32 v33, v32
    s_nop 1
    v_permlane16_swap_b32 v32, v33
    v_add_f32 v32, v32, v33
    v_mov_b32 v33, v32
    s_nop 1
    v_permlane32_swap_b32 v32, v33
    v_add_f32 v32, v32, v33
    v_rcp_f32 v32, v32
    s_nop 0
    v_mul_f32 v200, v200, v32
    v_mul_f32 v201, v201, v32
    v_mul_f32 v202, v202, v32
    v_mul_f32 v203, v203, v32
    v_mul_f32 v204, v204, v32
    v_mul_f32 v205, v205, v32
    v_mul_f32 v206, v206, v32
    v_mul_f32 v207, v207, v32
    v_mul_f32 v208, v208, v32
    v_mul_f32 v209, v209, v32
    v_mul_f32 v210, v210, v32
    v_mul_f32 v211, v211, v32
    v_cvt_pk_bf16_f32 v228, v200, v201
    v_cvt_pk_bf16_f32 v229, v202, v203
    v_cvt_pk_bf16_f32 v230, v204, v205
    v_cvt_pk_bf16_f32 v231, v206, v207
    v_cvt_pk_bf16_f32 v232, v208, v209
    v_cvt_pk_bf16_f32 v233, v210, v211
    v_mov_b32 v234, 0
    v_mov_b32 v235, 0
    v_perm_b32 v240, v132, v128, s64
    v_perm_b32 v241, v140, v136, s64
    v_perm_b32 v242, v148, v144, s64
    v_perm_b32 v243, v156, v152, s64
    s_nop 1
    v_mfma_f32_16x16x32_bf16 a[0:3], v[212:215], v[240:243], a[0:3]
    v_mfma_f32_16x16x32_bf16 a[4:7], v[220:223], v[240:243], a[4:7]
    v_mfma_f32_16x16x32_bf16 a[8:11], v[228:231], v[240:243], a[8:11]
    v_perm_b32 v244, v132, v128, s65
    v_perm_b32 v245, v140, v136, s65
    v_perm_b32 v246, v148, v144, s65
    v_perm_b32 v247, v156, v152, s65
    s_nop 1
    v_mfma_f32_16x16x32_bf16 a[12:15], v[212:215], v[244:247], a[12:15]
    v_mfma_f32_16x16x32_bf16 a[16:19], v[220:223], v[244:247], a[16:19]
    v_mfma_f32_16x16x32_bf16 a[20:23], v[228:231], v[244:247], a[20:23]
    v_perm_b32 v240, v133, v129, s64
    v_perm_b32 v241, v141, v137, s64
    v_perm_b32 v242, v149, v145, s64
    v_perm_b32 v243, v157, v153, s64
    s_nop 1
    v_mfma_f32_16x16x32_bf16 a[24:27], v[212:215], v[240:243], a[24:27]
    v_mfma_f32_16x16x32_bf16 a[28:31], v[220:223], v[240:243], a[28:31]
    v_mfma_f32_16x16x32_bf16 a[32:35], v[228:231], v[240:243], a[32:35]
    v_perm_b32 v244, v133, v129, s65
    v_perm_b32 v245, v141, v137, s65
    v_perm_b32 v246, v149, v145, s65
    v_perm_b32 v247, v157, v153, s65
    s_nop 1
    v_mfma_f32_16x16x32_bf16 a[36:39], v[212:215], v[244:247], a[36:39]
    v_mfma_f32_16x16x32_bf16 a[40:43], v[220:223], v[244:247], a[40:43]
    v_mfma_f32_16x16x32_bf16 a[44:47], v[228:231], v[244:247], a[44:47]
    v_perm_b32 v240, v134, v130, s64
    v_perm_b32 v241, v142, v138, s64
    v_perm_b32 v242, v150, v146, s64
    v_perm_b32 v243, v158, v154, s64
    s_nop 1
    v_mfma_f32_16x16x32_bf16 a[48:51], v[212:215], v[240:243], a[48:51]
    v_mfma_f32_16x16x32_bf16 a[52:55], v[220:223], v[240:243], a[52:55]
    v_mfma_f32_16x16x32_bf16 a[56:59], v[228:231], v[240:243], a[56:59]
    v_perm_b32 v244, v134, v130, s65
    v_perm_b32 v245, v142, v138, s65
    v_perm_b32 v246, v150, v146, s65
    v_perm_b32 v247, v158, v154, s65
    s_nop 1
    v_mfma_f32_16x16x32_bf16 a[60:63], v[212:215], v[244:247], a[60:63]
    v_mfma_f32_16x16x32_bf16 a[64:67], v[220:223], v[244:247], a[64:67]
    v_mfma_f32_16x16x32_bf16 a[68:71], v[228:231], v[244:247], a[68:71]
    v_perm_b32 v240, v135, v131, s64
    v_perm_b32 v241, v143, v139, s64
    v_perm_b32 v242, v151, v147, s64
    v_perm_b32 v243, v159, v155, s64
    s_nop 1
    v_mfma_f32_16x16x32_bf16 a[72:75], v[212:215], v[240:243], a[72:75]
    v_mfma_f32_16x16x32_bf16 a[76:79], v[220:223], v[240:243], a[76:79]
    v_mfma_f32_16x16x32_bf16 a[80:83], v[228:231], v[240:243], a[80:83]
    v_perm_b32 v244, v135, v131, s65
    v_perm_b32 v245, v143, v139, s65
    v_perm_b32 v246, v151, v147, s65
    v_perm_b32 v247, v159, v155, s65
    s_nop 1
    v_mfma_f32_16x16x32_bf16 a[84:87], v[212:215], v[244:247], a[84:87]
    v_mfma_f32_16x16x32_bf16 a[88:91], v[220:223], v[244:247], a[88:91]
    v_mfma_f32_16x16x32_bf16 a[92:95], v[228:231], v[244:247], a[92:95]
    v_mov_b32 v242, 0
    v_mov_b32 v243, 0
    v_mov_b32 v246, 0
    v_mov_b32 v247, 0
    v_perm_b32 v240, v164, v160, s64
    v_perm_b32 v241, v172, v168, s64
    s_nop 1
    v_mfma_f32_16x16x32_bf16 a[0:3], v[216:219], v[240:243], a[0:3]
    v_mfma_f32_16x16x32_bf16 a[4:7], v[224:227], v[240:243], a[4:7]
    v_mfma_f32_16x16x32_bf16 a[8:11], v[232:235], v[240:243], a[8:11]
    v_perm_b32 v244, v164, v160, s65
    v_perm_b32 v245, v172, v168, s65
    s_nop 1
    v_mfma_f32_16x16x32_bf16 a[12:15], v[216:219], v[244:247], a[12:15]
    v_mfma_f32_16x16x32_bf16 a[16:19], v[224:227], v[244:247], a[16:19]
    v_mfma_f32_16x16x32_bf16 a[20:23], v[232:235], v[244:247], a[20:23]
    v_perm_b32 v240, v165, v161, s64
    v_perm_b32 v241, v173, v169, s64
    s_nop 1
    v_mfma_f32_16x16x32_bf16 a[24:27], v[216:219], v[240:243], a[24:27]
    v_mfma_f32_16x16x32_bf16 a[28:31], v[224:227], v[240:243], a[28:31]
    v_mfma_f32_16x16x32_bf16 a[32:35], v[232:235], v[240:243], a[32:35]
    v_perm_b32 v244, v165, v161, s65
    v_perm_b32 v245, v173, v169, s65
    s_nop 1
    v_mfma_f32_16x16x32_bf16 a[36:39], v[216:219], v[244:247], a[36:39]
    v_mfma_f32_16x16x32_bf16 a[40:43], v[224:227], v[244:247], a[40:43]
    v_mfma_f32_16x16x32_bf16 a[44:47], v[232:235], v[244:247], a[44:47]
    v_perm_b32 v240, v166, v162, s64
    v_perm_b32 v241, v174, v170, s64
    s_nop 1
    v_mfma_f32_16x16x32_bf16 a[48:51], v[216:219], v[240:243], a[48:51]
    v_mfma_f32_16x16x32_bf16 a[52:55], v[224:227], v[240:243], a[52:55]
    v_mfma_f32_16x16x32_bf16 a[56:59], v[232:235], v[240:243], a[56:59]
    v_perm_b32 v244, v166, v162, s65
    v_perm_b32 v245, v174, v170, s65
    s_nop 1
    v_mfma_f32_16x16x32_bf16 a[60:63], v[216:219], v[244:247], a[60:63]
    v_mfma_f32_16x16x32_bf16 a[64:67], v[224:227], v[244:247], a[64:67]
    v_mfma_f32_16x16x32_bf16 a[68:71], v[232:235], v[244:247], a[68:71]
    v_perm_b32 v240, v167, v163, s64
    v_perm_b32 v241, v175, v171, s64
    s_nop 1
    v_mfma_f32_16x16x32_bf16 a[72:75], v[216:219], v[240:243], a[72:75]
    v_mfma_f32_16x16x32_bf16 a[76:79], v[224:227], v[240:243], a[76:79]
    v_mfma_f32_16x16x32_bf16 a[80:83], v[232:235], v[240:243], a[80:83]
    v_perm_b32 v244, v167, v163, s65
    v_perm_b32 v245, v175, v171, s65
    s_nop 1
    v_mfma_f32_16x16x32_bf16 a[84:87], v[216:219], v[244:247], a[84:87]
    v_mfma_f32_16x16x32_bf16 a[88:91], v[224:227], v[244:247], a[88:91]
    v_mfma_f32_16x16x32_bf16 a[92:95], v[232:235], v[244:247], a[92:95]
    s_add_u32 s50, s54, 0xe200000
    s_mov_b32 s56, s50
    s_mul_i32 s57, s53, 12
    v_accvgpr_read_b32 v216, a0
    v_accvgpr_read_b32 v217, a12
    v_accvgpr_read_b32 v218, a24
    v_accvgpr_read_b32 v219, a36
    v_accvgpr_read_b32 v220, a48
    v_accvgpr_read_b32 v221, a60
    v_accvgpr_read_b32 v222, a72
    v_accvgpr_read_b32 v223, a84
    v_cvt_pk_bf16_f32 v224, v216, v217
    v_cvt_pk_bf16_f32 v225, v218, v219
    v_cvt_pk_bf16_f32 v226, v220, v221
    v_cvt_pk_bf16_f32 v227, v222, v223
    buffer_store_dwordx4 v[224:227], v16, s[8:11], s56 offen
    s_waitcnt vmcnt(1)
    s_add_u32 s56, s56, s53
    v_accvgpr_read_b32 v228, a1
    v_accvgpr_read_b32 v229, a13
    v_accvgpr_read_b32 v230, a25
    v_accvgpr_read_b32 v231, a37
    v_accvgpr_read_b32 v232, a49
    v_accvgpr_read_b32 v233, a61
    v_accvgpr_read_b32 v234, a73
    v_accvgpr_read_b32 v235, a85
    v_cvt_pk_bf16_f32 v236, v228, v229
    v_cvt_pk_bf16_f32 v237, v230, v231
    v_cvt_pk_bf16_f32 v238, v232, v233
    v_cvt_pk_bf16_f32 v239, v234, v235
    buffer_store_dwordx4 v[236:239], v16, s[8:11], s56 offen
    s_waitcnt vmcnt(1)
    s_add_u32 s56, s56, s53
    v_accvgpr_read_b32 v216, a2
    v_accvgpr_read_b32 v217, a14
    v_accvgpr_read_b32 v218, a26
    v_accvgpr_read_b32 v219, a38
    v_accvgpr_read_b32 v220, a50
    v_accvgpr_read_b32 v221, a62
    v_accvgpr_read_b32 v222, a74
    v_accvgpr_read_b32 v223, a86
    v_cvt_pk_bf16_f32 v224, v216, v217
    v_cvt_pk_bf16_f32 v225, v218, v219
    v_cvt_pk_bf16_f32 v226, v220, v221
    v_cvt_pk_bf16_f32 v227, v222, v223
    buffer_store_dwordx4 v[224:227], v16, s[8:11], s56 offen
    s_waitcnt vmcnt(1)
    s_add_u32 s56, s56, s53
    v_accvgpr_read_b32 v228, a3
    v_accvgpr_read_b32 v229, a15
    v_accvgpr_read_b32 v230, a27
    v_accvgpr_read_b32 v231, a39
    v_accvgpr_read_b32 v232, a51
    v_accvgpr_read_b32 v233, a63
    v_accvgpr_read_b32 v234, a75
    v_accvgpr_read_b32 v235, a87
    v_cvt_pk_bf16_f32 v236, v228, v229
    v_cvt_pk_bf16_f32 v237, v230, v231
    v_cvt_pk_bf16_f32 v238, v232, v233
    v_cvt_pk_bf16_f32 v239, v234, v235
    buffer_store_dwordx4 v[236:239], v16, s[8:11], s56 offen
    s_waitcnt vmcnt(1)
    s_add_u32 s56, s56, s53
    s_add_u32 s56, s56, s57
    v_accvgpr_read_b32 v216, a4
    v_accvgpr_read_b32 v217, a16
    v_accvgpr_read_b32 v218, a28
    v_accvgpr_read_b32 v219, a40
    v_accvgpr_read_b32 v220, a52
    v_accvgpr_read_b32 v221, a64
    v_accvgpr_read_b32 v222, a76
    v_accvgpr_read_b32 v223, a88
    v_cvt_pk_bf16_f32 v224, v216, v217
    v_cvt_pk_bf16_f32 v225, v218, v219
    v_cvt_pk_bf16_f32 v226, v220, v221
    v_cvt_pk_bf16_f32 v227, v222, v223
    buffer_store_dwordx4 v[224:227], v16, s[8:11], s56 offen
    s_waitcnt vmcnt(1)
    s_add_u32 s56, s56, s53
    v_accvgpr_read_b32 v228, a5
    v_accvgpr_read_b32 v229, a17
    v_accvgpr_read_b32 v230, a29
    v_accvgpr_read_b32 v231, a41
    v_accvgpr_read_b32 v232, a53
    v_accvgpr_read_b32 v233, a65
    v_accvgpr_read_b32 v234, a77
    v_accvgpr_read_b32 v235, a89
    v_cvt_pk_bf16_f32 v236, v228, v229
    v_cvt_pk_bf16_f32 v237, v230, v231
    v_cvt_pk_bf16_f32 v238, v232, v233
    v_cvt_pk_bf16_f32 v239, v234, v235
    buffer_store_dwordx4 v[236:239], v16, s[8:11], s56 offen
    s_waitcnt vmcnt(1)
    s_add_u32 s56, s56, s53
    v_accvgpr_read_b32 v216, a6
    v_accvgpr_read_b32 v217, a18
    v_accvgpr_read_b32 v218, a30
    v_accvgpr_read_b32 v219, a42
    v_accvgpr_read_b32 v220, a54
    v_accvgpr_read_b32 v221, a66
    v_accvgpr_read_b32 v222, a78
    v_accvgpr_read_b32 v223, a90
    v_cvt_pk_bf16_f32 v224, v216, v217
    v_cvt_pk_bf16_f32 v225, v218, v219
    v_cvt_pk_bf16_f32 v226, v220, v221
    v_cvt_pk_bf16_f32 v227, v222, v223
    buffer_store_dwordx4 v[224:227], v16, s[8:11], s56 offen
    s_waitcnt vmcnt(1)
    s_add_u32 s56, s56, s53
    v_accvgpr_read_b32 v228, a7
    v_accvgpr_read_b32 v229, a19
    v_accvgpr_read_b32 v230, a31
    v_accvgpr_read_b32 v231, a43
    v_accvgpr_read_b32 v232, a55
    v_accvgpr_read_b32 v233, a67
    v_accvgpr_read_b32 v234, a79
    v_accvgpr_read_b32 v235, a91
    v_cvt_pk_bf16_f32 v236, v228, v229
    v_cvt_pk_bf16_f32 v237, v230, v231
    v_cvt_pk_bf16_f32 v238, v232, v233
    v_cvt_pk_bf16_f32 v239, v234, v235
    buffer_store_dwordx4 v[236:239], v16, s[8:11], s56 offen
    s_waitcnt vmcnt(1)
    s_add_u32 s56, s56, s53
    s_add_u32 s56, s56, s57
    v_accvgpr_read_b32 v216, a8
    v_accvgpr_read_b32 v217, a20
    v_accvgpr_read_b32 v218, a32
    v_accvgpr_read_b32 v219, a44
    v_accvgpr_read_b32 v220, a56
    v_accvgpr_read_b32 v221, a68
    v_accvgpr_read_b32 v222, a80
    v_accvgpr_read_b32 v223, a92
    v_cvt_pk_bf16_f32 v224, v216, v217
    v_cvt_pk_bf16_f32 v225, v218, v219
    v_cvt_pk_bf16_f32 v226, v220, v221
    v_cvt_pk_bf16_f32 v227, v222, v223
    buffer_store_dwordx4 v[224:227], v16, s[8:11], s56 offen
    s_waitcnt vmcnt(1)
    s_add_u32 s56, s56, s53
    v_accvgpr_read_b32 v228, a9
    v_accvgpr_read_b32 v229, a21
    v_accvgpr_read_b32 v230, a33
    v_accvgpr_read_b32 v231, a45
    v_accvgpr_read_b32 v232, a57
    v_accvgpr_read_b32 v233, a69
    v_accvgpr_read_b32 v234, a81
    v_accvgpr_read_b32 v235, a93
    v_cvt_pk_bf16_f32 v236, v228, v229
    v_cvt_pk_bf16_f32 v237, v230, v231
    v_cvt_pk_bf16_f32 v238, v232, v233
    v_cvt_pk_bf16_f32 v239, v234, v235
    buffer_store_dwordx4 v[236:239], v16, s[8:11], s56 offen
    s_waitcnt vmcnt(1)
    s_add_u32 s56, s56, s53
    v_accvgpr_read_b32 v216, a10
    v_accvgpr_read_b32 v217, a22
    v_accvgpr_read_b32 v218, a34
    v_accvgpr_read_b32 v219, a46
    v_accvgpr_read_b32 v220, a58
    v_accvgpr_read_b32 v221, a70
    v_accvgpr_read_b32 v222, a82
    v_accvgpr_read_b32 v223, a94
    v_cvt_pk_bf16_f32 v224, v216, v217
    v_cvt_pk_bf16_f32 v225, v218, v219
    v_cvt_pk_bf16_f32 v226, v220, v221
    v_cvt_pk_bf16_f32 v227, v222, v223
    buffer_store_dwordx4 v[224:227], v16, s[8:11], s56 offen
    s_waitcnt vmcnt(1)
    s_add_u32 s56, s56, s53
    v_accvgpr_read_b32 v228, a11
    v_accvgpr_read_b32 v229, a23
    v_accvgpr_read_b32 v230, a35
    v_accvgpr_read_b32 v231, a47
    v_accvgpr_read_b32 v232, a59
    v_accvgpr_read_b32 v233, a71
    v_accvgpr_read_b32 v234, a83
    v_accvgpr_read_b32 v235, a95
    v_cvt_pk_bf16_f32 v236, v228, v229
    v_cvt_pk_bf16_f32 v237, v230, v231
    v_cvt_pk_bf16_f32 v238, v232, v233
    v_cvt_pk_bf16_f32 v239, v234, v235
    buffer_store_dwordx4 v[236:239], v16, s[8:11], s56 offen
    s_waitcnt vmcnt(1)
    s_add_u32 s56, s56, s53
    s_add_u32 s56, s56, s57
    s_waitcnt vmcnt(0)
    s_add_u32 s54, s54, 256
    s_cmp_lt_u32 s54, 8192
    s_cbranch_scc1 fbh_343
    s_mov_b32 s56, 0xe28e000
fbe_344:
    s_add_u32 s57, s56, 0x80000
    buffer_load_dwordx4 v[32:35], v20, s[8:11], s56 offen
    buffer_load_dwordx4 v[36:39], v20, s[8:11], s57 offen
    s_waitcnt vmcnt(0)
    v_lshlrev_b32 v40, 16, v32
    v_and_b32 v41, s67, v32
    v_lshlrev_b32 v42, 16, v33
    v_and_b32 v43, s67, v33
    v_lshlrev_b32 v44, 16, v34
    v_and_b32 v45, s67, v34
    v_lshlrev_b32 v46, 16, v35
    v_and_b32 v47, s67, v35
    v_lshlrev_b32 v48, 16, v36
    v_and_b32 v49, s67, v36
    v_lshlrev_b32 v50, 16, v37
    v_and_b32 v51, s67, v37
    v_lshlrev_b32 v52, 16, v38
    v_and_b32 v53, s67, v38
    v_lshlrev_b32 v54, 16, v39
    v_and_b32 v55, s67, v39
    v_mul_f32 v56, 0xbfb8aa3b, v40
    v_exp_f32 v56, v56
    s_nop 0
    v_add_f32 v56, 1.0, v56
    v_rcp_f32 v56, v56
    s_nop 0
    v_mul_f32 v40, v40, v56
    v_mul_f32 v40, v40, v48
    v_mul_f32 v57, 0xbfb8aa3b, v41
    v_exp_f32 v57, v57
    s_nop 0
    v_add_f32 v57, 1.0, v57
    v_rcp_f32 v57, v57
    s_nop 0
    v_mul_f32 v41, v41, v57
    v_mul_f32 v41, v41, v49
    v_mul_f32 v58, 0xbfb8aa3b, v42
    v_exp_f32 v58, v58
    s_nop 0
    v_add_f32 v58, 1.0, v58
    v_rcp_f32 v58, v58
    s_nop 0
    v_mul_f32 v42, v42, v58
    v_mul_f32 v42, v42, v50
    v_mul_f32 v59, 0xbfb8aa3b, v43
    v_exp_f32 v59, v59
    s_nop 0
    v_add_f32 v59, 1.0, v59
    v_rcp_f32 v59, v59
    s_nop 0
    v_mul_f32 v43, v43, v59
    v_mul_f32 v43, v43, v51
    v_mul_f32 v60, 0xbfb8aa3b, v44
    v_exp_f32 v60, v60
    s_nop 0
    v_add_f32 v60, 1.0, v60
    v_rcp_f32 v60, v60
    s_nop 0
    v_mul_f32 v44, v44, v60
    v_mul_f32 v44, v44, v52
    v_mul_f32 v61, 0xbfb8aa3b, v45
    v_exp_f32 v61, v61
    s_nop 0
    v_add_f32 v61, 1.0, v61
    v_rcp_f32 v61, v61
    s_nop 0
    v_mul_f32 v45, v45, v61
    v_mul_f32 v45, v45, v53
    v_mul_f32 v62, 0xbfb8aa3b, v46
    v_exp_f32 v62, v62
    s_nop 0
    v_add_f32 v62, 1.0, v62
    v_rcp_f32 v62, v62
    s_nop 0
    v_mul_f32 v46, v46, v62
    v_mul_f32 v46, v46, v54
    v_mul_f32 v63, 0xbfb8aa3b, v47
    v_exp_f32 v63, v63
    s_nop 0
    v_add_f32 v63, 1.0, v63
    v_rcp_f32 v63, v63
    s_nop 0
    v_mul_f32 v47, v47, v63
    v_mul_f32 v47, v47, v55
    v_cvt_pk_bf16_f32 v64, v40, v41
    v_cvt_pk_bf16_f32 v65, v42, v43
    v_cvt_pk_bf16_f32 v66, v44, v45
    v_cvt_pk_bf16_f32 v67, v46, v47
    buffer_store_dwordx4 v[64:67], v20, s[8:11], s56 offen
    s_waitcnt vmcnt(0)
    s_add_u32 s56, s56, 1024
    s_cmp_lt_u32 s56, 0xe2c6000
    s_cbranch_scc1 fbe_344
fbna_342:
    s_cmp_lt_u32 s41, 7
    s_cbranch_scc1 fbjob_338
    s_load_dwordx2 s[32:33], s[0:1], 88
    s_waitcnt lgkmcnt(0)
    s_mov_b32 s28, s32
    s_mov_b32 s29, s33
    s_mov_b32 s30, 0x800
    s_mov_b32 s31, 0x20000
    buffer_load_dwordx4 v[32:35], v20, s[28:31], 0 offen offset:0
    buffer_load_dwordx4 v[36:39], v20, s[28:31], 0 offen offset:1024
    s_waitcnt vmcnt(0)
    v_lshlrev_b32 v128, 16, v32
    v_and_b32 v129, s67, v32
    v_lshlrev_b32 v130, 16, v33
    v_and_b32 v131, s67, v33
    v_lshlrev_b32 v132, 16, v34
    v_and_b32 v133, s67, v34
    v_lshlrev_b32 v134, 16, v35
    v_and_b32 v135, s67, v35
    v_lshlrev_b32 v136, 16, v36
    v_and_b32 v137, s67, v36
    v_lshlrev_b32 v138, 16, v37
    v_and_b32 v139, s67, v37
    v_lshlrev_b32 v140, 16, v38
    v_and_b32 v141, s67, v38
    v_lshlrev_b32 v142, 16, v39
    v_and_b32 v143, s67, v39
    s_mov_b32 s45, 16384
    s_lshl_b32 s59, s40, 16
fbr_345:
    s_add_u32 s56, s45, 0xe000000
    buffer_load_dwordx4 v[32:35], v20, s[8:11], s56 offen offset:0
    buffer_load_dwordx4 v[36:39], v20, s[8:11], s56 offen offset:1024
    s_add_u32 s56, s45, 0xe380000
    buffer_load_dwordx4 v[40:43], v20, s[8:11], s56 offen offset:0
    buffer_load_dwordx4 v[44:47], v20, s[8:11], s56 offen offset:1024
    s_add_u32 s56, s45, 0xe400000
    buffer_load_dwordx4 v[48:51], v20, s[8:11], s56 offen offset:0
    buffer_load_dwordx4 v[52:55], v20, s[8:11], s56 offen offset:1024
    s_waitcnt vmcnt(0)
    v_lshlrev_b32 v64, 16, v32
    v_and_b32 v65, s67, v32
    v_lshlrev_b32 v66, 16, v33
    v_and_b32 v67, s67, v33
    v_lshlrev_b32 v68, 16, v34
    v_and_b32 v69, s67, v34
    v_lshlrev_b32 v70, 16, v35
    v_and_b32 v71, s67, v35
    v_lshlrev_b32 v72, 16, v36
    v_and_b32 v73, s67, v36
    v_lshlrev_b32 v74, 16, v37
    v_and_b32 v75, s67, v37
    v_lshlrev_b32 v76, 16, v38
    v_and_b32 v77, s67, v38
    v_lshlrev_b32 v78, 16, v39
    v_and_b32 v79, s67, v39
    v_lshlrev_b32 v80, 16, v40
    v_and_b32 v81, s67, v40
    v_lshlrev_b32 v82, 16, v41
    v_and_b32 v83, s67, v41
    v_lshlrev_b32 v84, 16, v42
    v_and_b32 v85, s67, v42
    v_lshlrev_b32 v86, 16, v43
    v_and_b32 v87, s67, v43
    v_lshlrev_b32 v88, 16, v44
    v_and_b32 v89, s67, v44
    v_lshlrev_b32 v90, 16, v45
    v_and_b32 v91, s67, v45
    v_lshlrev_b32 v92, 16, v46
    v_and_b32 v93, s67, v46
    v_lshlrev_b32 v94, 16, v47
    v_and_b32 v95, s67, v47
    v_lshlrev_b32 v96, 16, v48
    v_and_b32 v97, s67, v48
    v_lshlrev_b32 v98, 16, v49
    v_and_b32 v99, s67, v49
    v_lshlrev_b32 v100, 16, v50
    v_and_b32 v101, s67, v50
    v_lshlrev_b32 v102, 16, v51
    v_and_b32 v103, s67, v51
    v_lshlrev_b32 v104, 16, v52
    v_and_b32 v105, s67, v52
    v_lshlrev_b32 v106, 16, v53
    v_and_b32 v107, s67, v53
    v_lshlrev_b32 v108, 16, v54
    v_and_b32 v109, s67, v54
    v_lshlrev_b32 v110, 16, v55
    v_and_b32 v111, s67, v55
    v_mul_f32 v32, v64, v128
    v_fma_f32 v32, v65, v129, v32
    v_fma_f32 v32, v66, v130, v32
    v_fma_f32 v32, v67, v131, v32
    v_fma_f32 v32, v68, v132, v32
    v_fma_f32 v32, v69, v133, v32
    v_fma_f32 v32, v70, v134, v32
    v_fma_f32 v32, v71, v135, v32
    v_fma_f32 v32, v72, v136, v32
    v_fma_f32 v32, v73, v137, v32
    v_fma_f32 v32, v74, v138, v32
    v_fma_f32 v32, v75, v139, v32
    v_fma_f32 v32, v76, v140, v32
    v_fma_f32 v32, v77, v141, v32
    v_fma_f32 v32, v78, v142, v32
    v_fma_f32 v32, v79, v143, v32
    v_mov_b32 v33, v32
    s_nop 1
    v_permlane16_swap_b32 v32, v33
    v_add_f32 v32, v32, v33
    v_mov_b32 v33, v32
    s_nop 1
    v_permlane32_swap_b32 v32, v33
    v_add_f32 v32, v32, v33
    s_nop 1
    v_mov_b32_dpp v33, v32 row_ror:8 row_mask:0xf bank_mask:0xf
    v_add_f32 v32, v32, v33
    s_nop 1
    v_mov_b32_dpp v33, v32 row_ror:4 row_mask:0xf bank_mask:0xf
    v_add_f32 v32, v32, v33
    s_nop 1
    v_mov_b32_dpp v33, v32 row_ror:2 row_mask:0xf bank_mask:0xf
    v_add_f32 v32, v32, v33
    s_nop 1
    v_mov_b32_dpp v33, v32 row_ror:1 row_mask:0xf bank_mask:0xf
    v_add_f32 v32, v32, v33
    v_mul_f32 v32, 0xbfb8aa3b, v32
    v_exp_f32 v32, v32
    s_nop 0
    v_add_f32 v32, 1.0, v32
    v_rcp_f32 v32, v32
    s_nop 0
    v_sub_f32 v33, 1.0, v32
    v_mul_f32 v96, v33, v96
    v_fma_f32 v96, v32, v80, v96
    v_mul_f32 v97, v33, v97
    v_fma_f32 v97, v32, v81, v97
    v_mul_f32 v98, v33, v98
    v_fma_f32 v98, v32, v82, v98
    v_mul_f32 v99, v33, v99
    v_fma_f32 v99, v32, v83, v99
    v_mul_f32 v100, v33, v100
    v_fma_f32 v100, v32, v84, v100
    v_mul_f32 v101, v33, v101
    v_fma_f32 v101, v32, v85, v101
    v_mul_f32 v102, v33, v102
    v_fma_f32 v102, v32, v86, v102
    v_mul_f32 v103, v33, v103
    v_fma_f32 v103, v32, v87, v103
    v_mul_f32 v104, v33, v104
    v_fma_f32 v104, v32, v88, v104
    v_mul_f32 v105, v33, v105
    v_fma_f32 v105, v32, v89, v105
    v_mul_f32 v106, v33, v106
    v_fma_f32 v106, v32, v90, v106
    v_mul_f32 v107, v33, v107
    v_fma_f32 v107, v32, v91, v107
    v_mul_f32 v108, v33, v108
    v_fma_f32 v108, v32, v92, v108
    v_mul_f32 v109, v33, v109
    v_fma_f32 v109, v32, v93, v109
    v_mul_f32 v110, v33, v110
    v_fma_f32 v110, v32, v94, v110
    v_mul_f32 v111, v33, v111
    v_fma_f32 v111, v32, v95, v111
    v_cvt_pk_bf16_f32 v40, v96, v97
    v_cvt_pk_bf16_f32 v41, v98, v99
    v_cvt_pk_bf16_f32 v42, v100, v101
    v_cvt_pk_bf16_f32 v43, v102, v103
    v_cvt_pk_bf16_f32 v44, v104, v105
    v_cvt_pk_bf16_f32 v45, v106, v107
    v_cvt_pk_bf16_f32 v46, v108, v109
    v_cvt_pk_bf16_f32 v47, v110, v111
    buffer_store_dwordx4 v[40:43], v20, s[24:27], s59 offen offset:0
    buffer_store_dwordx4 v[44:47], v20, s[24:27], s59 offen offset:1024
    s_waitcnt vmcnt(0)
    s_add_u32 s59, s59, 2048
    s_add_u32 s45, s45, 2048
    s_cmp_lt_u32 s45, 81920
    s_cbranch_scc1 fbr_345
    s_add_u32 s40, s40, 1
    s_cmp_lt_u32 s40, 64
    s_cbranch_scc1 fbseg_334
    s_branch L_end
L_end:
    s_endpgm
.section .rodata,"a"
.p2align 6
.amdhsa_kernel gated_mix__memory_aug_recurrent_mem_tr__swiglu_ffn__prompt_kernel
  .amdhsa_next_free_vgpr 512
  .amdhsa_next_free_sgpr 102
  .amdhsa_accum_offset 256
  .amdhsa_group_segment_fixed_size 0
  .amdhsa_kernarg_size 120
  .amdhsa_user_sgpr_count 2
  .amdhsa_user_sgpr_kernarg_segment_ptr 1
  .amdhsa_system_sgpr_workgroup_id_x 1
.end_amdhsa_kernel
```
